```python
import torch

def _softmax(x, axis=-1):
    return torch.softmax(x, dim=axis)
def _gelu(x):
    return torch.nn.functional.gelu(x, approximate="tanh")
def _silu(x):
    return torch.nn.functional.silu(x)
def _sigmoid(x):
    return torch.sigmoid(x)
def _layernorm(x, axis=-1, eps=1e-5):
    m = x.mean(dim=axis, keepdim=True)
    v = x.var(dim=axis, keepdim=True, unbiased=False)
    return (x - m) / torch.sqrt(v + eps)
def _scatter_add(tgt, idx, src, axis=0):
    return tgt.clone().index_add_(axis, idx, src)
def _segment_sum(src, seg, n):
    out = torch.zeros((n,) + src.shape[1:], dtype=src.dtype)
    return out.index_add_(0, seg, src)
def _pad(x, pw):
    flat = tuple(v for pair in reversed(pw) for v in pair)
    return torch.nn.functional.pad(x, flat)

kernel_name = 'parallel_sum__sliding_block__glu_gated_swiglu__prompt'

def setup_inputs():

    _w = (lambda a: (lambda t: t.to(torch.bfloat16) if t.is_floating_point() else t)(torch.as_tensor(a)))
    def _A_setup():
        B, S, D = 1, 2048, 1024
        return {
            "x": _w((lambda *s: torch.randn(*s, dtype=torch.bfloat16) * 0.05)(B, S, D)),
            "wqkv": _w((lambda *s: torch.randn(*s, dtype=torch.bfloat16) * 0.05)(D, 3 * D)),
            "wo": _w((lambda *s: torch.randn(*s, dtype=torch.bfloat16) * 0.05)(D, D)),
        }
    _A_in = _A_setup()

    def _B_setup():
        B, S, D, F = 1, 2048, 1024, 3584
        return {
            "x": _w((lambda *s: torch.randn(*s, dtype=torch.bfloat16) * 0.05)(B, S, D)),
            "w1": _w((lambda *s: torch.randn(*s, dtype=torch.bfloat16) * 0.8)(D, F) * (2.0 / D) ** 0.5),
            "w3": _w((lambda *s: torch.randn(*s, dtype=torch.bfloat16) * 0.8)(D, F) * (2.0 / D) ** 0.5),
            "w2": _w((lambda *s: torch.randn(*s, dtype=torch.bfloat16) * 0.8)(F, D) * (2.0 / F) ** 0.5),
        }
    _B_in = _B_setup()

    return {
        "A_x": _A_in["x"],
        "A_wqkv": _A_in["wqkv"],
        "A_wo": _A_in["wo"],
        "B_x": _B_in["x"],
        "B_w1": _B_in["w1"],
        "B_w3": _B_in["w3"],
        "B_w2": _B_in["w2"],
    }

def reference(A_x, A_wqkv, A_wo, B_x, B_w1, B_w3, B_w2):
    def _A_ref(x, wqkv, wo):
        B, S, D = x.shape
        H = 32; Dh = D // H; W = 256
        qkv = (lambda x, *d: x.permute(*d))((x @ wqkv).reshape(B, S, 3, H, Dh), 2, 0, 3, 1, 4)
        q, k, v = qkv[0], qkv[1], qkv[2]
        scores = torch.einsum("bhqd,bhkd->bhqk", q, k) * (Dh ** -0.5)
        idx = torch.arange(S)
        mask = (idx[:, None] - idx[None, :] >= 0) & (idx[:, None] - idx[None, :] < W)
        scores = torch.where(mask[None, None], scores, -1e9)
        p = _softmax(scores, axis=-1)
        o = torch.einsum("bhqk,bhkd->bhqd", p, v)
        return (lambda x, *d: x.permute(*d))(o, 0, 2, 1, 3).reshape(B, S, D) @ wo

    def _B_ref(x, w1, w3, w2):
        gate = torch.einsum("bsd,df->bsf", x, w1)
        up = torch.einsum("bsd,df->bsf", x, w3)
        h = _silu(gate) * up
        out = torch.einsum("bsf,fd->bsd", h, w2)
        return out

    x = A_x
    xn = _layernorm(x, axis=-1)
    return x + _A_ref(xn, A_wqkv, A_wo) + _B_ref(xn, B_w1, B_w3, B_w2)
```

```asm
; @launch grid=(256,1,1) block=(256,1,1) lds=163840
.amdgcn_target "amdgcn-amd-amdhsa--gfx950"
.text
.globl parallel_sum__sliding_block__glu_gated_swiglu__prompt_kernel
.p2align 8
.type parallel_sum__sliding_block__glu_gated_swiglu__prompt_kernel,@function
parallel_sum__sliding_block__glu_gated_swiglu__prompt_kernel:
s_cmp_ge_u32 s2, 256
s_cbranch_scc1 L_end
s_getpc_b64 s[88:89]
s_movk_i32 s90, 4096
s_mov_b32 s91, 0x00020000
v_and_b32 v28, 63, v0
v_lshlrev_b32 v28, 7, v28
buffer_load_dword a255, v28, s[88:91], 0 offen
s_load_dwordx16 s[4:19], s[0:1], 0
s_load_dwordx4 s[20:23], s[0:1], 64
v_lshrrev_b32 v25, 6, v0
v_and_b32 v0, 63, v0
s_lshr_b32 s50, s2, 3
v_readfirstlane_b32 s40, v25
s_and_b32 s41, s50, 7
s_lshr_b32 s50, s50, 3
s_and_b32 s51, s2, 7
s_lshl_b32 s51, s51, 2
s_add_u32 s42, s50, s51
s_lshl_b32 s50, s41, 8
s_lshr_b32 s51, s2, 6
s_lshl_b32 s51, s51, 6
s_add_u32 s50, s50, s51
s_lshl_b32 s51, s40, 4
s_add_u32 s50, s50, s51
s_lshl_b32 s70, s50, 11
v_and_b32 v25, 15, v0
v_lshrrev_b32 v26, 4, v0
v_min_u32 v26, 0, v26
v_lshlrev_b32 v26, 7, v26
v_lshl_add_u32 v27, v25, 11, v26
s_cmp_eq_u32 s40, 0
s_movk_i32 s54, 7168
s_cselect_b32 s54, 6144, s54
s_cselect_b64 vcc, -1, 0
s_cselect_b32 s50, 64, 224
s_cselect_b32 s51, 12, 14
s_mul_i32 s50, s50, s42
v_and_b32 v190, 15, v0
v_lshrrev_b32 v191, 4, v0
s_lshl_b32 s52, s41, 2
v_add_u32 v191, s52, v191
v_mul_lo_u32 v191, v191, s54
v_lshrrev_b32 v192, 2, v190
v_lshlrev_b32 v192, 11, v192
v_and_b32 v24, 3, v190
v_lshl_add_u32 v192, v24, 4, v192
v_lshlrev_b32 v24, 4, v190
v_cndmask_b32 v24, v24, v192, vcc
v_add3_u32 v24, v24, v191, s50
v_cmp_gt_u32 vcc, s51, v190
v_bfrev_b32 v192, 1
s_nop 0
v_cndmask_b32 v24, v192, v24, vcc
s_lshl_b32 s58, s54, 10
s_cmp_eq_u32 s40, 3
s_cselect_b32 s58, 0, s58
s_mov_b32 s59, 0x00020000
s_lshl_b32 s54, s54, 5
s_mul_i32 s55, s54, 0
s_mov_b32 s26, 4194304
s_mov_b32 s27, 0x00020000
s_waitcnt lgkmcnt(0)
s_mov_b32 s24, s4
s_mov_b32 s25, s5
buffer_load_dword a255, v27, s[24:27], s70 offen
s_cmp_eq_u32 s40, 0
s_cselect_b32 s56, s6, s12
s_cselect_b32 s57, s7, s13
s_cmp_eq_u32 s40, 2
s_cselect_b32 s56, s14, s56
s_cselect_b32 s57, s15, s57
buffer_load_dwordx4 a[192:195], v24, s[56:59], s55 offen
s_add_u32 s55, s55, s54
buffer_load_dwordx4 a[196:199], v24, s[56:59], s55 offen
s_add_u32 s55, s55, s54
s_getpc_b64 s[88:89]
L_pc_L_body:
s_add_u32 s88, s88, L_body - L_pc_L_body
s_addc_u32 s89, s89, 0
s_mov_b32 s90, L_codeend - L_body
s_mov_b32 s91, 0x00020000
s_lshr_b32 s50, s2, 3
s_lshl_b32 s50, s50, 2
s_add_u32 s50, s50, s40
s_mul_i32 s50, s50, 384
v_min_u32 v29, 2, v0
v_lshlrev_b32 v29, 7, v29
buffer_load_dword a255, v29, s[88:91], s50 offen
s_lshl_b32 s50, s41, 8
s_lshl_b32 s51, s40, 6
s_add_u32 s50, s50, s51
s_lshl_b32 s47, s40, 13
v_lshrrev_b32 v25, 3, v0
v_add_u32 v26, s50, v25
v_lshlrev_b32 v26, 11, v26
v_lshrrev_b32 v25, 1, v25
v_and_b32 v27, 7, v0
v_xor_b32 v27, v27, v25
v_lshlrev_b32 v27, 4, v27
v_xor_b32 v28, 64, v27
v_add_u32 v1, v26, v27
v_add_u32 v28, v26, v28
v_add_u32 v2, 15360, v28
v_add_u32 v3, 30720, v1
v_add_u32 v4, 46080, v28
v_add_u32 v5, 65536, v1
v_add_u32 v6, 80896, v28
v_add_u32 v7, 96256, v1
v_add_u32 v8, 111616, v28
s_mov_b32 s43, 0
s_mov_b32 s44, 0
s_mov_b32 s45, 0
s_mov_b32 s28, s6
s_mov_b32 s29, s7
s_mov_b32 s30, 0x600000
s_mov_b32 s31, 0x00020000
s_lshl_b32 s50, s40, 4
s_lshl_b32 s51, s42, 6
s_mul_i32 s48, s40, 3072
s_add_u32 s48, s48, 65536
v_add_u32 v25, 0, v0
v_mul_u32_u24 v26, 43691, v25
v_lshrrev_b32 v26, 19, v26
v_mul_u32_u24 v27, 12, v26
v_sub_u32 v27, v25, v27
v_lshrrev_b32 v28, 2, v26
v_and_b32 v28, 2, v28
v_xor_b32 v27, v27, v28
v_lshrrev_b32 v28, 2, v27
v_lshlrev_b32 v28, 11, v28
v_and_b32 v27, 3, v27
v_lshl_add_u32 v27, v27, 4, v28
v_add_u32 v26, s50, v26
v_mul_u32_u24 v26, 6144, v26
v_add3_u32 v9, v26, v27, s51
v_add_u32 v25, 64, v0
v_mul_u32_u24 v26, 43691, v25
v_lshrrev_b32 v26, 19, v26
v_mul_u32_u24 v27, 12, v26
v_sub_u32 v27, v25, v27
v_lshrrev_b32 v28, 2, v26
v_and_b32 v28, 2, v28
v_xor_b32 v27, v27, v28
v_lshrrev_b32 v28, 2, v27
v_lshlrev_b32 v28, 11, v28
v_and_b32 v27, 3, v27
v_lshl_add_u32 v27, v27, 4, v28
v_add_u32 v26, s50, v26
v_mul_u32_u24 v26, 6144, v26
v_add3_u32 v10, v26, v27, s51
v_subrev_u32 v10, 1024, v10
v_add_u32 v25, 128, v0
v_mul_u32_u24 v26, 43691, v25
v_lshrrev_b32 v26, 19, v26
v_mul_u32_u24 v27, 12, v26
v_sub_u32 v27, v25, v27
v_lshrrev_b32 v28, 2, v26
v_and_b32 v28, 2, v28
v_xor_b32 v27, v27, v28
v_lshrrev_b32 v28, 2, v27
v_lshlrev_b32 v28, 11, v28
v_and_b32 v27, 3, v27
v_lshl_add_u32 v27, v27, 4, v28
v_add_u32 v26, s50, v26
v_mul_u32_u24 v26, 6144, v26
v_add3_u32 v11, v26, v27, s51
v_subrev_u32 v11, 2048, v11
s_add_u32 m0, s47, 0
s_nop 0
buffer_load_dwordx4 v1, s[24:27], s43 offen offset:0 lds
buffer_load_dwordx4 v2, s[24:27], s43 offen offset:1024 lds
buffer_load_dwordx4 v3, s[24:27], s43 offen offset:2048 lds
buffer_load_dwordx4 v4, s[24:27], s43 offen offset:3072 lds
s_add_u32 m0, s47, 4096
s_nop 0
buffer_load_dwordx4 v5, s[24:27], s43 offen offset:0 lds
buffer_load_dwordx4 v6, s[24:27], s43 offen offset:1024 lds
buffer_load_dwordx4 v7, s[24:27], s43 offen offset:2048 lds
buffer_load_dwordx4 v8, s[24:27], s43 offen offset:3072 lds
s_add_u32 s43, s43, 128
s_add_u32 m0, s48, 0
s_nop 0
buffer_load_dwordx4 v9, s[28:31], s44 offen offset:0 lds
buffer_load_dwordx4 v10, s[28:31], s44 offen offset:1024 lds
buffer_load_dwordx4 v11, s[28:31], s44 offen offset:2048 lds
s_add_u32 s44, s44, 393216
s_and_b32 s70, s40, 1
s_lshl_b32 s70, s70, 5
s_mul_i32 s71, s42, 224
s_mul_i32 s49, s40, 7168
s_add_u32 s49, s49, 77824
s_cmp_ge_u32 s40, 2
s_cselect_b32 s32, s14, s12
s_cselect_b32 s33, s15, s13
s_mov_b32 s34, 7340032
s_mov_b32 s35, 0x00020000
v_add_u32 v25, 0, v0
v_mul_u32_u24 v26, 37450, v25
v_lshrrev_b32 v26, 19, v26
v_mul_u32_u24 v27, 14, v26
v_sub_u32 v27, v25, v27
v_lshl_add_u32 v27, v27, 4, s71
v_and_b32 v28, 4, v26
v_lshlrev_b32 v28, 1, v28
v_and_b32 v29, 8, v26
v_lshrrev_b32 v29, 1, v29
v_and_b32 v26, 0x13, v26
v_or3_b32 v26, v26, v28, v29
v_add_u32 v26, s70, v26
v_mul_u32_u24 v26, 7168, v26
v_add_u32 v12, v26, v27
v_add_u32 v25, 64, v0
v_mul_u32_u24 v26, 37450, v25
v_lshrrev_b32 v26, 19, v26
v_mul_u32_u24 v27, 14, v26
v_sub_u32 v27, v25, v27
v_lshl_add_u32 v27, v27, 4, s71
v_and_b32 v28, 4, v26
v_lshlrev_b32 v28, 1, v28
v_and_b32 v29, 8, v26
v_lshrrev_b32 v29, 1, v29
v_and_b32 v26, 0x13, v26
v_or3_b32 v26, v26, v28, v29
v_add_u32 v26, s70, v26
v_mul_u32_u24 v26, 7168, v26
v_add_u32 v13, v26, v27
v_subrev_u32 v13, 1024, v13
v_add_u32 v25, 128, v0
v_mul_u32_u24 v26, 37450, v25
v_lshrrev_b32 v26, 19, v26
v_mul_u32_u24 v27, 14, v26
v_sub_u32 v27, v25, v27
v_lshl_add_u32 v27, v27, 4, s71
v_and_b32 v28, 4, v26
v_lshlrev_b32 v28, 1, v28
v_and_b32 v29, 8, v26
v_lshrrev_b32 v29, 1, v29
v_and_b32 v26, 0x13, v26
v_or3_b32 v26, v26, v28, v29
v_add_u32 v26, s70, v26
v_mul_u32_u24 v26, 7168, v26
v_add_u32 v14, v26, v27
v_subrev_u32 v14, 2048, v14
v_add_u32 v25, 192, v0
v_mul_u32_u24 v26, 37450, v25
v_lshrrev_b32 v26, 19, v26
v_mul_u32_u24 v27, 14, v26
v_sub_u32 v27, v25, v27
v_lshl_add_u32 v27, v27, 4, s71
v_and_b32 v28, 4, v26
v_lshlrev_b32 v28, 1, v28
v_and_b32 v29, 8, v26
v_lshrrev_b32 v29, 1, v29
v_and_b32 v26, 0x13, v26
v_or3_b32 v26, v26, v28, v29
v_add_u32 v26, s70, v26
v_mul_u32_u24 v26, 7168, v26
v_add_u32 v15, v26, v27
v_subrev_u32 v15, 3072, v15
v_add_u32 v25, 256, v0
v_mul_u32_u24 v26, 37450, v25
v_lshrrev_b32 v26, 19, v26
v_mul_u32_u24 v27, 14, v26
v_sub_u32 v27, v25, v27
v_lshl_add_u32 v27, v27, 4, s71
v_and_b32 v28, 4, v26
v_lshlrev_b32 v28, 1, v28
v_and_b32 v29, 8, v26
v_lshrrev_b32 v29, 1, v29
v_and_b32 v26, 0x13, v26
v_or3_b32 v26, v26, v28, v29
v_add_u32 v26, s70, v26
v_mul_u32_u24 v26, 7168, v26
v_add_u32 v16, v26, v27
v_add_u32 v25, 320, v0
v_mul_u32_u24 v26, 37450, v25
v_lshrrev_b32 v26, 19, v26
v_mul_u32_u24 v27, 14, v26
v_sub_u32 v27, v25, v27
v_lshl_add_u32 v27, v27, 4, s71
v_and_b32 v28, 4, v26
v_lshlrev_b32 v28, 1, v28
v_and_b32 v29, 8, v26
v_lshrrev_b32 v29, 1, v29
v_and_b32 v26, 0x13, v26
v_or3_b32 v26, v26, v28, v29
v_add_u32 v26, s70, v26
v_mul_u32_u24 v26, 7168, v26
v_add_u32 v17, v26, v27
v_subrev_u32 v17, 1024, v17
v_add_u32 v25, 384, v0
v_mul_u32_u24 v26, 37450, v25
v_lshrrev_b32 v26, 19, v26
v_mul_u32_u24 v27, 14, v26
v_sub_u32 v27, v25, v27
v_lshl_add_u32 v27, v27, 4, s71
v_and_b32 v28, 4, v26
v_lshlrev_b32 v28, 1, v28
v_and_b32 v29, 8, v26
v_lshrrev_b32 v29, 1, v29
v_and_b32 v26, 0x13, v26
v_or3_b32 v26, v26, v28, v29
v_add_u32 v26, s70, v26
v_mul_u32_u24 v26, 7168, v26
v_add_u32 v18, v26, v27
v_subrev_u32 v18, 2048, v18
v_and_b32 v25, 15, v0
v_lshrrev_b32 v26, 4, v0
v_lshrrev_b32 v27, 1, v25
v_xor_b32 v27, v27, v26
v_lshlrev_b32 v27, 4, v27
v_lshlrev_b32 v28, 7, v25
v_add3_u32 v19, v27, v28, s47
v_xor_b32 v20, 64, v19
v_lshrrev_b32 v27, 2, v25
v_and_b32 v28, 3, v0
v_lshlrev_b32 v28, 3, v28
v_lshl_add_u32 v29, v26, 3, v27
v_mul_u32_u24 v29, 192, v29
v_add_u32 v29, v29, v28
v_add_u32 v29, 65536, v29
v_and_b32 v25, 1, v26
v_lshl_add_u32 v21, v25, 5, v29
v_xor_b32 v22, 1, v25
v_lshl_add_u32 v22, v22, 5, v29
v_lshrrev_b32 v29, 1, v26
v_lshlrev_b32 v29, 4, v29
v_lshl_add_u32 v29, v25, 2, v29
v_add_u32 v29, v29, v27
v_mul_u32_u24 v29, 224, v29
v_add_u32 v29, v29, v28
v_add_u32 v23, 77824, v29
s_add_u32 m0, s49, 0
s_nop 0
buffer_load_dwordx4 v12, s[32:35], s45 offen offset:0 lds
buffer_load_dwordx4 v13, s[32:35], s45 offen offset:1024 lds
buffer_load_dwordx4 v14, s[32:35], s45 offen offset:2048 lds
buffer_load_dwordx4 v15, s[32:35], s45 offen offset:3072 lds
s_mov_b32 s36, s22
s_mov_b32 s37, s23
s_mov_b32 s38, 0x10000000
s_mov_b32 s39, 0x00020000
s_mov_b32 s64, s20
s_mov_b32 s65, s21
s_mov_b32 s66, 0x100
s_mov_b32 s67, 0x00020000
v_cmp_eq_u32 vcc, 0, v190
v_mov_b32 v191, 0x3f80
s_nop 0
v_cndmask_b32 v192, 0, v191, vcc
v_cmp_eq_u32 vcc, 1, v190
v_mov_b32 v191, 0x3f800000
s_nop 0
v_cndmask_b32 v192, v192, v191, vcc
v_accvgpr_write_b32 a240, v192
v_cmp_eq_u32 vcc, 2, v190
v_mov_b32 v191, 0x3f80
s_nop 0
v_cndmask_b32 v192, 0, v191, vcc
v_cmp_eq_u32 vcc, 3, v190
v_mov_b32 v191, 0x3f800000
s_nop 0
v_cndmask_b32 v192, v192, v191, vcc
v_accvgpr_write_b32 a241, v192
v_cmp_eq_u32 vcc, 4, v190
v_mov_b32 v191, 0x3f80
s_nop 0
v_cndmask_b32 v192, 0, v191, vcc
v_cmp_eq_u32 vcc, 5, v190
v_mov_b32 v191, 0x3f800000
s_nop 0
v_cndmask_b32 v192, v192, v191, vcc
v_accvgpr_write_b32 a242, v192
v_cmp_eq_u32 vcc, 6, v190
v_mov_b32 v191, 0x3f80
s_nop 0
v_cndmask_b32 v192, 0, v191, vcc
v_cmp_eq_u32 vcc, 7, v190
v_mov_b32 v191, 0x3f800000
s_nop 0
v_cndmask_b32 v192, v192, v191, vcc
v_accvgpr_write_b32 a243, v192
v_mov_b32 v190, 0x7f817f81
v_accvgpr_write_b32 a250, v190
v_accvgpr_write_b32 a251, v190
v_accvgpr_write_b32 a252, v190
v_accvgpr_write_b32 a253, v190
s_waitcnt vmcnt(7)
ds_read_b128 a[96:99], v19 offset:0
ds_read_b128 a[100:103], v20 offset:0
ds_read_b128 a[104:107], v19 offset:2048
ds_read_b128 a[108:111], v20 offset:2048
ds_read_b128 a[112:115], v19 offset:4096
ds_read_b128 a[116:119], v20 offset:4096
ds_read_b128 a[120:123], v19 offset:6144
ds_read_b128 a[124:127], v20 offset:6144
s_waitcnt vmcnt(4)
s_barrier
ds_read_b64_tr_b16 a[160:161], v21 offset:0
ds_read_b64_tr_b16 a[162:163], v21 offset:768
ds_read_b64_tr_b16 a[164:165], v21 offset:6144
ds_read_b64_tr_b16 a[166:167], v21 offset:6912
ds_read_b64_tr_b16 a[168:169], v22 offset:0
ds_read_b64_tr_b16 a[170:171], v22 offset:768
ds_read_b64_tr_b16 a[172:173], v22 offset:6144
ds_read_b64_tr_b16 a[174:175], v22 offset:6912
L_body:
s_waitcnt lgkmcnt(4)
v_mfma_f32_16x16x32_bf16 a[0:3], a[160:163], a[96:99], 0
ds_read_b64_tr_b16 a[176:177], v21 offset:64
v_mfma_f32_16x16x32_bf16 a[0:3], a[164:167], a[100:103], a[0:3]
ds_read_b64_tr_b16 a[178:179], v21 offset:832
v_mfma_f32_16x16x32_bf16 a[4:7], a[160:163], a[104:107], 0
ds_read_b64_tr_b16 a[180:181], v21 offset:6208
v_mfma_f32_16x16x32_bf16 a[4:7], a[164:167], a[108:111], a[4:7]
ds_read_b64_tr_b16 a[182:183], v21 offset:6976
s_add_u32 m0, s49, 4096
v_mfma_f32_16x16x32_bf16 a[8:11], a[160:163], a[112:115], 0
buffer_load_dwordx4 v16, s[32:35], s45 offen offset:0 lds
v_mfma_f32_16x16x32_bf16 a[8:11], a[164:167], a[116:119], a[8:11]
v_mfma_f32_16x16x32_bf16 a[12:15], a[160:163], a[120:123], 0
buffer_load_dwordx4 v17, s[32:35], s45 offen offset:1024 lds
v_mfma_f32_16x16x32_bf16 a[12:15], a[164:167], a[124:127], a[12:15]
s_waitcnt lgkmcnt(4)
v_mfma_f32_16x16x32_bf16 a[28:31], a[168:171], a[120:123], 0
ds_read_b64_tr_b16 a[184:185], v22 offset:64
v_mfma_f32_16x16x32_bf16 a[28:31], a[172:175], a[124:127], a[28:31]
ds_read_b64_tr_b16 a[186:187], v22 offset:832
v_mfma_f32_16x16x32_bf16 a[24:27], a[168:171], a[112:115], 0
ds_read_b64_tr_b16 a[188:189], v22 offset:6208
v_mfma_f32_16x16x32_bf16 a[24:27], a[172:175], a[116:119], a[24:27]
ds_read_b64_tr_b16 a[190:191], v22 offset:6976
v_mfma_f32_16x16x32_bf16 a[20:23], a[168:171], a[104:107], 0
buffer_load_dwordx4 v18, s[32:35], s45 offen offset:2048 lds
s_add_u32 s45, s45, 458752
v_mfma_f32_16x16x32_bf16 a[20:23], a[172:175], a[108:111], a[20:23]
v_mfma_f32_16x16x32_bf16 a[244:247], a[240:243], a[192:195], 0
v_mfma_f32_16x16x32_bf16 a[16:19], a[168:171], a[96:99], 0
v_mfma_f32_16x16x32_bf16 a[16:19], a[172:175], a[100:103], a[16:19]
s_waitcnt lgkmcnt(4)
v_mfma_f32_16x16x32_bf16 a[32:35], a[176:179], a[96:99], 0
ds_read_b64_tr_b16 a[160:161], v21 offset:128
v_mfma_f32_16x16x32_bf16 a[32:35], a[180:183], a[100:103], a[32:35]
ds_read_b64_tr_b16 a[162:163], v21 offset:896
v_mfma_f32_16x16x32_bf16 a[36:39], a[176:179], a[104:107], 0
ds_read_b64_tr_b16 a[164:165], v21 offset:6272
v_mfma_f32_16x16x32_bf16 a[36:39], a[180:183], a[108:111], a[36:39]
ds_read_b64_tr_b16 a[166:167], v21 offset:7040
v_mfma_f32_16x16x32_bf16 a[40:43], a[176:179], a[112:115], 0
v_mfma_f32_16x16x32_bf16 a[244:247], a[240:243], a[196:199], a[244:247]
v_mfma_f32_16x16x32_bf16 a[40:43], a[180:183], a[116:119], a[40:43]
v_mfma_f32_16x16x32_bf16 a[44:47], a[176:179], a[120:123], 0
v_mfma_f32_16x16x32_bf16 a[44:47], a[180:183], a[124:127], a[44:47]
s_waitcnt lgkmcnt(4)
v_mfma_f32_16x16x32_bf16 a[60:63], a[184:187], a[120:123], 0
ds_read_b64_tr_b16 a[168:169], v22 offset:128
v_lshrrev_b32 v248, 5, v0
v_mfma_f32_16x16x32_bf16 a[60:63], a[188:191], a[124:127], a[60:63]
ds_read_b64_tr_b16 a[170:171], v22 offset:896
v_and_b32 v249, 31, v0
v_mfma_f32_16x16x32_bf16 a[56:59], a[184:187], a[112:115], 0
ds_read_b64_tr_b16 a[172:173], v22 offset:6272
v_lshlrev_b32 v249, 4, v249
v_mfma_f32_16x16x32_bf16 a[56:59], a[188:191], a[116:119], a[56:59]
ds_read_b64_tr_b16 a[174:175], v22 offset:7040
v_lshl_add_u32 v249, v248, 11, v249
v_mfma_f32_16x16x32_bf16 a[52:55], a[184:187], a[104:107], 0
s_lshl_b32 s52, s2, 3
s_lshl_b32 s53, s40, 1
v_mfma_f32_16x16x32_bf16 a[52:55], a[188:191], a[108:111], a[52:55]
s_add_u32 s62, s52, s53
s_lshl_b32 s52, s62, 11
v_mfma_f32_16x16x32_bf16 a[48:51], a[184:187], a[96:99], 0
buffer_load_dwordx4 v[200:203], v249, s[24:27], s52 offen offset:0
buffer_load_dwordx4 v[204:207], v249, s[24:27], s52 offen offset:512
v_mfma_f32_16x16x32_bf16 a[48:51], a[188:191], a[100:103], a[48:51]
buffer_load_dwordx4 v[208:211], v249, s[24:27], s52 offen offset:1024
buffer_load_dwordx4 v[212:215], v249, s[24:27], s52 offen offset:1536
s_waitcnt vmcnt(4) lgkmcnt(0)
s_barrier
v_mfma_f32_16x16x32_bf16 a[64:67], a[96:99], a[160:163], 0
ds_read_b64_tr_b16 a[176:177], v23 offset:0
v_mfma_f32_16x16x32_bf16 a[64:67], a[100:103], a[164:167], a[64:67]
ds_read_b64_tr_b16 a[178:179], v23 offset:1792
v_mfma_f32_16x16x32_bf16 a[68:71], a[104:107], a[160:163], 0
ds_read_b64_tr_b16 a[180:181], v23 offset:7168
v_mfma_f32_16x16x32_bf16 a[68:71], a[108:111], a[164:167], a[68:71]
ds_read_b64_tr_b16 a[182:183], v23 offset:8960
s_add_u32 m0, s47, 32768
v_mfma_f32_16x16x32_bf16 a[72:75], a[112:115], a[160:163], 0
buffer_load_dwordx4 v1, s[24:27], s43 offen offset:0 lds
v_mfma_f32_16x16x32_bf16 a[72:75], a[116:119], a[164:167], a[72:75]
v_mfma_f32_16x16x32_bf16 a[76:79], a[120:123], a[160:163], 0
buffer_load_dwordx4 v2, s[24:27], s43 offen offset:1024 lds
v_mfma_f32_16x16x32_bf16 a[76:79], a[124:127], a[164:167], a[76:79]
v_mfma_f32_16x16x32_bf16 a[92:95], a[120:123], a[168:171], 0
ds_read_b64_tr_b16 a[184:185], v23 offset:32
v_mfma_f32_16x16x32_bf16 a[92:95], a[124:127], a[172:175], a[92:95]
ds_read_b64_tr_b16 a[186:187], v23 offset:1824
v_mfma_f32_16x16x32_bf16 a[88:91], a[112:115], a[168:171], 0
ds_read_b64_tr_b16 a[188:189], v23 offset:7200
v_mfma_f32_16x16x32_bf16 a[88:91], a[116:119], a[172:175], a[88:91]
ds_read_b64_tr_b16 a[190:191], v23 offset:8992
v_mfma_f32_16x16x32_bf16 a[84:87], a[104:107], a[168:171], 0
buffer_load_dwordx4 v3, s[24:27], s43 offen offset:2048 lds
v_mfma_f32_16x16x32_bf16 a[84:87], a[108:111], a[172:175], a[84:87]
v_mfma_f32_16x16x32_bf16 a[80:83], a[96:99], a[168:171], 0
buffer_load_dwordx4 v4, s[24:27], s43 offen offset:3072 lds
v_mfma_f32_16x16x32_bf16 a[80:83], a[100:103], a[172:175], a[80:83]
s_waitcnt lgkmcnt(4)
v_mfma_f32_16x16x32_bf16 v[32:35], a[176:179], a[96:99], 0
ds_read_b64_tr_b16 a[160:161], v23 offset:64
v_mfma_f32_16x16x32_bf16 v[32:35], a[180:183], a[100:103], v[32:35]
ds_read_b64_tr_b16 a[162:163], v23 offset:1856
v_mfma_f32_16x16x32_bf16 v[36:39], a[176:179], a[104:107], 0
ds_read_b64_tr_b16 a[164:165], v23 offset:7232
v_mfma_f32_16x16x32_bf16 v[36:39], a[180:183], a[108:111], v[36:39]
ds_read_b64_tr_b16 a[166:167], v23 offset:9024
s_add_u32 m0, s47, 36864
v_mfma_f32_16x16x32_bf16 v[40:43], a[176:179], a[112:115], 0
buffer_load_dwordx4 v5, s[24:27], s43 offen offset:0 lds
v_mfma_f32_16x16x32_bf16 v[40:43], a[180:183], a[116:119], v[40:43]
v_mfma_f32_16x16x32_bf16 v[44:47], a[176:179], a[120:123], 0
v_mfma_f32_16x16x32_bf16 v[44:47], a[180:183], a[124:127], v[44:47]
s_waitcnt lgkmcnt(4)
v_mfma_f32_16x16x32_bf16 v[60:63], a[184:187], a[120:123], 0
ds_read_b64_tr_b16 a[168:169], v23 offset:96
v_mfma_f32_16x16x32_bf16 v[60:63], a[188:191], a[124:127], v[60:63]
ds_read_b64_tr_b16 a[170:171], v23 offset:1888
v_mfma_f32_16x16x32_bf16 v[56:59], a[184:187], a[112:115], 0
ds_read_b64_tr_b16 a[172:173], v23 offset:7264
v_mfma_f32_16x16x32_bf16 v[56:59], a[188:191], a[116:119], v[56:59]
ds_read_b64_tr_b16 a[174:175], v23 offset:9056
v_mfma_f32_16x16x32_bf16 v[52:55], a[184:187], a[104:107], 0
buffer_load_dwordx4 v6, s[24:27], s43 offen offset:1024 lds
v_mfma_f32_16x16x32_bf16 v[52:55], a[188:191], a[108:111], v[52:55]
v_mfma_f32_16x16x32_bf16 v[48:51], a[184:187], a[96:99], 0
buffer_load_dwordx4 v7, s[24:27], s43 offen offset:2048 lds
v_mfma_f32_16x16x32_bf16 v[48:51], a[188:191], a[100:103], v[48:51]
s_waitcnt lgkmcnt(4)
v_mfma_f32_16x16x32_bf16 v[64:67], a[160:163], a[96:99], 0
ds_read_b64_tr_b16 a[176:177], v23 offset:128
v_mfma_f32_16x16x32_bf16 v[64:67], a[164:167], a[100:103], v[64:67]
ds_read_b64_tr_b16 a[178:179], v23 offset:1920
v_mfma_f32_16x16x32_bf16 v[68:71], a[160:163], a[104:107], 0
ds_read_b64_tr_b16 a[180:181], v23 offset:7296
v_mfma_f32_16x16x32_bf16 v[68:71], a[164:167], a[108:111], v[68:71]
ds_read_b64_tr_b16 a[182:183], v23 offset:9088
v_mfma_f32_16x16x32_bf16 v[72:75], a[160:163], a[112:115], 0
buffer_load_dwordx4 v8, s[24:27], s43 offen offset:3072 lds
s_add_u32 s43, s43, 128
v_mfma_f32_16x16x32_bf16 v[72:75], a[164:167], a[116:119], v[72:75]
v_mfma_f32_16x16x32_bf16 v[76:79], a[160:163], a[120:123], 0
v_mfma_f32_16x16x32_bf16 v[76:79], a[164:167], a[124:127], v[76:79]
s_waitcnt lgkmcnt(4)
v_mfma_f32_16x16x32_bf16 v[92:95], a[168:171], a[120:123], 0
ds_read_b64_tr_b16 a[184:185], v23 offset:160
v_mfma_f32_16x16x32_bf16 v[92:95], a[172:175], a[124:127], v[92:95]
ds_read_b64_tr_b16 a[186:187], v23 offset:1952
v_mfma_f32_16x16x32_bf16 v[88:91], a[168:171], a[112:115], 0
ds_read_b64_tr_b16 a[188:189], v23 offset:7328
v_mfma_f32_16x16x32_bf16 v[88:91], a[172:175], a[116:119], v[88:91]
ds_read_b64_tr_b16 a[190:191], v23 offset:9120
s_add_u32 m0, s48, 40960
v_mfma_f32_16x16x32_bf16 v[84:87], a[168:171], a[104:107], 0
buffer_load_dwordx4 v9, s[28:31], s44 offen offset:0 lds
v_mfma_f32_16x16x32_bf16 v[84:87], a[172:175], a[108:111], v[84:87]
v_mfma_f32_16x16x32_bf16 v[80:83], a[168:171], a[96:99], 0
buffer_load_dwordx4 v10, s[28:31], s44 offen offset:1024 lds
v_mfma_f32_16x16x32_bf16 v[80:83], a[172:175], a[100:103], v[80:83]
s_waitcnt lgkmcnt(4)
v_mfma_f32_16x16x32_bf16 v[96:99], a[176:179], a[96:99], 0
ds_read_b64_tr_b16 a[160:161], v23 offset:192
v_mfma_f32_16x16x32_bf16 v[96:99], a[180:183], a[100:103], v[96:99]
ds_read_b64_tr_b16 a[162:163], v23 offset:1984
v_mfma_f32_16x16x32_bf16 v[100:103], a[176:179], a[104:107], 0
ds_read_b64_tr_b16 a[164:165], v23 offset:7360
v_mfma_f32_16x16x32_bf16 v[100:103], a[180:183], a[108:111], v[100:103]
ds_read_b64_tr_b16 a[166:167], v23 offset:9152
v_mfma_f32_16x16x32_bf16 v[104:107], a[176:179], a[112:115], 0
buffer_load_dwordx4 v11, s[28:31], s44 offen offset:2048 lds
s_add_u32 s44, s44, 393216
v_mfma_f32_16x16x32_bf16 v[104:107], a[180:183], a[116:119], v[104:107]
v_mfma_f32_16x16x32_bf16 v[108:111], a[176:179], a[120:123], 0
v_mfma_f32_16x16x32_bf16 v[108:111], a[180:183], a[124:127], v[108:111]
s_waitcnt lgkmcnt(4)
v_mfma_f32_16x16x32_bf16 v[124:127], a[184:187], a[120:123], 0
ds_read_b64_tr_b16 a[168:169], v23 offset:14336
v_mfma_f32_16x16x32_bf16 v[124:127], a[188:191], a[124:127], v[124:127]
ds_read_b64_tr_b16 a[170:171], v23 offset:16128
v_mfma_f32_16x16x32_bf16 v[120:123], a[184:187], a[112:115], 0
ds_read_b64_tr_b16 a[172:173], v23 offset:21504
v_mfma_f32_16x16x32_bf16 v[120:123], a[188:191], a[116:119], v[120:123]
ds_read_b64_tr_b16 a[174:175], v23 offset:23296
v_mfma_f32_16x16x32_bf16 v[116:119], a[184:187], a[104:107], 0
v_mfma_f32_16x16x32_bf16 v[116:119], a[188:191], a[108:111], v[116:119]
v_mfma_f32_16x16x32_bf16 v[112:115], a[184:187], a[96:99], 0
v_mfma_f32_16x16x32_bf16 v[112:115], a[188:191], a[100:103], v[112:115]
s_waitcnt vmcnt(11)
v_lshlrev_b32 v216, 16, v200
v_and_b32 v217, 0xffff0000, v200
v_lshlrev_b32 v218, 16, v201
v_and_b32 v219, 0xffff0000, v201
v_lshlrev_b32 v220, 16, v202
v_and_b32 v221, 0xffff0000, v202
v_lshlrev_b32 v222, 16, v203
v_and_b32 v223, 0xffff0000, v203
v_lshlrev_b32 v224, 16, v204
v_and_b32 v225, 0xffff0000, v204
v_lshlrev_b32 v226, 16, v205
v_and_b32 v227, 0xffff0000, v205
v_lshlrev_b32 v228, 16, v206
v_and_b32 v229, 0xffff0000, v206
v_lshlrev_b32 v230, 16, v207
v_and_b32 v231, 0xffff0000, v207
v_lshlrev_b32 v232, 16, v208
v_and_b32 v233, 0xffff0000, v208
v_lshlrev_b32 v234, 16, v209
v_and_b32 v235, 0xffff0000, v209
v_lshlrev_b32 v236, 16, v210
v_and_b32 v237, 0xffff0000, v210
v_lshlrev_b32 v238, 16, v211
v_and_b32 v239, 0xffff0000, v211
v_lshlrev_b32 v240, 16, v212
v_and_b32 v241, 0xffff0000, v212
v_lshlrev_b32 v242, 16, v213
v_and_b32 v243, 0xffff0000, v213
v_lshlrev_b32 v244, 16, v214
v_and_b32 v245, 0xffff0000, v214
v_lshlrev_b32 v246, 16, v215
v_and_b32 v247, 0xffff0000, v215
v_pk_add_f32 v[250:251], v[216:217], v[218:219]
v_pk_add_f32 v[252:253], v[220:221], v[222:223]
v_pk_add_f32 v[250:251], v[250:251], v[224:225]
v_pk_add_f32 v[252:253], v[252:253], v[226:227]
v_pk_add_f32 v[250:251], v[250:251], v[228:229]
v_pk_add_f32 v[252:253], v[252:253], v[230:231]
v_pk_add_f32 v[250:251], v[250:251], v[232:233]
v_pk_add_f32 v[252:253], v[252:253], v[234:235]
v_pk_add_f32 v[250:251], v[250:251], v[236:237]
v_pk_add_f32 v[252:253], v[252:253], v[238:239]
v_pk_add_f32 v[250:251], v[250:251], v[240:241]
v_pk_add_f32 v[252:253], v[252:253], v[242:243]
v_pk_add_f32 v[250:251], v[250:251], v[244:245]
v_pk_add_f32 v[252:253], v[252:253], v[246:247]
v_pk_add_f32 v[250:251], v[250:251], v[252:253]
v_add_f32 v250, v250, v251
s_nop 1
v_add_f32_dpp v250, v250, v250 row_ror:8 row_mask:0xf bank_mask:0xf
s_nop 1
v_add_f32_dpp v250, v250, v250 row_ror:4 row_mask:0xf bank_mask:0xf
s_nop 1
v_add_f32_dpp v250, v250, v250 row_ror:2 row_mask:0xf bank_mask:0xf
s_nop 1
v_add_f32_dpp v250, v250, v250 row_ror:1 row_mask:0xf bank_mask:0xf
v_mov_b32 v249, v250
s_nop 1
v_permlane16_swap_b32 v250, v249
v_add_f32 v250, v250, v249
v_mul_f32 v250, 0xba800000, v250
v_pk_add_f32 v[216:217], v[216:217], v[250:251] op_sel_hi:[1,0]
v_pk_add_f32 v[218:219], v[218:219], v[250:251] op_sel_hi:[1,0]
v_pk_add_f32 v[220:221], v[220:221], v[250:251] op_sel_hi:[1,0]
v_pk_add_f32 v[222:223], v[222:223], v[250:251] op_sel_hi:[1,0]
v_pk_add_f32 v[224:225], v[224:225], v[250:251] op_sel_hi:[1,0]
v_pk_add_f32 v[226:227], v[226:227], v[250:251] op_sel_hi:[1,0]
v_pk_add_f32 v[228:229], v[228:229], v[250:251] op_sel_hi:[1,0]
v_pk_add_f32 v[230:231], v[230:231], v[250:251] op_sel_hi:[1,0]
v_pk_add_f32 v[232:233], v[232:233], v[250:251] op_sel_hi:[1,0]
v_pk_add_f32 v[234:235], v[234:235], v[250:251] op_sel_hi:[1,0]
v_pk_add_f32 v[236:237], v[236:237], v[250:251] op_sel_hi:[1,0]
v_pk_add_f32 v[238:239], v[238:239], v[250:251] op_sel_hi:[1,0]
v_pk_add_f32 v[240:241], v[240:241], v[250:251] op_sel_hi:[1,0]
v_pk_add_f32 v[242:243], v[242:243], v[250:251] op_sel_hi:[1,0]
v_pk_add_f32 v[244:245], v[244:245], v[250:251] op_sel_hi:[1,0]
v_pk_add_f32 v[246:247], v[246:247], v[250:251] op_sel_hi:[1,0]
v_pk_mul_f32 v[252:253], v[216:217], v[216:217]
v_pk_mul_f32 v[254:255], v[218:219], v[218:219]
v_pk_fma_f32 v[252:253], v[220:221], v[220:221], v[252:253]
v_pk_fma_f32 v[254:255], v[222:223], v[222:223], v[254:255]
v_pk_fma_f32 v[252:253], v[224:225], v[224:225], v[252:253]
v_pk_fma_f32 v[254:255], v[226:227], v[226:227], v[254:255]
v_pk_fma_f32 v[252:253], v[228:229], v[228:229], v[252:253]
v_pk_fma_f32 v[254:255], v[230:231], v[230:231], v[254:255]
v_pk_fma_f32 v[252:253], v[232:233], v[232:233], v[252:253]
v_pk_fma_f32 v[254:255], v[234:235], v[234:235], v[254:255]
v_pk_fma_f32 v[252:253], v[236:237], v[236:237], v[252:253]
v_pk_fma_f32 v[254:255], v[238:239], v[238:239], v[254:255]
v_pk_fma_f32 v[252:253], v[240:241], v[240:241], v[252:253]
v_pk_fma_f32 v[254:255], v[242:243], v[242:243], v[254:255]
v_pk_fma_f32 v[252:253], v[244:245], v[244:245], v[252:253]
v_pk_fma_f32 v[254:255], v[246:247], v[246:247], v[254:255]
v_pk_add_f32 v[252:253], v[252:253], v[254:255]
v_add_f32 v251, v252, v253
s_nop 1
v_add_f32_dpp v251, v251, v251 row_ror:8 row_mask:0xf bank_mask:0xf
s_nop 1
v_add_f32_dpp v251, v251, v251 row_ror:4 row_mask:0xf bank_mask:0xf
s_nop 1
v_add_f32_dpp v251, v251, v251 row_ror:2 row_mask:0xf bank_mask:0xf
s_nop 1
v_add_f32_dpp v251, v251, v251 row_ror:1 row_mask:0xf bank_mask:0xf
v_mov_b32 v249, v251
s_nop 1
v_permlane16_swap_b32 v251, v249
v_add_f32 v251, v251, v249
v_mul_f32 v251, 0x3a800000, v251
v_cvt_pk_bf16_f32 v250, v250, v250
v_lshlrev_b32 v250, 16, v250
v_cvt_pk_bf16_f32 v251, v251, v251
v_lshlrev_b32 v251, 16, v251
v_add_f32 v251, 0x3727c5ac, v251
v_cvt_pk_bf16_f32 v251, v251, v251
v_lshlrev_b32 v251, 16, v251
v_sqrt_f32 v251, v251
s_nop 0
v_cvt_pk_bf16_f32 v251, v251, v251
v_lshlrev_b32 v251, 16, v251
v_rcp_f32 v27, v251
v_mov_b32 v26, v250
v_and_b32 v252, 31, v0
v_cmp_gt_u32 vcc, 8, v252
v_lshlrev_b32 v252, 4, v252
v_lshl_add_u32 v252, v248, 3, v252
v_bfrev_b32 v254, 1
v_cndmask_b32 v25, v254, v252, vcc
s_lshl_b32 s50, s62, 6
s_add_u32 s50, s50, 33554432
buffer_store_dwordx2 v[26:27], v25, s[36:39], s50 offen sc1
s_lshl_b32 s63, s41, 5
s_add_u32 s63, s63, s42
s_lshl_b32 s63, s63, 2
s_add_u32 s63, s63, s40
s_lshl_b32 s63, s63, 7
s_add_u32 s63, s63, 35651584
v_cmp_gt_u32 vcc, 32, v0
v_lshlrev_b32 v28, 2, v0
v_bfrev_b32 v29, 1
v_cndmask_b32 v28, v29, v28, vcc
v_mov_b32 v29, 0
buffer_store_dword v29, v28, s[36:39], s63 offen sc1
s_waitcnt lgkmcnt(4)
v_mfma_f32_16x16x32_bf16 v[128:131], a[160:163], a[96:99], 0
ds_read_b64_tr_b16 a[176:177], v23 offset:14368
buffer_load_dwordx4 a[200:203], v24, s[56:59], s55 offen
v_mfma_f32_16x16x32_bf16 v[128:131], a[164:167], a[100:103], v[128:131]
ds_read_b64_tr_b16 a[178:179], v23 offset:16160
s_add_u32 s55, s55, s54
v_mfma_f32_16x16x32_bf16 v[132:135], a[160:163], a[104:107], 0
ds_read_b64_tr_b16 a[180:181], v23 offset:21536
buffer_load_dwordx4 a[204:207], v24, s[56:59], s55 offen
v_mfma_f32_16x16x32_bf16 v[132:135], a[164:167], a[108:111], v[132:135]
ds_read_b64_tr_b16 a[182:183], v23 offset:23328
s_add_u32 s55, s55, s54
v_mfma_f32_16x16x32_bf16 v[136:139], a[160:163], a[112:115], 0
buffer_load_dwordx4 a[208:211], v24, s[56:59], s55 offen
s_add_u32 s55, s55, s54
v_mfma_f32_16x16x32_bf16 v[136:139], a[164:167], a[116:119], v[136:139]
buffer_load_dwordx4 a[212:215], v24, s[56:59], s55 offen
s_add_u32 s55, s55, s54
v_mfma_f32_16x16x32_bf16 v[140:143], a[160:163], a[120:123], 0
v_mfma_f32_16x16x32_bf16 v[140:143], a[164:167], a[124:127], v[140:143]
s_waitcnt lgkmcnt(4)
v_mfma_f32_16x16x32_bf16 v[156:159], a[168:171], a[120:123], 0
ds_read_b64_tr_b16 a[184:185], v23 offset:14400
v_mfma_f32_16x16x32_bf16 v[156:159], a[172:175], a[124:127], v[156:159]
ds_read_b64_tr_b16 a[186:187], v23 offset:16192
v_mfma_f32_16x16x32_bf16 v[152:155], a[168:171], a[112:115], 0
ds_read_b64_tr_b16 a[188:189], v23 offset:21568
v_mfma_f32_16x16x32_bf16 v[152:155], a[172:175], a[116:119], v[152:155]
ds_read_b64_tr_b16 a[190:191], v23 offset:23360
s_add_u32 m0, s49, 40960
v_mfma_f32_16x16x32_bf16 v[148:151], a[168:171], a[104:107], 0
buffer_load_dwordx4 v12, s[32:35], s45 offen offset:0 lds
v_mfma_f32_16x16x32_bf16 v[148:151], a[172:175], a[108:111], v[148:151]
v_mfma_f32_16x16x32_bf16 v[144:147], a[168:171], a[96:99], 0
v_mfma_f32_16x16x32_bf16 v[144:147], a[172:175], a[100:103], v[144:147]
s_waitcnt lgkmcnt(4)
v_mfma_f32_16x16x32_bf16 v[160:163], a[176:179], a[96:99], 0
ds_read_b64_tr_b16 a[160:161], v23 offset:14432
v_mfma_f32_16x16x32_bf16 v[160:163], a[180:183], a[100:103], v[160:163]
ds_read_b64_tr_b16 a[162:163], v23 offset:16224
v_mfma_f32_16x16x32_bf16 v[164:167], a[176:179], a[104:107], 0
ds_read_b64_tr_b16 a[164:165], v23 offset:21600
v_mfma_f32_16x16x32_bf16 v[164:167], a[180:183], a[108:111], v[164:167]
ds_read_b64_tr_b16 a[166:167], v23 offset:23392
v_mfma_f32_16x16x32_bf16 v[168:171], a[176:179], a[112:115], 0
buffer_load_dwordx4 v13, s[32:35], s45 offen offset:1024 lds
v_mfma_f32_16x16x32_bf16 v[168:171], a[180:183], a[116:119], v[168:171]
v_mfma_f32_16x16x32_bf16 v[172:175], a[176:179], a[120:123], 0
v_mfma_f32_16x16x32_bf16 v[172:175], a[180:183], a[124:127], v[172:175]
s_waitcnt vmcnt(11)
s_waitcnt lgkmcnt(4)
v_mfma_f32_16x16x32_bf16 v[188:191], a[184:187], a[120:123], 0
ds_read_b64_tr_b16 a[168:169], v23 offset:14464
v_mfma_f32_16x16x32_bf16 v[188:191], a[188:191], a[124:127], v[188:191]
ds_read_b64_tr_b16 a[170:171], v23 offset:16256
v_mfma_f32_16x16x32_bf16 v[184:187], a[184:187], a[112:115], 0
ds_read_b64_tr_b16 a[172:173], v23 offset:21632
v_mfma_f32_16x16x32_bf16 v[184:187], a[188:191], a[116:119], v[184:187]
ds_read_b64_tr_b16 a[174:175], v23 offset:23424
v_mfma_f32_16x16x32_bf16 v[180:183], a[184:187], a[104:107], 0
ds_read_b128 a[128:131], v19 offset:32768
buffer_load_dwordx4 v14, s[32:35], s45 offen offset:2048 lds
v_mfma_f32_16x16x32_bf16 v[180:183], a[188:191], a[108:111], v[180:183]
ds_read_b128 a[132:135], v20 offset:32768
v_mfma_f32_16x16x32_bf16 v[176:179], a[184:187], a[96:99], 0
ds_read_b128 a[136:139], v19 offset:34816
v_mfma_f32_16x16x32_bf16 v[176:179], a[188:191], a[100:103], v[176:179]
ds_read_b128 a[140:143], v20 offset:34816
s_waitcnt lgkmcnt(8)
v_mfma_f32_16x16x32_bf16 v[192:195], a[160:163], a[96:99], 0
ds_read_b64_tr_b16 a[176:177], v23 offset:14496
v_mfma_f32_16x16x32_bf16 v[192:195], a[164:167], a[100:103], v[192:195]
ds_read_b64_tr_b16 a[178:179], v23 offset:16288
v_mfma_f32_16x16x32_bf16 v[196:199], a[160:163], a[104:107], 0
ds_read_b64_tr_b16 a[180:181], v23 offset:21664
v_mfma_f32_16x16x32_bf16 v[196:199], a[164:167], a[108:111], v[196:199]
ds_read_b64_tr_b16 a[182:183], v23 offset:23456
v_mfma_f32_16x16x32_bf16 v[200:203], a[160:163], a[112:115], 0
ds_read_b128 a[144:147], v19 offset:36864
buffer_load_dwordx4 v15, s[32:35], s45 offen offset:3072 lds
v_mfma_f32_16x16x32_bf16 v[200:203], a[164:167], a[116:119], v[200:203]
ds_read_b128 a[148:151], v20 offset:36864
v_mfma_f32_16x16x32_bf16 v[204:207], a[160:163], a[120:123], 0
ds_read_b128 a[152:155], v19 offset:38912
v_mfma_f32_16x16x32_bf16 v[204:207], a[164:167], a[124:127], v[204:207]
ds_read_b128 a[156:159], v20 offset:38912
s_waitcnt lgkmcnt(12)
v_mfma_f32_16x16x32_bf16 v[220:223], a[168:171], a[120:123], 0
ds_read_b64_tr_b16 a[184:185], v23 offset:14528
v_mfma_f32_16x16x32_bf16 v[220:223], a[172:175], a[124:127], v[220:223]
ds_read_b64_tr_b16 a[186:187], v23 offset:16320
v_mfma_f32_16x16x32_bf16 v[216:219], a[168:171], a[112:115], 0
ds_read_b64_tr_b16 a[188:189], v23 offset:21696
v_mfma_f32_16x16x32_bf16 v[216:219], a[172:175], a[116:119], v[216:219]
ds_read_b64_tr_b16 a[190:191], v23 offset:23488
s_add_u32 m0, s49, 45056
v_mfma_f32_16x16x32_bf16 v[212:215], a[168:171], a[104:107], 0
buffer_load_dwordx4 v16, s[32:35], s45 offen offset:0 lds
v_mfma_f32_16x16x32_bf16 v[212:215], a[172:175], a[108:111], v[212:215]
v_mfma_f32_16x16x32_bf16 v[208:211], a[168:171], a[96:99], 0
v_mfma_f32_16x16x32_bf16 v[208:211], a[172:175], a[100:103], v[208:211]
s_waitcnt vmcnt(11) lgkmcnt(0)
s_barrier
v_mfma_f32_16x16x32_bf16 v[224:227], a[176:179], a[96:99], 0
ds_read_b64_tr_b16 a[160:161], v21 offset:40960
v_mfma_f32_16x16x32_bf16 v[224:227], a[180:183], a[100:103], v[224:227]
ds_read_b64_tr_b16 a[162:163], v21 offset:41728
v_mfma_f32_16x16x32_bf16 v[228:231], a[176:179], a[104:107], 0
ds_read_b64_tr_b16 a[164:165], v21 offset:47104
v_mfma_f32_16x16x32_bf16 v[228:231], a[180:183], a[108:111], v[228:231]
ds_read_b64_tr_b16 a[166:167], v21 offset:47872
v_mfma_f32_16x16x32_bf16 v[232:235], a[176:179], a[112:115], 0
buffer_load_dwordx4 v17, s[32:35], s45 offen offset:1024 lds
v_mfma_f32_16x16x32_bf16 v[232:235], a[180:183], a[116:119], v[232:235]
v_mfma_f32_16x16x32_bf16 v[236:239], a[176:179], a[120:123], 0
v_mfma_f32_16x16x32_bf16 v[236:239], a[180:183], a[124:127], v[236:239]
v_mfma_f32_16x16x32_bf16 v[252:255], a[184:187], a[120:123], 0
ds_read_b64_tr_b16 a[168:169], v22 offset:40960
v_mfma_f32_16x16x32_bf16 v[252:255], a[188:191], a[124:127], v[252:255]
ds_read_b64_tr_b16 a[170:171], v22 offset:41728
v_mfma_f32_16x16x32_bf16 v[248:251], a[184:187], a[112:115], 0
ds_read_b64_tr_b16 a[172:173], v22 offset:47104
v_mfma_f32_16x16x32_bf16 v[248:251], a[188:191], a[116:119], v[248:251]
ds_read_b64_tr_b16 a[174:175], v22 offset:47872
v_mfma_f32_16x16x32_bf16 v[244:247], a[184:187], a[104:107], 0
buffer_load_dwordx4 v18, s[32:35], s45 offen offset:2048 lds
s_add_u32 s45, s45, 458752
v_mfma_f32_16x16x32_bf16 v[244:247], a[188:191], a[108:111], v[244:247]
v_mfma_f32_16x16x32_bf16 v[240:243], a[184:187], a[96:99], 0
v_mfma_f32_16x16x32_bf16 v[240:243], a[188:191], a[100:103], v[240:243]
s_waitcnt lgkmcnt(4)
v_mfma_f32_16x16x32_bf16 a[0:3], a[160:163], a[128:131], a[0:3]
ds_read_b64_tr_b16 a[176:177], v21 offset:41024
v_mfma_f32_16x16x32_bf16 a[0:3], a[164:167], a[132:135], a[0:3]
ds_read_b64_tr_b16 a[178:179], v21 offset:41792
v_mfma_f32_16x16x32_bf16 a[4:7], a[160:163], a[136:139], a[4:7]
ds_read_b64_tr_b16 a[180:181], v21 offset:47168
v_mfma_f32_16x16x32_bf16 a[4:7], a[164:167], a[140:143], a[4:7]
ds_read_b64_tr_b16 a[182:183], v21 offset:47936
s_add_u32 m0, s47, 0
v_mfma_f32_16x16x32_bf16 a[8:11], a[160:163], a[144:147], a[8:11]
buffer_load_dwordx4 v1, s[24:27], s43 offen offset:0 lds
v_mfma_f32_16x16x32_bf16 a[8:11], a[164:167], a[148:151], a[8:11]
v_mfma_f32_16x16x32_bf16 a[12:15], a[160:163], a[152:155], a[12:15]
buffer_load_dwordx4 v2, s[24:27], s43 offen offset:1024 lds
v_mfma_f32_16x16x32_bf16 a[12:15], a[164:167], a[156:159], a[12:15]
s_waitcnt lgkmcnt(4)
v_mfma_f32_16x16x32_bf16 a[28:31], a[168:171], a[152:155], a[28:31]
ds_read_b64_tr_b16 a[184:185], v22 offset:41024
v_mfma_f32_16x16x32_bf16 a[28:31], a[172:175], a[156:159], a[28:31]
ds_read_b64_tr_b16 a[186:187], v22 offset:41792
v_mfma_f32_16x16x32_bf16 a[24:27], a[168:171], a[144:147], a[24:27]
ds_read_b64_tr_b16 a[188:189], v22 offset:47168
v_mfma_f32_16x16x32_bf16 a[24:27], a[172:175], a[148:151], a[24:27]
ds_read_b64_tr_b16 a[190:191], v22 offset:47936
v_mfma_f32_16x16x32_bf16 a[20:23], a[168:171], a[136:139], a[20:23]
buffer_load_dwordx4 v3, s[24:27], s43 offen offset:2048 lds
v_mfma_f32_16x16x32_bf16 a[20:23], a[172:175], a[140:143], a[20:23]
s_waitcnt vmcnt(13)
v_mfma_f32_16x16x32_bf16 a[244:247], a[240:243], a[200:203], a[244:247]
v_mfma_f32_16x16x32_bf16 a[16:19], a[168:171], a[128:131], a[16:19]
v_mfma_f32_16x16x32_bf16 a[16:19], a[172:175], a[132:135], a[16:19]
s_waitcnt lgkmcnt(4)
v_mfma_f32_16x16x32_bf16 a[32:35], a[176:179], a[128:131], a[32:35]
ds_read_b64_tr_b16 a[160:161], v21 offset:41088
v_mfma_f32_16x16x32_bf16 a[32:35], a[180:183], a[132:135], a[32:35]
ds_read_b64_tr_b16 a[162:163], v21 offset:41856
v_mfma_f32_16x16x32_bf16 a[36:39], a[176:179], a[136:139], a[36:39]
ds_read_b64_tr_b16 a[164:165], v21 offset:47232
v_mfma_f32_16x16x32_bf16 a[36:39], a[180:183], a[140:143], a[36:39]
ds_read_b64_tr_b16 a[166:167], v21 offset:48000
v_mfma_f32_16x16x32_bf16 a[40:43], a[176:179], a[144:147], a[40:43]
buffer_load_dwordx4 v4, s[24:27], s43 offen offset:3072 lds
v_mfma_f32_16x16x32_bf16 a[40:43], a[180:183], a[148:151], a[40:43]
v_mfma_f32_16x16x32_bf16 a[44:47], a[176:179], a[152:155], a[44:47]
v_mfma_f32_16x16x32_bf16 a[44:47], a[180:183], a[156:159], a[44:47]
s_waitcnt lgkmcnt(4)
v_mfma_f32_16x16x32_bf16 a[60:63], a[184:187], a[152:155], a[60:63]
ds_read_b64_tr_b16 a[168:169], v22 offset:41088
v_mfma_f32_16x16x32_bf16 a[60:63], a[188:191], a[156:159], a[60:63]
ds_read_b64_tr_b16 a[170:171], v22 offset:41856
v_mfma_f32_16x16x32_bf16 a[56:59], a[184:187], a[144:147], a[56:59]
ds_read_b64_tr_b16 a[172:173], v22 offset:47232
v_mfma_f32_16x16x32_bf16 a[56:59], a[188:191], a[148:151], a[56:59]
ds_read_b64_tr_b16 a[174:175], v22 offset:48000
s_add_u32 m0, s47, 4096
v_mfma_f32_16x16x32_bf16 a[52:55], a[184:187], a[136:139], a[52:55]
buffer_load_dwordx4 v5, s[24:27], s43 offen offset:0 lds
v_mfma_f32_16x16x32_bf16 a[52:55], a[188:191], a[140:143], a[52:55]
s_waitcnt vmcnt(14)
v_mfma_f32_16x16x32_bf16 a[244:247], a[240:243], a[204:207], a[244:247]
v_mfma_f32_16x16x32_bf16 a[48:51], a[184:187], a[128:131], a[48:51]
buffer_load_dwordx4 v6, s[24:27], s43 offen offset:1024 lds
v_mfma_f32_16x16x32_bf16 a[48:51], a[188:191], a[132:135], a[48:51]
s_waitcnt vmcnt(6) lgkmcnt(0)
s_barrier
v_mfma_f32_16x16x32_bf16 a[64:67], a[128:131], a[160:163], a[64:67]
ds_read_b64_tr_b16 a[176:177], v23 offset:40960
v_mfma_f32_16x16x32_bf16 a[64:67], a[132:135], a[164:167], a[64:67]
ds_read_b64_tr_b16 a[178:179], v23 offset:42752
v_mfma_f32_16x16x32_bf16 a[68:71], a[136:139], a[160:163], a[68:71]
ds_read_b64_tr_b16 a[180:181], v23 offset:48128
v_mfma_f32_16x16x32_bf16 a[68:71], a[140:143], a[164:167], a[68:71]
ds_read_b64_tr_b16 a[182:183], v23 offset:49920
v_mfma_f32_16x16x32_bf16 a[72:75], a[144:147], a[160:163], a[72:75]
buffer_load_dwordx4 v7, s[24:27], s43 offen offset:2048 lds
v_mfma_f32_16x16x32_bf16 a[72:75], a[148:151], a[164:167], a[72:75]
v_mfma_f32_16x16x32_bf16 a[76:79], a[152:155], a[160:163], a[76:79]
v_mfma_f32_16x16x32_bf16 a[76:79], a[156:159], a[164:167], a[76:79]
v_mfma_f32_16x16x32_bf16 a[92:95], a[152:155], a[168:171], a[92:95]
ds_read_b64_tr_b16 a[184:185], v23 offset:40992
v_mfma_f32_16x16x32_bf16 a[92:95], a[156:159], a[172:175], a[92:95]
ds_read_b64_tr_b16 a[186:187], v23 offset:42784
v_mfma_f32_16x16x32_bf16 a[88:91], a[144:147], a[168:171], a[88:91]
ds_read_b64_tr_b16 a[188:189], v23 offset:48160
v_mfma_f32_16x16x32_bf16 a[88:91], a[148:151], a[172:175], a[88:91]
ds_read_b64_tr_b16 a[190:191], v23 offset:49952
v_mfma_f32_16x16x32_bf16 a[84:87], a[136:139], a[168:171], a[84:87]
buffer_load_dwordx4 v8, s[24:27], s43 offen offset:3072 lds
s_add_u32 s43, s43, 128
v_mfma_f32_16x16x32_bf16 a[84:87], a[140:143], a[172:175], a[84:87]
v_mfma_f32_16x16x32_bf16 a[244:247], a[240:243], a[208:211], a[244:247]
v_mfma_f32_16x16x32_bf16 a[80:83], a[128:131], a[168:171], a[80:83]
v_mfma_f32_16x16x32_bf16 a[80:83], a[132:135], a[172:175], a[80:83]
s_waitcnt lgkmcnt(4)
v_mfma_f32_16x16x32_bf16 v[32:35], a[176:179], a[128:131], v[32:35]
ds_read_b64_tr_b16 a[160:161], v23 offset:41024
v_mfma_f32_16x16x32_bf16 v[32:35], a[180:183], a[132:135], v[32:35]
ds_read_b64_tr_b16 a[162:163], v23 offset:42816
v_mfma_f32_16x16x32_bf16 v[36:39], a[176:179], a[136:139], v[36:39]
ds_read_b64_tr_b16 a[164:165], v23 offset:48192
v_mfma_f32_16x16x32_bf16 v[36:39], a[180:183], a[140:143], v[36:39]
ds_read_b64_tr_b16 a[166:167], v23 offset:49984
s_add_u32 m0, s48, 0
v_mfma_f32_16x16x32_bf16 v[40:43], a[176:179], a[144:147], v[40:43]
buffer_load_dwordx4 v9, s[28:31], s44 offen offset:0 lds
v_mfma_f32_16x16x32_bf16 v[40:43], a[180:183], a[148:151], v[40:43]
v_mfma_f32_16x16x32_bf16 v[44:47], a[176:179], a[152:155], v[44:47]
v_mfma_f32_16x16x32_bf16 v[44:47], a[180:183], a[156:159], v[44:47]
s_waitcnt lgkmcnt(4)
v_mfma_f32_16x16x32_bf16 v[60:63], a[184:187], a[152:155], v[60:63]
ds_read_b64_tr_b16 a[168:169], v23 offset:41056
v_mfma_f32_16x16x32_bf16 v[60:63], a[188:191], a[156:159], v[60:63]
ds_read_b64_tr_b16 a[170:171], v23 offset:42848
v_mfma_f32_16x16x32_bf16 v[56:59], a[184:187], a[144:147], v[56:59]
ds_read_b64_tr_b16 a[172:173], v23 offset:48224
v_mfma_f32_16x16x32_bf16 v[56:59], a[188:191], a[148:151], v[56:59]
ds_read_b64_tr_b16 a[174:175], v23 offset:50016
v_mfma_f32_16x16x32_bf16 v[52:55], a[184:187], a[136:139], v[52:55]
buffer_load_dwordx4 v10, s[28:31], s44 offen offset:1024 lds
v_mfma_f32_16x16x32_bf16 v[52:55], a[188:191], a[140:143], v[52:55]
v_mfma_f32_16x16x32_bf16 v[48:51], a[184:187], a[128:131], v[48:51]
v_mfma_f32_16x16x32_bf16 v[48:51], a[188:191], a[132:135], v[48:51]
s_waitcnt lgkmcnt(4)
v_mfma_f32_16x16x32_bf16 v[64:67], a[160:163], a[128:131], v[64:67]
ds_read_b64_tr_b16 a[176:177], v23 offset:41088
v_mfma_f32_16x16x32_bf16 v[64:67], a[164:167], a[132:135], v[64:67]
ds_read_b64_tr_b16 a[178:179], v23 offset:42880
v_mfma_f32_16x16x32_bf16 v[68:71], a[160:163], a[136:139], v[68:71]
ds_read_b64_tr_b16 a[180:181], v23 offset:48256
v_mfma_f32_16x16x32_bf16 v[68:71], a[164:167], a[140:143], v[68:71]
ds_read_b64_tr_b16 a[182:183], v23 offset:50048
v_mfma_f32_16x16x32_bf16 v[72:75], a[160:163], a[144:147], v[72:75]
buffer_load_dwordx4 v11, s[28:31], s44 offen offset:2048 lds
s_add_u32 s44, s44, 393216
v_mfma_f32_16x16x32_bf16 v[72:75], a[164:167], a[148:151], v[72:75]
v_mfma_f32_16x16x32_bf16 v[76:79], a[160:163], a[152:155], v[76:79]
v_mfma_f32_16x16x32_bf16 v[76:79], a[164:167], a[156:159], v[76:79]
s_waitcnt lgkmcnt(4)
v_mfma_f32_16x16x32_bf16 v[92:95], a[168:171], a[152:155], v[92:95]
ds_read_b64_tr_b16 a[184:185], v23 offset:41120
v_mfma_f32_16x16x32_bf16 v[92:95], a[172:175], a[156:159], v[92:95]
ds_read_b64_tr_b16 a[186:187], v23 offset:42912
v_mfma_f32_16x16x32_bf16 v[88:91], a[168:171], a[144:147], v[88:91]
ds_read_b64_tr_b16 a[188:189], v23 offset:48288
v_mfma_f32_16x16x32_bf16 v[88:91], a[172:175], a[148:151], v[88:91]
ds_read_b64_tr_b16 a[190:191], v23 offset:50080
s_add_u32 m0, s49, 0
v_mfma_f32_16x16x32_bf16 v[84:87], a[168:171], a[136:139], v[84:87]
buffer_load_dwordx4 v12, s[32:35], s45 offen offset:0 lds
v_mfma_f32_16x16x32_bf16 v[84:87], a[172:175], a[140:143], v[84:87]
v_mfma_f32_16x16x32_bf16 a[244:247], a[240:243], a[212:215], a[244:247]
v_mfma_f32_16x16x32_bf16 v[80:83], a[168:171], a[128:131], v[80:83]
v_mfma_f32_16x16x32_bf16 v[80:83], a[172:175], a[132:135], v[80:83]
s_waitcnt lgkmcnt(4)
v_mfma_f32_16x16x32_bf16 v[96:99], a[176:179], a[128:131], v[96:99]
ds_read_b64_tr_b16 a[160:161], v23 offset:41152
v_mfma_f32_16x16x32_bf16 v[96:99], a[180:183], a[132:135], v[96:99]
ds_read_b64_tr_b16 a[162:163], v23 offset:42944
v_mfma_f32_16x16x32_bf16 v[100:103], a[176:179], a[136:139], v[100:103]
ds_read_b64_tr_b16 a[164:165], v23 offset:48320
v_mfma_f32_16x16x32_bf16 v[100:103], a[180:183], a[140:143], v[100:103]
ds_read_b64_tr_b16 a[166:167], v23 offset:50112
v_mfma_f32_16x16x32_bf16 v[104:107], a[176:179], a[144:147], v[104:107]
buffer_load_dwordx4 v13, s[32:35], s45 offen offset:1024 lds
v_mfma_f32_16x16x32_bf16 v[104:107], a[180:183], a[148:151], v[104:107]
v_mfma_f32_16x16x32_bf16 v[108:111], a[176:179], a[152:155], v[108:111]
v_mfma_f32_16x16x32_bf16 v[108:111], a[180:183], a[156:159], v[108:111]
s_waitcnt lgkmcnt(4)
v_mfma_f32_16x16x32_bf16 v[124:127], a[184:187], a[152:155], v[124:127]
ds_read_b64_tr_b16 a[168:169], v23 offset:55296
v_mfma_f32_16x16x32_bf16 v[124:127], a[188:191], a[156:159], v[124:127]
ds_read_b64_tr_b16 a[170:171], v23 offset:57088
v_mfma_f32_16x16x32_bf16 v[120:123], a[184:187], a[144:147], v[120:123]
ds_read_b64_tr_b16 a[172:173], v23 offset:62464
v_mfma_f32_16x16x32_bf16 v[120:123], a[188:191], a[148:151], v[120:123]
ds_read_b64_tr_b16 a[174:175], v23 offset:64256
v_mfma_f32_16x16x32_bf16 v[116:119], a[184:187], a[136:139], v[116:119]
buffer_load_dwordx4 v14, s[32:35], s45 offen offset:2048 lds
v_mfma_f32_16x16x32_bf16 v[116:119], a[188:191], a[140:143], v[116:119]
v_mfma_f32_16x16x32_bf16 v[112:115], a[184:187], a[128:131], v[112:115]
v_mfma_f32_16x16x32_bf16 v[112:115], a[188:191], a[132:135], v[112:115]
s_waitcnt lgkmcnt(4)
v_mfma_f32_16x16x32_bf16 v[128:131], a[160:163], a[128:131], v[128:131]
ds_read_b64_tr_b16 a[176:177], v23 offset:55328
buffer_load_dwordx4 a[216:219], v24, s[56:59], s55 offen
v_mfma_f32_16x16x32_bf16 v[128:131], a[164:167], a[132:135], v[128:131]
ds_read_b64_tr_b16 a[178:179], v23 offset:57120
s_add_u32 s55, s55, s54
v_mfma_f32_16x16x32_bf16 v[132:135], a[160:163], a[136:139], v[132:135]
ds_read_b64_tr_b16 a[180:181], v23 offset:62496
buffer_load_dwordx4 a[220:223], v24, s[56:59], s55 offen
v_mfma_f32_16x16x32_bf16 v[132:135], a[164:167], a[140:143], v[132:135]
ds_read_b64_tr_b16 a[182:183], v23 offset:64288
s_add_u32 s55, s55, s54
v_mfma_f32_16x16x32_bf16 v[136:139], a[160:163], a[144:147], v[136:139]
buffer_load_dwordx4 v15, s[32:35], s45 offen offset:3072 lds
buffer_load_dwordx4 a[224:227], v24, s[56:59], s55 offen
v_mfma_f32_16x16x32_bf16 v[136:139], a[164:167], a[148:151], v[136:139]
s_add_u32 s55, s55, s54
buffer_load_dwordx4 a[228:231], v24, s[56:59], s55 offen
v_mfma_f32_16x16x32_bf16 v[140:143], a[160:163], a[152:155], v[140:143]
s_add_u32 s55, s55, s54
v_mfma_f32_16x16x32_bf16 v[140:143], a[164:167], a[156:159], v[140:143]
s_waitcnt lgkmcnt(4)
v_mfma_f32_16x16x32_bf16 v[156:159], a[168:171], a[152:155], v[156:159]
ds_read_b64_tr_b16 a[184:185], v23 offset:55360
v_mfma_f32_16x16x32_bf16 v[156:159], a[172:175], a[156:159], v[156:159]
ds_read_b64_tr_b16 a[186:187], v23 offset:57152
v_mfma_f32_16x16x32_bf16 v[152:155], a[168:171], a[144:147], v[152:155]
ds_read_b64_tr_b16 a[188:189], v23 offset:62528
v_mfma_f32_16x16x32_bf16 v[152:155], a[172:175], a[148:151], v[152:155]
ds_read_b64_tr_b16 a[190:191], v23 offset:64320
s_add_u32 m0, s49, 4096
v_mfma_f32_16x16x32_bf16 v[148:151], a[168:171], a[136:139], v[148:151]
buffer_load_dwordx4 v16, s[32:35], s45 offen offset:0 lds
v_mfma_f32_16x16x32_bf16 v[148:151], a[172:175], a[140:143], v[148:151]
v_mfma_f32_16x16x32_bf16 v[144:147], a[168:171], a[128:131], v[144:147]
v_mfma_f32_16x16x32_bf16 v[144:147], a[172:175], a[132:135], v[144:147]
s_waitcnt vmcnt(12)
s_waitcnt lgkmcnt(4)
v_mfma_f32_16x16x32_bf16 v[160:163], a[176:179], a[128:131], v[160:163]
ds_read_b64_tr_b16 a[160:161], v23 offset:55392
v_mfma_f32_16x16x32_bf16 v[160:163], a[180:183], a[132:135], v[160:163]
ds_read_b64_tr_b16 a[162:163], v23 offset:57184
v_mfma_f32_16x16x32_bf16 v[164:167], a[176:179], a[136:139], v[164:167]
ds_read_b64_tr_b16 a[164:165], v23 offset:62560
v_mfma_f32_16x16x32_bf16 v[164:167], a[180:183], a[140:143], v[164:167]
ds_read_b64_tr_b16 a[166:167], v23 offset:64352
v_mfma_f32_16x16x32_bf16 v[168:171], a[176:179], a[144:147], v[168:171]
ds_read_b128 a[96:99], v19 offset:0
buffer_load_dwordx4 v17, s[32:35], s45 offen offset:1024 lds
v_mfma_f32_16x16x32_bf16 v[168:171], a[180:183], a[148:151], v[168:171]
ds_read_b128 a[100:103], v20 offset:0
v_mfma_f32_16x16x32_bf16 v[172:175], a[176:179], a[152:155], v[172:175]
ds_read_b128 a[104:107], v19 offset:2048
v_mfma_f32_16x16x32_bf16 v[172:175], a[180:183], a[156:159], v[172:175]
ds_read_b128 a[108:111], v20 offset:2048
s_waitcnt lgkmcnt(8)
v_mfma_f32_16x16x32_bf16 v[188:191], a[184:187], a[152:155], v[188:191]
ds_read_b64_tr_b16 a[168:169], v23 offset:55424
v_mfma_f32_16x16x32_bf16 v[188:191], a[188:191], a[156:159], v[188:191]
ds_read_b64_tr_b16 a[170:171], v23 offset:57216
v_mfma_f32_16x16x32_bf16 v[184:187], a[184:187], a[144:147], v[184:187]
ds_read_b64_tr_b16 a[172:173], v23 offset:62592
v_mfma_f32_16x16x32_bf16 v[184:187], a[188:191], a[148:151], v[184:187]
ds_read_b64_tr_b16 a[174:175], v23 offset:64384
v_mfma_f32_16x16x32_bf16 v[180:183], a[184:187], a[136:139], v[180:183]
ds_read_b128 a[112:115], v19 offset:4096
buffer_load_dwordx4 v18, s[32:35], s45 offen offset:2048 lds
s_add_u32 s45, s45, 458752
v_mfma_f32_16x16x32_bf16 v[180:183], a[188:191], a[140:143], v[180:183]
ds_read_b128 a[116:119], v20 offset:4096
v_mfma_f32_16x16x32_bf16 v[176:179], a[184:187], a[128:131], v[176:179]
ds_read_b128 a[120:123], v19 offset:6144
v_mfma_f32_16x16x32_bf16 v[176:179], a[188:191], a[132:135], v[176:179]
ds_read_b128 a[124:127], v20 offset:6144
s_waitcnt lgkmcnt(12)
v_mfma_f32_16x16x32_bf16 v[192:195], a[160:163], a[128:131], v[192:195]
ds_read_b64_tr_b16 a[176:177], v23 offset:55456
v_mfma_f32_16x16x32_bf16 v[192:195], a[164:167], a[132:135], v[192:195]
ds_read_b64_tr_b16 a[178:179], v23 offset:57248
v_mfma_f32_16x16x32_bf16 v[196:199], a[160:163], a[136:139], v[196:199]
ds_read_b64_tr_b16 a[180:181], v23 offset:62624
v_mfma_f32_16x16x32_bf16 v[196:199], a[164:167], a[140:143], v[196:199]
ds_read_b64_tr_b16 a[182:183], v23 offset:64416
v_mfma_f32_16x16x32_bf16 v[200:203], a[160:163], a[144:147], v[200:203]
v_mfma_f32_16x16x32_bf16 v[200:203], a[164:167], a[148:151], v[200:203]
v_mfma_f32_16x16x32_bf16 v[204:207], a[160:163], a[152:155], v[204:207]
v_mfma_f32_16x16x32_bf16 v[204:207], a[164:167], a[156:159], v[204:207]
s_waitcnt lgkmcnt(8)
v_mfma_f32_16x16x32_bf16 v[220:223], a[168:171], a[152:155], v[220:223]
ds_read_b64_tr_b16 a[184:185], v23 offset:55488
v_mfma_f32_16x16x32_bf16 v[220:223], a[172:175], a[156:159], v[220:223]
ds_read_b64_tr_b16 a[186:187], v23 offset:57280
v_mfma_f32_16x16x32_bf16 v[216:219], a[168:171], a[144:147], v[216:219]
ds_read_b64_tr_b16 a[188:189], v23 offset:62656
v_mfma_f32_16x16x32_bf16 v[216:219], a[172:175], a[148:151], v[216:219]
ds_read_b64_tr_b16 a[190:191], v23 offset:64448
s_add_u32 m0, s48, 40960
v_mfma_f32_16x16x32_bf16 v[212:215], a[168:171], a[136:139], v[212:215]
buffer_load_dwordx4 v9, s[28:31], s44 offen offset:0 lds
v_mfma_f32_16x16x32_bf16 v[212:215], a[172:175], a[140:143], v[212:215]
v_mfma_f32_16x16x32_bf16 v[208:211], a[168:171], a[128:131], v[208:211]
v_mfma_f32_16x16x32_bf16 v[208:211], a[172:175], a[132:135], v[208:211]
s_waitcnt vmcnt(12) lgkmcnt(0)
s_barrier
v_mfma_f32_16x16x32_bf16 v[224:227], a[176:179], a[128:131], v[224:227]
ds_read_b64_tr_b16 a[160:161], v21 offset:0
v_mfma_f32_16x16x32_bf16 v[224:227], a[180:183], a[132:135], v[224:227]
ds_read_b64_tr_b16 a[162:163], v21 offset:768
v_mfma_f32_16x16x32_bf16 v[228:231], a[176:179], a[136:139], v[228:231]
ds_read_b64_tr_b16 a[164:165], v21 offset:6144
v_mfma_f32_16x16x32_bf16 v[228:231], a[180:183], a[140:143], v[228:231]
ds_read_b64_tr_b16 a[166:167], v21 offset:6912
v_mfma_f32_16x16x32_bf16 v[232:235], a[176:179], a[144:147], v[232:235]
buffer_load_dwordx4 v10, s[28:31], s44 offen offset:1024 lds
v_mfma_f32_16x16x32_bf16 v[232:235], a[180:183], a[148:151], v[232:235]
v_mfma_f32_16x16x32_bf16 v[236:239], a[176:179], a[152:155], v[236:239]
v_mfma_f32_16x16x32_bf16 v[236:239], a[180:183], a[156:159], v[236:239]
v_mfma_f32_16x16x32_bf16 v[252:255], a[184:187], a[152:155], v[252:255]
ds_read_b64_tr_b16 a[168:169], v22 offset:0
v_mfma_f32_16x16x32_bf16 v[252:255], a[188:191], a[156:159], v[252:255]
ds_read_b64_tr_b16 a[170:171], v22 offset:768
v_mfma_f32_16x16x32_bf16 v[248:251], a[184:187], a[144:147], v[248:251]
ds_read_b64_tr_b16 a[172:173], v22 offset:6144
v_mfma_f32_16x16x32_bf16 v[248:251], a[188:191], a[148:151], v[248:251]
ds_read_b64_tr_b16 a[174:175], v22 offset:6912
v_mfma_f32_16x16x32_bf16 v[244:247], a[184:187], a[136:139], v[244:247]
buffer_load_dwordx4 v11, s[28:31], s44 offen offset:2048 lds
s_add_u32 s44, s44, 393216
v_mfma_f32_16x16x32_bf16 v[244:247], a[188:191], a[140:143], v[244:247]
v_mfma_f32_16x16x32_bf16 v[240:243], a[184:187], a[128:131], v[240:243]
v_mfma_f32_16x16x32_bf16 v[240:243], a[188:191], a[132:135], v[240:243]
s_waitcnt lgkmcnt(4)
v_mfma_f32_16x16x32_bf16 a[0:3], a[160:163], a[96:99], a[0:3]
ds_read_b64_tr_b16 a[176:177], v21 offset:64
v_mfma_f32_16x16x32_bf16 a[0:3], a[164:167], a[100:103], a[0:3]
ds_read_b64_tr_b16 a[178:179], v21 offset:832
v_mfma_f32_16x16x32_bf16 a[4:7], a[160:163], a[104:107], a[4:7]
ds_read_b64_tr_b16 a[180:181], v21 offset:6208
v_mfma_f32_16x16x32_bf16 a[4:7], a[164:167], a[108:111], a[4:7]
ds_read_b64_tr_b16 a[182:183], v21 offset:6976
s_add_u32 m0, s47, 32768
v_mfma_f32_16x16x32_bf16 a[8:11], a[160:163], a[112:115], a[8:11]
buffer_load_dwordx4 v1, s[24:27], s43 offen offset:0 lds
v_mfma_f32_16x16x32_bf16 a[8:11], a[164:167], a[116:119], a[8:11]
v_mfma_f32_16x16x32_bf16 a[12:15], a[160:163], a[120:123], a[12:15]
buffer_load_dwordx4 v2, s[24:27], s43 offen offset:1024 lds
v_mfma_f32_16x16x32_bf16 a[12:15], a[164:167], a[124:127], a[12:15]
s_waitcnt lgkmcnt(4)
v_mfma_f32_16x16x32_bf16 a[28:31], a[168:171], a[120:123], a[28:31]
ds_read_b64_tr_b16 a[184:185], v22 offset:64
v_mfma_f32_16x16x32_bf16 a[28:31], a[172:175], a[124:127], a[28:31]
ds_read_b64_tr_b16 a[186:187], v22 offset:832
v_mfma_f32_16x16x32_bf16 a[24:27], a[168:171], a[112:115], a[24:27]
ds_read_b64_tr_b16 a[188:189], v22 offset:6208
v_mfma_f32_16x16x32_bf16 a[24:27], a[172:175], a[116:119], a[24:27]
ds_read_b64_tr_b16 a[190:191], v22 offset:6976
v_mfma_f32_16x16x32_bf16 a[20:23], a[168:171], a[104:107], a[20:23]
buffer_load_dwordx4 v3, s[24:27], s43 offen offset:2048 lds
v_mfma_f32_16x16x32_bf16 a[20:23], a[172:175], a[108:111], a[20:23]
s_waitcnt vmcnt(13)
v_mfma_f32_16x16x32_bf16 a[244:247], a[240:243], a[216:219], a[244:247]
v_mfma_f32_16x16x32_bf16 a[16:19], a[168:171], a[96:99], a[16:19]
buffer_load_dwordx4 v4, s[24:27], s43 offen offset:3072 lds
v_mfma_f32_16x16x32_bf16 a[16:19], a[172:175], a[100:103], a[16:19]
s_waitcnt lgkmcnt(4)
v_mfma_f32_16x16x32_bf16 a[32:35], a[176:179], a[96:99], a[32:35]
ds_read_b64_tr_b16 a[160:161], v21 offset:128
v_mfma_f32_16x16x32_bf16 a[32:35], a[180:183], a[100:103], a[32:35]
ds_read_b64_tr_b16 a[162:163], v21 offset:896
v_mfma_f32_16x16x32_bf16 a[36:39], a[176:179], a[104:107], a[36:39]
ds_read_b64_tr_b16 a[164:165], v21 offset:6272
v_mfma_f32_16x16x32_bf16 a[36:39], a[180:183], a[108:111], a[36:39]
ds_read_b64_tr_b16 a[166:167], v21 offset:7040
s_add_u32 m0, s47, 36864
v_mfma_f32_16x16x32_bf16 a[40:43], a[176:179], a[112:115], a[40:43]
buffer_load_dwordx4 v5, s[24:27], s43 offen offset:0 lds
v_mfma_f32_16x16x32_bf16 a[40:43], a[180:183], a[116:119], a[40:43]
v_mfma_f32_16x16x32_bf16 a[44:47], a[176:179], a[120:123], a[44:47]
v_mfma_f32_16x16x32_bf16 a[44:47], a[180:183], a[124:127], a[44:47]
s_waitcnt lgkmcnt(4)
v_mfma_f32_16x16x32_bf16 a[60:63], a[184:187], a[120:123], a[60:63]
ds_read_b64_tr_b16 a[168:169], v22 offset:128
v_mfma_f32_16x16x32_bf16 a[60:63], a[188:191], a[124:127], a[60:63]
ds_read_b64_tr_b16 a[170:171], v22 offset:896
v_mfma_f32_16x16x32_bf16 a[56:59], a[184:187], a[112:115], a[56:59]
ds_read_b64_tr_b16 a[172:173], v22 offset:6272
v_mfma_f32_16x16x32_bf16 a[56:59], a[188:191], a[116:119], a[56:59]
ds_read_b64_tr_b16 a[174:175], v22 offset:7040
v_mfma_f32_16x16x32_bf16 a[52:55], a[184:187], a[104:107], a[52:55]
buffer_load_dwordx4 v6, s[24:27], s43 offen offset:1024 lds
v_mfma_f32_16x16x32_bf16 a[52:55], a[188:191], a[108:111], a[52:55]
s_waitcnt vmcnt(15)
v_mfma_f32_16x16x32_bf16 a[244:247], a[240:243], a[220:223], a[244:247]
v_mfma_f32_16x16x32_bf16 a[48:51], a[184:187], a[96:99], a[48:51]
buffer_load_dwordx4 v7, s[24:27], s43 offen offset:2048 lds
v_mfma_f32_16x16x32_bf16 a[48:51], a[188:191], a[100:103], a[48:51]
s_waitcnt vmcnt(10) lgkmcnt(0)
s_barrier
v_mfma_f32_16x16x32_bf16 a[64:67], a[96:99], a[160:163], a[64:67]
ds_read_b64_tr_b16 a[176:177], v23 offset:0
v_mfma_f32_16x16x32_bf16 a[64:67], a[100:103], a[164:167], a[64:67]
ds_read_b64_tr_b16 a[178:179], v23 offset:1792
v_mfma_f32_16x16x32_bf16 a[68:71], a[104:107], a[160:163], a[68:71]
ds_read_b64_tr_b16 a[180:181], v23 offset:7168
v_mfma_f32_16x16x32_bf16 a[68:71], a[108:111], a[164:167], a[68:71]
ds_read_b64_tr_b16 a[182:183], v23 offset:8960
v_mfma_f32_16x16x32_bf16 a[72:75], a[112:115], a[160:163], a[72:75]
buffer_load_dwordx4 v8, s[24:27], s43 offen offset:3072 lds
s_add_u32 s43, s43, 128
v_mfma_f32_16x16x32_bf16 a[72:75], a[116:119], a[164:167], a[72:75]
v_mfma_f32_16x16x32_bf16 a[76:79], a[120:123], a[160:163], a[76:79]
v_mfma_f32_16x16x32_bf16 a[76:79], a[124:127], a[164:167], a[76:79]
v_mfma_f32_16x16x32_bf16 a[92:95], a[120:123], a[168:171], a[92:95]
ds_read_b64_tr_b16 a[184:185], v23 offset:32
v_mfma_f32_16x16x32_bf16 a[92:95], a[124:127], a[172:175], a[92:95]
ds_read_b64_tr_b16 a[186:187], v23 offset:1824
v_mfma_f32_16x16x32_bf16 a[88:91], a[112:115], a[168:171], a[88:91]
ds_read_b64_tr_b16 a[188:189], v23 offset:7200
v_mfma_f32_16x16x32_bf16 a[88:91], a[116:119], a[172:175], a[88:91]
ds_read_b64_tr_b16 a[190:191], v23 offset:8992
s_add_u32 m0, s49, 40960
v_mfma_f32_16x16x32_bf16 a[84:87], a[104:107], a[168:171], a[84:87]
buffer_load_dwordx4 v12, s[32:35], s45 offen offset:0 lds
v_mfma_f32_16x16x32_bf16 a[84:87], a[108:111], a[172:175], a[84:87]
v_mfma_f32_16x16x32_bf16 a[244:247], a[240:243], a[224:227], a[244:247]
v_mfma_f32_16x16x32_bf16 a[80:83], a[96:99], a[168:171], a[80:83]
buffer_load_dwordx4 v13, s[32:35], s45 offen offset:1024 lds
v_mfma_f32_16x16x32_bf16 a[80:83], a[100:103], a[172:175], a[80:83]
s_waitcnt lgkmcnt(4)
v_mfma_f32_16x16x32_bf16 v[32:35], a[176:179], a[96:99], v[32:35]
ds_read_b64_tr_b16 a[160:161], v23 offset:64
v_mfma_f32_16x16x32_bf16 v[32:35], a[180:183], a[100:103], v[32:35]
ds_read_b64_tr_b16 a[162:163], v23 offset:1856
v_mfma_f32_16x16x32_bf16 v[36:39], a[176:179], a[104:107], v[36:39]
ds_read_b64_tr_b16 a[164:165], v23 offset:7232
v_mfma_f32_16x16x32_bf16 v[36:39], a[180:183], a[108:111], v[36:39]
ds_read_b64_tr_b16 a[166:167], v23 offset:9024
v_mfma_f32_16x16x32_bf16 v[40:43], a[176:179], a[112:115], v[40:43]
buffer_load_dwordx4 v14, s[32:35], s45 offen offset:2048 lds
v_mfma_f32_16x16x32_bf16 v[40:43], a[180:183], a[116:119], v[40:43]
v_mfma_f32_16x16x32_bf16 v[44:47], a[176:179], a[120:123], v[44:47]
v_mfma_f32_16x16x32_bf16 v[44:47], a[180:183], a[124:127], v[44:47]
s_waitcnt lgkmcnt(4)
v_mfma_f32_16x16x32_bf16 v[60:63], a[184:187], a[120:123], v[60:63]
ds_read_b64_tr_b16 a[168:169], v23 offset:96
v_mfma_f32_16x16x32_bf16 v[60:63], a[188:191], a[124:127], v[60:63]
ds_read_b64_tr_b16 a[170:171], v23 offset:1888
v_mfma_f32_16x16x32_bf16 v[56:59], a[184:187], a[112:115], v[56:59]
ds_read_b64_tr_b16 a[172:173], v23 offset:7264
v_mfma_f32_16x16x32_bf16 v[56:59], a[188:191], a[116:119], v[56:59]
ds_read_b64_tr_b16 a[174:175], v23 offset:9056
v_mfma_f32_16x16x32_bf16 v[52:55], a[184:187], a[104:107], v[52:55]
buffer_load_dwordx4 v15, s[32:35], s45 offen offset:3072 lds
v_mfma_f32_16x16x32_bf16 v[52:55], a[188:191], a[108:111], v[52:55]
s_add_u32 m0, s49, 45056
v_mfma_f32_16x16x32_bf16 v[48:51], a[184:187], a[96:99], v[48:51]
buffer_load_dwordx4 v16, s[32:35], s45 offen offset:0 lds
v_mfma_f32_16x16x32_bf16 v[48:51], a[188:191], a[100:103], v[48:51]
s_waitcnt lgkmcnt(4)
v_mfma_f32_16x16x32_bf16 v[64:67], a[160:163], a[96:99], v[64:67]
ds_read_b64_tr_b16 a[176:177], v23 offset:128
v_mfma_f32_16x16x32_bf16 v[64:67], a[164:167], a[100:103], v[64:67]
ds_read_b64_tr_b16 a[178:179], v23 offset:1920
v_mfma_f32_16x16x32_bf16 v[68:71], a[160:163], a[104:107], v[68:71]
ds_read_b64_tr_b16 a[180:181], v23 offset:7296
v_mfma_f32_16x16x32_bf16 v[68:71], a[164:167], a[108:111], v[68:71]
ds_read_b64_tr_b16 a[182:183], v23 offset:9088
v_mfma_f32_16x16x32_bf16 v[72:75], a[160:163], a[112:115], v[72:75]
buffer_load_dwordx4 v17, s[32:35], s45 offen offset:1024 lds
v_mfma_f32_16x16x32_bf16 v[72:75], a[164:167], a[116:119], v[72:75]
v_mfma_f32_16x16x32_bf16 v[76:79], a[160:163], a[120:123], v[76:79]
v_mfma_f32_16x16x32_bf16 v[76:79], a[164:167], a[124:127], v[76:79]
s_waitcnt lgkmcnt(4)
v_mfma_f32_16x16x32_bf16 v[92:95], a[168:171], a[120:123], v[92:95]
ds_read_b64_tr_b16 a[184:185], v23 offset:160
v_mfma_f32_16x16x32_bf16 v[92:95], a[172:175], a[124:127], v[92:95]
ds_read_b64_tr_b16 a[186:187], v23 offset:1952
v_mfma_f32_16x16x32_bf16 v[88:91], a[168:171], a[112:115], v[88:91]
ds_read_b64_tr_b16 a[188:189], v23 offset:7328
v_mfma_f32_16x16x32_bf16 v[88:91], a[172:175], a[116:119], v[88:91]
ds_read_b64_tr_b16 a[190:191], v23 offset:9120
v_mfma_f32_16x16x32_bf16 v[84:87], a[168:171], a[104:107], v[84:87]
buffer_load_dwordx4 v18, s[32:35], s45 offen offset:2048 lds
s_add_u32 s45, s45, 458752
v_mfma_f32_16x16x32_bf16 v[84:87], a[172:175], a[108:111], v[84:87]
v_mfma_f32_16x16x32_bf16 a[244:247], a[240:243], a[228:231], a[244:247]
v_mfma_f32_16x16x32_bf16 v[80:83], a[168:171], a[96:99], v[80:83]
v_mfma_f32_16x16x32_bf16 v[80:83], a[172:175], a[100:103], v[80:83]
s_waitcnt lgkmcnt(4)
v_mfma_f32_16x16x32_bf16 v[96:99], a[176:179], a[96:99], v[96:99]
ds_read_b64_tr_b16 a[160:161], v23 offset:192
v_mfma_f32_16x16x32_bf16 v[96:99], a[180:183], a[100:103], v[96:99]
ds_read_b64_tr_b16 a[162:163], v23 offset:1984
v_mfma_f32_16x16x32_bf16 v[100:103], a[176:179], a[104:107], v[100:103]
ds_read_b64_tr_b16 a[164:165], v23 offset:7360
v_mfma_f32_16x16x32_bf16 v[100:103], a[180:183], a[108:111], v[100:103]
ds_read_b64_tr_b16 a[166:167], v23 offset:9152
s_add_u32 m0, s48, 0
v_mfma_f32_16x16x32_bf16 v[104:107], a[176:179], a[112:115], v[104:107]
buffer_load_dwordx4 v9, s[28:31], s44 offen offset:0 lds
v_mfma_f32_16x16x32_bf16 v[104:107], a[180:183], a[116:119], v[104:107]
v_mfma_f32_16x16x32_bf16 v[108:111], a[176:179], a[120:123], v[108:111]
buffer_load_dwordx4 v10, s[28:31], s44 offen offset:1024 lds
v_mfma_f32_16x16x32_bf16 v[108:111], a[180:183], a[124:127], v[108:111]
s_waitcnt lgkmcnt(4)
v_mfma_f32_16x16x32_bf16 v[124:127], a[184:187], a[120:123], v[124:127]
ds_read_b64_tr_b16 a[168:169], v23 offset:14336
v_mfma_f32_16x16x32_bf16 v[124:127], a[188:191], a[124:127], v[124:127]
ds_read_b64_tr_b16 a[170:171], v23 offset:16128
v_mfma_f32_16x16x32_bf16 v[120:123], a[184:187], a[112:115], v[120:123]
ds_read_b64_tr_b16 a[172:173], v23 offset:21504
v_mfma_f32_16x16x32_bf16 v[120:123], a[188:191], a[116:119], v[120:123]
ds_read_b64_tr_b16 a[174:175], v23 offset:23296
v_mfma_f32_16x16x32_bf16 v[116:119], a[184:187], a[104:107], v[116:119]
buffer_load_dwordx4 v11, s[28:31], s44 offen offset:2048 lds
s_add_u32 s44, s44, 393216
v_mfma_f32_16x16x32_bf16 v[116:119], a[188:191], a[108:111], v[116:119]
v_mfma_f32_16x16x32_bf16 v[112:115], a[184:187], a[96:99], v[112:115]
v_mfma_f32_16x16x32_bf16 v[112:115], a[188:191], a[100:103], v[112:115]
s_waitcnt vmcnt(10)
s_waitcnt lgkmcnt(4)
v_mfma_f32_16x16x32_bf16 v[128:131], a[160:163], a[96:99], v[128:131]
ds_read_b64_tr_b16 a[176:177], v23 offset:14368
buffer_load_dwordx4 a[232:235], v24, s[56:59], s55 offen
v_mfma_f32_16x16x32_bf16 v[128:131], a[164:167], a[100:103], v[128:131]
ds_read_b64_tr_b16 a[178:179], v23 offset:16160
s_add_u32 s55, s55, s54
v_mfma_f32_16x16x32_bf16 v[132:135], a[160:163], a[104:107], v[132:135]
ds_read_b64_tr_b16 a[180:181], v23 offset:21536
buffer_load_dwordx4 a[236:239], v24, s[56:59], s55 offen
v_mfma_f32_16x16x32_bf16 v[132:135], a[164:167], a[108:111], v[132:135]
ds_read_b64_tr_b16 a[182:183], v23 offset:23328
s_add_u32 s55, s55, s54
v_mfma_f32_16x16x32_bf16 v[136:139], a[160:163], a[112:115], v[136:139]
ds_read_b128 a[128:131], v19 offset:32768
buffer_load_dwordx4 a[192:195], v24, s[56:59], s55 offen
v_mfma_f32_16x16x32_bf16 v[136:139], a[164:167], a[116:119], v[136:139]
ds_read_b128 a[132:135], v20 offset:32768
s_add_u32 s55, s55, s54
v_mfma_f32_16x16x32_bf16 v[140:143], a[160:163], a[120:123], v[140:143]
ds_read_b128 a[136:139], v19 offset:34816
buffer_load_dwordx4 a[196:199], v24, s[56:59], s55 offen
v_mfma_f32_16x16x32_bf16 v[140:143], a[164:167], a[124:127], v[140:143]
ds_read_b128 a[140:143], v20 offset:34816
s_add_u32 s55, s55, s54
s_waitcnt lgkmcnt(8)
v_mfma_f32_16x16x32_bf16 v[156:159], a[168:171], a[120:123], v[156:159]
ds_read_b64_tr_b16 a[184:185], v23 offset:14400
v_mfma_f32_16x16x32_bf16 v[156:159], a[172:175], a[124:127], v[156:159]
ds_read_b64_tr_b16 a[186:187], v23 offset:16192
v_mfma_f32_16x16x32_bf16 v[152:155], a[168:171], a[112:115], v[152:155]
ds_read_b64_tr_b16 a[188:189], v23 offset:21568
v_mfma_f32_16x16x32_bf16 v[152:155], a[172:175], a[116:119], v[152:155]
ds_read_b64_tr_b16 a[190:191], v23 offset:23360
v_mfma_f32_16x16x32_bf16 v[148:151], a[168:171], a[104:107], v[148:151]
ds_read_b128 a[144:147], v19 offset:36864
v_mfma_f32_16x16x32_bf16 v[148:151], a[172:175], a[108:111], v[148:151]
ds_read_b128 a[148:151], v20 offset:36864
v_mfma_f32_16x16x32_bf16 v[144:147], a[168:171], a[96:99], v[144:147]
ds_read_b128 a[152:155], v19 offset:38912
v_mfma_f32_16x16x32_bf16 v[144:147], a[172:175], a[100:103], v[144:147]
ds_read_b128 a[156:159], v20 offset:38912
s_waitcnt lgkmcnt(12)
v_mfma_f32_16x16x32_bf16 v[160:163], a[176:179], a[96:99], v[160:163]
ds_read_b64_tr_b16 a[160:161], v23 offset:14432
v_mfma_f32_16x16x32_bf16 v[160:163], a[180:183], a[100:103], v[160:163]
ds_read_b64_tr_b16 a[162:163], v23 offset:16224
v_mfma_f32_16x16x32_bf16 v[164:167], a[176:179], a[104:107], v[164:167]
ds_read_b64_tr_b16 a[164:165], v23 offset:21600
v_mfma_f32_16x16x32_bf16 v[164:167], a[180:183], a[108:111], v[164:167]
ds_read_b64_tr_b16 a[166:167], v23 offset:23392
s_add_u32 m0, s47, 0
v_mfma_f32_16x16x32_bf16 v[168:171], a[176:179], a[112:115], v[168:171]
buffer_load_dwordx4 v1, s[24:27], s43 offen offset:0 lds
v_mfma_f32_16x16x32_bf16 v[168:171], a[180:183], a[116:119], v[168:171]
v_mfma_f32_16x16x32_bf16 v[172:175], a[176:179], a[120:123], v[172:175]
buffer_load_dwordx4 v2, s[24:27], s43 offen offset:1024 lds
v_mfma_f32_16x16x32_bf16 v[172:175], a[180:183], a[124:127], v[172:175]
s_waitcnt lgkmcnt(8)
v_mfma_f32_16x16x32_bf16 v[188:191], a[184:187], a[120:123], v[188:191]
ds_read_b64_tr_b16 a[168:169], v23 offset:14464
v_mfma_f32_16x16x32_bf16 v[188:191], a[188:191], a[124:127], v[188:191]
ds_read_b64_tr_b16 a[170:171], v23 offset:16256
v_mfma_f32_16x16x32_bf16 v[184:187], a[184:187], a[112:115], v[184:187]
ds_read_b64_tr_b16 a[172:173], v23 offset:21632
v_mfma_f32_16x16x32_bf16 v[184:187], a[188:191], a[116:119], v[184:187]
ds_read_b64_tr_b16 a[174:175], v23 offset:23424
v_mfma_f32_16x16x32_bf16 v[180:183], a[184:187], a[104:107], v[180:183]
buffer_load_dwordx4 v3, s[24:27], s43 offen offset:2048 lds
v_mfma_f32_16x16x32_bf16 v[180:183], a[188:191], a[108:111], v[180:183]
v_mfma_f32_16x16x32_bf16 v[176:179], a[184:187], a[96:99], v[176:179]
buffer_load_dwordx4 v4, s[24:27], s43 offen offset:3072 lds
v_mfma_f32_16x16x32_bf16 v[176:179], a[188:191], a[100:103], v[176:179]
s_waitcnt lgkmcnt(4)
v_mfma_f32_16x16x32_bf16 v[192:195], a[160:163], a[96:99], v[192:195]
ds_read_b64_tr_b16 a[176:177], v23 offset:14496
v_mfma_f32_16x16x32_bf16 v[192:195], a[164:167], a[100:103], v[192:195]
ds_read_b64_tr_b16 a[178:179], v23 offset:16288
v_mfma_f32_16x16x32_bf16 v[196:199], a[160:163], a[104:107], v[196:199]
ds_read_b64_tr_b16 a[180:181], v23 offset:21664
v_mfma_f32_16x16x32_bf16 v[196:199], a[164:167], a[108:111], v[196:199]
ds_read_b64_tr_b16 a[182:183], v23 offset:23456
s_add_u32 m0, s47, 4096
v_mfma_f32_16x16x32_bf16 v[200:203], a[160:163], a[112:115], v[200:203]
buffer_load_dwordx4 v5, s[24:27], s43 offen offset:0 lds
v_mfma_f32_16x16x32_bf16 v[200:203], a[164:167], a[116:119], v[200:203]
v_mfma_f32_16x16x32_bf16 v[204:207], a[160:163], a[120:123], v[204:207]
buffer_load_dwordx4 v6, s[24:27], s43 offen offset:1024 lds
v_mfma_f32_16x16x32_bf16 v[204:207], a[164:167], a[124:127], v[204:207]
s_waitcnt lgkmcnt(4)
v_mfma_f32_16x16x32_bf16 v[220:223], a[168:171], a[120:123], v[220:223]
ds_read_b64_tr_b16 a[184:185], v23 offset:14528
v_mfma_f32_16x16x32_bf16 v[220:223], a[172:175], a[124:127], v[220:223]
ds_read_b64_tr_b16 a[186:187], v23 offset:16320
v_mfma_f32_16x16x32_bf16 v[216:219], a[168:171], a[112:115], v[216:219]
ds_read_b64_tr_b16 a[188:189], v23 offset:21696
v_mfma_f32_16x16x32_bf16 v[216:219], a[172:175], a[116:119], v[216:219]
ds_read_b64_tr_b16 a[190:191], v23 offset:23488
v_mfma_f32_16x16x32_bf16 v[212:215], a[168:171], a[104:107], v[212:215]
buffer_load_dwordx4 v7, s[24:27], s43 offen offset:2048 lds
v_mfma_f32_16x16x32_bf16 v[212:215], a[172:175], a[108:111], v[212:215]
v_mfma_f32_16x16x32_bf16 v[208:211], a[168:171], a[96:99], v[208:211]
buffer_load_dwordx4 v8, s[24:27], s43 offen offset:3072 lds
s_add_u32 s43, s43, 128
v_mfma_f32_16x16x32_bf16 v[208:211], a[172:175], a[100:103], v[208:211]
s_waitcnt lgkmcnt(0)
s_barrier
v_mfma_f32_16x16x32_bf16 v[224:227], a[176:179], a[96:99], v[224:227]
ds_read_b64_tr_b16 a[160:161], v21 offset:40960
v_mfma_f32_16x16x32_bf16 v[224:227], a[180:183], a[100:103], v[224:227]
ds_read_b64_tr_b16 a[162:163], v21 offset:41728
v_mfma_f32_16x16x32_bf16 v[228:231], a[176:179], a[104:107], v[228:231]
ds_read_b64_tr_b16 a[164:165], v21 offset:47104
v_mfma_f32_16x16x32_bf16 v[228:231], a[180:183], a[108:111], v[228:231]
ds_read_b64_tr_b16 a[166:167], v21 offset:47872
s_add_u32 m0, s49, 0
v_mfma_f32_16x16x32_bf16 v[232:235], a[176:179], a[112:115], v[232:235]
buffer_load_dwordx4 v12, s[32:35], s45 offen offset:0 lds
v_mfma_f32_16x16x32_bf16 v[232:235], a[180:183], a[116:119], v[232:235]
v_mfma_f32_16x16x32_bf16 v[236:239], a[176:179], a[120:123], v[236:239]
v_mfma_f32_16x16x32_bf16 v[236:239], a[180:183], a[124:127], v[236:239]
v_mfma_f32_16x16x32_bf16 v[252:255], a[184:187], a[120:123], v[252:255]
ds_read_b64_tr_b16 a[168:169], v22 offset:40960
v_mfma_f32_16x16x32_bf16 v[252:255], a[188:191], a[124:127], v[252:255]
ds_read_b64_tr_b16 a[170:171], v22 offset:41728
v_mfma_f32_16x16x32_bf16 v[248:251], a[184:187], a[112:115], v[248:251]
ds_read_b64_tr_b16 a[172:173], v22 offset:47104
v_mfma_f32_16x16x32_bf16 v[248:251], a[188:191], a[116:119], v[248:251]
ds_read_b64_tr_b16 a[174:175], v22 offset:47872
v_mfma_f32_16x16x32_bf16 v[244:247], a[184:187], a[104:107], v[244:247]
buffer_load_dwordx4 v13, s[32:35], s45 offen offset:1024 lds
v_mfma_f32_16x16x32_bf16 v[244:247], a[188:191], a[108:111], v[244:247]
v_mfma_f32_16x16x32_bf16 v[240:243], a[184:187], a[96:99], v[240:243]
v_mfma_f32_16x16x32_bf16 v[240:243], a[188:191], a[100:103], v[240:243]
s_waitcnt lgkmcnt(4)
v_mfma_f32_16x16x32_bf16 a[0:3], a[160:163], a[128:131], a[0:3]
ds_read_b64_tr_b16 a[176:177], v21 offset:41024
v_mfma_f32_16x16x32_bf16 a[0:3], a[164:167], a[132:135], a[0:3]
ds_read_b64_tr_b16 a[178:179], v21 offset:41792
v_mfma_f32_16x16x32_bf16 a[4:7], a[160:163], a[136:139], a[4:7]
ds_read_b64_tr_b16 a[180:181], v21 offset:47168
v_mfma_f32_16x16x32_bf16 a[4:7], a[164:167], a[140:143], a[4:7]
ds_read_b64_tr_b16 a[182:183], v21 offset:47936
v_mfma_f32_16x16x32_bf16 a[8:11], a[160:163], a[144:147], a[8:11]
buffer_load_dwordx4 v14, s[32:35], s45 offen offset:2048 lds
v_mfma_f32_16x16x32_bf16 a[8:11], a[164:167], a[148:151], a[8:11]
v_mfma_f32_16x16x32_bf16 a[12:15], a[160:163], a[152:155], a[12:15]
buffer_load_dwordx4 v15, s[32:35], s45 offen offset:3072 lds
v_mfma_f32_16x16x32_bf16 a[12:15], a[164:167], a[156:159], a[12:15]
s_waitcnt lgkmcnt(4)
v_mfma_f32_16x16x32_bf16 a[28:31], a[168:171], a[152:155], a[28:31]
ds_read_b64_tr_b16 a[184:185], v22 offset:41024
v_mfma_f32_16x16x32_bf16 a[28:31], a[172:175], a[156:159], a[28:31]
ds_read_b64_tr_b16 a[186:187], v22 offset:41792
v_mfma_f32_16x16x32_bf16 a[24:27], a[168:171], a[144:147], a[24:27]
ds_read_b64_tr_b16 a[188:189], v22 offset:47168
v_mfma_f32_16x16x32_bf16 a[24:27], a[172:175], a[148:151], a[24:27]
ds_read_b64_tr_b16 a[190:191], v22 offset:47936
s_add_u32 m0, s49, 4096
v_mfma_f32_16x16x32_bf16 a[20:23], a[168:171], a[136:139], a[20:23]
buffer_load_dwordx4 v16, s[32:35], s45 offen offset:0 lds
v_mfma_f32_16x16x32_bf16 a[20:23], a[172:175], a[140:143], a[20:23]
s_waitcnt vmcnt(16)
v_mfma_f32_16x16x32_bf16 a[244:247], a[240:243], a[232:235], a[244:247]
v_mfma_f32_16x16x32_bf16 a[16:19], a[168:171], a[128:131], a[16:19]
v_mfma_f32_16x16x32_bf16 a[16:19], a[172:175], a[132:135], a[16:19]
s_waitcnt lgkmcnt(4)
v_mfma_f32_16x16x32_bf16 a[32:35], a[176:179], a[128:131], a[32:35]
ds_read_b64_tr_b16 a[160:161], v21 offset:41088
v_mfma_f32_16x16x32_bf16 a[32:35], a[180:183], a[132:135], a[32:35]
ds_read_b64_tr_b16 a[162:163], v21 offset:41856
v_mfma_f32_16x16x32_bf16 a[36:39], a[176:179], a[136:139], a[36:39]
ds_read_b64_tr_b16 a[164:165], v21 offset:47232
v_mfma_f32_16x16x32_bf16 a[36:39], a[180:183], a[140:143], a[36:39]
ds_read_b64_tr_b16 a[166:167], v21 offset:48000
v_mfma_f32_16x16x32_bf16 a[40:43], a[176:179], a[144:147], a[40:43]
buffer_load_dwordx4 v17, s[32:35], s45 offen offset:1024 lds
v_mfma_f32_16x16x32_bf16 a[40:43], a[180:183], a[148:151], a[40:43]
v_mfma_f32_16x16x32_bf16 a[44:47], a[176:179], a[152:155], a[44:47]
v_mfma_f32_16x16x32_bf16 a[44:47], a[180:183], a[156:159], a[44:47]
s_waitcnt lgkmcnt(4)
v_mfma_f32_16x16x32_bf16 a[60:63], a[184:187], a[152:155], a[60:63]
ds_read_b64_tr_b16 a[168:169], v22 offset:41088
v_mfma_f32_16x16x32_bf16 a[60:63], a[188:191], a[156:159], a[60:63]
ds_read_b64_tr_b16 a[170:171], v22 offset:41856
v_mfma_f32_16x16x32_bf16 a[56:59], a[184:187], a[144:147], a[56:59]
ds_read_b64_tr_b16 a[172:173], v22 offset:47232
v_mfma_f32_16x16x32_bf16 a[56:59], a[188:191], a[148:151], a[56:59]
ds_read_b64_tr_b16 a[174:175], v22 offset:48000
v_mfma_f32_16x16x32_bf16 a[52:55], a[184:187], a[136:139], a[52:55]
buffer_load_dwordx4 v18, s[32:35], s45 offen offset:2048 lds
s_add_u32 s45, s45, 458752
v_mfma_f32_16x16x32_bf16 a[52:55], a[188:191], a[140:143], a[52:55]
s_waitcnt vmcnt(17)
v_mfma_f32_16x16x32_bf16 a[244:247], a[240:243], a[236:239], a[244:247]
v_mfma_f32_16x16x32_bf16 a[48:51], a[184:187], a[128:131], a[48:51]
v_mfma_f32_16x16x32_bf16 a[48:51], a[188:191], a[132:135], a[48:51]
s_waitcnt lgkmcnt(0)
s_barrier
v_mfma_f32_16x16x32_bf16 a[64:67], a[128:131], a[160:163], a[64:67]
ds_read_b64_tr_b16 a[176:177], v23 offset:40960
v_mfma_f32_16x16x32_bf16 a[64:67], a[132:135], a[164:167], a[64:67]
ds_read_b64_tr_b16 a[178:179], v23 offset:42752
v_mfma_f32_16x16x32_bf16 a[68:71], a[136:139], a[160:163], a[68:71]
ds_read_b64_tr_b16 a[180:181], v23 offset:48128
v_mfma_f32_16x16x32_bf16 a[68:71], a[140:143], a[164:167], a[68:71]
ds_read_b64_tr_b16 a[182:183], v23 offset:49920
s_add_u32 m0, s48, 40960
v_mfma_f32_16x16x32_bf16 a[72:75], a[144:147], a[160:163], a[72:75]
buffer_load_dwordx4 v9, s[28:31], s44 offen offset:0 lds
v_mfma_f32_16x16x32_bf16 a[72:75], a[148:151], a[164:167], a[72:75]
v_mfma_f32_16x16x32_bf16 a[76:79], a[152:155], a[160:163], a[76:79]
v_mfma_f32_16x16x32_bf16 a[76:79], a[156:159], a[164:167], a[76:79]
v_mfma_f32_16x16x32_bf16 a[92:95], a[152:155], a[168:171], a[92:95]
ds_read_b64_tr_b16 a[184:185], v23 offset:40992
v_mfma_f32_16x16x32_bf16 a[92:95], a[156:159], a[172:175], a[92:95]
ds_read_b64_tr_b16 a[186:187], v23 offset:42784
v_mfma_f32_16x16x32_bf16 a[88:91], a[144:147], a[168:171], a[88:91]
ds_read_b64_tr_b16 a[188:189], v23 offset:48160
v_mfma_f32_16x16x32_bf16 a[88:91], a[148:151], a[172:175], a[88:91]
ds_read_b64_tr_b16 a[190:191], v23 offset:49952
v_mfma_f32_16x16x32_bf16 a[84:87], a[136:139], a[168:171], a[84:87]
buffer_load_dwordx4 v10, s[28:31], s44 offen offset:1024 lds
v_mfma_f32_16x16x32_bf16 a[84:87], a[140:143], a[172:175], a[84:87]
s_waitcnt vmcnt(18)
v_mfma_f32_16x16x32_bf16 a[244:247], a[240:243], a[192:195], a[244:247]
v_mfma_f32_16x16x32_bf16 a[80:83], a[128:131], a[168:171], a[80:83]
v_mfma_f32_16x16x32_bf16 a[80:83], a[132:135], a[172:175], a[80:83]
s_waitcnt lgkmcnt(4)
v_mfma_f32_16x16x32_bf16 v[32:35], a[176:179], a[128:131], v[32:35]
ds_read_b64_tr_b16 a[160:161], v23 offset:41024
v_mfma_f32_16x16x32_bf16 v[32:35], a[180:183], a[132:135], v[32:35]
ds_read_b64_tr_b16 a[162:163], v23 offset:42816
v_mfma_f32_16x16x32_bf16 v[36:39], a[176:179], a[136:139], v[36:39]
ds_read_b64_tr_b16 a[164:165], v23 offset:48192
v_mfma_f32_16x16x32_bf16 v[36:39], a[180:183], a[140:143], v[36:39]
ds_read_b64_tr_b16 a[166:167], v23 offset:49984
v_mfma_f32_16x16x32_bf16 v[40:43], a[176:179], a[144:147], v[40:43]
buffer_load_dwordx4 v11, s[28:31], s44 offen offset:2048 lds
s_add_u32 s44, s44, 393216
v_mfma_f32_16x16x32_bf16 v[40:43], a[180:183], a[148:151], v[40:43]
v_mfma_f32_16x16x32_bf16 v[44:47], a[176:179], a[152:155], v[44:47]
v_mfma_f32_16x16x32_bf16 v[44:47], a[180:183], a[156:159], v[44:47]
s_waitcnt lgkmcnt(4)
v_mfma_f32_16x16x32_bf16 v[60:63], a[184:187], a[152:155], v[60:63]
ds_read_b64_tr_b16 a[168:169], v23 offset:41056
v_mfma_f32_16x16x32_bf16 v[60:63], a[188:191], a[156:159], v[60:63]
ds_read_b64_tr_b16 a[170:171], v23 offset:42848
v_mfma_f32_16x16x32_bf16 v[56:59], a[184:187], a[144:147], v[56:59]
ds_read_b64_tr_b16 a[172:173], v23 offset:48224
v_mfma_f32_16x16x32_bf16 v[56:59], a[188:191], a[148:151], v[56:59]
ds_read_b64_tr_b16 a[174:175], v23 offset:50016
s_add_u32 m0, s47, 32768
v_mfma_f32_16x16x32_bf16 v[52:55], a[184:187], a[136:139], v[52:55]
buffer_load_dwordx4 v1, s[24:27], s43 offen offset:0 lds
v_mfma_f32_16x16x32_bf16 v[52:55], a[188:191], a[140:143], v[52:55]
v_mfma_f32_16x16x32_bf16 v[48:51], a[184:187], a[128:131], v[48:51]
buffer_load_dwordx4 v2, s[24:27], s43 offen offset:1024 lds
v_mfma_f32_16x16x32_bf16 v[48:51], a[188:191], a[132:135], v[48:51]
s_waitcnt lgkmcnt(4)
v_mfma_f32_16x16x32_bf16 v[64:67], a[160:163], a[128:131], v[64:67]
ds_read_b64_tr_b16 a[176:177], v23 offset:41088
v_mfma_f32_16x16x32_bf16 v[64:67], a[164:167], a[132:135], v[64:67]
ds_read_b64_tr_b16 a[178:179], v23 offset:42880
v_mfma_f32_16x16x32_bf16 v[68:71], a[160:163], a[136:139], v[68:71]
ds_read_b64_tr_b16 a[180:181], v23 offset:48256
v_mfma_f32_16x16x32_bf16 v[68:71], a[164:167], a[140:143], v[68:71]
ds_read_b64_tr_b16 a[182:183], v23 offset:50048
v_mfma_f32_16x16x32_bf16 v[72:75], a[160:163], a[144:147], v[72:75]
buffer_load_dwordx4 v3, s[24:27], s43 offen offset:2048 lds
v_mfma_f32_16x16x32_bf16 v[72:75], a[164:167], a[148:151], v[72:75]
v_mfma_f32_16x16x32_bf16 v[76:79], a[160:163], a[152:155], v[76:79]
buffer_load_dwordx4 v4, s[24:27], s43 offen offset:3072 lds
v_mfma_f32_16x16x32_bf16 v[76:79], a[164:167], a[156:159], v[76:79]
s_waitcnt lgkmcnt(4)
v_mfma_f32_16x16x32_bf16 v[92:95], a[168:171], a[152:155], v[92:95]
ds_read_b64_tr_b16 a[184:185], v23 offset:41120
v_mfma_f32_16x16x32_bf16 v[92:95], a[172:175], a[156:159], v[92:95]
ds_read_b64_tr_b16 a[186:187], v23 offset:42912
v_mfma_f32_16x16x32_bf16 v[88:91], a[168:171], a[144:147], v[88:91]
ds_read_b64_tr_b16 a[188:189], v23 offset:48288
v_mfma_f32_16x16x32_bf16 v[88:91], a[172:175], a[148:151], v[88:91]
ds_read_b64_tr_b16 a[190:191], v23 offset:50080
s_add_u32 m0, s47, 36864
v_mfma_f32_16x16x32_bf16 v[84:87], a[168:171], a[136:139], v[84:87]
buffer_load_dwordx4 v5, s[24:27], s43 offen offset:0 lds
v_mfma_f32_16x16x32_bf16 v[84:87], a[172:175], a[140:143], v[84:87]
s_waitcnt vmcnt(23)
v_mfma_f32_16x16x32_bf16 a[244:247], a[240:243], a[196:199], a[244:247]
v_mfma_f32_16x16x32_bf16 v[80:83], a[168:171], a[128:131], v[80:83]
buffer_load_dwordx4 v6, s[24:27], s43 offen offset:1024 lds
v_mfma_f32_16x16x32_bf16 v[80:83], a[172:175], a[132:135], v[80:83]
s_waitcnt lgkmcnt(4)
v_mfma_f32_16x16x32_bf16 v[96:99], a[176:179], a[128:131], v[96:99]
ds_read_b64_tr_b16 a[160:161], v23 offset:41152
v_mfma_f32_16x16x32_bf16 v[96:99], a[180:183], a[132:135], v[96:99]
ds_read_b64_tr_b16 a[162:163], v23 offset:42944
v_mfma_f32_16x16x32_bf16 v[100:103], a[176:179], a[136:139], v[100:103]
ds_read_b64_tr_b16 a[164:165], v23 offset:48320
v_mfma_f32_16x16x32_bf16 v[100:103], a[180:183], a[140:143], v[100:103]
ds_read_b64_tr_b16 a[166:167], v23 offset:50112
v_mfma_f32_16x16x32_bf16 v[104:107], a[176:179], a[144:147], v[104:107]
buffer_load_dwordx4 v7, s[24:27], s43 offen offset:2048 lds
v_mfma_f32_16x16x32_bf16 v[104:107], a[180:183], a[148:151], v[104:107]
v_mfma_f32_16x16x32_bf16 v[108:111], a[176:179], a[152:155], v[108:111]
buffer_load_dwordx4 v8, s[24:27], s43 offen offset:3072 lds
s_add_u32 s43, s43, 128
v_mfma_f32_16x16x32_bf16 v[108:111], a[180:183], a[156:159], v[108:111]
s_waitcnt vmcnt(18)
s_waitcnt lgkmcnt(4)
v_mfma_f32_16x16x32_bf16 v[124:127], a[184:187], a[152:155], v[124:127]
ds_read_b64_tr_b16 a[168:169], v23 offset:55296
v_mfma_f32_16x16x32_bf16 v[124:127], a[188:191], a[156:159], v[124:127]
ds_read_b64_tr_b16 a[170:171], v23 offset:57088
v_mfma_f32_16x16x32_bf16 v[120:123], a[184:187], a[144:147], v[120:123]
ds_read_b64_tr_b16 a[172:173], v23 offset:62464
v_mfma_f32_16x16x32_bf16 v[120:123], a[188:191], a[148:151], v[120:123]
ds_read_b64_tr_b16 a[174:175], v23 offset:64256
v_mfma_f32_16x16x32_bf16 v[116:119], a[184:187], a[136:139], v[116:119]
ds_read_b128 a[96:99], v19 offset:0
v_mfma_f32_16x16x32_bf16 v[116:119], a[188:191], a[140:143], v[116:119]
ds_read_b128 a[100:103], v20 offset:0
v_mfma_f32_16x16x32_bf16 v[112:115], a[184:187], a[128:131], v[112:115]
ds_read_b128 a[104:107], v19 offset:2048
v_mfma_f32_16x16x32_bf16 v[112:115], a[188:191], a[132:135], v[112:115]
ds_read_b128 a[108:111], v20 offset:2048
s_waitcnt lgkmcnt(8)
v_mfma_f32_16x16x32_bf16 v[128:131], a[160:163], a[128:131], v[128:131]
ds_read_b64_tr_b16 a[176:177], v23 offset:55328
buffer_load_dwordx4 a[200:203], v24, s[56:59], s55 offen
v_mfma_f32_16x16x32_bf16 v[128:131], a[164:167], a[132:135], v[128:131]
ds_read_b64_tr_b16 a[178:179], v23 offset:57120
s_add_u32 s55, s55, s54
v_mfma_f32_16x16x32_bf16 v[132:135], a[160:163], a[136:139], v[132:135]
ds_read_b64_tr_b16 a[180:181], v23 offset:62496
buffer_load_dwordx4 a[204:207], v24, s[56:59], s55 offen
v_mfma_f32_16x16x32_bf16 v[132:135], a[164:167], a[140:143], v[132:135]
ds_read_b64_tr_b16 a[182:183], v23 offset:64288
s_add_u32 s55, s55, s54
v_mfma_f32_16x16x32_bf16 v[136:139], a[160:163], a[144:147], v[136:139]
ds_read_b128 a[112:115], v19 offset:4096
buffer_load_dwordx4 a[208:211], v24, s[56:59], s55 offen
v_mfma_f32_16x16x32_bf16 v[136:139], a[164:167], a[148:151], v[136:139]
ds_read_b128 a[116:119], v20 offset:4096
s_add_u32 s55, s55, s54
v_mfma_f32_16x16x32_bf16 v[140:143], a[160:163], a[152:155], v[140:143]
ds_read_b128 a[120:123], v19 offset:6144
buffer_load_dwordx4 a[212:215], v24, s[56:59], s55 offen
v_mfma_f32_16x16x32_bf16 v[140:143], a[164:167], a[156:159], v[140:143]
ds_read_b128 a[124:127], v20 offset:6144
s_add_u32 s55, s55, s54
s_waitcnt lgkmcnt(12)
v_mfma_f32_16x16x32_bf16 v[156:159], a[168:171], a[152:155], v[156:159]
ds_read_b64_tr_b16 a[184:185], v23 offset:55360
v_mfma_f32_16x16x32_bf16 v[156:159], a[172:175], a[156:159], v[156:159]
ds_read_b64_tr_b16 a[186:187], v23 offset:57152
v_mfma_f32_16x16x32_bf16 v[152:155], a[168:171], a[144:147], v[152:155]
ds_read_b64_tr_b16 a[188:189], v23 offset:62528
v_mfma_f32_16x16x32_bf16 v[152:155], a[172:175], a[148:151], v[152:155]
ds_read_b64_tr_b16 a[190:191], v23 offset:64320
v_mfma_f32_16x16x32_bf16 v[148:151], a[168:171], a[136:139], v[148:151]
v_mfma_f32_16x16x32_bf16 v[148:151], a[172:175], a[140:143], v[148:151]
v_mfma_f32_16x16x32_bf16 v[144:147], a[168:171], a[128:131], v[144:147]
v_mfma_f32_16x16x32_bf16 v[144:147], a[172:175], a[132:135], v[144:147]
s_waitcnt lgkmcnt(4)
v_mfma_f32_16x16x32_bf16 v[160:163], a[176:179], a[128:131], v[160:163]
ds_read_b64_tr_b16 a[160:161], v23 offset:55392
v_mfma_f32_16x16x32_bf16 v[160:163], a[180:183], a[132:135], v[160:163]
ds_read_b64_tr_b16 a[162:163], v23 offset:57184
v_mfma_f32_16x16x32_bf16 v[164:167], a[176:179], a[136:139], v[164:167]
ds_read_b64_tr_b16 a[164:165], v23 offset:62560
v_mfma_f32_16x16x32_bf16 v[164:167], a[180:183], a[140:143], v[164:167]
ds_read_b64_tr_b16 a[166:167], v23 offset:64352
s_add_u32 m0, s47, 0
v_mfma_f32_16x16x32_bf16 v[168:171], a[176:179], a[144:147], v[168:171]
buffer_load_dwordx4 v1, s[24:27], s43 offen offset:0 lds
v_mfma_f32_16x16x32_bf16 v[168:171], a[180:183], a[148:151], v[168:171]
v_mfma_f32_16x16x32_bf16 v[172:175], a[176:179], a[152:155], v[172:175]
buffer_load_dwordx4 v2, s[24:27], s43 offen offset:1024 lds
v_mfma_f32_16x16x32_bf16 v[172:175], a[180:183], a[156:159], v[172:175]
s_waitcnt lgkmcnt(4)
v_mfma_f32_16x16x32_bf16 v[188:191], a[184:187], a[152:155], v[188:191]
ds_read_b64_tr_b16 a[168:169], v23 offset:55424
v_mfma_f32_16x16x32_bf16 v[188:191], a[188:191], a[156:159], v[188:191]
ds_read_b64_tr_b16 a[170:171], v23 offset:57216
v_mfma_f32_16x16x32_bf16 v[184:187], a[184:187], a[144:147], v[184:187]
ds_read_b64_tr_b16 a[172:173], v23 offset:62592
v_mfma_f32_16x16x32_bf16 v[184:187], a[188:191], a[148:151], v[184:187]
ds_read_b64_tr_b16 a[174:175], v23 offset:64384
v_mfma_f32_16x16x32_bf16 v[180:183], a[184:187], a[136:139], v[180:183]
buffer_load_dwordx4 v3, s[24:27], s43 offen offset:2048 lds
v_mfma_f32_16x16x32_bf16 v[180:183], a[188:191], a[140:143], v[180:183]
v_mfma_f32_16x16x32_bf16 v[176:179], a[184:187], a[128:131], v[176:179]
buffer_load_dwordx4 v4, s[24:27], s43 offen offset:3072 lds
v_mfma_f32_16x16x32_bf16 v[176:179], a[188:191], a[132:135], v[176:179]
s_waitcnt lgkmcnt(4)
v_mfma_f32_16x16x32_bf16 v[192:195], a[160:163], a[128:131], v[192:195]
ds_read_b64_tr_b16 a[176:177], v23 offset:55456
v_mfma_f32_16x16x32_bf16 v[192:195], a[164:167], a[132:135], v[192:195]
ds_read_b64_tr_b16 a[178:179], v23 offset:57248
v_mfma_f32_16x16x32_bf16 v[196:199], a[160:163], a[136:139], v[196:199]
ds_read_b64_tr_b16 a[180:181], v23 offset:62624
v_mfma_f32_16x16x32_bf16 v[196:199], a[164:167], a[140:143], v[196:199]
ds_read_b64_tr_b16 a[182:183], v23 offset:64416
s_add_u32 m0, s47, 4096
v_mfma_f32_16x16x32_bf16 v[200:203], a[160:163], a[144:147], v[200:203]
buffer_load_dwordx4 v5, s[24:27], s43 offen offset:0 lds
v_mfma_f32_16x16x32_bf16 v[200:203], a[164:167], a[148:151], v[200:203]
v_mfma_f32_16x16x32_bf16 v[204:207], a[160:163], a[152:155], v[204:207]
buffer_load_dwordx4 v6, s[24:27], s43 offen offset:1024 lds
v_mfma_f32_16x16x32_bf16 v[204:207], a[164:167], a[156:159], v[204:207]
s_waitcnt lgkmcnt(4)
v_mfma_f32_16x16x32_bf16 v[220:223], a[168:171], a[152:155], v[220:223]
ds_read_b64_tr_b16 a[184:185], v23 offset:55488
v_mfma_f32_16x16x32_bf16 v[220:223], a[172:175], a[156:159], v[220:223]
ds_read_b64_tr_b16 a[186:187], v23 offset:57280
v_mfma_f32_16x16x32_bf16 v[216:219], a[168:171], a[144:147], v[216:219]
ds_read_b64_tr_b16 a[188:189], v23 offset:62656
v_mfma_f32_16x16x32_bf16 v[216:219], a[172:175], a[148:151], v[216:219]
ds_read_b64_tr_b16 a[190:191], v23 offset:64448
v_mfma_f32_16x16x32_bf16 v[212:215], a[168:171], a[136:139], v[212:215]
buffer_load_dwordx4 v7, s[24:27], s43 offen offset:2048 lds
v_mfma_f32_16x16x32_bf16 v[212:215], a[172:175], a[140:143], v[212:215]
v_mfma_f32_16x16x32_bf16 v[208:211], a[168:171], a[128:131], v[208:211]
buffer_load_dwordx4 v8, s[24:27], s43 offen offset:3072 lds
s_add_u32 s43, s43, 128
v_mfma_f32_16x16x32_bf16 v[208:211], a[172:175], a[132:135], v[208:211]
s_waitcnt lgkmcnt(0)
s_barrier
v_mfma_f32_16x16x32_bf16 v[224:227], a[176:179], a[128:131], v[224:227]
ds_read_b64_tr_b16 a[160:161], v21 offset:0
v_mfma_f32_16x16x32_bf16 v[224:227], a[180:183], a[132:135], v[224:227]
ds_read_b64_tr_b16 a[162:163], v21 offset:768
v_mfma_f32_16x16x32_bf16 v[228:231], a[176:179], a[136:139], v[228:231]
ds_read_b64_tr_b16 a[164:165], v21 offset:6144
v_mfma_f32_16x16x32_bf16 v[228:231], a[180:183], a[140:143], v[228:231]
ds_read_b64_tr_b16 a[166:167], v21 offset:6912
s_add_u32 m0, s49, 40960
v_mfma_f32_16x16x32_bf16 v[232:235], a[176:179], a[144:147], v[232:235]
buffer_load_dwordx4 v12, s[32:35], s45 offen offset:0 lds
v_mfma_f32_16x16x32_bf16 v[232:235], a[180:183], a[148:151], v[232:235]
v_mfma_f32_16x16x32_bf16 v[236:239], a[176:179], a[152:155], v[236:239]
v_mfma_f32_16x16x32_bf16 v[236:239], a[180:183], a[156:159], v[236:239]
v_mfma_f32_16x16x32_bf16 v[252:255], a[184:187], a[152:155], v[252:255]
ds_read_b64_tr_b16 a[168:169], v22 offset:0
v_mfma_f32_16x16x32_bf16 v[252:255], a[188:191], a[156:159], v[252:255]
ds_read_b64_tr_b16 a[170:171], v22 offset:768
v_mfma_f32_16x16x32_bf16 v[248:251], a[184:187], a[144:147], v[248:251]
ds_read_b64_tr_b16 a[172:173], v22 offset:6144
v_mfma_f32_16x16x32_bf16 v[248:251], a[188:191], a[148:151], v[248:251]
ds_read_b64_tr_b16 a[174:175], v22 offset:6912
v_mfma_f32_16x16x32_bf16 v[244:247], a[184:187], a[136:139], v[244:247]
buffer_load_dwordx4 v13, s[32:35], s45 offen offset:1024 lds
v_mfma_f32_16x16x32_bf16 v[244:247], a[188:191], a[140:143], v[244:247]
v_mfma_f32_16x16x32_bf16 v[240:243], a[184:187], a[128:131], v[240:243]
v_mfma_f32_16x16x32_bf16 v[240:243], a[188:191], a[132:135], v[240:243]
s_waitcnt lgkmcnt(4)
v_mfma_f32_16x16x32_bf16 a[0:3], a[160:163], a[96:99], a[0:3]
ds_read_b64_tr_b16 a[176:177], v21 offset:64
v_mfma_f32_16x16x32_bf16 a[0:3], a[164:167], a[100:103], a[0:3]
ds_read_b64_tr_b16 a[178:179], v21 offset:832
v_mfma_f32_16x16x32_bf16 a[4:7], a[160:163], a[104:107], a[4:7]
ds_read_b64_tr_b16 a[180:181], v21 offset:6208
v_mfma_f32_16x16x32_bf16 a[4:7], a[164:167], a[108:111], a[4:7]
ds_read_b64_tr_b16 a[182:183], v21 offset:6976
v_mfma_f32_16x16x32_bf16 a[8:11], a[160:163], a[112:115], a[8:11]
buffer_load_dwordx4 v14, s[32:35], s45 offen offset:2048 lds
v_mfma_f32_16x16x32_bf16 a[8:11], a[164:167], a[116:119], a[8:11]
v_mfma_f32_16x16x32_bf16 a[12:15], a[160:163], a[120:123], a[12:15]
buffer_load_dwordx4 v15, s[32:35], s45 offen offset:3072 lds
v_mfma_f32_16x16x32_bf16 a[12:15], a[164:167], a[124:127], a[12:15]
s_waitcnt lgkmcnt(4)
v_mfma_f32_16x16x32_bf16 a[28:31], a[168:171], a[120:123], a[28:31]
ds_read_b64_tr_b16 a[184:185], v22 offset:64
v_mfma_f32_16x16x32_bf16 a[28:31], a[172:175], a[124:127], a[28:31]
ds_read_b64_tr_b16 a[186:187], v22 offset:832
v_mfma_f32_16x16x32_bf16 a[24:27], a[168:171], a[112:115], a[24:27]
ds_read_b64_tr_b16 a[188:189], v22 offset:6208
v_mfma_f32_16x16x32_bf16 a[24:27], a[172:175], a[116:119], a[24:27]
ds_read_b64_tr_b16 a[190:191], v22 offset:6976
s_add_u32 m0, s49, 45056
v_mfma_f32_16x16x32_bf16 a[20:23], a[168:171], a[104:107], a[20:23]
buffer_load_dwordx4 v16, s[32:35], s45 offen offset:0 lds
v_mfma_f32_16x16x32_bf16 a[20:23], a[172:175], a[108:111], a[20:23]
s_waitcnt vmcnt(16)
v_mfma_f32_16x16x32_bf16 a[244:247], a[240:243], a[200:203], a[244:247]
v_mfma_f32_16x16x32_bf16 a[16:19], a[168:171], a[96:99], a[16:19]
v_mfma_f32_16x16x32_bf16 a[16:19], a[172:175], a[100:103], a[16:19]
s_waitcnt lgkmcnt(4)
v_mfma_f32_16x16x32_bf16 a[32:35], a[176:179], a[96:99], a[32:35]
ds_read_b64_tr_b16 a[160:161], v21 offset:128
v_mfma_f32_16x16x32_bf16 a[32:35], a[180:183], a[100:103], a[32:35]
ds_read_b64_tr_b16 a[162:163], v21 offset:896
v_mfma_f32_16x16x32_bf16 a[36:39], a[176:179], a[104:107], a[36:39]
ds_read_b64_tr_b16 a[164:165], v21 offset:6272
v_mfma_f32_16x16x32_bf16 a[36:39], a[180:183], a[108:111], a[36:39]
ds_read_b64_tr_b16 a[166:167], v21 offset:7040
v_mfma_f32_16x16x32_bf16 a[40:43], a[176:179], a[112:115], a[40:43]
buffer_load_dwordx4 v17, s[32:35], s45 offen offset:1024 lds
v_mfma_f32_16x16x32_bf16 a[40:43], a[180:183], a[116:119], a[40:43]
v_mfma_f32_16x16x32_bf16 a[44:47], a[176:179], a[120:123], a[44:47]
v_mfma_f32_16x16x32_bf16 a[44:47], a[180:183], a[124:127], a[44:47]
s_waitcnt lgkmcnt(4)
v_mfma_f32_16x16x32_bf16 a[60:63], a[184:187], a[120:123], a[60:63]
ds_read_b64_tr_b16 a[168:169], v22 offset:128
v_mfma_f32_16x16x32_bf16 a[60:63], a[188:191], a[124:127], a[60:63]
ds_read_b64_tr_b16 a[170:171], v22 offset:896
v_mfma_f32_16x16x32_bf16 a[56:59], a[184:187], a[112:115], a[56:59]
ds_read_b64_tr_b16 a[172:173], v22 offset:6272
v_mfma_f32_16x16x32_bf16 a[56:59], a[188:191], a[116:119], a[56:59]
ds_read_b64_tr_b16 a[174:175], v22 offset:7040
v_mfma_f32_16x16x32_bf16 a[52:55], a[184:187], a[104:107], a[52:55]
buffer_load_dwordx4 v18, s[32:35], s45 offen offset:2048 lds
s_add_u32 s45, s45, 458752
v_mfma_f32_16x16x32_bf16 a[52:55], a[188:191], a[108:111], a[52:55]
s_waitcnt vmcnt(17)
v_mfma_f32_16x16x32_bf16 a[244:247], a[240:243], a[204:207], a[244:247]
v_mfma_f32_16x16x32_bf16 a[48:51], a[184:187], a[96:99], a[48:51]
v_mfma_f32_16x16x32_bf16 a[48:51], a[188:191], a[100:103], a[48:51]
s_waitcnt lgkmcnt(0)
s_barrier
v_mfma_f32_16x16x32_bf16 a[64:67], a[96:99], a[160:163], a[64:67]
ds_read_b64_tr_b16 a[176:177], v23 offset:0
v_mfma_f32_16x16x32_bf16 a[64:67], a[100:103], a[164:167], a[64:67]
ds_read_b64_tr_b16 a[178:179], v23 offset:1792
v_mfma_f32_16x16x32_bf16 a[68:71], a[104:107], a[160:163], a[68:71]
ds_read_b64_tr_b16 a[180:181], v23 offset:7168
v_mfma_f32_16x16x32_bf16 a[68:71], a[108:111], a[164:167], a[68:71]
ds_read_b64_tr_b16 a[182:183], v23 offset:8960
s_add_u32 m0, s48, 0
v_mfma_f32_16x16x32_bf16 a[72:75], a[112:115], a[160:163], a[72:75]
buffer_load_dwordx4 v9, s[28:31], s44 offen offset:0 lds
v_mfma_f32_16x16x32_bf16 a[72:75], a[116:119], a[164:167], a[72:75]
v_mfma_f32_16x16x32_bf16 a[76:79], a[120:123], a[160:163], a[76:79]
v_mfma_f32_16x16x32_bf16 a[76:79], a[124:127], a[164:167], a[76:79]
v_mfma_f32_16x16x32_bf16 a[92:95], a[120:123], a[168:171], a[92:95]
ds_read_b64_tr_b16 a[184:185], v23 offset:32
v_mfma_f32_16x16x32_bf16 a[92:95], a[124:127], a[172:175], a[92:95]
ds_read_b64_tr_b16 a[186:187], v23 offset:1824
v_mfma_f32_16x16x32_bf16 a[88:91], a[112:115], a[168:171], a[88:91]
ds_read_b64_tr_b16 a[188:189], v23 offset:7200
v_mfma_f32_16x16x32_bf16 a[88:91], a[116:119], a[172:175], a[88:91]
ds_read_b64_tr_b16 a[190:191], v23 offset:8992
v_mfma_f32_16x16x32_bf16 a[84:87], a[104:107], a[168:171], a[84:87]
buffer_load_dwordx4 v10, s[28:31], s44 offen offset:1024 lds
v_mfma_f32_16x16x32_bf16 a[84:87], a[108:111], a[172:175], a[84:87]
s_waitcnt vmcnt(18)
v_mfma_f32_16x16x32_bf16 a[244:247], a[240:243], a[208:211], a[244:247]
v_mfma_f32_16x16x32_bf16 a[80:83], a[96:99], a[168:171], a[80:83]
v_mfma_f32_16x16x32_bf16 a[80:83], a[100:103], a[172:175], a[80:83]
s_waitcnt lgkmcnt(4)
v_mfma_f32_16x16x32_bf16 v[32:35], a[176:179], a[96:99], v[32:35]
ds_read_b64_tr_b16 a[160:161], v23 offset:64
v_mfma_f32_16x16x32_bf16 v[32:35], a[180:183], a[100:103], v[32:35]
ds_read_b64_tr_b16 a[162:163], v23 offset:1856
v_mfma_f32_16x16x32_bf16 v[36:39], a[176:179], a[104:107], v[36:39]
ds_read_b64_tr_b16 a[164:165], v23 offset:7232
v_mfma_f32_16x16x32_bf16 v[36:39], a[180:183], a[108:111], v[36:39]
ds_read_b64_tr_b16 a[166:167], v23 offset:9024
v_mfma_f32_16x16x32_bf16 v[40:43], a[176:179], a[112:115], v[40:43]
buffer_load_dwordx4 v11, s[28:31], s44 offen offset:2048 lds
s_add_u32 s44, s44, 393216
v_mfma_f32_16x16x32_bf16 v[40:43], a[180:183], a[116:119], v[40:43]
v_mfma_f32_16x16x32_bf16 v[44:47], a[176:179], a[120:123], v[44:47]
v_mfma_f32_16x16x32_bf16 v[44:47], a[180:183], a[124:127], v[44:47]
s_waitcnt lgkmcnt(4)
v_mfma_f32_16x16x32_bf16 v[60:63], a[184:187], a[120:123], v[60:63]
ds_read_b64_tr_b16 a[168:169], v23 offset:96
v_mfma_f32_16x16x32_bf16 v[60:63], a[188:191], a[124:127], v[60:63]
ds_read_b64_tr_b16 a[170:171], v23 offset:1888
v_mfma_f32_16x16x32_bf16 v[56:59], a[184:187], a[112:115], v[56:59]
ds_read_b64_tr_b16 a[172:173], v23 offset:7264
v_mfma_f32_16x16x32_bf16 v[56:59], a[188:191], a[116:119], v[56:59]
ds_read_b64_tr_b16 a[174:175], v23 offset:9056
v_mfma_f32_16x16x32_bf16 v[52:55], a[184:187], a[104:107], v[52:55]
v_mfma_f32_16x16x32_bf16 v[52:55], a[188:191], a[108:111], v[52:55]
v_mfma_f32_16x16x32_bf16 v[48:51], a[184:187], a[96:99], v[48:51]
v_mfma_f32_16x16x32_bf16 v[48:51], a[188:191], a[100:103], v[48:51]
s_waitcnt lgkmcnt(4)
v_mfma_f32_16x16x32_bf16 v[64:67], a[160:163], a[96:99], v[64:67]
ds_read_b64_tr_b16 a[176:177], v23 offset:128
v_mfma_f32_16x16x32_bf16 v[64:67], a[164:167], a[100:103], v[64:67]
ds_read_b64_tr_b16 a[178:179], v23 offset:1920
v_mfma_f32_16x16x32_bf16 v[68:71], a[160:163], a[104:107], v[68:71]
ds_read_b64_tr_b16 a[180:181], v23 offset:7296
v_mfma_f32_16x16x32_bf16 v[68:71], a[164:167], a[108:111], v[68:71]
ds_read_b64_tr_b16 a[182:183], v23 offset:9088
v_mfma_f32_16x16x32_bf16 v[72:75], a[160:163], a[112:115], v[72:75]
ds_read_b128 a[128:131], v19 offset:32768
v_mfma_f32_16x16x32_bf16 v[72:75], a[164:167], a[116:119], v[72:75]
ds_read_b128 a[132:135], v20 offset:32768
v_mfma_f32_16x16x32_bf16 v[76:79], a[160:163], a[120:123], v[76:79]
ds_read_b128 a[136:139], v19 offset:34816
v_mfma_f32_16x16x32_bf16 v[76:79], a[164:167], a[124:127], v[76:79]
ds_read_b128 a[140:143], v20 offset:34816
s_waitcnt lgkmcnt(8)
v_mfma_f32_16x16x32_bf16 v[92:95], a[168:171], a[120:123], v[92:95]
ds_read_b64_tr_b16 a[184:185], v23 offset:160
s_waitcnt vmcnt(18)
v_mfma_f32_16x16x32_bf16 a[244:247], a[240:243], a[212:215], a[244:247]
v_mfma_f32_16x16x32_bf16 v[92:95], a[172:175], a[124:127], v[92:95]
ds_read_b64_tr_b16 a[186:187], v23 offset:1952
v_mfma_f32_16x16x32_bf16 v[88:91], a[168:171], a[112:115], v[88:91]
ds_read_b64_tr_b16 a[188:189], v23 offset:7328
v_mfma_f32_16x16x32_bf16 v[88:91], a[172:175], a[116:119], v[88:91]
ds_read_b64_tr_b16 a[190:191], v23 offset:9120
v_mfma_f32_16x16x32_bf16 v[84:87], a[168:171], a[104:107], v[84:87]
ds_read_b128 a[144:147], v19 offset:36864
v_mfma_f32_16x16x32_bf16 v[84:87], a[172:175], a[108:111], v[84:87]
ds_read_b128 a[148:151], v20 offset:36864
v_mfma_f32_16x16x32_bf16 v[80:83], a[168:171], a[96:99], v[80:83]
ds_read_b128 a[152:155], v19 offset:38912
v_mfma_f32_16x16x32_bf16 v[80:83], a[172:175], a[100:103], v[80:83]
ds_read_b128 a[156:159], v20 offset:38912
s_waitcnt lgkmcnt(12)
v_mfma_f32_16x16x32_bf16 v[96:99], a[176:179], a[96:99], v[96:99]
ds_read_b64_tr_b16 a[160:161], v23 offset:192
v_mfma_f32_16x16x32_bf16 v[96:99], a[180:183], a[100:103], v[96:99]
ds_read_b64_tr_b16 a[162:163], v23 offset:1984
v_mfma_f32_16x16x32_bf16 v[100:103], a[176:179], a[104:107], v[100:103]
ds_read_b64_tr_b16 a[164:165], v23 offset:7360
v_mfma_f32_16x16x32_bf16 v[100:103], a[180:183], a[108:111], v[100:103]
ds_read_b64_tr_b16 a[166:167], v23 offset:9152
v_mfma_f32_16x16x32_bf16 v[104:107], a[176:179], a[112:115], v[104:107]
v_mfma_f32_16x16x32_bf16 v[104:107], a[180:183], a[116:119], v[104:107]
v_mfma_f32_16x16x32_bf16 v[108:111], a[176:179], a[120:123], v[108:111]
v_mfma_f32_16x16x32_bf16 v[108:111], a[180:183], a[124:127], v[108:111]
s_waitcnt lgkmcnt(4)
v_mfma_f32_16x16x32_bf16 v[124:127], a[184:187], a[120:123], v[124:127]
ds_read_b64_tr_b16 a[168:169], v23 offset:14336
v_mfma_f32_16x16x32_bf16 v[124:127], a[188:191], a[124:127], v[124:127]
ds_read_b64_tr_b16 a[170:171], v23 offset:16128
v_mfma_f32_16x16x32_bf16 v[120:123], a[184:187], a[112:115], v[120:123]
ds_read_b64_tr_b16 a[172:173], v23 offset:21504
v_mfma_f32_16x16x32_bf16 v[120:123], a[188:191], a[116:119], v[120:123]
ds_read_b64_tr_b16 a[174:175], v23 offset:23296
s_add_u32 m0, s47, 32768
v_mfma_f32_16x16x32_bf16 v[116:119], a[184:187], a[104:107], v[116:119]
buffer_load_dwordx4 v1, s[24:27], s43 offen offset:0 lds
v_mfma_f32_16x16x32_bf16 v[116:119], a[188:191], a[108:111], v[116:119]
v_mfma_f32_16x16x32_bf16 v[112:115], a[184:187], a[96:99], v[112:115]
buffer_load_dwordx4 v2, s[24:27], s43 offen offset:1024 lds
v_mfma_f32_16x16x32_bf16 v[112:115], a[188:191], a[100:103], v[112:115]
s_waitcnt lgkmcnt(4)
v_mfma_f32_16x16x32_bf16 v[128:131], a[160:163], a[96:99], v[128:131]
ds_read_b64_tr_b16 a[176:177], v23 offset:14368
buffer_load_dwordx4 a[216:219], v24, s[56:59], s55 offen
v_mfma_f32_16x16x32_bf16 v[128:131], a[164:167], a[100:103], v[128:131]
ds_read_b64_tr_b16 a[178:179], v23 offset:16160
s_add_u32 s55, s55, s54
v_mfma_f32_16x16x32_bf16 v[132:135], a[160:163], a[104:107], v[132:135]
ds_read_b64_tr_b16 a[180:181], v23 offset:21536
buffer_load_dwordx4 a[220:223], v24, s[56:59], s55 offen
v_mfma_f32_16x16x32_bf16 v[132:135], a[164:167], a[108:111], v[132:135]
ds_read_b64_tr_b16 a[182:183], v23 offset:23328
s_add_u32 s55, s55, s54
v_mfma_f32_16x16x32_bf16 v[136:139], a[160:163], a[112:115], v[136:139]
buffer_load_dwordx4 v3, s[24:27], s43 offen offset:2048 lds
buffer_load_dwordx4 a[224:227], v24, s[56:59], s55 offen
v_mfma_f32_16x16x32_bf16 v[136:139], a[164:167], a[116:119], v[136:139]
s_add_u32 s55, s55, s54
buffer_load_dwordx4 a[228:231], v24, s[56:59], s55 offen
v_mfma_f32_16x16x32_bf16 v[140:143], a[160:163], a[120:123], v[140:143]
s_add_u32 s55, s55, s54
v_mfma_f32_16x16x32_bf16 v[140:143], a[164:167], a[124:127], v[140:143]
s_waitcnt lgkmcnt(4)
v_mfma_f32_16x16x32_bf16 v[156:159], a[168:171], a[120:123], v[156:159]
ds_read_b64_tr_b16 a[184:185], v23 offset:14400
v_mfma_f32_16x16x32_bf16 v[156:159], a[172:175], a[124:127], v[156:159]
ds_read_b64_tr_b16 a[186:187], v23 offset:16192
v_mfma_f32_16x16x32_bf16 v[152:155], a[168:171], a[112:115], v[152:155]
ds_read_b64_tr_b16 a[188:189], v23 offset:21568
v_mfma_f32_16x16x32_bf16 v[152:155], a[172:175], a[116:119], v[152:155]
ds_read_b64_tr_b16 a[190:191], v23 offset:23360
v_mfma_f32_16x16x32_bf16 v[148:151], a[168:171], a[104:107], v[148:151]
buffer_load_dwordx4 v4, s[24:27], s43 offen offset:3072 lds
v_mfma_f32_16x16x32_bf16 v[148:151], a[172:175], a[108:111], v[148:151]
v_mfma_f32_16x16x32_bf16 v[144:147], a[168:171], a[96:99], v[144:147]
v_mfma_f32_16x16x32_bf16 v[144:147], a[172:175], a[100:103], v[144:147]
s_waitcnt lgkmcnt(4)
v_mfma_f32_16x16x32_bf16 v[160:163], a[176:179], a[96:99], v[160:163]
ds_read_b64_tr_b16 a[160:161], v23 offset:14432
v_mfma_f32_16x16x32_bf16 v[160:163], a[180:183], a[100:103], v[160:163]
ds_read_b64_tr_b16 a[162:163], v23 offset:16224
v_mfma_f32_16x16x32_bf16 v[164:167], a[176:179], a[104:107], v[164:167]
ds_read_b64_tr_b16 a[164:165], v23 offset:21600
v_mfma_f32_16x16x32_bf16 v[164:167], a[180:183], a[108:111], v[164:167]
ds_read_b64_tr_b16 a[166:167], v23 offset:23392
s_add_u32 m0, s47, 36864
v_mfma_f32_16x16x32_bf16 v[168:171], a[176:179], a[112:115], v[168:171]
buffer_load_dwordx4 v5, s[24:27], s43 offen offset:0 lds
v_mfma_f32_16x16x32_bf16 v[168:171], a[180:183], a[116:119], v[168:171]
v_mfma_f32_16x16x32_bf16 v[172:175], a[176:179], a[120:123], v[172:175]
v_mfma_f32_16x16x32_bf16 v[172:175], a[180:183], a[124:127], v[172:175]
s_waitcnt lgkmcnt(4)
v_mfma_f32_16x16x32_bf16 v[188:191], a[184:187], a[120:123], v[188:191]
ds_read_b64_tr_b16 a[168:169], v23 offset:14464
v_mfma_f32_16x16x32_bf16 v[188:191], a[188:191], a[124:127], v[188:191]
ds_read_b64_tr_b16 a[170:171], v23 offset:16256
v_mfma_f32_16x16x32_bf16 v[184:187], a[184:187], a[112:115], v[184:187]
ds_read_b64_tr_b16 a[172:173], v23 offset:21632
v_mfma_f32_16x16x32_bf16 v[184:187], a[188:191], a[116:119], v[184:187]
ds_read_b64_tr_b16 a[174:175], v23 offset:23424
v_mfma_f32_16x16x32_bf16 v[180:183], a[184:187], a[104:107], v[180:183]
buffer_load_dwordx4 v6, s[24:27], s43 offen offset:1024 lds
v_mfma_f32_16x16x32_bf16 v[180:183], a[188:191], a[108:111], v[180:183]
v_mfma_f32_16x16x32_bf16 v[176:179], a[184:187], a[96:99], v[176:179]
v_mfma_f32_16x16x32_bf16 v[176:179], a[188:191], a[100:103], v[176:179]
s_waitcnt lgkmcnt(4)
v_mfma_f32_16x16x32_bf16 v[192:195], a[160:163], a[96:99], v[192:195]
ds_read_b64_tr_b16 a[176:177], v23 offset:14496
v_mfma_f32_16x16x32_bf16 v[192:195], a[164:167], a[100:103], v[192:195]
ds_read_b64_tr_b16 a[178:179], v23 offset:16288
v_mfma_f32_16x16x32_bf16 v[196:199], a[160:163], a[104:107], v[196:199]
ds_read_b64_tr_b16 a[180:181], v23 offset:21664
v_mfma_f32_16x16x32_bf16 v[196:199], a[164:167], a[108:111], v[196:199]
ds_read_b64_tr_b16 a[182:183], v23 offset:23456
v_mfma_f32_16x16x32_bf16 v[200:203], a[160:163], a[112:115], v[200:203]
buffer_load_dwordx4 v7, s[24:27], s43 offen offset:2048 lds
v_mfma_f32_16x16x32_bf16 v[200:203], a[164:167], a[116:119], v[200:203]
v_mfma_f32_16x16x32_bf16 v[204:207], a[160:163], a[120:123], v[204:207]
v_mfma_f32_16x16x32_bf16 v[204:207], a[164:167], a[124:127], v[204:207]
s_waitcnt lgkmcnt(4)
v_mfma_f32_16x16x32_bf16 v[220:223], a[168:171], a[120:123], v[220:223]
ds_read_b64_tr_b16 a[184:185], v23 offset:14528
v_mfma_f32_16x16x32_bf16 v[220:223], a[172:175], a[124:127], v[220:223]
ds_read_b64_tr_b16 a[186:187], v23 offset:16320
v_mfma_f32_16x16x32_bf16 v[216:219], a[168:171], a[112:115], v[216:219]
ds_read_b64_tr_b16 a[188:189], v23 offset:21696
v_mfma_f32_16x16x32_bf16 v[216:219], a[172:175], a[116:119], v[216:219]
ds_read_b64_tr_b16 a[190:191], v23 offset:23488
v_mfma_f32_16x16x32_bf16 v[212:215], a[168:171], a[104:107], v[212:215]
buffer_load_dwordx4 v8, s[24:27], s43 offen offset:3072 lds
s_add_u32 s43, s43, 128
v_mfma_f32_16x16x32_bf16 v[212:215], a[172:175], a[108:111], v[212:215]
v_mfma_f32_16x16x32_bf16 v[208:211], a[168:171], a[96:99], v[208:211]
v_mfma_f32_16x16x32_bf16 v[208:211], a[172:175], a[100:103], v[208:211]
s_waitcnt lgkmcnt(0)
s_barrier
v_mfma_f32_16x16x32_bf16 v[224:227], a[176:179], a[96:99], v[224:227]
ds_read_b64_tr_b16 a[160:161], v21 offset:40960
v_mfma_f32_16x16x32_bf16 v[224:227], a[180:183], a[100:103], v[224:227]
ds_read_b64_tr_b16 a[162:163], v21 offset:41728
v_mfma_f32_16x16x32_bf16 v[228:231], a[176:179], a[104:107], v[228:231]
ds_read_b64_tr_b16 a[164:165], v21 offset:47104
v_mfma_f32_16x16x32_bf16 v[228:231], a[180:183], a[108:111], v[228:231]
ds_read_b64_tr_b16 a[166:167], v21 offset:47872
s_add_u32 m0, s49, 0
v_mfma_f32_16x16x32_bf16 v[232:235], a[176:179], a[112:115], v[232:235]
buffer_load_dwordx4 v12, s[32:35], s45 offen offset:0 lds
v_mfma_f32_16x16x32_bf16 v[232:235], a[180:183], a[116:119], v[232:235]
v_mfma_f32_16x16x32_bf16 v[236:239], a[176:179], a[120:123], v[236:239]
v_mfma_f32_16x16x32_bf16 v[236:239], a[180:183], a[124:127], v[236:239]
v_mfma_f32_16x16x32_bf16 v[252:255], a[184:187], a[120:123], v[252:255]
ds_read_b64_tr_b16 a[168:169], v22 offset:40960
v_mfma_f32_16x16x32_bf16 v[252:255], a[188:191], a[124:127], v[252:255]
ds_read_b64_tr_b16 a[170:171], v22 offset:41728
v_mfma_f32_16x16x32_bf16 v[248:251], a[184:187], a[112:115], v[248:251]
ds_read_b64_tr_b16 a[172:173], v22 offset:47104
v_mfma_f32_16x16x32_bf16 v[248:251], a[188:191], a[116:119], v[248:251]
ds_read_b64_tr_b16 a[174:175], v22 offset:47872
v_mfma_f32_16x16x32_bf16 v[244:247], a[184:187], a[104:107], v[244:247]
buffer_load_dwordx4 v13, s[32:35], s45 offen offset:1024 lds
v_mfma_f32_16x16x32_bf16 v[244:247], a[188:191], a[108:111], v[244:247]
v_mfma_f32_16x16x32_bf16 v[240:243], a[184:187], a[96:99], v[240:243]
v_mfma_f32_16x16x32_bf16 v[240:243], a[188:191], a[100:103], v[240:243]
s_waitcnt lgkmcnt(4)
v_mfma_f32_16x16x32_bf16 a[0:3], a[160:163], a[128:131], a[0:3]
ds_read_b64_tr_b16 a[176:177], v21 offset:41024
v_mfma_f32_16x16x32_bf16 a[0:3], a[164:167], a[132:135], a[0:3]
ds_read_b64_tr_b16 a[178:179], v21 offset:41792
v_mfma_f32_16x16x32_bf16 a[4:7], a[160:163], a[136:139], a[4:7]
ds_read_b64_tr_b16 a[180:181], v21 offset:47168
v_mfma_f32_16x16x32_bf16 a[4:7], a[164:167], a[140:143], a[4:7]
ds_read_b64_tr_b16 a[182:183], v21 offset:47936
v_mfma_f32_16x16x32_bf16 a[8:11], a[160:163], a[144:147], a[8:11]
buffer_load_dwordx4 v14, s[32:35], s45 offen offset:2048 lds
v_mfma_f32_16x16x32_bf16 a[8:11], a[164:167], a[148:151], a[8:11]
v_mfma_f32_16x16x32_bf16 a[12:15], a[160:163], a[152:155], a[12:15]
buffer_load_dwordx4 v15, s[32:35], s45 offen offset:3072 lds
v_mfma_f32_16x16x32_bf16 a[12:15], a[164:167], a[156:159], a[12:15]
s_waitcnt lgkmcnt(4)
v_mfma_f32_16x16x32_bf16 a[28:31], a[168:171], a[152:155], a[28:31]
ds_read_b64_tr_b16 a[184:185], v22 offset:41024
v_mfma_f32_16x16x32_bf16 a[28:31], a[172:175], a[156:159], a[28:31]
ds_read_b64_tr_b16 a[186:187], v22 offset:41792
v_mfma_f32_16x16x32_bf16 a[24:27], a[168:171], a[144:147], a[24:27]
ds_read_b64_tr_b16 a[188:189], v22 offset:47168
v_mfma_f32_16x16x32_bf16 a[24:27], a[172:175], a[148:151], a[24:27]
ds_read_b64_tr_b16 a[190:191], v22 offset:47936
s_add_u32 m0, s49, 4096
v_mfma_f32_16x16x32_bf16 a[20:23], a[168:171], a[136:139], a[20:23]
buffer_load_dwordx4 v16, s[32:35], s45 offen offset:0 lds
v_mfma_f32_16x16x32_bf16 a[20:23], a[172:175], a[140:143], a[20:23]
s_waitcnt vmcnt(14)
v_mfma_f32_16x16x32_bf16 a[244:247], a[240:243], a[216:219], a[244:247]
v_mfma_f32_16x16x32_bf16 a[16:19], a[168:171], a[128:131], a[16:19]
v_mfma_f32_16x16x32_bf16 a[16:19], a[172:175], a[132:135], a[16:19]
s_waitcnt lgkmcnt(4)
v_mfma_f32_16x16x32_bf16 a[32:35], a[176:179], a[128:131], a[32:35]
ds_read_b64_tr_b16 a[160:161], v21 offset:41088
v_mfma_f32_16x16x32_bf16 a[32:35], a[180:183], a[132:135], a[32:35]
ds_read_b64_tr_b16 a[162:163], v21 offset:41856
v_mfma_f32_16x16x32_bf16 a[36:39], a[176:179], a[136:139], a[36:39]
ds_read_b64_tr_b16 a[164:165], v21 offset:47232
v_mfma_f32_16x16x32_bf16 a[36:39], a[180:183], a[140:143], a[36:39]
ds_read_b64_tr_b16 a[166:167], v21 offset:48000
v_mfma_f32_16x16x32_bf16 a[40:43], a[176:179], a[144:147], a[40:43]
buffer_load_dwordx4 v17, s[32:35], s45 offen offset:1024 lds
v_mfma_f32_16x16x32_bf16 a[40:43], a[180:183], a[148:151], a[40:43]
v_mfma_f32_16x16x32_bf16 a[44:47], a[176:179], a[152:155], a[44:47]
v_mfma_f32_16x16x32_bf16 a[44:47], a[180:183], a[156:159], a[44:47]
s_waitcnt lgkmcnt(4)
v_mfma_f32_16x16x32_bf16 a[60:63], a[184:187], a[152:155], a[60:63]
ds_read_b64_tr_b16 a[168:169], v22 offset:41088
v_mfma_f32_16x16x32_bf16 a[60:63], a[188:191], a[156:159], a[60:63]
ds_read_b64_tr_b16 a[170:171], v22 offset:41856
v_mfma_f32_16x16x32_bf16 a[56:59], a[184:187], a[144:147], a[56:59]
ds_read_b64_tr_b16 a[172:173], v22 offset:47232
v_mfma_f32_16x16x32_bf16 a[56:59], a[188:191], a[148:151], a[56:59]
ds_read_b64_tr_b16 a[174:175], v22 offset:48000
v_mfma_f32_16x16x32_bf16 a[52:55], a[184:187], a[136:139], a[52:55]
buffer_load_dwordx4 v18, s[32:35], s45 offen offset:2048 lds
s_add_u32 s45, s45, 458752
v_mfma_f32_16x16x32_bf16 a[52:55], a[188:191], a[140:143], a[52:55]
s_waitcnt vmcnt(15)
v_mfma_f32_16x16x32_bf16 a[244:247], a[240:243], a[220:223], a[244:247]
v_mfma_f32_16x16x32_bf16 a[48:51], a[184:187], a[128:131], a[48:51]
v_mfma_f32_16x16x32_bf16 a[48:51], a[188:191], a[132:135], a[48:51]
s_waitcnt lgkmcnt(0)
s_barrier
v_mfma_f32_16x16x32_bf16 a[64:67], a[128:131], a[160:163], a[64:67]
ds_read_b64_tr_b16 a[176:177], v23 offset:40960
v_mfma_f32_16x16x32_bf16 a[64:67], a[132:135], a[164:167], a[64:67]
ds_read_b64_tr_b16 a[178:179], v23 offset:42752
v_mfma_f32_16x16x32_bf16 a[68:71], a[136:139], a[160:163], a[68:71]
ds_read_b64_tr_b16 a[180:181], v23 offset:48128
v_mfma_f32_16x16x32_bf16 a[68:71], a[140:143], a[164:167], a[68:71]
ds_read_b64_tr_b16 a[182:183], v23 offset:49920
s_add_u32 m0, s48, 40960
v_mfma_f32_16x16x32_bf16 a[72:75], a[144:147], a[160:163], a[72:75]
buffer_load_dwordx4 v9, s[28:31], s44 offen offset:0 lds
v_mfma_f32_16x16x32_bf16 a[72:75], a[148:151], a[164:167], a[72:75]
v_mfma_f32_16x16x32_bf16 a[76:79], a[152:155], a[160:163], a[76:79]
v_mfma_f32_16x16x32_bf16 a[76:79], a[156:159], a[164:167], a[76:79]
v_mfma_f32_16x16x32_bf16 a[92:95], a[152:155], a[168:171], a[92:95]
ds_read_b64_tr_b16 a[184:185], v23 offset:40992
v_mfma_f32_16x16x32_bf16 a[92:95], a[156:159], a[172:175], a[92:95]
ds_read_b64_tr_b16 a[186:187], v23 offset:42784
v_mfma_f32_16x16x32_bf16 a[88:91], a[144:147], a[168:171], a[88:91]
ds_read_b64_tr_b16 a[188:189], v23 offset:48160
v_mfma_f32_16x16x32_bf16 a[88:91], a[148:151], a[172:175], a[88:91]
ds_read_b64_tr_b16 a[190:191], v23 offset:49952
v_mfma_f32_16x16x32_bf16 a[84:87], a[136:139], a[168:171], a[84:87]
buffer_load_dwordx4 v10, s[28:31], s44 offen offset:1024 lds
v_mfma_f32_16x16x32_bf16 a[84:87], a[140:143], a[172:175], a[84:87]
s_waitcnt vmcnt(15)
v_mfma_f32_16x16x32_bf16 a[244:247], a[240:243], a[224:227], a[244:247]
v_mfma_f32_16x16x32_bf16 a[80:83], a[128:131], a[168:171], a[80:83]
v_mfma_f32_16x16x32_bf16 a[80:83], a[132:135], a[172:175], a[80:83]
s_waitcnt lgkmcnt(4)
v_mfma_f32_16x16x32_bf16 v[32:35], a[176:179], a[128:131], v[32:35]
ds_read_b64_tr_b16 a[160:161], v23 offset:41024
v_mfma_f32_16x16x32_bf16 v[32:35], a[180:183], a[132:135], v[32:35]
ds_read_b64_tr_b16 a[162:163], v23 offset:42816
v_mfma_f32_16x16x32_bf16 v[36:39], a[176:179], a[136:139], v[36:39]
ds_read_b64_tr_b16 a[164:165], v23 offset:48192
v_mfma_f32_16x16x32_bf16 v[36:39], a[180:183], a[140:143], v[36:39]
ds_read_b64_tr_b16 a[166:167], v23 offset:49984
v_mfma_f32_16x16x32_bf16 v[40:43], a[176:179], a[144:147], v[40:43]
buffer_load_dwordx4 v11, s[28:31], s44 offen offset:2048 lds
s_add_u32 s44, s44, 393216
v_mfma_f32_16x16x32_bf16 v[40:43], a[180:183], a[148:151], v[40:43]
v_mfma_f32_16x16x32_bf16 v[44:47], a[176:179], a[152:155], v[44:47]
v_mfma_f32_16x16x32_bf16 v[44:47], a[180:183], a[156:159], v[44:47]
s_waitcnt lgkmcnt(4)
v_mfma_f32_16x16x32_bf16 v[60:63], a[184:187], a[152:155], v[60:63]
ds_read_b64_tr_b16 a[168:169], v23 offset:41056
v_mfma_f32_16x16x32_bf16 v[60:63], a[188:191], a[156:159], v[60:63]
ds_read_b64_tr_b16 a[170:171], v23 offset:42848
v_mfma_f32_16x16x32_bf16 v[56:59], a[184:187], a[144:147], v[56:59]
ds_read_b64_tr_b16 a[172:173], v23 offset:48224
v_mfma_f32_16x16x32_bf16 v[56:59], a[188:191], a[148:151], v[56:59]
ds_read_b64_tr_b16 a[174:175], v23 offset:50016
v_mfma_f32_16x16x32_bf16 v[52:55], a[184:187], a[136:139], v[52:55]
v_mfma_f32_16x16x32_bf16 v[52:55], a[188:191], a[140:143], v[52:55]
v_mfma_f32_16x16x32_bf16 v[48:51], a[184:187], a[128:131], v[48:51]
v_mfma_f32_16x16x32_bf16 v[48:51], a[188:191], a[132:135], v[48:51]
s_waitcnt lgkmcnt(4)
v_mfma_f32_16x16x32_bf16 v[64:67], a[160:163], a[128:131], v[64:67]
ds_read_b64_tr_b16 a[176:177], v23 offset:41088
v_mfma_f32_16x16x32_bf16 v[64:67], a[164:167], a[132:135], v[64:67]
ds_read_b64_tr_b16 a[178:179], v23 offset:42880
v_mfma_f32_16x16x32_bf16 v[68:71], a[160:163], a[136:139], v[68:71]
ds_read_b64_tr_b16 a[180:181], v23 offset:48256
v_mfma_f32_16x16x32_bf16 v[68:71], a[164:167], a[140:143], v[68:71]
ds_read_b64_tr_b16 a[182:183], v23 offset:50048
v_mfma_f32_16x16x32_bf16 v[72:75], a[160:163], a[144:147], v[72:75]
ds_read_b128 a[96:99], v19 offset:0
v_mfma_f32_16x16x32_bf16 v[72:75], a[164:167], a[148:151], v[72:75]
ds_read_b128 a[100:103], v20 offset:0
v_mfma_f32_16x16x32_bf16 v[76:79], a[160:163], a[152:155], v[76:79]
ds_read_b128 a[104:107], v19 offset:2048
v_mfma_f32_16x16x32_bf16 v[76:79], a[164:167], a[156:159], v[76:79]
ds_read_b128 a[108:111], v20 offset:2048
s_waitcnt lgkmcnt(8)
v_mfma_f32_16x16x32_bf16 v[92:95], a[168:171], a[152:155], v[92:95]
ds_read_b64_tr_b16 a[184:185], v23 offset:41120
s_waitcnt vmcnt(15)
v_mfma_f32_16x16x32_bf16 a[244:247], a[240:243], a[228:231], a[244:247]
v_mfma_f32_16x16x32_bf16 v[92:95], a[172:175], a[156:159], v[92:95]
ds_read_b64_tr_b16 a[186:187], v23 offset:42912
v_mfma_f32_16x16x32_bf16 v[88:91], a[168:171], a[144:147], v[88:91]
ds_read_b64_tr_b16 a[188:189], v23 offset:48288
v_mfma_f32_16x16x32_bf16 v[88:91], a[172:175], a[148:151], v[88:91]
ds_read_b64_tr_b16 a[190:191], v23 offset:50080
v_mfma_f32_16x16x32_bf16 v[84:87], a[168:171], a[136:139], v[84:87]
ds_read_b128 a[112:115], v19 offset:4096
v_mfma_f32_16x16x32_bf16 v[84:87], a[172:175], a[140:143], v[84:87]
ds_read_b128 a[116:119], v20 offset:4096
v_mfma_f32_16x16x32_bf16 v[80:83], a[168:171], a[128:131], v[80:83]
ds_read_b128 a[120:123], v19 offset:6144
v_mfma_f32_16x16x32_bf16 v[80:83], a[172:175], a[132:135], v[80:83]
ds_read_b128 a[124:127], v20 offset:6144
s_waitcnt lgkmcnt(12)
v_mfma_f32_16x16x32_bf16 v[96:99], a[176:179], a[128:131], v[96:99]
ds_read_b64_tr_b16 a[160:161], v23 offset:41152
v_mfma_f32_16x16x32_bf16 v[96:99], a[180:183], a[132:135], v[96:99]
ds_read_b64_tr_b16 a[162:163], v23 offset:42944
v_mfma_f32_16x16x32_bf16 v[100:103], a[176:179], a[136:139], v[100:103]
ds_read_b64_tr_b16 a[164:165], v23 offset:48320
v_mfma_f32_16x16x32_bf16 v[100:103], a[180:183], a[140:143], v[100:103]
ds_read_b64_tr_b16 a[166:167], v23 offset:50112
v_mfma_f32_16x16x32_bf16 v[104:107], a[176:179], a[144:147], v[104:107]
v_mfma_f32_16x16x32_bf16 v[104:107], a[180:183], a[148:151], v[104:107]
v_mfma_f32_16x16x32_bf16 v[108:111], a[176:179], a[152:155], v[108:111]
v_mfma_f32_16x16x32_bf16 v[108:111], a[180:183], a[156:159], v[108:111]
s_waitcnt lgkmcnt(4)
v_mfma_f32_16x16x32_bf16 v[124:127], a[184:187], a[152:155], v[124:127]
ds_read_b64_tr_b16 a[168:169], v23 offset:55296
v_mfma_f32_16x16x32_bf16 v[124:127], a[188:191], a[156:159], v[124:127]
ds_read_b64_tr_b16 a[170:171], v23 offset:57088
v_mfma_f32_16x16x32_bf16 v[120:123], a[184:187], a[144:147], v[120:123]
ds_read_b64_tr_b16 a[172:173], v23 offset:62464
v_mfma_f32_16x16x32_bf16 v[120:123], a[188:191], a[148:151], v[120:123]
ds_read_b64_tr_b16 a[174:175], v23 offset:64256
s_add_u32 m0, s47, 0
v_mfma_f32_16x16x32_bf16 v[116:119], a[184:187], a[136:139], v[116:119]
buffer_load_dwordx4 v1, s[24:27], s43 offen offset:0 lds
v_mfma_f32_16x16x32_bf16 v[116:119], a[188:191], a[140:143], v[116:119]
v_mfma_f32_16x16x32_bf16 v[112:115], a[184:187], a[128:131], v[112:115]
buffer_load_dwordx4 v2, s[24:27], s43 offen offset:1024 lds
v_mfma_f32_16x16x32_bf16 v[112:115], a[188:191], a[132:135], v[112:115]
s_waitcnt lgkmcnt(4)
v_mfma_f32_16x16x32_bf16 v[128:131], a[160:163], a[128:131], v[128:131]
ds_read_b64_tr_b16 a[176:177], v23 offset:55328
buffer_load_dwordx4 a[232:235], v24, s[56:59], s55 offen
v_mfma_f32_16x16x32_bf16 v[128:131], a[164:167], a[132:135], v[128:131]
ds_read_b64_tr_b16 a[178:179], v23 offset:57120
s_add_u32 s55, s55, s54
v_mfma_f32_16x16x32_bf16 v[132:135], a[160:163], a[136:139], v[132:135]
ds_read_b64_tr_b16 a[180:181], v23 offset:62496
buffer_load_dwordx4 a[236:239], v24, s[56:59], s55 offen
v_mfma_f32_16x16x32_bf16 v[132:135], a[164:167], a[140:143], v[132:135]
ds_read_b64_tr_b16 a[182:183], v23 offset:64288
s_add_u32 s55, s55, s54
v_mfma_f32_16x16x32_bf16 v[136:139], a[160:163], a[144:147], v[136:139]
buffer_load_dwordx4 v3, s[24:27], s43 offen offset:2048 lds
buffer_load_dwordx4 a[192:195], v24, s[56:59], s55 offen
v_mfma_f32_16x16x32_bf16 v[136:139], a[164:167], a[148:151], v[136:139]
s_add_u32 s55, s55, s54
buffer_load_dwordx4 a[196:199], v24, s[56:59], s55 offen
v_mfma_f32_16x16x32_bf16 v[140:143], a[160:163], a[152:155], v[140:143]
s_add_u32 s55, s55, s54
v_mfma_f32_16x16x32_bf16 v[140:143], a[164:167], a[156:159], v[140:143]
s_waitcnt lgkmcnt(4)
v_mfma_f32_16x16x32_bf16 v[156:159], a[168:171], a[152:155], v[156:159]
ds_read_b64_tr_b16 a[184:185], v23 offset:55360
v_mfma_f32_16x16x32_bf16 v[156:159], a[172:175], a[156:159], v[156:159]
ds_read_b64_tr_b16 a[186:187], v23 offset:57152
v_mfma_f32_16x16x32_bf16 v[152:155], a[168:171], a[144:147], v[152:155]
ds_read_b64_tr_b16 a[188:189], v23 offset:62528
v_mfma_f32_16x16x32_bf16 v[152:155], a[172:175], a[148:151], v[152:155]
ds_read_b64_tr_b16 a[190:191], v23 offset:64320
v_mfma_f32_16x16x32_bf16 v[148:151], a[168:171], a[136:139], v[148:151]
buffer_load_dwordx4 v4, s[24:27], s43 offen offset:3072 lds
v_mfma_f32_16x16x32_bf16 v[148:151], a[172:175], a[140:143], v[148:151]
s_lshl_b32 s50, s2, 2
v_mfma_f32_16x16x32_bf16 v[144:147], a[168:171], a[128:131], v[144:147]
s_add_u32 s50, s50, s40
v_mfma_f32_16x16x32_bf16 v[144:147], a[172:175], a[132:135], v[144:147]
s_lshl_b32 s50, s50, 12
s_waitcnt lgkmcnt(4)
v_mfma_f32_16x16x32_bf16 v[160:163], a[176:179], a[128:131], v[160:163]
ds_read_b64_tr_b16 a[160:161], v23 offset:55392
v_mfma_f32_16x16x32_bf16 v[160:163], a[180:183], a[132:135], v[160:163]
ds_read_b64_tr_b16 a[162:163], v23 offset:57184
v_mfma_f32_16x16x32_bf16 v[164:167], a[176:179], a[136:139], v[164:167]
ds_read_b64_tr_b16 a[164:165], v23 offset:62560
v_mfma_f32_16x16x32_bf16 v[164:167], a[180:183], a[140:143], v[164:167]
ds_read_b64_tr_b16 a[166:167], v23 offset:64352
s_add_u32 m0, s47, 4096
v_mfma_f32_16x16x32_bf16 v[168:171], a[176:179], a[144:147], v[168:171]
buffer_load_dwordx4 v5, s[24:27], s43 offen offset:0 lds
v_mfma_f32_16x16x32_bf16 v[168:171], a[180:183], a[148:151], v[168:171]
s_add_u32 s50, s50, 37748736
v_mfma_f32_16x16x32_bf16 v[172:175], a[176:179], a[152:155], v[172:175]
v_lshlrev_b32 v29, 4, v0
v_mfma_f32_16x16x32_bf16 v[172:175], a[180:183], a[156:159], v[172:175]
buffer_store_dwordx4 a[250:253], v29, s[36:39], s50 offen offset:0 sc1
s_waitcnt lgkmcnt(4)
v_mfma_f32_16x16x32_bf16 v[188:191], a[184:187], a[152:155], v[188:191]
ds_read_b64_tr_b16 a[168:169], v23 offset:55424
v_mfma_f32_16x16x32_bf16 v[188:191], a[188:191], a[156:159], v[188:191]
ds_read_b64_tr_b16 a[170:171], v23 offset:57216
v_mfma_f32_16x16x32_bf16 v[184:187], a[184:187], a[144:147], v[184:187]
ds_read_b64_tr_b16 a[172:173], v23 offset:62592
v_mfma_f32_16x16x32_bf16 v[184:187], a[188:191], a[148:151], v[184:187]
ds_read_b64_tr_b16 a[174:175], v23 offset:64384
v_mfma_f32_16x16x32_bf16 v[180:183], a[184:187], a[136:139], v[180:183]
buffer_load_dwordx4 v6, s[24:27], s43 offen offset:1024 lds
v_mfma_f32_16x16x32_bf16 v[180:183], a[188:191], a[140:143], v[180:183]
v_mfma_f32_16x16x32_bf16 v[176:179], a[184:187], a[128:131], v[176:179]
v_mfma_f32_16x16x32_bf16 v[176:179], a[188:191], a[132:135], v[176:179]
s_waitcnt lgkmcnt(4)
v_mfma_f32_16x16x32_bf16 v[192:195], a[160:163], a[128:131], v[192:195]
ds_read_b64_tr_b16 a[176:177], v23 offset:55456
v_mfma_f32_16x16x32_bf16 v[192:195], a[164:167], a[132:135], v[192:195]
ds_read_b64_tr_b16 a[178:179], v23 offset:57248
v_mfma_f32_16x16x32_bf16 v[196:199], a[160:163], a[136:139], v[196:199]
ds_read_b64_tr_b16 a[180:181], v23 offset:62624
v_mfma_f32_16x16x32_bf16 v[196:199], a[164:167], a[140:143], v[196:199]
ds_read_b64_tr_b16 a[182:183], v23 offset:64416
v_mfma_f32_16x16x32_bf16 v[200:203], a[160:163], a[144:147], v[200:203]
buffer_load_dwordx4 v7, s[24:27], s43 offen offset:2048 lds
v_mfma_f32_16x16x32_bf16 v[200:203], a[164:167], a[148:151], v[200:203]
v_mfma_f32_16x16x32_bf16 v[204:207], a[160:163], a[152:155], v[204:207]
v_mfma_f32_16x16x32_bf16 v[204:207], a[164:167], a[156:159], v[204:207]
s_waitcnt lgkmcnt(4)
v_mfma_f32_16x16x32_bf16 v[220:223], a[168:171], a[152:155], v[220:223]
ds_read_b64_tr_b16 a[184:185], v23 offset:55488
v_mfma_f32_16x16x32_bf16 v[220:223], a[172:175], a[156:159], v[220:223]
ds_read_b64_tr_b16 a[186:187], v23 offset:57280
v_mfma_f32_16x16x32_bf16 v[216:219], a[168:171], a[144:147], v[216:219]
ds_read_b64_tr_b16 a[188:189], v23 offset:62656
v_mfma_f32_16x16x32_bf16 v[216:219], a[172:175], a[148:151], v[216:219]
ds_read_b64_tr_b16 a[190:191], v23 offset:64448
v_mfma_f32_16x16x32_bf16 v[212:215], a[168:171], a[136:139], v[212:215]
buffer_load_dwordx4 v8, s[24:27], s43 offen offset:3072 lds
s_add_u32 s43, s43, 128
v_mfma_f32_16x16x32_bf16 v[212:215], a[172:175], a[140:143], v[212:215]
v_mfma_f32_16x16x32_bf16 v[208:211], a[168:171], a[128:131], v[208:211]
v_mfma_f32_16x16x32_bf16 v[208:211], a[172:175], a[132:135], v[208:211]
s_waitcnt lgkmcnt(0)
s_barrier
v_mfma_f32_16x16x32_bf16 v[224:227], a[176:179], a[128:131], v[224:227]
ds_read_b64_tr_b16 a[160:161], v21 offset:0
v_mfma_f32_16x16x32_bf16 v[224:227], a[180:183], a[132:135], v[224:227]
ds_read_b64_tr_b16 a[162:163], v21 offset:768
v_mfma_f32_16x16x32_bf16 v[228:231], a[176:179], a[136:139], v[228:231]
ds_read_b64_tr_b16 a[164:165], v21 offset:6144
v_mfma_f32_16x16x32_bf16 v[228:231], a[180:183], a[140:143], v[228:231]
ds_read_b64_tr_b16 a[166:167], v21 offset:6912
s_add_u32 m0, s49, 40960
v_mfma_f32_16x16x32_bf16 v[232:235], a[176:179], a[144:147], v[232:235]
buffer_load_dwordx4 v12, s[32:35], s45 offen offset:0 lds
v_mfma_f32_16x16x32_bf16 v[232:235], a[180:183], a[148:151], v[232:235]
v_mfma_f32_16x16x32_bf16 v[236:239], a[176:179], a[152:155], v[236:239]
v_mfma_f32_16x16x32_bf16 v[236:239], a[180:183], a[156:159], v[236:239]
v_mfma_f32_16x16x32_bf16 v[252:255], a[184:187], a[152:155], v[252:255]
ds_read_b64_tr_b16 a[168:169], v22 offset:0
v_mfma_f32_16x16x32_bf16 v[252:255], a[188:191], a[156:159], v[252:255]
ds_read_b64_tr_b16 a[170:171], v22 offset:768
v_mfma_f32_16x16x32_bf16 v[248:251], a[184:187], a[144:147], v[248:251]
ds_read_b64_tr_b16 a[172:173], v22 offset:6144
v_mfma_f32_16x16x32_bf16 v[248:251], a[188:191], a[148:151], v[248:251]
ds_read_b64_tr_b16 a[174:175], v22 offset:6912
v_mfma_f32_16x16x32_bf16 v[244:247], a[184:187], a[136:139], v[244:247]
buffer_load_dwordx4 v13, s[32:35], s45 offen offset:1024 lds
v_mfma_f32_16x16x32_bf16 v[244:247], a[188:191], a[140:143], v[244:247]
v_mfma_f32_16x16x32_bf16 v[240:243], a[184:187], a[128:131], v[240:243]
v_mfma_f32_16x16x32_bf16 v[240:243], a[188:191], a[132:135], v[240:243]
s_waitcnt lgkmcnt(4)
v_mfma_f32_16x16x32_bf16 a[0:3], a[160:163], a[96:99], a[0:3]
ds_read_b64_tr_b16 a[176:177], v21 offset:64
v_mfma_f32_16x16x32_bf16 a[0:3], a[164:167], a[100:103], a[0:3]
ds_read_b64_tr_b16 a[178:179], v21 offset:832
v_mfma_f32_16x16x32_bf16 a[4:7], a[160:163], a[104:107], a[4:7]
ds_read_b64_tr_b16 a[180:181], v21 offset:6208
v_mfma_f32_16x16x32_bf16 a[4:7], a[164:167], a[108:111], a[4:7]
ds_read_b64_tr_b16 a[182:183], v21 offset:6976
v_mfma_f32_16x16x32_bf16 a[8:11], a[160:163], a[112:115], a[8:11]
buffer_load_dwordx4 v14, s[32:35], s45 offen offset:2048 lds
v_mfma_f32_16x16x32_bf16 a[8:11], a[164:167], a[116:119], a[8:11]
v_mfma_f32_16x16x32_bf16 a[12:15], a[160:163], a[120:123], a[12:15]
buffer_load_dwordx4 v15, s[32:35], s45 offen offset:3072 lds
v_mfma_f32_16x16x32_bf16 a[12:15], a[164:167], a[124:127], a[12:15]
s_waitcnt lgkmcnt(4)
v_mfma_f32_16x16x32_bf16 a[28:31], a[168:171], a[120:123], a[28:31]
ds_read_b64_tr_b16 a[184:185], v22 offset:64
v_mfma_f32_16x16x32_bf16 a[28:31], a[172:175], a[124:127], a[28:31]
ds_read_b64_tr_b16 a[186:187], v22 offset:832
v_mfma_f32_16x16x32_bf16 a[24:27], a[168:171], a[112:115], a[24:27]
ds_read_b64_tr_b16 a[188:189], v22 offset:6208
v_mfma_f32_16x16x32_bf16 a[24:27], a[172:175], a[116:119], a[24:27]
ds_read_b64_tr_b16 a[190:191], v22 offset:6976
s_add_u32 m0, s49, 45056
v_mfma_f32_16x16x32_bf16 a[20:23], a[168:171], a[104:107], a[20:23]
buffer_load_dwordx4 v16, s[32:35], s45 offen offset:0 lds
v_mfma_f32_16x16x32_bf16 a[20:23], a[172:175], a[108:111], a[20:23]
s_waitcnt vmcnt(15)
v_mfma_f32_16x16x32_bf16 a[244:247], a[240:243], a[232:235], a[244:247]
v_mfma_f32_16x16x32_bf16 a[16:19], a[168:171], a[96:99], a[16:19]
v_mfma_f32_16x16x32_bf16 a[16:19], a[172:175], a[100:103], a[16:19]
s_waitcnt lgkmcnt(4)
v_mfma_f32_16x16x32_bf16 a[32:35], a[176:179], a[96:99], a[32:35]
ds_read_b64_tr_b16 a[160:161], v21 offset:128
v_mfma_f32_16x16x32_bf16 a[32:35], a[180:183], a[100:103], a[32:35]
ds_read_b64_tr_b16 a[162:163], v21 offset:896
v_mfma_f32_16x16x32_bf16 a[36:39], a[176:179], a[104:107], a[36:39]
ds_read_b64_tr_b16 a[164:165], v21 offset:6272
v_mfma_f32_16x16x32_bf16 a[36:39], a[180:183], a[108:111], a[36:39]
ds_read_b64_tr_b16 a[166:167], v21 offset:7040
v_mfma_f32_16x16x32_bf16 a[40:43], a[176:179], a[112:115], a[40:43]
buffer_load_dwordx4 v17, s[32:35], s45 offen offset:1024 lds
v_mfma_f32_16x16x32_bf16 a[40:43], a[180:183], a[116:119], a[40:43]
v_mfma_f32_16x16x32_bf16 a[44:47], a[176:179], a[120:123], a[44:47]
v_mfma_f32_16x16x32_bf16 a[44:47], a[180:183], a[124:127], a[44:47]
s_waitcnt lgkmcnt(4)
v_mfma_f32_16x16x32_bf16 a[60:63], a[184:187], a[120:123], a[60:63]
ds_read_b64_tr_b16 a[168:169], v22 offset:128
v_mfma_f32_16x16x32_bf16 a[60:63], a[188:191], a[124:127], a[60:63]
ds_read_b64_tr_b16 a[170:171], v22 offset:896
v_mfma_f32_16x16x32_bf16 a[56:59], a[184:187], a[112:115], a[56:59]
ds_read_b64_tr_b16 a[172:173], v22 offset:6272
v_mfma_f32_16x16x32_bf16 a[56:59], a[188:191], a[116:119], a[56:59]
ds_read_b64_tr_b16 a[174:175], v22 offset:7040
v_mfma_f32_16x16x32_bf16 a[52:55], a[184:187], a[104:107], a[52:55]
buffer_load_dwordx4 v18, s[32:35], s45 offen offset:2048 lds
s_add_u32 s45, s45, 458752
v_mfma_f32_16x16x32_bf16 a[52:55], a[188:191], a[108:111], a[52:55]
s_waitcnt vmcnt(16)
v_mfma_f32_16x16x32_bf16 a[244:247], a[240:243], a[236:239], a[244:247]
v_mfma_f32_16x16x32_bf16 a[48:51], a[184:187], a[96:99], a[48:51]
v_mfma_f32_16x16x32_bf16 a[48:51], a[188:191], a[100:103], a[48:51]
s_waitcnt lgkmcnt(0)
s_barrier
v_mfma_f32_16x16x32_bf16 a[64:67], a[96:99], a[160:163], a[64:67]
ds_read_b64_tr_b16 a[176:177], v23 offset:0
v_mfma_f32_16x16x32_bf16 a[64:67], a[100:103], a[164:167], a[64:67]
ds_read_b64_tr_b16 a[178:179], v23 offset:1792
v_mfma_f32_16x16x32_bf16 a[68:71], a[104:107], a[160:163], a[68:71]
ds_read_b64_tr_b16 a[180:181], v23 offset:7168
v_mfma_f32_16x16x32_bf16 a[68:71], a[108:111], a[164:167], a[68:71]
ds_read_b64_tr_b16 a[182:183], v23 offset:8960
s_add_u32 m0, s48, 0
v_mfma_f32_16x16x32_bf16 a[72:75], a[112:115], a[160:163], a[72:75]
buffer_load_dwordx4 v9, s[28:31], s44 offen offset:0 lds
v_mfma_f32_16x16x32_bf16 a[72:75], a[116:119], a[164:167], a[72:75]
v_mfma_f32_16x16x32_bf16 a[76:79], a[120:123], a[160:163], a[76:79]
v_mfma_f32_16x16x32_bf16 a[76:79], a[124:127], a[164:167], a[76:79]
v_mfma_f32_16x16x32_bf16 a[92:95], a[120:123], a[168:171], a[92:95]
ds_read_b64_tr_b16 a[184:185], v23 offset:32
v_mfma_f32_16x16x32_bf16 a[92:95], a[124:127], a[172:175], a[92:95]
ds_read_b64_tr_b16 a[186:187], v23 offset:1824
v_mfma_f32_16x16x32_bf16 a[88:91], a[112:115], a[168:171], a[88:91]
ds_read_b64_tr_b16 a[188:189], v23 offset:7200
v_mfma_f32_16x16x32_bf16 a[88:91], a[116:119], a[172:175], a[88:91]
ds_read_b64_tr_b16 a[190:191], v23 offset:8992
v_mfma_f32_16x16x32_bf16 a[84:87], a[104:107], a[168:171], a[84:87]
buffer_load_dwordx4 v10, s[28:31], s44 offen offset:1024 lds
v_mfma_f32_16x16x32_bf16 a[84:87], a[108:111], a[172:175], a[84:87]
s_waitcnt vmcnt(16)
v_mfma_f32_16x16x32_bf16 a[244:247], a[240:243], a[192:195], a[244:247]
v_mfma_f32_16x16x32_bf16 a[80:83], a[96:99], a[168:171], a[80:83]
v_mfma_f32_16x16x32_bf16 a[80:83], a[100:103], a[172:175], a[80:83]
s_waitcnt lgkmcnt(4)
v_mfma_f32_16x16x32_bf16 v[32:35], a[176:179], a[96:99], v[32:35]
ds_read_b64_tr_b16 a[160:161], v23 offset:64
v_mfma_f32_16x16x32_bf16 v[32:35], a[180:183], a[100:103], v[32:35]
ds_read_b64_tr_b16 a[162:163], v23 offset:1856
v_mfma_f32_16x16x32_bf16 v[36:39], a[176:179], a[104:107], v[36:39]
ds_read_b64_tr_b16 a[164:165], v23 offset:7232
v_mfma_f32_16x16x32_bf16 v[36:39], a[180:183], a[108:111], v[36:39]
ds_read_b64_tr_b16 a[166:167], v23 offset:9024
v_mfma_f32_16x16x32_bf16 v[40:43], a[176:179], a[112:115], v[40:43]
buffer_load_dwordx4 v11, s[28:31], s44 offen offset:2048 lds
s_add_u32 s44, s44, 393216
v_mfma_f32_16x16x32_bf16 v[40:43], a[180:183], a[116:119], v[40:43]
v_mfma_f32_16x16x32_bf16 v[44:47], a[176:179], a[120:123], v[44:47]
v_mfma_f32_16x16x32_bf16 v[44:47], a[180:183], a[124:127], v[44:47]
s_waitcnt lgkmcnt(4)
v_mfma_f32_16x16x32_bf16 v[60:63], a[184:187], a[120:123], v[60:63]
ds_read_b64_tr_b16 a[168:169], v23 offset:96
v_mfma_f32_16x16x32_bf16 v[60:63], a[188:191], a[124:127], v[60:63]
ds_read_b64_tr_b16 a[170:171], v23 offset:1888
v_mfma_f32_16x16x32_bf16 v[56:59], a[184:187], a[112:115], v[56:59]
ds_read_b64_tr_b16 a[172:173], v23 offset:7264
v_mfma_f32_16x16x32_bf16 v[56:59], a[188:191], a[116:119], v[56:59]
ds_read_b64_tr_b16 a[174:175], v23 offset:9056
v_mfma_f32_16x16x32_bf16 v[52:55], a[184:187], a[104:107], v[52:55]
v_mfma_f32_16x16x32_bf16 v[52:55], a[188:191], a[108:111], v[52:55]
v_mfma_f32_16x16x32_bf16 v[48:51], a[184:187], a[96:99], v[48:51]
v_mfma_f32_16x16x32_bf16 v[48:51], a[188:191], a[100:103], v[48:51]
s_waitcnt lgkmcnt(4)
v_mfma_f32_16x16x32_bf16 v[64:67], a[160:163], a[96:99], v[64:67]
ds_read_b64_tr_b16 a[176:177], v23 offset:128
v_mfma_f32_16x16x32_bf16 v[64:67], a[164:167], a[100:103], v[64:67]
ds_read_b64_tr_b16 a[178:179], v23 offset:1920
v_mfma_f32_16x16x32_bf16 v[68:71], a[160:163], a[104:107], v[68:71]
ds_read_b64_tr_b16 a[180:181], v23 offset:7296
v_mfma_f32_16x16x32_bf16 v[68:71], a[164:167], a[108:111], v[68:71]
ds_read_b64_tr_b16 a[182:183], v23 offset:9088
v_mfma_f32_16x16x32_bf16 v[72:75], a[160:163], a[112:115], v[72:75]
ds_read_b128 a[128:131], v19 offset:32768
v_mfma_f32_16x16x32_bf16 v[72:75], a[164:167], a[116:119], v[72:75]
ds_read_b128 a[132:135], v20 offset:32768
v_mfma_f32_16x16x32_bf16 v[76:79], a[160:163], a[120:123], v[76:79]
ds_read_b128 a[136:139], v19 offset:34816
v_mfma_f32_16x16x32_bf16 v[76:79], a[164:167], a[124:127], v[76:79]
ds_read_b128 a[140:143], v20 offset:34816
s_waitcnt lgkmcnt(8)
v_mfma_f32_16x16x32_bf16 v[92:95], a[168:171], a[120:123], v[92:95]
ds_read_b64_tr_b16 a[184:185], v23 offset:160
s_waitcnt vmcnt(16)
v_mfma_f32_16x16x32_bf16 a[244:247], a[240:243], a[196:199], a[244:247]
v_mfma_f32_16x16x32_bf16 v[92:95], a[172:175], a[124:127], v[92:95]
ds_read_b64_tr_b16 a[186:187], v23 offset:1952
v_mfma_f32_16x16x32_bf16 v[88:91], a[168:171], a[112:115], v[88:91]
ds_read_b64_tr_b16 a[188:189], v23 offset:7328
v_mfma_f32_16x16x32_bf16 v[88:91], a[172:175], a[116:119], v[88:91]
ds_read_b64_tr_b16 a[190:191], v23 offset:9120
v_mfma_f32_16x16x32_bf16 v[84:87], a[168:171], a[104:107], v[84:87]
ds_read_b128 a[144:147], v19 offset:36864
v_mfma_f32_16x16x32_bf16 v[84:87], a[172:175], a[108:111], v[84:87]
ds_read_b128 a[148:151], v20 offset:36864
v_mfma_f32_16x16x32_bf16 v[80:83], a[168:171], a[96:99], v[80:83]
ds_read_b128 a[152:155], v19 offset:38912
v_mfma_f32_16x16x32_bf16 v[80:83], a[172:175], a[100:103], v[80:83]
ds_read_b128 a[156:159], v20 offset:38912
s_waitcnt lgkmcnt(12)
v_mfma_f32_16x16x32_bf16 v[96:99], a[176:179], a[96:99], v[96:99]
ds_read_b64_tr_b16 a[160:161], v23 offset:192
v_mfma_f32_16x16x32_bf16 v[96:99], a[180:183], a[100:103], v[96:99]
ds_read_b64_tr_b16 a[162:163], v23 offset:1984
v_mfma_f32_16x16x32_bf16 v[100:103], a[176:179], a[104:107], v[100:103]
ds_read_b64_tr_b16 a[164:165], v23 offset:7360
v_mfma_f32_16x16x32_bf16 v[100:103], a[180:183], a[108:111], v[100:103]
ds_read_b64_tr_b16 a[166:167], v23 offset:9152
v_mfma_f32_16x16x32_bf16 v[104:107], a[176:179], a[112:115], v[104:107]
v_mfma_f32_16x16x32_bf16 v[104:107], a[180:183], a[116:119], v[104:107]
v_mfma_f32_16x16x32_bf16 v[108:111], a[176:179], a[120:123], v[108:111]
v_mfma_f32_16x16x32_bf16 v[108:111], a[180:183], a[124:127], v[108:111]
s_waitcnt lgkmcnt(4)
v_mfma_f32_16x16x32_bf16 v[124:127], a[184:187], a[120:123], v[124:127]
ds_read_b64_tr_b16 a[168:169], v23 offset:14336
v_mfma_f32_16x16x32_bf16 v[124:127], a[188:191], a[124:127], v[124:127]
ds_read_b64_tr_b16 a[170:171], v23 offset:16128
v_mfma_f32_16x16x32_bf16 v[120:123], a[184:187], a[112:115], v[120:123]
ds_read_b64_tr_b16 a[172:173], v23 offset:21504
v_mfma_f32_16x16x32_bf16 v[120:123], a[188:191], a[116:119], v[120:123]
ds_read_b64_tr_b16 a[174:175], v23 offset:23296
s_add_u32 m0, s47, 32768
v_mfma_f32_16x16x32_bf16 v[116:119], a[184:187], a[104:107], v[116:119]
buffer_load_dwordx4 v1, s[24:27], s43 offen offset:0 lds
v_mfma_f32_16x16x32_bf16 v[116:119], a[188:191], a[108:111], v[116:119]
v_mfma_f32_16x16x32_bf16 v[112:115], a[184:187], a[96:99], v[112:115]
buffer_load_dwordx4 v2, s[24:27], s43 offen offset:1024 lds
v_mfma_f32_16x16x32_bf16 v[112:115], a[188:191], a[100:103], v[112:115]
s_waitcnt lgkmcnt(4)
v_mfma_f32_16x16x32_bf16 v[128:131], a[160:163], a[96:99], v[128:131]
ds_read_b64_tr_b16 a[176:177], v23 offset:14368
buffer_load_dwordx4 a[200:203], v24, s[56:59], s55 offen
v_mfma_f32_16x16x32_bf16 v[128:131], a[164:167], a[100:103], v[128:131]
ds_read_b64_tr_b16 a[178:179], v23 offset:16160
s_add_u32 s55, s55, s54
v_mfma_f32_16x16x32_bf16 v[132:135], a[160:163], a[104:107], v[132:135]
ds_read_b64_tr_b16 a[180:181], v23 offset:21536
buffer_load_dwordx4 a[204:207], v24, s[56:59], s55 offen
v_mfma_f32_16x16x32_bf16 v[132:135], a[164:167], a[108:111], v[132:135]
ds_read_b64_tr_b16 a[182:183], v23 offset:23328
s_add_u32 s55, s55, s54
v_mfma_f32_16x16x32_bf16 v[136:139], a[160:163], a[112:115], v[136:139]
buffer_load_dwordx4 v3, s[24:27], s43 offen offset:2048 lds
buffer_load_dwordx4 a[208:211], v24, s[56:59], s55 offen
v_mfma_f32_16x16x32_bf16 v[136:139], a[164:167], a[116:119], v[136:139]
s_add_u32 s55, s55, s54
buffer_load_dwordx4 a[212:215], v24, s[56:59], s55 offen
v_mfma_f32_16x16x32_bf16 v[140:143], a[160:163], a[120:123], v[140:143]
s_add_u32 s55, s55, s54
v_mfma_f32_16x16x32_bf16 v[140:143], a[164:167], a[124:127], v[140:143]
s_waitcnt lgkmcnt(4)
v_mfma_f32_16x16x32_bf16 v[156:159], a[168:171], a[120:123], v[156:159]
ds_read_b64_tr_b16 a[184:185], v23 offset:14400
v_mfma_f32_16x16x32_bf16 v[156:159], a[172:175], a[124:127], v[156:159]
ds_read_b64_tr_b16 a[186:187], v23 offset:16192
v_mfma_f32_16x16x32_bf16 v[152:155], a[168:171], a[112:115], v[152:155]
ds_read_b64_tr_b16 a[188:189], v23 offset:21568
v_mfma_f32_16x16x32_bf16 v[152:155], a[172:175], a[116:119], v[152:155]
ds_read_b64_tr_b16 a[190:191], v23 offset:23360
v_mfma_f32_16x16x32_bf16 v[148:151], a[168:171], a[104:107], v[148:151]
buffer_load_dwordx4 v4, s[24:27], s43 offen offset:3072 lds
v_mfma_f32_16x16x32_bf16 v[148:151], a[172:175], a[108:111], v[148:151]
s_lshl_b32 s50, s2, 2
v_mfma_f32_16x16x32_bf16 v[144:147], a[168:171], a[96:99], v[144:147]
s_add_u32 s50, s50, s40
v_mfma_f32_16x16x32_bf16 v[144:147], a[172:175], a[100:103], v[144:147]
s_lshl_b32 s50, s50, 12
s_waitcnt lgkmcnt(4)
v_mfma_f32_16x16x32_bf16 v[160:163], a[176:179], a[96:99], v[160:163]
ds_read_b64_tr_b16 a[160:161], v23 offset:14432
v_mfma_f32_16x16x32_bf16 v[160:163], a[180:183], a[100:103], v[160:163]
ds_read_b64_tr_b16 a[162:163], v23 offset:16224
v_mfma_f32_16x16x32_bf16 v[164:167], a[176:179], a[104:107], v[164:167]
ds_read_b64_tr_b16 a[164:165], v23 offset:21600
v_mfma_f32_16x16x32_bf16 v[164:167], a[180:183], a[108:111], v[164:167]
ds_read_b64_tr_b16 a[166:167], v23 offset:23392
s_add_u32 m0, s47, 36864
v_mfma_f32_16x16x32_bf16 v[168:171], a[176:179], a[112:115], v[168:171]
buffer_load_dwordx4 v5, s[24:27], s43 offen offset:0 lds
v_mfma_f32_16x16x32_bf16 v[168:171], a[180:183], a[116:119], v[168:171]
s_add_u32 s50, s50, 37748736
v_mfma_f32_16x16x32_bf16 v[172:175], a[176:179], a[120:123], v[172:175]
v_lshlrev_b32 v29, 4, v0
v_mfma_f32_16x16x32_bf16 v[172:175], a[180:183], a[124:127], v[172:175]
buffer_store_dwordx4 a[250:253], v29, s[36:39], s50 offen offset:1024 sc1
s_waitcnt lgkmcnt(4)
v_mfma_f32_16x16x32_bf16 v[188:191], a[184:187], a[120:123], v[188:191]
ds_read_b64_tr_b16 a[168:169], v23 offset:14464
v_mfma_f32_16x16x32_bf16 v[188:191], a[188:191], a[124:127], v[188:191]
ds_read_b64_tr_b16 a[170:171], v23 offset:16256
v_mfma_f32_16x16x32_bf16 v[184:187], a[184:187], a[112:115], v[184:187]
ds_read_b64_tr_b16 a[172:173], v23 offset:21632
v_mfma_f32_16x16x32_bf16 v[184:187], a[188:191], a[116:119], v[184:187]
ds_read_b64_tr_b16 a[174:175], v23 offset:23424
v_mfma_f32_16x16x32_bf16 v[180:183], a[184:187], a[104:107], v[180:183]
buffer_load_dwordx4 v6, s[24:27], s43 offen offset:1024 lds
v_mfma_f32_16x16x32_bf16 v[180:183], a[188:191], a[108:111], v[180:183]
v_mfma_f32_16x16x32_bf16 v[176:179], a[184:187], a[96:99], v[176:179]
v_mfma_f32_16x16x32_bf16 v[176:179], a[188:191], a[100:103], v[176:179]
s_waitcnt lgkmcnt(4)
v_mfma_f32_16x16x32_bf16 v[192:195], a[160:163], a[96:99], v[192:195]
ds_read_b64_tr_b16 a[176:177], v23 offset:14496
v_mfma_f32_16x16x32_bf16 v[192:195], a[164:167], a[100:103], v[192:195]
ds_read_b64_tr_b16 a[178:179], v23 offset:16288
v_mfma_f32_16x16x32_bf16 v[196:199], a[160:163], a[104:107], v[196:199]
ds_read_b64_tr_b16 a[180:181], v23 offset:21664
v_mfma_f32_16x16x32_bf16 v[196:199], a[164:167], a[108:111], v[196:199]
ds_read_b64_tr_b16 a[182:183], v23 offset:23456
v_mfma_f32_16x16x32_bf16 v[200:203], a[160:163], a[112:115], v[200:203]
buffer_load_dwordx4 v7, s[24:27], s43 offen offset:2048 lds
v_mfma_f32_16x16x32_bf16 v[200:203], a[164:167], a[116:119], v[200:203]
v_mfma_f32_16x16x32_bf16 v[204:207], a[160:163], a[120:123], v[204:207]
v_mfma_f32_16x16x32_bf16 v[204:207], a[164:167], a[124:127], v[204:207]
s_waitcnt lgkmcnt(4)
v_mfma_f32_16x16x32_bf16 v[220:223], a[168:171], a[120:123], v[220:223]
ds_read_b64_tr_b16 a[184:185], v23 offset:14528
v_mfma_f32_16x16x32_bf16 v[220:223], a[172:175], a[124:127], v[220:223]
ds_read_b64_tr_b16 a[186:187], v23 offset:16320
v_mfma_f32_16x16x32_bf16 v[216:219], a[168:171], a[112:115], v[216:219]
ds_read_b64_tr_b16 a[188:189], v23 offset:21696
v_mfma_f32_16x16x32_bf16 v[216:219], a[172:175], a[116:119], v[216:219]
ds_read_b64_tr_b16 a[190:191], v23 offset:23488
v_mfma_f32_16x16x32_bf16 v[212:215], a[168:171], a[104:107], v[212:215]
buffer_load_dwordx4 v8, s[24:27], s43 offen offset:3072 lds
s_add_u32 s43, s43, 128
v_mfma_f32_16x16x32_bf16 v[212:215], a[172:175], a[108:111], v[212:215]
v_mfma_f32_16x16x32_bf16 v[208:211], a[168:171], a[96:99], v[208:211]
v_mfma_f32_16x16x32_bf16 v[208:211], a[172:175], a[100:103], v[208:211]
s_waitcnt lgkmcnt(0)
s_barrier
v_mfma_f32_16x16x32_bf16 v[224:227], a[176:179], a[96:99], v[224:227]
ds_read_b64_tr_b16 a[160:161], v21 offset:40960
v_mfma_f32_16x16x32_bf16 v[224:227], a[180:183], a[100:103], v[224:227]
ds_read_b64_tr_b16 a[162:163], v21 offset:41728
v_mfma_f32_16x16x32_bf16 v[228:231], a[176:179], a[104:107], v[228:231]
ds_read_b64_tr_b16 a[164:165], v21 offset:47104
v_mfma_f32_16x16x32_bf16 v[228:231], a[180:183], a[108:111], v[228:231]
ds_read_b64_tr_b16 a[166:167], v21 offset:47872
s_add_u32 m0, s49, 0
v_mfma_f32_16x16x32_bf16 v[232:235], a[176:179], a[112:115], v[232:235]
buffer_load_dwordx4 v12, s[32:35], s45 offen offset:0 lds
v_mfma_f32_16x16x32_bf16 v[232:235], a[180:183], a[116:119], v[232:235]
v_mfma_f32_16x16x32_bf16 v[236:239], a[176:179], a[120:123], v[236:239]
v_mfma_f32_16x16x32_bf16 v[236:239], a[180:183], a[124:127], v[236:239]
v_mfma_f32_16x16x32_bf16 v[252:255], a[184:187], a[120:123], v[252:255]
ds_read_b64_tr_b16 a[168:169], v22 offset:40960
v_mfma_f32_16x16x32_bf16 v[252:255], a[188:191], a[124:127], v[252:255]
ds_read_b64_tr_b16 a[170:171], v22 offset:41728
v_mfma_f32_16x16x32_bf16 v[248:251], a[184:187], a[112:115], v[248:251]
ds_read_b64_tr_b16 a[172:173], v22 offset:47104
v_mfma_f32_16x16x32_bf16 v[248:251], a[188:191], a[116:119], v[248:251]
ds_read_b64_tr_b16 a[174:175], v22 offset:47872
v_mfma_f32_16x16x32_bf16 v[244:247], a[184:187], a[104:107], v[244:247]
buffer_load_dwordx4 v13, s[32:35], s45 offen offset:1024 lds
v_mfma_f32_16x16x32_bf16 v[244:247], a[188:191], a[108:111], v[244:247]
v_mfma_f32_16x16x32_bf16 v[240:243], a[184:187], a[96:99], v[240:243]
v_mfma_f32_16x16x32_bf16 v[240:243], a[188:191], a[100:103], v[240:243]
s_waitcnt lgkmcnt(4)
v_mfma_f32_16x16x32_bf16 a[0:3], a[160:163], a[128:131], a[0:3]
ds_read_b64_tr_b16 a[176:177], v21 offset:41024
v_mfma_f32_16x16x32_bf16 a[0:3], a[164:167], a[132:135], a[0:3]
ds_read_b64_tr_b16 a[178:179], v21 offset:41792
v_mfma_f32_16x16x32_bf16 a[4:7], a[160:163], a[136:139], a[4:7]
ds_read_b64_tr_b16 a[180:181], v21 offset:47168
v_mfma_f32_16x16x32_bf16 a[4:7], a[164:167], a[140:143], a[4:7]
ds_read_b64_tr_b16 a[182:183], v21 offset:47936
v_mfma_f32_16x16x32_bf16 a[8:11], a[160:163], a[144:147], a[8:11]
buffer_load_dwordx4 v14, s[32:35], s45 offen offset:2048 lds
v_mfma_f32_16x16x32_bf16 a[8:11], a[164:167], a[148:151], a[8:11]
v_mfma_f32_16x16x32_bf16 a[12:15], a[160:163], a[152:155], a[12:15]
buffer_load_dwordx4 v15, s[32:35], s45 offen offset:3072 lds
v_mfma_f32_16x16x32_bf16 a[12:15], a[164:167], a[156:159], a[12:15]
s_waitcnt lgkmcnt(4)
v_mfma_f32_16x16x32_bf16 a[28:31], a[168:171], a[152:155], a[28:31]
ds_read_b64_tr_b16 a[184:185], v22 offset:41024
v_mfma_f32_16x16x32_bf16 a[28:31], a[172:175], a[156:159], a[28:31]
ds_read_b64_tr_b16 a[186:187], v22 offset:41792
v_mfma_f32_16x16x32_bf16 a[24:27], a[168:171], a[144:147], a[24:27]
ds_read_b64_tr_b16 a[188:189], v22 offset:47168
v_mfma_f32_16x16x32_bf16 a[24:27], a[172:175], a[148:151], a[24:27]
ds_read_b64_tr_b16 a[190:191], v22 offset:47936
s_add_u32 m0, s49, 4096
v_mfma_f32_16x16x32_bf16 a[20:23], a[168:171], a[136:139], a[20:23]
buffer_load_dwordx4 v16, s[32:35], s45 offen offset:0 lds
v_mfma_f32_16x16x32_bf16 a[20:23], a[172:175], a[140:143], a[20:23]
s_waitcnt vmcnt(15)
v_mfma_f32_16x16x32_bf16 a[244:247], a[240:243], a[200:203], a[244:247]
v_mfma_f32_16x16x32_bf16 a[16:19], a[168:171], a[128:131], a[16:19]
v_mfma_f32_16x16x32_bf16 a[16:19], a[172:175], a[132:135], a[16:19]
s_waitcnt lgkmcnt(4)
v_mfma_f32_16x16x32_bf16 a[32:35], a[176:179], a[128:131], a[32:35]
ds_read_b64_tr_b16 a[160:161], v21 offset:41088
v_mfma_f32_16x16x32_bf16 a[32:35], a[180:183], a[132:135], a[32:35]
ds_read_b64_tr_b16 a[162:163], v21 offset:41856
v_mfma_f32_16x16x32_bf16 a[36:39], a[176:179], a[136:139], a[36:39]
ds_read_b64_tr_b16 a[164:165], v21 offset:47232
v_mfma_f32_16x16x32_bf16 a[36:39], a[180:183], a[140:143], a[36:39]
ds_read_b64_tr_b16 a[166:167], v21 offset:48000
v_mfma_f32_16x16x32_bf16 a[40:43], a[176:179], a[144:147], a[40:43]
buffer_load_dwordx4 v17, s[32:35], s45 offen offset:1024 lds
v_mfma_f32_16x16x32_bf16 a[40:43], a[180:183], a[148:151], a[40:43]
v_mfma_f32_16x16x32_bf16 a[44:47], a[176:179], a[152:155], a[44:47]
v_mfma_f32_16x16x32_bf16 a[44:47], a[180:183], a[156:159], a[44:47]
s_waitcnt lgkmcnt(4)
v_mfma_f32_16x16x32_bf16 a[60:63], a[184:187], a[152:155], a[60:63]
ds_read_b64_tr_b16 a[168:169], v22 offset:41088
v_mfma_f32_16x16x32_bf16 a[60:63], a[188:191], a[156:159], a[60:63]
ds_read_b64_tr_b16 a[170:171], v22 offset:41856
v_mfma_f32_16x16x32_bf16 a[56:59], a[184:187], a[144:147], a[56:59]
ds_read_b64_tr_b16 a[172:173], v22 offset:47232
v_mfma_f32_16x16x32_bf16 a[56:59], a[188:191], a[148:151], a[56:59]
ds_read_b64_tr_b16 a[174:175], v22 offset:48000
v_mfma_f32_16x16x32_bf16 a[52:55], a[184:187], a[136:139], a[52:55]
buffer_load_dwordx4 v18, s[32:35], s45 offen offset:2048 lds
s_add_u32 s45, s45, 458752
v_mfma_f32_16x16x32_bf16 a[52:55], a[188:191], a[140:143], a[52:55]
s_waitcnt vmcnt(16)
v_mfma_f32_16x16x32_bf16 a[244:247], a[240:243], a[204:207], a[244:247]
v_mfma_f32_16x16x32_bf16 a[48:51], a[184:187], a[128:131], a[48:51]
v_mfma_f32_16x16x32_bf16 a[48:51], a[188:191], a[132:135], a[48:51]
s_waitcnt lgkmcnt(0)
s_barrier
v_mfma_f32_16x16x32_bf16 a[64:67], a[128:131], a[160:163], a[64:67]
ds_read_b64_tr_b16 a[176:177], v23 offset:40960
v_mfma_f32_16x16x32_bf16 a[64:67], a[132:135], a[164:167], a[64:67]
ds_read_b64_tr_b16 a[178:179], v23 offset:42752
v_mfma_f32_16x16x32_bf16 a[68:71], a[136:139], a[160:163], a[68:71]
ds_read_b64_tr_b16 a[180:181], v23 offset:48128
v_mfma_f32_16x16x32_bf16 a[68:71], a[140:143], a[164:167], a[68:71]
ds_read_b64_tr_b16 a[182:183], v23 offset:49920
s_add_u32 m0, s48, 40960
v_mfma_f32_16x16x32_bf16 a[72:75], a[144:147], a[160:163], a[72:75]
buffer_load_dwordx4 v9, s[28:31], s44 offen offset:0 lds
v_mfma_f32_16x16x32_bf16 a[72:75], a[148:151], a[164:167], a[72:75]
v_mfma_f32_16x16x32_bf16 a[76:79], a[152:155], a[160:163], a[76:79]
v_mfma_f32_16x16x32_bf16 a[76:79], a[156:159], a[164:167], a[76:79]
v_mfma_f32_16x16x32_bf16 a[92:95], a[152:155], a[168:171], a[92:95]
ds_read_b64_tr_b16 a[184:185], v23 offset:40992
v_mfma_f32_16x16x32_bf16 a[92:95], a[156:159], a[172:175], a[92:95]
ds_read_b64_tr_b16 a[186:187], v23 offset:42784
v_mfma_f32_16x16x32_bf16 a[88:91], a[144:147], a[168:171], a[88:91]
ds_read_b64_tr_b16 a[188:189], v23 offset:48160
v_mfma_f32_16x16x32_bf16 a[88:91], a[148:151], a[172:175], a[88:91]
ds_read_b64_tr_b16 a[190:191], v23 offset:49952
v_mfma_f32_16x16x32_bf16 a[84:87], a[136:139], a[168:171], a[84:87]
buffer_load_dwordx4 v10, s[28:31], s44 offen offset:1024 lds
v_mfma_f32_16x16x32_bf16 a[84:87], a[140:143], a[172:175], a[84:87]
s_waitcnt vmcnt(16)
v_mfma_f32_16x16x32_bf16 a[244:247], a[240:243], a[208:211], a[244:247]
v_mfma_f32_16x16x32_bf16 a[80:83], a[128:131], a[168:171], a[80:83]
v_mfma_f32_16x16x32_bf16 a[80:83], a[132:135], a[172:175], a[80:83]
s_waitcnt lgkmcnt(4)
v_mfma_f32_16x16x32_bf16 v[32:35], a[176:179], a[128:131], v[32:35]
ds_read_b64_tr_b16 a[160:161], v23 offset:41024
v_mfma_f32_16x16x32_bf16 v[32:35], a[180:183], a[132:135], v[32:35]
ds_read_b64_tr_b16 a[162:163], v23 offset:42816
v_mfma_f32_16x16x32_bf16 v[36:39], a[176:179], a[136:139], v[36:39]
ds_read_b64_tr_b16 a[164:165], v23 offset:48192
v_mfma_f32_16x16x32_bf16 v[36:39], a[180:183], a[140:143], v[36:39]
ds_read_b64_tr_b16 a[166:167], v23 offset:49984
v_mfma_f32_16x16x32_bf16 v[40:43], a[176:179], a[144:147], v[40:43]
buffer_load_dwordx4 v11, s[28:31], s44 offen offset:2048 lds
s_add_u32 s44, s44, 393216
v_mfma_f32_16x16x32_bf16 v[40:43], a[180:183], a[148:151], v[40:43]
v_mfma_f32_16x16x32_bf16 v[44:47], a[176:179], a[152:155], v[44:47]
v_mfma_f32_16x16x32_bf16 v[44:47], a[180:183], a[156:159], v[44:47]
s_waitcnt lgkmcnt(4)
v_mfma_f32_16x16x32_bf16 v[60:63], a[184:187], a[152:155], v[60:63]
ds_read_b64_tr_b16 a[168:169], v23 offset:41056
v_mfma_f32_16x16x32_bf16 v[60:63], a[188:191], a[156:159], v[60:63]
ds_read_b64_tr_b16 a[170:171], v23 offset:42848
v_mfma_f32_16x16x32_bf16 v[56:59], a[184:187], a[144:147], v[56:59]
ds_read_b64_tr_b16 a[172:173], v23 offset:48224
v_mfma_f32_16x16x32_bf16 v[56:59], a[188:191], a[148:151], v[56:59]
ds_read_b64_tr_b16 a[174:175], v23 offset:50016
v_mfma_f32_16x16x32_bf16 v[52:55], a[184:187], a[136:139], v[52:55]
v_mfma_f32_16x16x32_bf16 v[52:55], a[188:191], a[140:143], v[52:55]
v_mfma_f32_16x16x32_bf16 v[48:51], a[184:187], a[128:131], v[48:51]
v_mfma_f32_16x16x32_bf16 v[48:51], a[188:191], a[132:135], v[48:51]
s_waitcnt lgkmcnt(4)
v_mfma_f32_16x16x32_bf16 v[64:67], a[160:163], a[128:131], v[64:67]
ds_read_b64_tr_b16 a[176:177], v23 offset:41088
v_mfma_f32_16x16x32_bf16 v[64:67], a[164:167], a[132:135], v[64:67]
ds_read_b64_tr_b16 a[178:179], v23 offset:42880
v_mfma_f32_16x16x32_bf16 v[68:71], a[160:163], a[136:139], v[68:71]
ds_read_b64_tr_b16 a[180:181], v23 offset:48256
v_mfma_f32_16x16x32_bf16 v[68:71], a[164:167], a[140:143], v[68:71]
ds_read_b64_tr_b16 a[182:183], v23 offset:50048
v_mfma_f32_16x16x32_bf16 v[72:75], a[160:163], a[144:147], v[72:75]
ds_read_b128 a[96:99], v19 offset:0
v_mfma_f32_16x16x32_bf16 v[72:75], a[164:167], a[148:151], v[72:75]
ds_read_b128 a[100:103], v20 offset:0
v_mfma_f32_16x16x32_bf16 v[76:79], a[160:163], a[152:155], v[76:79]
ds_read_b128 a[104:107], v19 offset:2048
v_mfma_f32_16x16x32_bf16 v[76:79], a[164:167], a[156:159], v[76:79]
ds_read_b128 a[108:111], v20 offset:2048
s_waitcnt lgkmcnt(8)
v_mfma_f32_16x16x32_bf16 v[92:95], a[168:171], a[152:155], v[92:95]
ds_read_b64_tr_b16 a[184:185], v23 offset:41120
s_waitcnt vmcnt(16)
v_mfma_f32_16x16x32_bf16 a[244:247], a[240:243], a[212:215], a[244:247]
v_mfma_f32_16x16x32_bf16 v[92:95], a[172:175], a[156:159], v[92:95]
ds_read_b64_tr_b16 a[186:187], v23 offset:42912
v_mfma_f32_16x16x32_bf16 v[88:91], a[168:171], a[144:147], v[88:91]
ds_read_b64_tr_b16 a[188:189], v23 offset:48288
v_mfma_f32_16x16x32_bf16 v[88:91], a[172:175], a[148:151], v[88:91]
ds_read_b64_tr_b16 a[190:191], v23 offset:50080
v_mfma_f32_16x16x32_bf16 v[84:87], a[168:171], a[136:139], v[84:87]
ds_read_b128 a[112:115], v19 offset:4096
v_mfma_f32_16x16x32_bf16 v[84:87], a[172:175], a[140:143], v[84:87]
ds_read_b128 a[116:119], v20 offset:4096
v_mfma_f32_16x16x32_bf16 v[80:83], a[168:171], a[128:131], v[80:83]
ds_read_b128 a[120:123], v19 offset:6144
v_mfma_f32_16x16x32_bf16 v[80:83], a[172:175], a[132:135], v[80:83]
ds_read_b128 a[124:127], v20 offset:6144
s_waitcnt lgkmcnt(12)
v_mfma_f32_16x16x32_bf16 v[96:99], a[176:179], a[128:131], v[96:99]
ds_read_b64_tr_b16 a[160:161], v23 offset:41152
v_mfma_f32_16x16x32_bf16 v[96:99], a[180:183], a[132:135], v[96:99]
ds_read_b64_tr_b16 a[162:163], v23 offset:42944
v_mfma_f32_16x16x32_bf16 v[100:103], a[176:179], a[136:139], v[100:103]
ds_read_b64_tr_b16 a[164:165], v23 offset:48320
v_mfma_f32_16x16x32_bf16 v[100:103], a[180:183], a[140:143], v[100:103]
ds_read_b64_tr_b16 a[166:167], v23 offset:50112
v_mfma_f32_16x16x32_bf16 v[104:107], a[176:179], a[144:147], v[104:107]
v_mfma_f32_16x16x32_bf16 v[104:107], a[180:183], a[148:151], v[104:107]
v_mfma_f32_16x16x32_bf16 v[108:111], a[176:179], a[152:155], v[108:111]
v_mfma_f32_16x16x32_bf16 v[108:111], a[180:183], a[156:159], v[108:111]
s_waitcnt lgkmcnt(4)
v_mfma_f32_16x16x32_bf16 v[124:127], a[184:187], a[152:155], v[124:127]
ds_read_b64_tr_b16 a[168:169], v23 offset:55296
v_mfma_f32_16x16x32_bf16 v[124:127], a[188:191], a[156:159], v[124:127]
ds_read_b64_tr_b16 a[170:171], v23 offset:57088
v_mfma_f32_16x16x32_bf16 v[120:123], a[184:187], a[144:147], v[120:123]
ds_read_b64_tr_b16 a[172:173], v23 offset:62464
v_mfma_f32_16x16x32_bf16 v[120:123], a[188:191], a[148:151], v[120:123]
ds_read_b64_tr_b16 a[174:175], v23 offset:64256
s_add_u32 m0, s47, 0
v_mfma_f32_16x16x32_bf16 v[116:119], a[184:187], a[136:139], v[116:119]
buffer_load_dwordx4 v1, s[24:27], s43 offen offset:0 lds
v_mfma_f32_16x16x32_bf16 v[116:119], a[188:191], a[140:143], v[116:119]
v_mfma_f32_16x16x32_bf16 v[112:115], a[184:187], a[128:131], v[112:115]
buffer_load_dwordx4 v2, s[24:27], s43 offen offset:1024 lds
v_mfma_f32_16x16x32_bf16 v[112:115], a[188:191], a[132:135], v[112:115]
s_waitcnt lgkmcnt(4)
v_mfma_f32_16x16x32_bf16 v[128:131], a[160:163], a[128:131], v[128:131]
ds_read_b64_tr_b16 a[176:177], v23 offset:55328
buffer_load_dwordx4 a[216:219], v24, s[56:59], s55 offen
v_mfma_f32_16x16x32_bf16 v[128:131], a[164:167], a[132:135], v[128:131]
ds_read_b64_tr_b16 a[178:179], v23 offset:57120
s_add_u32 s55, s55, s54
v_mfma_f32_16x16x32_bf16 v[132:135], a[160:163], a[136:139], v[132:135]
ds_read_b64_tr_b16 a[180:181], v23 offset:62496
buffer_load_dwordx4 a[220:223], v24, s[56:59], s55 offen
v_mfma_f32_16x16x32_bf16 v[132:135], a[164:167], a[140:143], v[132:135]
ds_read_b64_tr_b16 a[182:183], v23 offset:64288
s_mov_b32 s55, 0
v_mfma_f32_16x16x32_bf16 v[136:139], a[160:163], a[144:147], v[136:139]
buffer_load_dwordx4 v3, s[24:27], s43 offen offset:2048 lds
v_mfma_f32_16x16x32_bf16 v[136:139], a[164:167], a[148:151], v[136:139]
v_mfma_f32_16x16x32_bf16 v[140:143], a[160:163], a[152:155], v[140:143]
v_mfma_f32_16x16x32_bf16 v[140:143], a[164:167], a[156:159], v[140:143]
s_waitcnt lgkmcnt(4)
v_mfma_f32_16x16x32_bf16 v[156:159], a[168:171], a[152:155], v[156:159]
ds_read_b64_tr_b16 a[184:185], v23 offset:55360
v_mfma_f32_16x16x32_bf16 v[156:159], a[172:175], a[156:159], v[156:159]
ds_read_b64_tr_b16 a[186:187], v23 offset:57152
v_mfma_f32_16x16x32_bf16 v[152:155], a[168:171], a[144:147], v[152:155]
ds_read_b64_tr_b16 a[188:189], v23 offset:62528
v_mfma_f32_16x16x32_bf16 v[152:155], a[172:175], a[148:151], v[152:155]
ds_read_b64_tr_b16 a[190:191], v23 offset:64320
v_mfma_f32_16x16x32_bf16 v[148:151], a[168:171], a[136:139], v[148:151]
buffer_load_dwordx4 v4, s[24:27], s43 offen offset:3072 lds
v_mfma_f32_16x16x32_bf16 v[148:151], a[172:175], a[140:143], v[148:151]
s_lshl_b32 s50, s2, 2
v_mfma_f32_16x16x32_bf16 v[144:147], a[168:171], a[128:131], v[144:147]
s_add_u32 s50, s50, s40
v_mfma_f32_16x16x32_bf16 v[144:147], a[172:175], a[132:135], v[144:147]
s_lshl_b32 s50, s50, 12
s_waitcnt lgkmcnt(4)
v_mfma_f32_16x16x32_bf16 v[160:163], a[176:179], a[128:131], v[160:163]
ds_read_b64_tr_b16 a[160:161], v23 offset:55392
v_mfma_f32_16x16x32_bf16 v[160:163], a[180:183], a[132:135], v[160:163]
ds_read_b64_tr_b16 a[162:163], v23 offset:57184
v_mfma_f32_16x16x32_bf16 v[164:167], a[176:179], a[136:139], v[164:167]
ds_read_b64_tr_b16 a[164:165], v23 offset:62560
v_mfma_f32_16x16x32_bf16 v[164:167], a[180:183], a[140:143], v[164:167]
ds_read_b64_tr_b16 a[166:167], v23 offset:64352
s_add_u32 m0, s47, 4096
v_mfma_f32_16x16x32_bf16 v[168:171], a[176:179], a[144:147], v[168:171]
buffer_load_dwordx4 v5, s[24:27], s43 offen offset:0 lds
v_mfma_f32_16x16x32_bf16 v[168:171], a[180:183], a[148:151], v[168:171]
s_add_u32 s50, s50, 37748736
v_mfma_f32_16x16x32_bf16 v[172:175], a[176:179], a[152:155], v[172:175]
v_lshlrev_b32 v29, 4, v0
v_mfma_f32_16x16x32_bf16 v[172:175], a[180:183], a[156:159], v[172:175]
buffer_store_dwordx4 a[250:253], v29, s[36:39], s50 offen offset:2048 sc1
s_waitcnt lgkmcnt(4)
v_mfma_f32_16x16x32_bf16 v[188:191], a[184:187], a[152:155], v[188:191]
ds_read_b64_tr_b16 a[168:169], v23 offset:55424
v_mfma_f32_16x16x32_bf16 v[188:191], a[188:191], a[156:159], v[188:191]
ds_read_b64_tr_b16 a[170:171], v23 offset:57216
v_mfma_f32_16x16x32_bf16 v[184:187], a[184:187], a[144:147], v[184:187]
ds_read_b64_tr_b16 a[172:173], v23 offset:62592
v_mfma_f32_16x16x32_bf16 v[184:187], a[188:191], a[148:151], v[184:187]
ds_read_b64_tr_b16 a[174:175], v23 offset:64384
v_mfma_f32_16x16x32_bf16 v[180:183], a[184:187], a[136:139], v[180:183]
buffer_load_dwordx4 v6, s[24:27], s43 offen offset:1024 lds
v_mfma_f32_16x16x32_bf16 v[180:183], a[188:191], a[140:143], v[180:183]
v_mfma_f32_16x16x32_bf16 v[176:179], a[184:187], a[128:131], v[176:179]
v_mfma_f32_16x16x32_bf16 v[176:179], a[188:191], a[132:135], v[176:179]
s_waitcnt lgkmcnt(4)
v_mfma_f32_16x16x32_bf16 v[192:195], a[160:163], a[128:131], v[192:195]
ds_read_b64_tr_b16 a[176:177], v23 offset:55456
v_mfma_f32_16x16x32_bf16 v[192:195], a[164:167], a[132:135], v[192:195]
ds_read_b64_tr_b16 a[178:179], v23 offset:57248
v_mfma_f32_16x16x32_bf16 v[196:199], a[160:163], a[136:139], v[196:199]
ds_read_b64_tr_b16 a[180:181], v23 offset:62624
v_mfma_f32_16x16x32_bf16 v[196:199], a[164:167], a[140:143], v[196:199]
ds_read_b64_tr_b16 a[182:183], v23 offset:64416
v_mfma_f32_16x16x32_bf16 v[200:203], a[160:163], a[144:147], v[200:203]
buffer_load_dwordx4 v7, s[24:27], s43 offen offset:2048 lds
v_mfma_f32_16x16x32_bf16 v[200:203], a[164:167], a[148:151], v[200:203]
v_mfma_f32_16x16x32_bf16 v[204:207], a[160:163], a[152:155], v[204:207]
v_mfma_f32_16x16x32_bf16 v[204:207], a[164:167], a[156:159], v[204:207]
s_waitcnt lgkmcnt(4)
v_mfma_f32_16x16x32_bf16 v[220:223], a[168:171], a[152:155], v[220:223]
ds_read_b64_tr_b16 a[184:185], v23 offset:55488
v_mfma_f32_16x16x32_bf16 v[220:223], a[172:175], a[156:159], v[220:223]
ds_read_b64_tr_b16 a[186:187], v23 offset:57280
v_mfma_f32_16x16x32_bf16 v[216:219], a[168:171], a[144:147], v[216:219]
ds_read_b64_tr_b16 a[188:189], v23 offset:62656
v_mfma_f32_16x16x32_bf16 v[216:219], a[172:175], a[148:151], v[216:219]
ds_read_b64_tr_b16 a[190:191], v23 offset:64448
v_mfma_f32_16x16x32_bf16 v[212:215], a[168:171], a[136:139], v[212:215]
buffer_load_dwordx4 v8, s[24:27], s43 offen offset:3072 lds
s_add_u32 s43, s43, 128
v_mfma_f32_16x16x32_bf16 v[212:215], a[172:175], a[140:143], v[212:215]
v_mfma_f32_16x16x32_bf16 v[208:211], a[168:171], a[128:131], v[208:211]
v_mfma_f32_16x16x32_bf16 v[208:211], a[172:175], a[132:135], v[208:211]
s_waitcnt lgkmcnt(0)
s_barrier
v_mfma_f32_16x16x32_bf16 v[224:227], a[176:179], a[128:131], v[224:227]
ds_read_b64_tr_b16 a[160:161], v21 offset:0
v_mfma_f32_16x16x32_bf16 v[224:227], a[180:183], a[132:135], v[224:227]
ds_read_b64_tr_b16 a[162:163], v21 offset:768
v_mfma_f32_16x16x32_bf16 v[228:231], a[176:179], a[136:139], v[228:231]
ds_read_b64_tr_b16 a[164:165], v21 offset:6144
v_mfma_f32_16x16x32_bf16 v[228:231], a[180:183], a[140:143], v[228:231]
ds_read_b64_tr_b16 a[166:167], v21 offset:6912
s_add_u32 m0, s49, 40960
v_mfma_f32_16x16x32_bf16 v[232:235], a[176:179], a[144:147], v[232:235]
buffer_load_dwordx4 v12, s[32:35], s45 offen offset:0 lds
v_mfma_f32_16x16x32_bf16 v[232:235], a[180:183], a[148:151], v[232:235]
v_mfma_f32_16x16x32_bf16 v[236:239], a[176:179], a[152:155], v[236:239]
v_mfma_f32_16x16x32_bf16 v[236:239], a[180:183], a[156:159], v[236:239]
v_mfma_f32_16x16x32_bf16 v[252:255], a[184:187], a[152:155], v[252:255]
ds_read_b64_tr_b16 a[168:169], v22 offset:0
v_mfma_f32_16x16x32_bf16 v[252:255], a[188:191], a[156:159], v[252:255]
ds_read_b64_tr_b16 a[170:171], v22 offset:768
v_mfma_f32_16x16x32_bf16 v[248:251], a[184:187], a[144:147], v[248:251]
ds_read_b64_tr_b16 a[172:173], v22 offset:6144
v_mfma_f32_16x16x32_bf16 v[248:251], a[188:191], a[148:151], v[248:251]
ds_read_b64_tr_b16 a[174:175], v22 offset:6912
v_mfma_f32_16x16x32_bf16 v[244:247], a[184:187], a[136:139], v[244:247]
buffer_load_dwordx4 v13, s[32:35], s45 offen offset:1024 lds
v_mfma_f32_16x16x32_bf16 v[244:247], a[188:191], a[140:143], v[244:247]
v_mfma_f32_16x16x32_bf16 v[240:243], a[184:187], a[128:131], v[240:243]
v_mfma_f32_16x16x32_bf16 v[240:243], a[188:191], a[132:135], v[240:243]
s_waitcnt lgkmcnt(4)
v_mfma_f32_16x16x32_bf16 a[0:3], a[160:163], a[96:99], a[0:3]
ds_read_b64_tr_b16 a[176:177], v21 offset:64
v_mfma_f32_16x16x32_bf16 a[0:3], a[164:167], a[100:103], a[0:3]
ds_read_b64_tr_b16 a[178:179], v21 offset:832
v_mfma_f32_16x16x32_bf16 a[4:7], a[160:163], a[104:107], a[4:7]
ds_read_b64_tr_b16 a[180:181], v21 offset:6208
v_mfma_f32_16x16x32_bf16 a[4:7], a[164:167], a[108:111], a[4:7]
ds_read_b64_tr_b16 a[182:183], v21 offset:6976
v_mfma_f32_16x16x32_bf16 a[8:11], a[160:163], a[112:115], a[8:11]
buffer_load_dwordx4 v14, s[32:35], s45 offen offset:2048 lds
v_mfma_f32_16x16x32_bf16 a[8:11], a[164:167], a[116:119], a[8:11]
v_mfma_f32_16x16x32_bf16 a[12:15], a[160:163], a[120:123], a[12:15]
buffer_load_dwordx4 v15, s[32:35], s45 offen offset:3072 lds
v_mfma_f32_16x16x32_bf16 a[12:15], a[164:167], a[124:127], a[12:15]
s_waitcnt lgkmcnt(4)
v_mfma_f32_16x16x32_bf16 a[28:31], a[168:171], a[120:123], a[28:31]
ds_read_b64_tr_b16 a[184:185], v22 offset:64
v_mfma_f32_16x16x32_bf16 a[28:31], a[172:175], a[124:127], a[28:31]
ds_read_b64_tr_b16 a[186:187], v22 offset:832
v_mfma_f32_16x16x32_bf16 a[24:27], a[168:171], a[112:115], a[24:27]
ds_read_b64_tr_b16 a[188:189], v22 offset:6208
v_mfma_f32_16x16x32_bf16 a[24:27], a[172:175], a[116:119], a[24:27]
ds_read_b64_tr_b16 a[190:191], v22 offset:6976
s_add_u32 m0, s49, 45056
v_mfma_f32_16x16x32_bf16 a[20:23], a[168:171], a[104:107], a[20:23]
buffer_load_dwordx4 v16, s[32:35], s45 offen offset:0 lds
v_mfma_f32_16x16x32_bf16 a[20:23], a[172:175], a[108:111], a[20:23]
s_waitcnt vmcnt(13)
v_mfma_f32_16x16x32_bf16 a[244:247], a[240:243], a[216:219], a[244:247]
v_mfma_f32_16x16x32_bf16 a[16:19], a[168:171], a[96:99], a[16:19]
v_mfma_f32_16x16x32_bf16 a[16:19], a[172:175], a[100:103], a[16:19]
s_waitcnt lgkmcnt(4)
v_mfma_f32_16x16x32_bf16 a[32:35], a[176:179], a[96:99], a[32:35]
ds_read_b64_tr_b16 a[160:161], v21 offset:128
v_mfma_f32_16x16x32_bf16 a[32:35], a[180:183], a[100:103], a[32:35]
ds_read_b64_tr_b16 a[162:163], v21 offset:896
v_mfma_f32_16x16x32_bf16 a[36:39], a[176:179], a[104:107], a[36:39]
ds_read_b64_tr_b16 a[164:165], v21 offset:6272
v_mfma_f32_16x16x32_bf16 a[36:39], a[180:183], a[108:111], a[36:39]
ds_read_b64_tr_b16 a[166:167], v21 offset:7040
v_mfma_f32_16x16x32_bf16 a[40:43], a[176:179], a[112:115], a[40:43]
buffer_load_dwordx4 v17, s[32:35], s45 offen offset:1024 lds
v_mfma_f32_16x16x32_bf16 a[40:43], a[180:183], a[116:119], a[40:43]
v_mfma_f32_16x16x32_bf16 a[44:47], a[176:179], a[120:123], a[44:47]
v_mfma_f32_16x16x32_bf16 a[44:47], a[180:183], a[124:127], a[44:47]
s_waitcnt lgkmcnt(4)
v_mfma_f32_16x16x32_bf16 a[60:63], a[184:187], a[120:123], a[60:63]
ds_read_b64_tr_b16 a[168:169], v22 offset:128
s_waitcnt vmcnt(13)
v_mfma_f32_16x16x32_bf16 a[244:247], a[240:243], a[220:223], a[244:247]
v_mfma_f32_16x16x32_bf16 a[60:63], a[188:191], a[124:127], a[60:63]
ds_read_b64_tr_b16 a[170:171], v22 offset:896
s_mov_b32 s56, s16
v_mfma_f32_16x16x32_bf16 a[56:59], a[184:187], a[112:115], a[56:59]
ds_read_b64_tr_b16 a[172:173], v22 offset:6272
s_mov_b32 s57, s17
v_mfma_f32_16x16x32_bf16 a[56:59], a[188:191], a[116:119], a[56:59]
ds_read_b64_tr_b16 a[174:175], v22 offset:7040
s_mov_b32 s58, 0x700000
v_mfma_f32_16x16x32_bf16 a[52:55], a[184:187], a[104:107], a[52:55]
buffer_load_dwordx4 v18, s[32:35], s45 offen offset:2048 lds
s_add_u32 s45, s45, 458752
v_mfma_f32_16x16x32_bf16 a[52:55], a[188:191], a[108:111], a[52:55]
s_mov_b32 s59, 0x00020000
s_and_b32 s50, s2, 1
v_mfma_f32_16x16x32_bf16 a[48:51], a[184:187], a[96:99], a[48:51]
s_lshl_b32 s50, s50, 6
v_mfma_f32_16x16x32_bf16 a[48:51], a[188:191], a[100:103], a[48:51]
s_waitcnt lgkmcnt(0)
s_barrier
v_mfma_f32_16x16x32_bf16 a[64:67], a[96:99], a[160:163], a[64:67]
ds_read_b64_tr_b16 a[176:177], v23 offset:0
s_and_b32 s51, s2, 4
v_mfma_f32_16x16x32_bf16 a[64:67], a[100:103], a[164:167], a[64:67]
ds_read_b64_tr_b16 a[178:179], v23 offset:1792
s_lshl_b32 s51, s51, 3
v_mfma_f32_16x16x32_bf16 a[68:71], a[104:107], a[160:163], a[68:71]
ds_read_b64_tr_b16 a[180:181], v23 offset:7168
s_add_u32 s50, s50, s51
v_mfma_f32_16x16x32_bf16 a[68:71], a[108:111], a[164:167], a[68:71]
ds_read_b64_tr_b16 a[182:183], v23 offset:8960
s_add_u32 m0, s48, 0
v_mfma_f32_16x16x32_bf16 a[72:75], a[112:115], a[160:163], a[72:75]
buffer_load_dwordx4 v9, s[28:31], s44 offen offset:0 lds
s_lshr_b32 s51, s2, 3
v_mfma_f32_16x16x32_bf16 a[72:75], a[116:119], a[164:167], a[72:75]
s_add_u32 s50, s50, s51
s_lshl_b32 s50, s50, 2
v_mfma_f32_16x16x32_bf16 a[76:79], a[120:123], a[160:163], a[76:79]
v_mfma_f32_16x16x32_bf16 a[76:79], a[124:127], a[164:167], a[76:79]
v_mfma_f32_16x16x32_bf16 a[92:95], a[120:123], a[168:171], a[92:95]
ds_read_b64_tr_b16 a[184:185], v23 offset:32
s_add_u32 s50, s50, s40
v_mfma_f32_16x16x32_bf16 a[92:95], a[124:127], a[172:175], a[92:95]
ds_read_b64_tr_b16 a[186:187], v23 offset:1824
s_mul_i32 s50, s50, 14336
v_mfma_f32_16x16x32_bf16 a[88:91], a[112:115], a[168:171], a[88:91]
ds_read_b64_tr_b16 a[188:189], v23 offset:7200
s_and_b32 s51, s2, 2
v_mfma_f32_16x16x32_bf16 a[88:91], a[116:119], a[172:175], a[88:91]
ds_read_b64_tr_b16 a[190:191], v23 offset:8992
s_lshl_b32 s51, s51, 9
v_mfma_f32_16x16x32_bf16 a[84:87], a[104:107], a[168:171], a[84:87]
buffer_load_dwordx4 v10, s[28:31], s44 offen offset:1024 lds
s_add_u32 s55, s50, s51
v_mfma_f32_16x16x32_bf16 a[84:87], a[108:111], a[172:175], a[84:87]
v_min_u32 v24, 7, v0
v_mfma_f32_16x16x32_bf16 a[80:83], a[96:99], a[168:171], a[80:83]
v_mfma_f32_16x16x32_bf16 a[80:83], a[100:103], a[172:175], a[80:83]
s_waitcnt lgkmcnt(4)
v_mfma_f32_16x16x32_bf16 v[32:35], a[176:179], a[96:99], v[32:35]
ds_read_b64_tr_b16 a[160:161], v23 offset:64
v_lshlrev_b32 v24, 7, v24
v_mfma_f32_16x16x32_bf16 v[32:35], a[180:183], a[100:103], v[32:35]
ds_read_b64_tr_b16 a[162:163], v23 offset:1856
v_min_u32 v25, 15, v0
v_mfma_f32_16x16x32_bf16 v[36:39], a[176:179], a[104:107], v[36:39]
ds_read_b64_tr_b16 a[164:165], v23 offset:7232
v_lshrrev_b32 v26, 3, v25
v_mfma_f32_16x16x32_bf16 v[36:39], a[180:183], a[108:111], v[36:39]
ds_read_b64_tr_b16 a[166:167], v23 offset:9024
v_and_b32 v25, 7, v25
v_mfma_f32_16x16x32_bf16 v[40:43], a[176:179], a[112:115], v[40:43]
buffer_load_dwordx4 v11, s[28:31], s44 offen offset:2048 lds
s_add_u32 s44, s44, 393216
v_mfma_f32_16x16x32_bf16 v[40:43], a[180:183], a[116:119], v[40:43]
v_lshlrev_b32 v25, 7, v25
v_lshl_add_u32 v24, v26, 11, v25
v_mfma_f32_16x16x32_bf16 v[44:47], a[176:179], a[120:123], v[44:47]
v_mfma_f32_16x16x32_bf16 v[44:47], a[180:183], a[124:127], v[44:47]
s_waitcnt lgkmcnt(4)
v_mfma_f32_16x16x32_bf16 v[60:63], a[184:187], a[120:123], v[60:63]
ds_read_b64_tr_b16 a[168:169], v23 offset:96
v_mfma_f32_16x16x32_bf16 v[60:63], a[188:191], a[124:127], v[60:63]
ds_read_b64_tr_b16 a[170:171], v23 offset:1888
v_mfma_f32_16x16x32_bf16 v[56:59], a[184:187], a[112:115], v[56:59]
ds_read_b64_tr_b16 a[172:173], v23 offset:7264
v_mfma_f32_16x16x32_bf16 v[56:59], a[188:191], a[116:119], v[56:59]
ds_read_b64_tr_b16 a[174:175], v23 offset:9056
v_mfma_f32_16x16x32_bf16 v[52:55], a[184:187], a[104:107], v[52:55]
buffer_load_dword a255, v24, s[56:59], s55 offen
v_mfma_f32_16x16x32_bf16 v[52:55], a[188:191], a[108:111], v[52:55]
s_add_u32 s55, s55, 4096
v_mfma_f32_16x16x32_bf16 v[48:51], a[184:187], a[96:99], v[48:51]
v_mfma_f32_16x16x32_bf16 v[48:51], a[188:191], a[100:103], v[48:51]
s_waitcnt lgkmcnt(4)
v_mfma_f32_16x16x32_bf16 v[64:67], a[160:163], a[96:99], v[64:67]
ds_read_b64_tr_b16 a[176:177], v23 offset:128
v_mfma_f32_16x16x32_bf16 v[64:67], a[164:167], a[100:103], v[64:67]
ds_read_b64_tr_b16 a[178:179], v23 offset:1920
v_mfma_f32_16x16x32_bf16 v[68:71], a[160:163], a[104:107], v[68:71]
ds_read_b64_tr_b16 a[180:181], v23 offset:7296
v_mfma_f32_16x16x32_bf16 v[68:71], a[164:167], a[108:111], v[68:71]
ds_read_b64_tr_b16 a[182:183], v23 offset:9088
v_mfma_f32_16x16x32_bf16 v[72:75], a[160:163], a[112:115], v[72:75]
ds_read_b128 a[128:131], v19 offset:32768
v_mfma_f32_16x16x32_bf16 v[72:75], a[164:167], a[116:119], v[72:75]
ds_read_b128 a[132:135], v20 offset:32768
v_mfma_f32_16x16x32_bf16 v[76:79], a[160:163], a[120:123], v[76:79]
ds_read_b128 a[136:139], v19 offset:34816
v_mfma_f32_16x16x32_bf16 v[76:79], a[164:167], a[124:127], v[76:79]
ds_read_b128 a[140:143], v20 offset:34816
s_waitcnt lgkmcnt(8)
v_mfma_f32_16x16x32_bf16 v[92:95], a[168:171], a[120:123], v[92:95]
ds_read_b64_tr_b16 a[184:185], v23 offset:160
v_mfma_f32_16x16x32_bf16 v[92:95], a[172:175], a[124:127], v[92:95]
ds_read_b64_tr_b16 a[186:187], v23 offset:1952
v_mfma_f32_16x16x32_bf16 v[88:91], a[168:171], a[112:115], v[88:91]
ds_read_b64_tr_b16 a[188:189], v23 offset:7328
v_mfma_f32_16x16x32_bf16 v[88:91], a[172:175], a[116:119], v[88:91]
ds_read_b64_tr_b16 a[190:191], v23 offset:9120
v_mfma_f32_16x16x32_bf16 v[84:87], a[168:171], a[104:107], v[84:87]
ds_read_b128 a[144:147], v19 offset:36864
v_mfma_f32_16x16x32_bf16 v[84:87], a[172:175], a[108:111], v[84:87]
ds_read_b128 a[148:151], v20 offset:36864
v_mfma_f32_16x16x32_bf16 v[80:83], a[168:171], a[96:99], v[80:83]
ds_read_b128 a[152:155], v19 offset:38912
v_mfma_f32_16x16x32_bf16 v[80:83], a[172:175], a[100:103], v[80:83]
ds_read_b128 a[156:159], v20 offset:38912
s_waitcnt lgkmcnt(12)
v_mfma_f32_16x16x32_bf16 v[96:99], a[176:179], a[96:99], v[96:99]
ds_read_b64_tr_b16 a[160:161], v23 offset:192
v_mfma_f32_16x16x32_bf16 v[96:99], a[180:183], a[100:103], v[96:99]
ds_read_b64_tr_b16 a[162:163], v23 offset:1984
v_mfma_f32_16x16x32_bf16 v[100:103], a[176:179], a[104:107], v[100:103]
ds_read_b64_tr_b16 a[164:165], v23 offset:7360
v_mfma_f32_16x16x32_bf16 v[100:103], a[180:183], a[108:111], v[100:103]
ds_read_b64_tr_b16 a[166:167], v23 offset:9152
v_mfma_f32_16x16x32_bf16 v[104:107], a[176:179], a[112:115], v[104:107]
v_mfma_f32_16x16x32_bf16 v[104:107], a[180:183], a[116:119], v[104:107]
v_mfma_f32_16x16x32_bf16 v[108:111], a[176:179], a[120:123], v[108:111]
v_mfma_f32_16x16x32_bf16 v[108:111], a[180:183], a[124:127], v[108:111]
s_waitcnt lgkmcnt(4)
v_mfma_f32_16x16x32_bf16 v[124:127], a[184:187], a[120:123], v[124:127]
ds_read_b64_tr_b16 a[168:169], v23 offset:14336
v_mfma_f32_16x16x32_bf16 v[124:127], a[188:191], a[124:127], v[124:127]
ds_read_b64_tr_b16 a[170:171], v23 offset:16128
v_mfma_f32_16x16x32_bf16 v[120:123], a[184:187], a[112:115], v[120:123]
ds_read_b64_tr_b16 a[172:173], v23 offset:21504
v_mfma_f32_16x16x32_bf16 v[120:123], a[188:191], a[116:119], v[120:123]
ds_read_b64_tr_b16 a[174:175], v23 offset:23296
s_add_u32 m0, s47, 32768
v_mfma_f32_16x16x32_bf16 v[116:119], a[184:187], a[104:107], v[116:119]
buffer_load_dwordx4 v1, s[24:27], s43 offen offset:0 lds
v_mfma_f32_16x16x32_bf16 v[116:119], a[188:191], a[108:111], v[116:119]
v_mfma_f32_16x16x32_bf16 v[112:115], a[184:187], a[96:99], v[112:115]
buffer_load_dwordx4 v2, s[24:27], s43 offen offset:1024 lds
v_mfma_f32_16x16x32_bf16 v[112:115], a[188:191], a[100:103], v[112:115]
s_waitcnt lgkmcnt(4)
v_mfma_f32_16x16x32_bf16 v[128:131], a[160:163], a[96:99], v[128:131]
ds_read_b64_tr_b16 a[176:177], v23 offset:14368
v_mfma_f32_16x16x32_bf16 v[128:131], a[164:167], a[100:103], v[128:131]
ds_read_b64_tr_b16 a[178:179], v23 offset:16160
v_mfma_f32_16x16x32_bf16 v[132:135], a[160:163], a[104:107], v[132:135]
ds_read_b64_tr_b16 a[180:181], v23 offset:21536
v_mfma_f32_16x16x32_bf16 v[132:135], a[164:167], a[108:111], v[132:135]
ds_read_b64_tr_b16 a[182:183], v23 offset:23328
v_mfma_f32_16x16x32_bf16 v[136:139], a[160:163], a[112:115], v[136:139]
buffer_load_dwordx4 v3, s[24:27], s43 offen offset:2048 lds
v_mfma_f32_16x16x32_bf16 v[136:139], a[164:167], a[116:119], v[136:139]
v_mfma_f32_16x16x32_bf16 v[140:143], a[160:163], a[120:123], v[140:143]
v_mfma_f32_16x16x32_bf16 v[140:143], a[164:167], a[124:127], v[140:143]
s_waitcnt lgkmcnt(4)
v_mfma_f32_16x16x32_bf16 v[156:159], a[168:171], a[120:123], v[156:159]
ds_read_b64_tr_b16 a[184:185], v23 offset:14400
v_mfma_f32_16x16x32_bf16 v[156:159], a[172:175], a[124:127], v[156:159]
ds_read_b64_tr_b16 a[186:187], v23 offset:16192
v_mfma_f32_16x16x32_bf16 v[152:155], a[168:171], a[112:115], v[152:155]
ds_read_b64_tr_b16 a[188:189], v23 offset:21568
v_mfma_f32_16x16x32_bf16 v[152:155], a[172:175], a[116:119], v[152:155]
ds_read_b64_tr_b16 a[190:191], v23 offset:23360
v_mfma_f32_16x16x32_bf16 v[148:151], a[168:171], a[104:107], v[148:151]
buffer_load_dwordx4 v4, s[24:27], s43 offen offset:3072 lds
v_mfma_f32_16x16x32_bf16 v[148:151], a[172:175], a[108:111], v[148:151]
s_lshl_b32 s50, s2, 2
v_mfma_f32_16x16x32_bf16 v[144:147], a[168:171], a[96:99], v[144:147]
s_add_u32 s50, s50, s40
v_mfma_f32_16x16x32_bf16 v[144:147], a[172:175], a[100:103], v[144:147]
s_lshl_b32 s50, s50, 12
s_waitcnt lgkmcnt(4)
v_mfma_f32_16x16x32_bf16 v[160:163], a[176:179], a[96:99], v[160:163]
ds_read_b64_tr_b16 a[160:161], v23 offset:14432
v_mfma_f32_16x16x32_bf16 v[160:163], a[180:183], a[100:103], v[160:163]
ds_read_b64_tr_b16 a[162:163], v23 offset:16224
v_mfma_f32_16x16x32_bf16 v[164:167], a[176:179], a[104:107], v[164:167]
ds_read_b64_tr_b16 a[164:165], v23 offset:21600
v_mfma_f32_16x16x32_bf16 v[164:167], a[180:183], a[108:111], v[164:167]
ds_read_b64_tr_b16 a[166:167], v23 offset:23392
s_add_u32 m0, s47, 36864
v_mfma_f32_16x16x32_bf16 v[168:171], a[176:179], a[112:115], v[168:171]
buffer_load_dwordx4 v5, s[24:27], s43 offen offset:0 lds
v_mfma_f32_16x16x32_bf16 v[168:171], a[180:183], a[116:119], v[168:171]
s_add_u32 s50, s50, 37748736
v_mfma_f32_16x16x32_bf16 v[172:175], a[176:179], a[120:123], v[172:175]
v_lshlrev_b32 v29, 4, v0
v_mfma_f32_16x16x32_bf16 v[172:175], a[180:183], a[124:127], v[172:175]
buffer_store_dwordx4 a[250:253], v29, s[36:39], s50 offen offset:3072 sc1
s_waitcnt lgkmcnt(4)
v_mfma_f32_16x16x32_bf16 v[188:191], a[184:187], a[120:123], v[188:191]
ds_read_b64_tr_b16 a[168:169], v23 offset:14464
v_mfma_f32_16x16x32_bf16 v[188:191], a[188:191], a[124:127], v[188:191]
ds_read_b64_tr_b16 a[170:171], v23 offset:16256
v_mfma_f32_16x16x32_bf16 v[184:187], a[184:187], a[112:115], v[184:187]
ds_read_b64_tr_b16 a[172:173], v23 offset:21632
v_mfma_f32_16x16x32_bf16 v[184:187], a[188:191], a[116:119], v[184:187]
ds_read_b64_tr_b16 a[174:175], v23 offset:23424
v_mfma_f32_16x16x32_bf16 v[180:183], a[184:187], a[104:107], v[180:183]
buffer_load_dwordx4 v6, s[24:27], s43 offen offset:1024 lds
v_mfma_f32_16x16x32_bf16 v[180:183], a[188:191], a[108:111], v[180:183]
v_mfma_f32_16x16x32_bf16 v[176:179], a[184:187], a[96:99], v[176:179]
v_mfma_f32_16x16x32_bf16 v[176:179], a[188:191], a[100:103], v[176:179]
s_waitcnt lgkmcnt(4)
v_mfma_f32_16x16x32_bf16 v[192:195], a[160:163], a[96:99], v[192:195]
ds_read_b64_tr_b16 a[176:177], v23 offset:14496
v_mfma_f32_16x16x32_bf16 v[192:195], a[164:167], a[100:103], v[192:195]
ds_read_b64_tr_b16 a[178:179], v23 offset:16288
v_mfma_f32_16x16x32_bf16 v[196:199], a[160:163], a[104:107], v[196:199]
ds_read_b64_tr_b16 a[180:181], v23 offset:21664
v_mfma_f32_16x16x32_bf16 v[196:199], a[164:167], a[108:111], v[196:199]
ds_read_b64_tr_b16 a[182:183], v23 offset:23456
v_mfma_f32_16x16x32_bf16 v[200:203], a[160:163], a[112:115], v[200:203]
buffer_load_dwordx4 v7, s[24:27], s43 offen offset:2048 lds
v_mfma_f32_16x16x32_bf16 v[200:203], a[164:167], a[116:119], v[200:203]
v_mfma_f32_16x16x32_bf16 v[204:207], a[160:163], a[120:123], v[204:207]
v_mfma_f32_16x16x32_bf16 v[204:207], a[164:167], a[124:127], v[204:207]
s_waitcnt lgkmcnt(4)
v_mfma_f32_16x16x32_bf16 v[220:223], a[168:171], a[120:123], v[220:223]
ds_read_b64_tr_b16 a[184:185], v23 offset:14528
v_mfma_f32_16x16x32_bf16 v[220:223], a[172:175], a[124:127], v[220:223]
ds_read_b64_tr_b16 a[186:187], v23 offset:16320
v_mfma_f32_16x16x32_bf16 v[216:219], a[168:171], a[112:115], v[216:219]
ds_read_b64_tr_b16 a[188:189], v23 offset:21696
v_mfma_f32_16x16x32_bf16 v[216:219], a[172:175], a[116:119], v[216:219]
ds_read_b64_tr_b16 a[190:191], v23 offset:23488
v_mfma_f32_16x16x32_bf16 v[212:215], a[168:171], a[104:107], v[212:215]
buffer_load_dwordx4 v8, s[24:27], s43 offen offset:3072 lds
s_add_u32 s43, s43, 128
v_mfma_f32_16x16x32_bf16 v[212:215], a[172:175], a[108:111], v[212:215]
v_mfma_f32_16x16x32_bf16 v[208:211], a[168:171], a[96:99], v[208:211]
v_mfma_f32_16x16x32_bf16 v[208:211], a[172:175], a[100:103], v[208:211]
s_waitcnt lgkmcnt(0)
s_barrier
v_mfma_f32_16x16x32_bf16 v[224:227], a[176:179], a[96:99], v[224:227]
ds_read_b64_tr_b16 a[160:161], v21 offset:40960
v_mfma_f32_16x16x32_bf16 v[224:227], a[180:183], a[100:103], v[224:227]
ds_read_b64_tr_b16 a[162:163], v21 offset:41728
v_mfma_f32_16x16x32_bf16 v[228:231], a[176:179], a[104:107], v[228:231]
ds_read_b64_tr_b16 a[164:165], v21 offset:47104
v_mfma_f32_16x16x32_bf16 v[228:231], a[180:183], a[108:111], v[228:231]
ds_read_b64_tr_b16 a[166:167], v21 offset:47872
s_add_u32 m0, s49, 0
v_mfma_f32_16x16x32_bf16 v[232:235], a[176:179], a[112:115], v[232:235]
buffer_load_dwordx4 v12, s[32:35], s45 offen offset:0 lds
v_mfma_f32_16x16x32_bf16 v[232:235], a[180:183], a[116:119], v[232:235]
v_mfma_f32_16x16x32_bf16 v[236:239], a[176:179], a[120:123], v[236:239]
v_mfma_f32_16x16x32_bf16 v[236:239], a[180:183], a[124:127], v[236:239]
v_mfma_f32_16x16x32_bf16 v[252:255], a[184:187], a[120:123], v[252:255]
ds_read_b64_tr_b16 a[168:169], v22 offset:40960
v_mfma_f32_16x16x32_bf16 v[252:255], a[188:191], a[124:127], v[252:255]
ds_read_b64_tr_b16 a[170:171], v22 offset:41728
v_mfma_f32_16x16x32_bf16 v[248:251], a[184:187], a[112:115], v[248:251]
ds_read_b64_tr_b16 a[172:173], v22 offset:47104
v_mfma_f32_16x16x32_bf16 v[248:251], a[188:191], a[116:119], v[248:251]
ds_read_b64_tr_b16 a[174:175], v22 offset:47872
v_mfma_f32_16x16x32_bf16 v[244:247], a[184:187], a[104:107], v[244:247]
buffer_load_dwordx4 v13, s[32:35], s45 offen offset:1024 lds
v_mfma_f32_16x16x32_bf16 v[244:247], a[188:191], a[108:111], v[244:247]
v_mfma_f32_16x16x32_bf16 v[240:243], a[184:187], a[96:99], v[240:243]
v_mfma_f32_16x16x32_bf16 v[240:243], a[188:191], a[100:103], v[240:243]
s_waitcnt lgkmcnt(4)
v_mfma_f32_16x16x32_bf16 a[0:3], a[160:163], a[128:131], a[0:3]
ds_read_b64_tr_b16 a[176:177], v21 offset:41024
v_and_b32 v25, 15, v0
v_mfma_f32_16x16x32_bf16 a[0:3], a[164:167], a[132:135], a[0:3]
ds_read_b64_tr_b16 a[178:179], v21 offset:41792
v_lshrrev_b32 v26, 4, v0
v_mfma_f32_16x16x32_bf16 a[4:7], a[160:163], a[136:139], a[4:7]
ds_read_b64_tr_b16 a[180:181], v21 offset:47168
v_lshlrev_b32 v26, 4, v26
v_mfma_f32_16x16x32_bf16 a[4:7], a[164:167], a[140:143], a[4:7]
ds_read_b64_tr_b16 a[182:183], v21 offset:47936
v_lshl_add_u32 v26, v25, 5, v26
v_mfma_f32_16x16x32_bf16 a[8:11], a[160:163], a[144:147], a[8:11]
buffer_load_dwordx4 v14, s[32:35], s45 offen offset:2048 lds
s_cmp_eq_u32 s40, 0
s_cselect_b32 s51, 12, 16
v_mfma_f32_16x16x32_bf16 a[8:11], a[164:167], a[148:151], a[8:11]
s_cmp_eq_u32 s40, 3
s_cselect_b32 s51, 0, s51
v_mfma_f32_16x16x32_bf16 a[12:15], a[160:163], a[152:155], a[12:15]
buffer_load_dwordx4 v15, s[32:35], s45 offen offset:3072 lds
v_mfma_f32_16x16x32_bf16 a[12:15], a[164:167], a[156:159], a[12:15]
s_waitcnt lgkmcnt(4)
v_mfma_f32_16x16x32_bf16 a[28:31], a[168:171], a[152:155], a[28:31]
ds_read_b64_tr_b16 a[184:185], v22 offset:41024
v_cmp_gt_u32 vcc, s51, v25
v_mfma_f32_16x16x32_bf16 a[28:31], a[172:175], a[156:159], a[28:31]
ds_read_b64_tr_b16 a[186:187], v22 offset:41792
v_bfrev_b32 v25, 1
v_mfma_f32_16x16x32_bf16 a[24:27], a[168:171], a[144:147], a[24:27]
ds_read_b64_tr_b16 a[188:189], v22 offset:47168
v_cndmask_b32 v26, v25, v26, vcc
v_mfma_f32_16x16x32_bf16 a[24:27], a[172:175], a[148:151], a[24:27]
ds_read_b64_tr_b16 a[190:191], v22 offset:47936
s_add_u32 m0, s49, 4096
v_mfma_f32_16x16x32_bf16 a[20:23], a[168:171], a[136:139], a[20:23]
buffer_load_dwordx4 v16, s[32:35], s45 offen offset:0 lds
v_cmp_gt_u32 vcc, 32, v0
v_mfma_f32_16x16x32_bf16 a[20:23], a[172:175], a[140:143], a[20:23]
s_nop 0
v_cndmask_b32 v26, v25, v26, vcc
s_lshl_b32 s50, s42, 3
v_mfma_f32_16x16x32_bf16 a[16:19], a[168:171], a[128:131], a[16:19]
s_add_u32 s50, s50, s41
v_mfma_f32_16x16x32_bf16 a[16:19], a[172:175], a[132:135], a[16:19]
s_waitcnt lgkmcnt(4)
v_mfma_f32_16x16x32_bf16 a[32:35], a[176:179], a[128:131], a[32:35]
ds_read_b64_tr_b16 a[160:161], v21 offset:41088
s_mul_i32 s50, s50, 1408
v_mfma_f32_16x16x32_bf16 a[32:35], a[180:183], a[132:135], a[32:35]
ds_read_b64_tr_b16 a[162:163], v21 offset:41856
s_add_u32 s50, s50, 34603008
v_mfma_f32_16x16x32_bf16 a[36:39], a[176:179], a[136:139], a[36:39]
ds_read_b64_tr_b16 a[164:165], v21 offset:47232
s_lshl_b32 s51, s40, 9
v_mfma_f32_16x16x32_bf16 a[36:39], a[180:183], a[140:143], a[36:39]
ds_read_b64_tr_b16 a[166:167], v21 offset:48000
s_sub_u32 s51, s51, 128
v_mfma_f32_16x16x32_bf16 a[40:43], a[176:179], a[144:147], a[40:43]
buffer_load_dwordx4 v17, s[32:35], s45 offen offset:1024 lds
s_max_i32 s51, s51, 0
v_mfma_f32_16x16x32_bf16 a[40:43], a[180:183], a[148:151], a[40:43]
s_add_u32 s50, s50, s51
buffer_store_dwordx4 a[244:247], v26, s[36:39], s50 offen sc1
v_mfma_f32_16x16x32_bf16 a[44:47], a[176:179], a[152:155], a[44:47]
v_mfma_f32_16x16x32_bf16 a[44:47], a[180:183], a[156:159], a[44:47]
s_waitcnt lgkmcnt(4)
v_mfma_f32_16x16x32_bf16 a[60:63], a[184:187], a[152:155], a[60:63]
ds_read_b64_tr_b16 a[168:169], v22 offset:41088
v_mfma_f32_16x16x32_bf16 a[60:63], a[188:191], a[156:159], a[60:63]
ds_read_b64_tr_b16 a[170:171], v22 offset:41856
v_mfma_f32_16x16x32_bf16 a[56:59], a[184:187], a[144:147], a[56:59]
ds_read_b64_tr_b16 a[172:173], v22 offset:47232
v_mfma_f32_16x16x32_bf16 a[56:59], a[188:191], a[148:151], a[56:59]
ds_read_b64_tr_b16 a[174:175], v22 offset:48000
v_mfma_f32_16x16x32_bf16 a[52:55], a[184:187], a[136:139], a[52:55]
buffer_load_dwordx4 v18, s[32:35], s45 offen offset:2048 lds
s_add_u32 s45, s45, 458752
v_mfma_f32_16x16x32_bf16 a[52:55], a[188:191], a[140:143], a[52:55]
v_mfma_f32_16x16x32_bf16 a[48:51], a[184:187], a[128:131], a[48:51]
v_mfma_f32_16x16x32_bf16 a[48:51], a[188:191], a[132:135], a[48:51]
s_waitcnt vmcnt(21) lgkmcnt(0)
s_barrier
v_mfma_f32_16x16x32_bf16 a[64:67], a[128:131], a[160:163], a[64:67]
ds_read_b64_tr_b16 a[176:177], v23 offset:40960
v_mfma_f32_16x16x32_bf16 a[64:67], a[132:135], a[164:167], a[64:67]
ds_read_b64_tr_b16 a[178:179], v23 offset:42752
v_mfma_f32_16x16x32_bf16 a[68:71], a[136:139], a[160:163], a[68:71]
ds_read_b64_tr_b16 a[180:181], v23 offset:48128
v_mfma_f32_16x16x32_bf16 a[68:71], a[140:143], a[164:167], a[68:71]
ds_read_b64_tr_b16 a[182:183], v23 offset:49920
s_add_u32 m0, s48, 40960
v_mfma_f32_16x16x32_bf16 a[72:75], a[144:147], a[160:163], a[72:75]
buffer_load_dwordx4 v9, s[28:31], s44 offen offset:0 lds
v_mfma_f32_16x16x32_bf16 a[72:75], a[148:151], a[164:167], a[72:75]
v_mfma_f32_16x16x32_bf16 a[76:79], a[152:155], a[160:163], a[76:79]
v_mfma_f32_16x16x32_bf16 a[76:79], a[156:159], a[164:167], a[76:79]
v_mfma_f32_16x16x32_bf16 a[92:95], a[152:155], a[168:171], a[92:95]
ds_read_b64_tr_b16 a[184:185], v23 offset:40992
v_mfma_f32_16x16x32_bf16 a[92:95], a[156:159], a[172:175], a[92:95]
ds_read_b64_tr_b16 a[186:187], v23 offset:42784
v_mfma_f32_16x16x32_bf16 a[88:91], a[144:147], a[168:171], a[88:91]
ds_read_b64_tr_b16 a[188:189], v23 offset:48160
v_mfma_f32_16x16x32_bf16 a[88:91], a[148:151], a[172:175], a[88:91]
ds_read_b64_tr_b16 a[190:191], v23 offset:49952
v_mfma_f32_16x16x32_bf16 a[84:87], a[136:139], a[168:171], a[84:87]
buffer_load_dwordx4 v10, s[28:31], s44 offen offset:1024 lds
v_mfma_f32_16x16x32_bf16 a[84:87], a[140:143], a[172:175], a[84:87]
v_mfma_f32_16x16x32_bf16 a[80:83], a[128:131], a[168:171], a[80:83]
v_mfma_f32_16x16x32_bf16 a[80:83], a[132:135], a[172:175], a[80:83]
s_waitcnt lgkmcnt(4)
v_mfma_f32_16x16x32_bf16 v[32:35], a[176:179], a[128:131], v[32:35]
ds_read_b64_tr_b16 a[160:161], v23 offset:41024
v_mfma_f32_16x16x32_bf16 v[32:35], a[180:183], a[132:135], v[32:35]
ds_read_b64_tr_b16 a[162:163], v23 offset:42816
v_mfma_f32_16x16x32_bf16 v[36:39], a[176:179], a[136:139], v[36:39]
ds_read_b64_tr_b16 a[164:165], v23 offset:48192
v_mfma_f32_16x16x32_bf16 v[36:39], a[180:183], a[140:143], v[36:39]
ds_read_b64_tr_b16 a[166:167], v23 offset:49984
v_mfma_f32_16x16x32_bf16 v[40:43], a[176:179], a[144:147], v[40:43]
buffer_load_dwordx4 v11, s[28:31], s44 offen offset:2048 lds
s_add_u32 s44, s44, 393216
v_mfma_f32_16x16x32_bf16 v[40:43], a[180:183], a[148:151], v[40:43]
v_mfma_f32_16x16x32_bf16 v[44:47], a[176:179], a[152:155], v[44:47]
v_mfma_f32_16x16x32_bf16 v[44:47], a[180:183], a[156:159], v[44:47]
s_waitcnt lgkmcnt(4)
v_mfma_f32_16x16x32_bf16 v[60:63], a[184:187], a[152:155], v[60:63]
ds_read_b64_tr_b16 a[168:169], v23 offset:41056
v_mfma_f32_16x16x32_bf16 v[60:63], a[188:191], a[156:159], v[60:63]
ds_read_b64_tr_b16 a[170:171], v23 offset:42848
v_mfma_f32_16x16x32_bf16 v[56:59], a[184:187], a[144:147], v[56:59]
ds_read_b64_tr_b16 a[172:173], v23 offset:48224
v_mfma_f32_16x16x32_bf16 v[56:59], a[188:191], a[148:151], v[56:59]
ds_read_b64_tr_b16 a[174:175], v23 offset:50016
v_mfma_f32_16x16x32_bf16 v[52:55], a[184:187], a[136:139], v[52:55]
buffer_load_dword a255, v24, s[56:59], s55 offen
v_mfma_f32_16x16x32_bf16 v[52:55], a[188:191], a[140:143], v[52:55]
s_add_u32 s55, s55, 4096
v_mfma_f32_16x16x32_bf16 v[48:51], a[184:187], a[128:131], v[48:51]
v_mfma_f32_16x16x32_bf16 v[48:51], a[188:191], a[132:135], v[48:51]
s_waitcnt lgkmcnt(4)
v_mfma_f32_16x16x32_bf16 v[64:67], a[160:163], a[128:131], v[64:67]
ds_read_b64_tr_b16 a[176:177], v23 offset:41088
v_mfma_f32_16x16x32_bf16 v[64:67], a[164:167], a[132:135], v[64:67]
ds_read_b64_tr_b16 a[178:179], v23 offset:42880
v_mfma_f32_16x16x32_bf16 v[68:71], a[160:163], a[136:139], v[68:71]
ds_read_b64_tr_b16 a[180:181], v23 offset:48256
v_mfma_f32_16x16x32_bf16 v[68:71], a[164:167], a[140:143], v[68:71]
ds_read_b64_tr_b16 a[182:183], v23 offset:50048
v_mfma_f32_16x16x32_bf16 v[72:75], a[160:163], a[144:147], v[72:75]
ds_read_b128 a[96:99], v19 offset:0
v_mfma_f32_16x16x32_bf16 v[72:75], a[164:167], a[148:151], v[72:75]
ds_read_b128 a[100:103], v20 offset:0
v_mfma_f32_16x16x32_bf16 v[76:79], a[160:163], a[152:155], v[76:79]
ds_read_b128 a[104:107], v19 offset:2048
v_mfma_f32_16x16x32_bf16 v[76:79], a[164:167], a[156:159], v[76:79]
ds_read_b128 a[108:111], v20 offset:2048
s_waitcnt lgkmcnt(8)
v_mfma_f32_16x16x32_bf16 v[92:95], a[168:171], a[152:155], v[92:95]
ds_read_b64_tr_b16 a[184:185], v23 offset:41120
v_mfma_f32_16x16x32_bf16 v[92:95], a[172:175], a[156:159], v[92:95]
ds_read_b64_tr_b16 a[186:187], v23 offset:42912
v_mfma_f32_16x16x32_bf16 v[88:91], a[168:171], a[144:147], v[88:91]
ds_read_b64_tr_b16 a[188:189], v23 offset:48288
v_mfma_f32_16x16x32_bf16 v[88:91], a[172:175], a[148:151], v[88:91]
ds_read_b64_tr_b16 a[190:191], v23 offset:50080
v_mfma_f32_16x16x32_bf16 v[84:87], a[168:171], a[136:139], v[84:87]
ds_read_b128 a[112:115], v19 offset:4096
v_mfma_f32_16x16x32_bf16 v[84:87], a[172:175], a[140:143], v[84:87]
ds_read_b128 a[116:119], v20 offset:4096
v_mfma_f32_16x16x32_bf16 v[80:83], a[168:171], a[128:131], v[80:83]
ds_read_b128 a[120:123], v19 offset:6144
v_mfma_f32_16x16x32_bf16 v[80:83], a[172:175], a[132:135], v[80:83]
ds_read_b128 a[124:127], v20 offset:6144
s_waitcnt lgkmcnt(12)
v_mfma_f32_16x16x32_bf16 v[96:99], a[176:179], a[128:131], v[96:99]
ds_read_b64_tr_b16 a[160:161], v23 offset:41152
v_mfma_f32_16x16x32_bf16 v[96:99], a[180:183], a[132:135], v[96:99]
ds_read_b64_tr_b16 a[162:163], v23 offset:42944
v_mfma_f32_16x16x32_bf16 v[100:103], a[176:179], a[136:139], v[100:103]
ds_read_b64_tr_b16 a[164:165], v23 offset:48320
v_mfma_f32_16x16x32_bf16 v[100:103], a[180:183], a[140:143], v[100:103]
ds_read_b64_tr_b16 a[166:167], v23 offset:50112
v_mfma_f32_16x16x32_bf16 v[104:107], a[176:179], a[144:147], v[104:107]
v_mfma_f32_16x16x32_bf16 v[104:107], a[180:183], a[148:151], v[104:107]
v_mfma_f32_16x16x32_bf16 v[108:111], a[176:179], a[152:155], v[108:111]
v_mfma_f32_16x16x32_bf16 v[108:111], a[180:183], a[156:159], v[108:111]
s_waitcnt lgkmcnt(4)
v_mfma_f32_16x16x32_bf16 v[124:127], a[184:187], a[152:155], v[124:127]
ds_read_b64_tr_b16 a[168:169], v23 offset:55296
v_mfma_f32_16x16x32_bf16 v[124:127], a[188:191], a[156:159], v[124:127]
ds_read_b64_tr_b16 a[170:171], v23 offset:57088
v_mfma_f32_16x16x32_bf16 v[120:123], a[184:187], a[144:147], v[120:123]
ds_read_b64_tr_b16 a[172:173], v23 offset:62464
v_mfma_f32_16x16x32_bf16 v[120:123], a[188:191], a[148:151], v[120:123]
ds_read_b64_tr_b16 a[174:175], v23 offset:64256
s_add_u32 m0, s47, 0
v_mfma_f32_16x16x32_bf16 v[116:119], a[184:187], a[136:139], v[116:119]
buffer_load_dwordx4 v1, s[24:27], s43 offen offset:0 lds
v_mfma_f32_16x16x32_bf16 v[116:119], a[188:191], a[140:143], v[116:119]
v_mfma_f32_16x16x32_bf16 v[112:115], a[184:187], a[128:131], v[112:115]
buffer_load_dwordx4 v2, s[24:27], s43 offen offset:1024 lds
v_mfma_f32_16x16x32_bf16 v[112:115], a[188:191], a[132:135], v[112:115]
s_waitcnt lgkmcnt(4)
v_mfma_f32_16x16x32_bf16 v[128:131], a[160:163], a[128:131], v[128:131]
ds_read_b64_tr_b16 a[176:177], v23 offset:55328
v_mfma_f32_16x16x32_bf16 v[128:131], a[164:167], a[132:135], v[128:131]
ds_read_b64_tr_b16 a[178:179], v23 offset:57120
v_mfma_f32_16x16x32_bf16 v[132:135], a[160:163], a[136:139], v[132:135]
ds_read_b64_tr_b16 a[180:181], v23 offset:62496
v_mfma_f32_16x16x32_bf16 v[132:135], a[164:167], a[140:143], v[132:135]
ds_read_b64_tr_b16 a[182:183], v23 offset:64288
v_mfma_f32_16x16x32_bf16 v[136:139], a[160:163], a[144:147], v[136:139]
buffer_load_dwordx4 v3, s[24:27], s43 offen offset:2048 lds
v_mfma_f32_16x16x32_bf16 v[136:139], a[164:167], a[148:151], v[136:139]
v_mfma_f32_16x16x32_bf16 v[140:143], a[160:163], a[152:155], v[140:143]
v_mfma_f32_16x16x32_bf16 v[140:143], a[164:167], a[156:159], v[140:143]
s_waitcnt lgkmcnt(4)
v_mfma_f32_16x16x32_bf16 v[156:159], a[168:171], a[152:155], v[156:159]
ds_read_b64_tr_b16 a[184:185], v23 offset:55360
v_mfma_f32_16x16x32_bf16 v[156:159], a[172:175], a[156:159], v[156:159]
ds_read_b64_tr_b16 a[186:187], v23 offset:57152
v_mfma_f32_16x16x32_bf16 v[152:155], a[168:171], a[144:147], v[152:155]
ds_read_b64_tr_b16 a[188:189], v23 offset:62528
v_mfma_f32_16x16x32_bf16 v[152:155], a[172:175], a[148:151], v[152:155]
ds_read_b64_tr_b16 a[190:191], v23 offset:64320
v_mfma_f32_16x16x32_bf16 v[148:151], a[168:171], a[136:139], v[148:151]
buffer_load_dwordx4 v4, s[24:27], s43 offen offset:3072 lds
v_mfma_f32_16x16x32_bf16 v[148:151], a[172:175], a[140:143], v[148:151]
v_mfma_f32_16x16x32_bf16 v[144:147], a[168:171], a[128:131], v[144:147]
v_mfma_f32_16x16x32_bf16 v[144:147], a[172:175], a[132:135], v[144:147]
s_waitcnt lgkmcnt(4)
v_mfma_f32_16x16x32_bf16 v[160:163], a[176:179], a[128:131], v[160:163]
ds_read_b64_tr_b16 a[160:161], v23 offset:55392
v_mfma_f32_16x16x32_bf16 v[160:163], a[180:183], a[132:135], v[160:163]
ds_read_b64_tr_b16 a[162:163], v23 offset:57184
v_mfma_f32_16x16x32_bf16 v[164:167], a[176:179], a[136:139], v[164:167]
ds_read_b64_tr_b16 a[164:165], v23 offset:62560
v_mfma_f32_16x16x32_bf16 v[164:167], a[180:183], a[140:143], v[164:167]
ds_read_b64_tr_b16 a[166:167], v23 offset:64352
s_add_u32 m0, s47, 4096
v_mfma_f32_16x16x32_bf16 v[168:171], a[176:179], a[144:147], v[168:171]
buffer_load_dwordx4 v5, s[24:27], s43 offen offset:0 lds
v_mfma_f32_16x16x32_bf16 v[168:171], a[180:183], a[148:151], v[168:171]
v_mfma_f32_16x16x32_bf16 v[172:175], a[176:179], a[152:155], v[172:175]
v_mfma_f32_16x16x32_bf16 v[172:175], a[180:183], a[156:159], v[172:175]
s_waitcnt lgkmcnt(4)
v_mfma_f32_16x16x32_bf16 v[188:191], a[184:187], a[152:155], v[188:191]
ds_read_b64_tr_b16 a[168:169], v23 offset:55424
v_mfma_f32_16x16x32_bf16 v[188:191], a[188:191], a[156:159], v[188:191]
ds_read_b64_tr_b16 a[170:171], v23 offset:57216
v_mfma_f32_16x16x32_bf16 v[184:187], a[184:187], a[144:147], v[184:187]
ds_read_b64_tr_b16 a[172:173], v23 offset:62592
v_mfma_f32_16x16x32_bf16 v[184:187], a[188:191], a[148:151], v[184:187]
ds_read_b64_tr_b16 a[174:175], v23 offset:64384
v_mfma_f32_16x16x32_bf16 v[180:183], a[184:187], a[136:139], v[180:183]
buffer_load_dwordx4 v6, s[24:27], s43 offen offset:1024 lds
v_mfma_f32_16x16x32_bf16 v[180:183], a[188:191], a[140:143], v[180:183]
v_mfma_f32_16x16x32_bf16 v[176:179], a[184:187], a[128:131], v[176:179]
v_mfma_f32_16x16x32_bf16 v[176:179], a[188:191], a[132:135], v[176:179]
s_waitcnt lgkmcnt(4)
v_mfma_f32_16x16x32_bf16 v[192:195], a[160:163], a[128:131], v[192:195]
ds_read_b64_tr_b16 a[176:177], v23 offset:55456
v_mfma_f32_16x16x32_bf16 v[192:195], a[164:167], a[132:135], v[192:195]
ds_read_b64_tr_b16 a[178:179], v23 offset:57248
v_mfma_f32_16x16x32_bf16 v[196:199], a[160:163], a[136:139], v[196:199]
ds_read_b64_tr_b16 a[180:181], v23 offset:62624
v_mfma_f32_16x16x32_bf16 v[196:199], a[164:167], a[140:143], v[196:199]
ds_read_b64_tr_b16 a[182:183], v23 offset:64416
v_mfma_f32_16x16x32_bf16 v[200:203], a[160:163], a[144:147], v[200:203]
buffer_load_dwordx4 v7, s[24:27], s43 offen offset:2048 lds
v_mfma_f32_16x16x32_bf16 v[200:203], a[164:167], a[148:151], v[200:203]
v_mfma_f32_16x16x32_bf16 v[204:207], a[160:163], a[152:155], v[204:207]
v_mfma_f32_16x16x32_bf16 v[204:207], a[164:167], a[156:159], v[204:207]
s_waitcnt lgkmcnt(4)
v_mfma_f32_16x16x32_bf16 v[220:223], a[168:171], a[152:155], v[220:223]
ds_read_b64_tr_b16 a[184:185], v23 offset:55488
v_mfma_f32_16x16x32_bf16 v[220:223], a[172:175], a[156:159], v[220:223]
ds_read_b64_tr_b16 a[186:187], v23 offset:57280
v_mfma_f32_16x16x32_bf16 v[216:219], a[168:171], a[144:147], v[216:219]
ds_read_b64_tr_b16 a[188:189], v23 offset:62656
v_mfma_f32_16x16x32_bf16 v[216:219], a[172:175], a[148:151], v[216:219]
ds_read_b64_tr_b16 a[190:191], v23 offset:64448
v_mfma_f32_16x16x32_bf16 v[212:215], a[168:171], a[136:139], v[212:215]
buffer_load_dwordx4 v8, s[24:27], s43 offen offset:3072 lds
s_add_u32 s43, s43, 128
v_mfma_f32_16x16x32_bf16 v[212:215], a[172:175], a[140:143], v[212:215]
v_mfma_f32_16x16x32_bf16 v[208:211], a[168:171], a[128:131], v[208:211]
v_mfma_f32_16x16x32_bf16 v[208:211], a[172:175], a[132:135], v[208:211]
s_waitcnt vmcnt(30) lgkmcnt(0)
s_barrier
v_mfma_f32_16x16x32_bf16 v[224:227], a[176:179], a[128:131], v[224:227]
ds_read_b64_tr_b16 a[160:161], v21 offset:0
v_mfma_f32_16x16x32_bf16 v[224:227], a[180:183], a[132:135], v[224:227]
ds_read_b64_tr_b16 a[162:163], v21 offset:768
v_mfma_f32_16x16x32_bf16 v[228:231], a[176:179], a[136:139], v[228:231]
ds_read_b64_tr_b16 a[164:165], v21 offset:6144
v_mfma_f32_16x16x32_bf16 v[228:231], a[180:183], a[140:143], v[228:231]
ds_read_b64_tr_b16 a[166:167], v21 offset:6912
s_add_u32 m0, s49, 40960
v_mfma_f32_16x16x32_bf16 v[232:235], a[176:179], a[144:147], v[232:235]
buffer_load_dwordx4 v12, s[32:35], s45 offen offset:0 lds
v_mfma_f32_16x16x32_bf16 v[232:235], a[180:183], a[148:151], v[232:235]
v_mfma_f32_16x16x32_bf16 v[236:239], a[176:179], a[152:155], v[236:239]
v_mfma_f32_16x16x32_bf16 v[236:239], a[180:183], a[156:159], v[236:239]
v_mfma_f32_16x16x32_bf16 v[252:255], a[184:187], a[152:155], v[252:255]
ds_read_b64_tr_b16 a[168:169], v22 offset:0
v_mfma_f32_16x16x32_bf16 v[252:255], a[188:191], a[156:159], v[252:255]
ds_read_b64_tr_b16 a[170:171], v22 offset:768
v_mfma_f32_16x16x32_bf16 v[248:251], a[184:187], a[144:147], v[248:251]
ds_read_b64_tr_b16 a[172:173], v22 offset:6144
v_mfma_f32_16x16x32_bf16 v[248:251], a[188:191], a[148:151], v[248:251]
ds_read_b64_tr_b16 a[174:175], v22 offset:6912
v_mfma_f32_16x16x32_bf16 v[244:247], a[184:187], a[136:139], v[244:247]
buffer_load_dwordx4 v13, s[32:35], s45 offen offset:1024 lds
v_mfma_f32_16x16x32_bf16 v[244:247], a[188:191], a[140:143], v[244:247]
v_mfma_f32_16x16x32_bf16 v[240:243], a[184:187], a[128:131], v[240:243]
v_mfma_f32_16x16x32_bf16 v[240:243], a[188:191], a[132:135], v[240:243]
s_waitcnt lgkmcnt(4)
v_mfma_f32_16x16x32_bf16 a[0:3], a[160:163], a[96:99], a[0:3]
ds_read_b64_tr_b16 a[176:177], v21 offset:64
v_mfma_f32_16x16x32_bf16 a[0:3], a[164:167], a[100:103], a[0:3]
ds_read_b64_tr_b16 a[178:179], v21 offset:832
v_mfma_f32_16x16x32_bf16 a[4:7], a[160:163], a[104:107], a[4:7]
ds_read_b64_tr_b16 a[180:181], v21 offset:6208
v_mfma_f32_16x16x32_bf16 a[4:7], a[164:167], a[108:111], a[4:7]
ds_read_b64_tr_b16 a[182:183], v21 offset:6976
v_mfma_f32_16x16x32_bf16 a[8:11], a[160:163], a[112:115], a[8:11]
buffer_load_dwordx4 v14, s[32:35], s45 offen offset:2048 lds
v_mfma_f32_16x16x32_bf16 a[8:11], a[164:167], a[116:119], a[8:11]
v_mfma_f32_16x16x32_bf16 a[12:15], a[160:163], a[120:123], a[12:15]
buffer_load_dwordx4 v15, s[32:35], s45 offen offset:3072 lds
v_mfma_f32_16x16x32_bf16 a[12:15], a[164:167], a[124:127], a[12:15]
s_waitcnt lgkmcnt(4)
v_mfma_f32_16x16x32_bf16 a[28:31], a[168:171], a[120:123], a[28:31]
ds_read_b64_tr_b16 a[184:185], v22 offset:64
v_mfma_f32_16x16x32_bf16 a[28:31], a[172:175], a[124:127], a[28:31]
ds_read_b64_tr_b16 a[186:187], v22 offset:832
v_mfma_f32_16x16x32_bf16 a[24:27], a[168:171], a[112:115], a[24:27]
ds_read_b64_tr_b16 a[188:189], v22 offset:6208
v_mfma_f32_16x16x32_bf16 a[24:27], a[172:175], a[116:119], a[24:27]
ds_read_b64_tr_b16 a[190:191], v22 offset:6976
s_add_u32 m0, s49, 45056
v_mfma_f32_16x16x32_bf16 a[20:23], a[168:171], a[104:107], a[20:23]
buffer_load_dwordx4 v16, s[32:35], s45 offen offset:0 lds
v_mfma_f32_16x16x32_bf16 a[20:23], a[172:175], a[108:111], a[20:23]
v_mfma_f32_16x16x32_bf16 a[16:19], a[168:171], a[96:99], a[16:19]
v_mfma_f32_16x16x32_bf16 a[16:19], a[172:175], a[100:103], a[16:19]
s_waitcnt lgkmcnt(4)
v_mfma_f32_16x16x32_bf16 a[32:35], a[176:179], a[96:99], a[32:35]
ds_read_b64_tr_b16 a[160:161], v21 offset:128
v_mfma_f32_16x16x32_bf16 a[32:35], a[180:183], a[100:103], a[32:35]
ds_read_b64_tr_b16 a[162:163], v21 offset:896
v_mfma_f32_16x16x32_bf16 a[36:39], a[176:179], a[104:107], a[36:39]
ds_read_b64_tr_b16 a[164:165], v21 offset:6272
v_mfma_f32_16x16x32_bf16 a[36:39], a[180:183], a[108:111], a[36:39]
ds_read_b64_tr_b16 a[166:167], v21 offset:7040
v_mfma_f32_16x16x32_bf16 a[40:43], a[176:179], a[112:115], a[40:43]
buffer_load_dwordx4 v17, s[32:35], s45 offen offset:1024 lds
v_mfma_f32_16x16x32_bf16 a[40:43], a[180:183], a[116:119], a[40:43]
v_mfma_f32_16x16x32_bf16 a[44:47], a[176:179], a[120:123], a[44:47]
v_mfma_f32_16x16x32_bf16 a[44:47], a[180:183], a[124:127], a[44:47]
s_waitcnt lgkmcnt(4)
v_mfma_f32_16x16x32_bf16 a[60:63], a[184:187], a[120:123], a[60:63]
ds_read_b64_tr_b16 a[168:169], v22 offset:128
v_mfma_f32_16x16x32_bf16 a[60:63], a[188:191], a[124:127], a[60:63]
ds_read_b64_tr_b16 a[170:171], v22 offset:896
v_mfma_f32_16x16x32_bf16 a[56:59], a[184:187], a[112:115], a[56:59]
ds_read_b64_tr_b16 a[172:173], v22 offset:6272
v_mfma_f32_16x16x32_bf16 a[56:59], a[188:191], a[116:119], a[56:59]
ds_read_b64_tr_b16 a[174:175], v22 offset:7040
v_mfma_f32_16x16x32_bf16 a[52:55], a[184:187], a[104:107], a[52:55]
buffer_load_dwordx4 v18, s[32:35], s45 offen offset:2048 lds
s_add_u32 s45, s45, 458752
v_mfma_f32_16x16x32_bf16 a[52:55], a[188:191], a[108:111], a[52:55]
v_mfma_f32_16x16x32_bf16 a[48:51], a[184:187], a[96:99], a[48:51]
v_mfma_f32_16x16x32_bf16 a[48:51], a[188:191], a[100:103], a[48:51]
s_waitcnt vmcnt(19) lgkmcnt(0)
s_barrier
v_mov_b32 v25, 1
s_and_b32 s50, s2, 63
s_lshl_b32 s50, s50, 2
v_mov_b32 v26, s50
s_cmp_eq_u32 s40, 3
s_cbranch_scc0 L_noatm
s_mov_b64 exec, 1
buffer_atomic_add v25, v26, s[64:67], 0 offen sc1
s_mov_b64 exec, -1
L_noatm:
v_mfma_f32_16x16x32_bf16 a[64:67], a[96:99], a[160:163], a[64:67]
ds_read_b64_tr_b16 a[176:177], v23 offset:0
v_mfma_f32_16x16x32_bf16 a[64:67], a[100:103], a[164:167], a[64:67]
ds_read_b64_tr_b16 a[178:179], v23 offset:1792
v_mfma_f32_16x16x32_bf16 a[68:71], a[104:107], a[160:163], a[68:71]
ds_read_b64_tr_b16 a[180:181], v23 offset:7168
v_mfma_f32_16x16x32_bf16 a[68:71], a[108:111], a[164:167], a[68:71]
ds_read_b64_tr_b16 a[182:183], v23 offset:8960
s_add_u32 m0, s48, 0
v_mfma_f32_16x16x32_bf16 a[72:75], a[112:115], a[160:163], a[72:75]
buffer_load_dwordx4 v9, s[28:31], s44 offen offset:0 lds
v_mfma_f32_16x16x32_bf16 a[72:75], a[116:119], a[164:167], a[72:75]
v_mfma_f32_16x16x32_bf16 a[76:79], a[120:123], a[160:163], a[76:79]
v_mfma_f32_16x16x32_bf16 a[76:79], a[124:127], a[164:167], a[76:79]
v_mfma_f32_16x16x32_bf16 a[92:95], a[120:123], a[168:171], a[92:95]
ds_read_b64_tr_b16 a[184:185], v23 offset:32
v_mfma_f32_16x16x32_bf16 a[92:95], a[124:127], a[172:175], a[92:95]
ds_read_b64_tr_b16 a[186:187], v23 offset:1824
v_mfma_f32_16x16x32_bf16 a[88:91], a[112:115], a[168:171], a[88:91]
ds_read_b64_tr_b16 a[188:189], v23 offset:7200
v_mfma_f32_16x16x32_bf16 a[88:91], a[116:119], a[172:175], a[88:91]
ds_read_b64_tr_b16 a[190:191], v23 offset:8992
v_mfma_f32_16x16x32_bf16 a[84:87], a[104:107], a[168:171], a[84:87]
buffer_load_dwordx4 v10, s[28:31], s44 offen offset:1024 lds
v_mfma_f32_16x16x32_bf16 a[84:87], a[108:111], a[172:175], a[84:87]
v_mfma_f32_16x16x32_bf16 a[80:83], a[96:99], a[168:171], a[80:83]
v_mfma_f32_16x16x32_bf16 a[80:83], a[100:103], a[172:175], a[80:83]
s_waitcnt lgkmcnt(4)
v_mfma_f32_16x16x32_bf16 v[32:35], a[176:179], a[96:99], v[32:35]
ds_read_b64_tr_b16 a[160:161], v23 offset:64
v_mfma_f32_16x16x32_bf16 v[32:35], a[180:183], a[100:103], v[32:35]
ds_read_b64_tr_b16 a[162:163], v23 offset:1856
v_mfma_f32_16x16x32_bf16 v[36:39], a[176:179], a[104:107], v[36:39]
ds_read_b64_tr_b16 a[164:165], v23 offset:7232
v_mfma_f32_16x16x32_bf16 v[36:39], a[180:183], a[108:111], v[36:39]
ds_read_b64_tr_b16 a[166:167], v23 offset:9024
v_mfma_f32_16x16x32_bf16 v[40:43], a[176:179], a[112:115], v[40:43]
buffer_load_dwordx4 v11, s[28:31], s44 offen offset:2048 lds
s_add_u32 s44, s44, 393216
v_mfma_f32_16x16x32_bf16 v[40:43], a[180:183], a[116:119], v[40:43]
v_mfma_f32_16x16x32_bf16 v[44:47], a[176:179], a[120:123], v[44:47]
v_mfma_f32_16x16x32_bf16 v[44:47], a[180:183], a[124:127], v[44:47]
s_waitcnt lgkmcnt(4)
v_mfma_f32_16x16x32_bf16 v[60:63], a[184:187], a[120:123], v[60:63]
ds_read_b64_tr_b16 a[168:169], v23 offset:96
v_mfma_f32_16x16x32_bf16 v[60:63], a[188:191], a[124:127], v[60:63]
ds_read_b64_tr_b16 a[170:171], v23 offset:1888
v_mfma_f32_16x16x32_bf16 v[56:59], a[184:187], a[112:115], v[56:59]
ds_read_b64_tr_b16 a[172:173], v23 offset:7264
v_mfma_f32_16x16x32_bf16 v[56:59], a[188:191], a[116:119], v[56:59]
ds_read_b64_tr_b16 a[174:175], v23 offset:9056
v_mfma_f32_16x16x32_bf16 v[52:55], a[184:187], a[104:107], v[52:55]
buffer_load_dword a255, v24, s[56:59], s55 offen
v_mfma_f32_16x16x32_bf16 v[52:55], a[188:191], a[108:111], v[52:55]
s_add_u32 s55, s55, 4096
v_mfma_f32_16x16x32_bf16 v[48:51], a[184:187], a[96:99], v[48:51]
v_mfma_f32_16x16x32_bf16 v[48:51], a[188:191], a[100:103], v[48:51]
s_waitcnt lgkmcnt(4)
v_mfma_f32_16x16x32_bf16 v[64:67], a[160:163], a[96:99], v[64:67]
ds_read_b64_tr_b16 a[176:177], v23 offset:128
v_mfma_f32_16x16x32_bf16 v[64:67], a[164:167], a[100:103], v[64:67]
ds_read_b64_tr_b16 a[178:179], v23 offset:1920
v_mfma_f32_16x16x32_bf16 v[68:71], a[160:163], a[104:107], v[68:71]
ds_read_b64_tr_b16 a[180:181], v23 offset:7296
v_mfma_f32_16x16x32_bf16 v[68:71], a[164:167], a[108:111], v[68:71]
ds_read_b64_tr_b16 a[182:183], v23 offset:9088
v_mfma_f32_16x16x32_bf16 v[72:75], a[160:163], a[112:115], v[72:75]
ds_read_b128 a[128:131], v19 offset:32768
v_mfma_f32_16x16x32_bf16 v[72:75], a[164:167], a[116:119], v[72:75]
ds_read_b128 a[132:135], v20 offset:32768
v_mfma_f32_16x16x32_bf16 v[76:79], a[160:163], a[120:123], v[76:79]
ds_read_b128 a[136:139], v19 offset:34816
v_mfma_f32_16x16x32_bf16 v[76:79], a[164:167], a[124:127], v[76:79]
ds_read_b128 a[140:143], v20 offset:34816
s_waitcnt lgkmcnt(8)
v_mfma_f32_16x16x32_bf16 v[92:95], a[168:171], a[120:123], v[92:95]
ds_read_b64_tr_b16 a[184:185], v23 offset:160
v_mfma_f32_16x16x32_bf16 v[92:95], a[172:175], a[124:127], v[92:95]
ds_read_b64_tr_b16 a[186:187], v23 offset:1952
v_mfma_f32_16x16x32_bf16 v[88:91], a[168:171], a[112:115], v[88:91]
ds_read_b64_tr_b16 a[188:189], v23 offset:7328
v_mfma_f32_16x16x32_bf16 v[88:91], a[172:175], a[116:119], v[88:91]
ds_read_b64_tr_b16 a[190:191], v23 offset:9120
v_mfma_f32_16x16x32_bf16 v[84:87], a[168:171], a[104:107], v[84:87]
ds_read_b128 a[144:147], v19 offset:36864
v_mfma_f32_16x16x32_bf16 v[84:87], a[172:175], a[108:111], v[84:87]
ds_read_b128 a[148:151], v20 offset:36864
v_mfma_f32_16x16x32_bf16 v[80:83], a[168:171], a[96:99], v[80:83]
ds_read_b128 a[152:155], v19 offset:38912
v_mfma_f32_16x16x32_bf16 v[80:83], a[172:175], a[100:103], v[80:83]
ds_read_b128 a[156:159], v20 offset:38912
s_waitcnt lgkmcnt(12)
v_mfma_f32_16x16x32_bf16 v[96:99], a[176:179], a[96:99], v[96:99]
ds_read_b64_tr_b16 a[160:161], v23 offset:192
v_mfma_f32_16x16x32_bf16 v[96:99], a[180:183], a[100:103], v[96:99]
ds_read_b64_tr_b16 a[162:163], v23 offset:1984
v_mfma_f32_16x16x32_bf16 v[100:103], a[176:179], a[104:107], v[100:103]
ds_read_b64_tr_b16 a[164:165], v23 offset:7360
v_mfma_f32_16x16x32_bf16 v[100:103], a[180:183], a[108:111], v[100:103]
ds_read_b64_tr_b16 a[166:167], v23 offset:9152
v_mfma_f32_16x16x32_bf16 v[104:107], a[176:179], a[112:115], v[104:107]
v_mfma_f32_16x16x32_bf16 v[104:107], a[180:183], a[116:119], v[104:107]
v_mfma_f32_16x16x32_bf16 v[108:111], a[176:179], a[120:123], v[108:111]
v_mfma_f32_16x16x32_bf16 v[108:111], a[180:183], a[124:127], v[108:111]
s_waitcnt lgkmcnt(4)
v_mfma_f32_16x16x32_bf16 v[124:127], a[184:187], a[120:123], v[124:127]
ds_read_b64_tr_b16 a[168:169], v23 offset:14336
v_mfma_f32_16x16x32_bf16 v[124:127], a[188:191], a[124:127], v[124:127]
ds_read_b64_tr_b16 a[170:171], v23 offset:16128
v_mfma_f32_16x16x32_bf16 v[120:123], a[184:187], a[112:115], v[120:123]
ds_read_b64_tr_b16 a[172:173], v23 offset:21504
v_mfma_f32_16x16x32_bf16 v[120:123], a[188:191], a[116:119], v[120:123]
ds_read_b64_tr_b16 a[174:175], v23 offset:23296
s_add_u32 m0, s47, 32768
v_mfma_f32_16x16x32_bf16 v[116:119], a[184:187], a[104:107], v[116:119]
buffer_load_dwordx4 v1, s[24:27], s43 offen offset:0 lds
v_mfma_f32_16x16x32_bf16 v[116:119], a[188:191], a[108:111], v[116:119]
v_mfma_f32_16x16x32_bf16 v[112:115], a[184:187], a[96:99], v[112:115]
buffer_load_dwordx4 v2, s[24:27], s43 offen offset:1024 lds
v_mfma_f32_16x16x32_bf16 v[112:115], a[188:191], a[100:103], v[112:115]
s_waitcnt lgkmcnt(4)
v_mfma_f32_16x16x32_bf16 v[128:131], a[160:163], a[96:99], v[128:131]
ds_read_b64_tr_b16 a[176:177], v23 offset:14368
v_mfma_f32_16x16x32_bf16 v[128:131], a[164:167], a[100:103], v[128:131]
ds_read_b64_tr_b16 a[178:179], v23 offset:16160
v_mfma_f32_16x16x32_bf16 v[132:135], a[160:163], a[104:107], v[132:135]
ds_read_b64_tr_b16 a[180:181], v23 offset:21536
v_mfma_f32_16x16x32_bf16 v[132:135], a[164:167], a[108:111], v[132:135]
ds_read_b64_tr_b16 a[182:183], v23 offset:23328
v_mfma_f32_16x16x32_bf16 v[136:139], a[160:163], a[112:115], v[136:139]
buffer_load_dwordx4 v3, s[24:27], s43 offen offset:2048 lds
v_mfma_f32_16x16x32_bf16 v[136:139], a[164:167], a[116:119], v[136:139]
v_mfma_f32_16x16x32_bf16 v[140:143], a[160:163], a[120:123], v[140:143]
v_mfma_f32_16x16x32_bf16 v[140:143], a[164:167], a[124:127], v[140:143]
s_waitcnt lgkmcnt(4)
v_mfma_f32_16x16x32_bf16 v[156:159], a[168:171], a[120:123], v[156:159]
ds_read_b64_tr_b16 a[184:185], v23 offset:14400
v_mfma_f32_16x16x32_bf16 v[156:159], a[172:175], a[124:127], v[156:159]
ds_read_b64_tr_b16 a[186:187], v23 offset:16192
v_mfma_f32_16x16x32_bf16 v[152:155], a[168:171], a[112:115], v[152:155]
ds_read_b64_tr_b16 a[188:189], v23 offset:21568
v_mfma_f32_16x16x32_bf16 v[152:155], a[172:175], a[116:119], v[152:155]
ds_read_b64_tr_b16 a[190:191], v23 offset:23360
v_mfma_f32_16x16x32_bf16 v[148:151], a[168:171], a[104:107], v[148:151]
buffer_load_dwordx4 v4, s[24:27], s43 offen offset:3072 lds
v_mfma_f32_16x16x32_bf16 v[148:151], a[172:175], a[108:111], v[148:151]
v_mfma_f32_16x16x32_bf16 v[144:147], a[168:171], a[96:99], v[144:147]
v_mfma_f32_16x16x32_bf16 v[144:147], a[172:175], a[100:103], v[144:147]
s_waitcnt lgkmcnt(4)
v_mfma_f32_16x16x32_bf16 v[160:163], a[176:179], a[96:99], v[160:163]
ds_read_b64_tr_b16 a[160:161], v23 offset:14432
v_mfma_f32_16x16x32_bf16 v[160:163], a[180:183], a[100:103], v[160:163]
ds_read_b64_tr_b16 a[162:163], v23 offset:16224
v_mfma_f32_16x16x32_bf16 v[164:167], a[176:179], a[104:107], v[164:167]
ds_read_b64_tr_b16 a[164:165], v23 offset:21600
v_mfma_f32_16x16x32_bf16 v[164:167], a[180:183], a[108:111], v[164:167]
ds_read_b64_tr_b16 a[166:167], v23 offset:23392
s_add_u32 m0, s47, 36864
v_mfma_f32_16x16x32_bf16 v[168:171], a[176:179], a[112:115], v[168:171]
buffer_load_dwordx4 v5, s[24:27], s43 offen offset:0 lds
v_mfma_f32_16x16x32_bf16 v[168:171], a[180:183], a[116:119], v[168:171]
v_mfma_f32_16x16x32_bf16 v[172:175], a[176:179], a[120:123], v[172:175]
v_mfma_f32_16x16x32_bf16 v[172:175], a[180:183], a[124:127], v[172:175]
s_waitcnt lgkmcnt(4)
v_mfma_f32_16x16x32_bf16 v[188:191], a[184:187], a[120:123], v[188:191]
ds_read_b64_tr_b16 a[168:169], v23 offset:14464
v_mfma_f32_16x16x32_bf16 v[188:191], a[188:191], a[124:127], v[188:191]
ds_read_b64_tr_b16 a[170:171], v23 offset:16256
v_mfma_f32_16x16x32_bf16 v[184:187], a[184:187], a[112:115], v[184:187]
ds_read_b64_tr_b16 a[172:173], v23 offset:21632
v_mfma_f32_16x16x32_bf16 v[184:187], a[188:191], a[116:119], v[184:187]
ds_read_b64_tr_b16 a[174:175], v23 offset:23424
v_mfma_f32_16x16x32_bf16 v[180:183], a[184:187], a[104:107], v[180:183]
buffer_load_dwordx4 v6, s[24:27], s43 offen offset:1024 lds
v_mfma_f32_16x16x32_bf16 v[180:183], a[188:191], a[108:111], v[180:183]
v_mfma_f32_16x16x32_bf16 v[176:179], a[184:187], a[96:99], v[176:179]
v_mfma_f32_16x16x32_bf16 v[176:179], a[188:191], a[100:103], v[176:179]
s_waitcnt lgkmcnt(4)
v_mfma_f32_16x16x32_bf16 v[192:195], a[160:163], a[96:99], v[192:195]
ds_read_b64_tr_b16 a[176:177], v23 offset:14496
v_mfma_f32_16x16x32_bf16 v[192:195], a[164:167], a[100:103], v[192:195]
ds_read_b64_tr_b16 a[178:179], v23 offset:16288
v_mfma_f32_16x16x32_bf16 v[196:199], a[160:163], a[104:107], v[196:199]
ds_read_b64_tr_b16 a[180:181], v23 offset:21664
v_mfma_f32_16x16x32_bf16 v[196:199], a[164:167], a[108:111], v[196:199]
ds_read_b64_tr_b16 a[182:183], v23 offset:23456
v_mfma_f32_16x16x32_bf16 v[200:203], a[160:163], a[112:115], v[200:203]
buffer_load_dwordx4 v7, s[24:27], s43 offen offset:2048 lds
v_mfma_f32_16x16x32_bf16 v[200:203], a[164:167], a[116:119], v[200:203]
v_mfma_f32_16x16x32_bf16 v[204:207], a[160:163], a[120:123], v[204:207]
v_mfma_f32_16x16x32_bf16 v[204:207], a[164:167], a[124:127], v[204:207]
s_waitcnt lgkmcnt(4)
v_mfma_f32_16x16x32_bf16 v[220:223], a[168:171], a[120:123], v[220:223]
ds_read_b64_tr_b16 a[184:185], v23 offset:14528
v_mfma_f32_16x16x32_bf16 v[220:223], a[172:175], a[124:127], v[220:223]
ds_read_b64_tr_b16 a[186:187], v23 offset:16320
v_mfma_f32_16x16x32_bf16 v[216:219], a[168:171], a[112:115], v[216:219]
ds_read_b64_tr_b16 a[188:189], v23 offset:21696
v_mfma_f32_16x16x32_bf16 v[216:219], a[172:175], a[116:119], v[216:219]
ds_read_b64_tr_b16 a[190:191], v23 offset:23488
v_mfma_f32_16x16x32_bf16 v[212:215], a[168:171], a[104:107], v[212:215]
buffer_load_dwordx4 v8, s[24:27], s43 offen offset:3072 lds
s_add_u32 s43, s43, 128
v_mfma_f32_16x16x32_bf16 v[212:215], a[172:175], a[108:111], v[212:215]
v_mfma_f32_16x16x32_bf16 v[208:211], a[168:171], a[96:99], v[208:211]
v_mfma_f32_16x16x32_bf16 v[208:211], a[172:175], a[100:103], v[208:211]
s_waitcnt vmcnt(28) lgkmcnt(0)
s_barrier
v_mfma_f32_16x16x32_bf16 v[224:227], a[176:179], a[96:99], v[224:227]
ds_read_b64_tr_b16 a[160:161], v21 offset:40960
v_mfma_f32_16x16x32_bf16 v[224:227], a[180:183], a[100:103], v[224:227]
ds_read_b64_tr_b16 a[162:163], v21 offset:41728
v_mfma_f32_16x16x32_bf16 v[228:231], a[176:179], a[104:107], v[228:231]
ds_read_b64_tr_b16 a[164:165], v21 offset:47104
v_mfma_f32_16x16x32_bf16 v[228:231], a[180:183], a[108:111], v[228:231]
ds_read_b64_tr_b16 a[166:167], v21 offset:47872
s_add_u32 m0, s49, 0
v_mfma_f32_16x16x32_bf16 v[232:235], a[176:179], a[112:115], v[232:235]
buffer_load_dwordx4 v12, s[32:35], s45 offen offset:0 lds
v_mfma_f32_16x16x32_bf16 v[232:235], a[180:183], a[116:119], v[232:235]
v_mfma_f32_16x16x32_bf16 v[236:239], a[176:179], a[120:123], v[236:239]
v_mfma_f32_16x16x32_bf16 v[236:239], a[180:183], a[124:127], v[236:239]
v_mfma_f32_16x16x32_bf16 v[252:255], a[184:187], a[120:123], v[252:255]
ds_read_b64_tr_b16 a[168:169], v22 offset:40960
v_mfma_f32_16x16x32_bf16 v[252:255], a[188:191], a[124:127], v[252:255]
ds_read_b64_tr_b16 a[170:171], v22 offset:41728
v_mfma_f32_16x16x32_bf16 v[248:251], a[184:187], a[112:115], v[248:251]
ds_read_b64_tr_b16 a[172:173], v22 offset:47104
v_mfma_f32_16x16x32_bf16 v[248:251], a[188:191], a[116:119], v[248:251]
ds_read_b64_tr_b16 a[174:175], v22 offset:47872
v_mfma_f32_16x16x32_bf16 v[244:247], a[184:187], a[104:107], v[244:247]
buffer_load_dwordx4 v13, s[32:35], s45 offen offset:1024 lds
v_mfma_f32_16x16x32_bf16 v[244:247], a[188:191], a[108:111], v[244:247]
v_mfma_f32_16x16x32_bf16 v[240:243], a[184:187], a[96:99], v[240:243]
v_mfma_f32_16x16x32_bf16 v[240:243], a[188:191], a[100:103], v[240:243]
s_waitcnt lgkmcnt(4)
v_mfma_f32_16x16x32_bf16 a[0:3], a[160:163], a[128:131], a[0:3]
ds_read_b64_tr_b16 a[176:177], v21 offset:41024
v_mfma_f32_16x16x32_bf16 a[0:3], a[164:167], a[132:135], a[0:3]
ds_read_b64_tr_b16 a[178:179], v21 offset:41792
v_mfma_f32_16x16x32_bf16 a[4:7], a[160:163], a[136:139], a[4:7]
ds_read_b64_tr_b16 a[180:181], v21 offset:47168
v_mfma_f32_16x16x32_bf16 a[4:7], a[164:167], a[140:143], a[4:7]
ds_read_b64_tr_b16 a[182:183], v21 offset:47936
v_mfma_f32_16x16x32_bf16 a[8:11], a[160:163], a[144:147], a[8:11]
buffer_load_dwordx4 v14, s[32:35], s45 offen offset:2048 lds
v_mfma_f32_16x16x32_bf16 a[8:11], a[164:167], a[148:151], a[8:11]
v_mfma_f32_16x16x32_bf16 a[12:15], a[160:163], a[152:155], a[12:15]
buffer_load_dwordx4 v15, s[32:35], s45 offen offset:3072 lds
v_mfma_f32_16x16x32_bf16 a[12:15], a[164:167], a[156:159], a[12:15]
s_waitcnt lgkmcnt(4)
v_mfma_f32_16x16x32_bf16 a[28:31], a[168:171], a[152:155], a[28:31]
ds_read_b64_tr_b16 a[184:185], v22 offset:41024
v_mfma_f32_16x16x32_bf16 a[28:31], a[172:175], a[156:159], a[28:31]
ds_read_b64_tr_b16 a[186:187], v22 offset:41792
v_mfma_f32_16x16x32_bf16 a[24:27], a[168:171], a[144:147], a[24:27]
ds_read_b64_tr_b16 a[188:189], v22 offset:47168
v_mfma_f32_16x16x32_bf16 a[24:27], a[172:175], a[148:151], a[24:27]
ds_read_b64_tr_b16 a[190:191], v22 offset:47936
s_add_u32 m0, s49, 4096
v_mfma_f32_16x16x32_bf16 a[20:23], a[168:171], a[136:139], a[20:23]
buffer_load_dwordx4 v16, s[32:35], s45 offen offset:0 lds
v_mfma_f32_16x16x32_bf16 a[20:23], a[172:175], a[140:143], a[20:23]
v_mfma_f32_16x16x32_bf16 a[16:19], a[168:171], a[128:131], a[16:19]
v_mfma_f32_16x16x32_bf16 a[16:19], a[172:175], a[132:135], a[16:19]
s_waitcnt lgkmcnt(4)
v_mfma_f32_16x16x32_bf16 a[32:35], a[176:179], a[128:131], a[32:35]
ds_read_b64_tr_b16 a[160:161], v21 offset:41088
v_mfma_f32_16x16x32_bf16 a[32:35], a[180:183], a[132:135], a[32:35]
ds_read_b64_tr_b16 a[162:163], v21 offset:41856
v_mfma_f32_16x16x32_bf16 a[36:39], a[176:179], a[136:139], a[36:39]
ds_read_b64_tr_b16 a[164:165], v21 offset:47232
v_mfma_f32_16x16x32_bf16 a[36:39], a[180:183], a[140:143], a[36:39]
ds_read_b64_tr_b16 a[166:167], v21 offset:48000
v_mfma_f32_16x16x32_bf16 a[40:43], a[176:179], a[144:147], a[40:43]
buffer_load_dwordx4 v17, s[32:35], s45 offen offset:1024 lds
v_mfma_f32_16x16x32_bf16 a[40:43], a[180:183], a[148:151], a[40:43]
v_mfma_f32_16x16x32_bf16 a[44:47], a[176:179], a[152:155], a[44:47]
v_mfma_f32_16x16x32_bf16 a[44:47], a[180:183], a[156:159], a[44:47]
s_waitcnt lgkmcnt(4)
v_mfma_f32_16x16x32_bf16 a[60:63], a[184:187], a[152:155], a[60:63]
ds_read_b64_tr_b16 a[168:169], v22 offset:41088
v_mfma_f32_16x16x32_bf16 a[60:63], a[188:191], a[156:159], a[60:63]
ds_read_b64_tr_b16 a[170:171], v22 offset:41856
v_mfma_f32_16x16x32_bf16 a[56:59], a[184:187], a[144:147], a[56:59]
ds_read_b64_tr_b16 a[172:173], v22 offset:47232
v_mfma_f32_16x16x32_bf16 a[56:59], a[188:191], a[148:151], a[56:59]
ds_read_b64_tr_b16 a[174:175], v22 offset:48000
v_mfma_f32_16x16x32_bf16 a[52:55], a[184:187], a[136:139], a[52:55]
buffer_load_dwordx4 v18, s[32:35], s45 offen offset:2048 lds
s_add_u32 s45, s45, 458752
v_mfma_f32_16x16x32_bf16 a[52:55], a[188:191], a[140:143], a[52:55]
v_mfma_f32_16x16x32_bf16 a[48:51], a[184:187], a[128:131], a[48:51]
v_mfma_f32_16x16x32_bf16 a[48:51], a[188:191], a[132:135], a[48:51]
s_waitcnt vmcnt(19) lgkmcnt(0)
s_barrier
v_mfma_f32_16x16x32_bf16 a[64:67], a[128:131], a[160:163], a[64:67]
ds_read_b64_tr_b16 a[176:177], v23 offset:40960
v_mfma_f32_16x16x32_bf16 a[64:67], a[132:135], a[164:167], a[64:67]
ds_read_b64_tr_b16 a[178:179], v23 offset:42752
v_mfma_f32_16x16x32_bf16 a[68:71], a[136:139], a[160:163], a[68:71]
ds_read_b64_tr_b16 a[180:181], v23 offset:48128
v_mfma_f32_16x16x32_bf16 a[68:71], a[140:143], a[164:167], a[68:71]
ds_read_b64_tr_b16 a[182:183], v23 offset:49920
s_add_u32 m0, s48, 40960
v_mfma_f32_16x16x32_bf16 a[72:75], a[144:147], a[160:163], a[72:75]
buffer_load_dwordx4 v9, s[28:31], s44 offen offset:0 lds
v_mfma_f32_16x16x32_bf16 a[72:75], a[148:151], a[164:167], a[72:75]
v_mfma_f32_16x16x32_bf16 a[76:79], a[152:155], a[160:163], a[76:79]
v_mfma_f32_16x16x32_bf16 a[76:79], a[156:159], a[164:167], a[76:79]
v_mfma_f32_16x16x32_bf16 a[92:95], a[152:155], a[168:171], a[92:95]
ds_read_b64_tr_b16 a[184:185], v23 offset:40992
v_mfma_f32_16x16x32_bf16 a[92:95], a[156:159], a[172:175], a[92:95]
ds_read_b64_tr_b16 a[186:187], v23 offset:42784
v_mfma_f32_16x16x32_bf16 a[88:91], a[144:147], a[168:171], a[88:91]
ds_read_b64_tr_b16 a[188:189], v23 offset:48160
v_mfma_f32_16x16x32_bf16 a[88:91], a[148:151], a[172:175], a[88:91]
ds_read_b64_tr_b16 a[190:191], v23 offset:49952
v_mfma_f32_16x16x32_bf16 a[84:87], a[136:139], a[168:171], a[84:87]
buffer_load_dwordx4 v10, s[28:31], s44 offen offset:1024 lds
v_mfma_f32_16x16x32_bf16 a[84:87], a[140:143], a[172:175], a[84:87]
s_getpc_b64 s[88:89]
L_pc_L_epi:
v_mfma_f32_16x16x32_bf16 a[80:83], a[128:131], a[168:171], a[80:83]
s_add_u32 s88, s88, L_epi - L_pc_L_epi
s_addc_u32 s89, s89, 0
v_mfma_f32_16x16x32_bf16 a[80:83], a[132:135], a[172:175], a[80:83]
s_mov_b32 s90, L_codeend - L_epi
s_waitcnt lgkmcnt(4)
v_mfma_f32_16x16x32_bf16 v[32:35], a[176:179], a[128:131], v[32:35]
ds_read_b64_tr_b16 a[160:161], v23 offset:41024
s_mov_b32 s91, 0x00020000
v_mfma_f32_16x16x32_bf16 v[32:35], a[180:183], a[132:135], v[32:35]
ds_read_b64_tr_b16 a[162:163], v23 offset:42816
s_lshr_b32 s50, s2, 3
v_mfma_f32_16x16x32_bf16 v[36:39], a[176:179], a[136:139], v[36:39]
ds_read_b64_tr_b16 a[164:165], v23 offset:48192
s_lshl_b32 s50, s50, 2
v_mfma_f32_16x16x32_bf16 v[36:39], a[180:183], a[140:143], v[36:39]
ds_read_b64_tr_b16 a[166:167], v23 offset:49984
s_add_u32 s50, s50, s40
v_mfma_f32_16x16x32_bf16 v[40:43], a[176:179], a[144:147], v[40:43]
buffer_load_dwordx4 v11, s[28:31], s44 offen offset:2048 lds
s_add_u32 s44, s44, 393216
v_mfma_f32_16x16x32_bf16 v[40:43], a[180:183], a[148:151], v[40:43]
v_mfma_f32_16x16x32_bf16 v[44:47], a[176:179], a[152:155], v[44:47]
v_mfma_f32_16x16x32_bf16 v[44:47], a[180:183], a[156:159], v[44:47]
s_waitcnt lgkmcnt(4)
v_mfma_f32_16x16x32_bf16 v[60:63], a[184:187], a[152:155], v[60:63]
ds_read_b64_tr_b16 a[168:169], v23 offset:41056
buffer_load_dword a255, v24, s[56:59], s55 offen
v_mfma_f32_16x16x32_bf16 v[60:63], a[188:191], a[156:159], v[60:63]
ds_read_b64_tr_b16 a[170:171], v23 offset:42848
s_add_u32 s55, s55, 4096
v_mfma_f32_16x16x32_bf16 v[56:59], a[184:187], a[144:147], v[56:59]
ds_read_b64_tr_b16 a[172:173], v23 offset:48224
s_mul_i32 s50, s50, 384
v_mfma_f32_16x16x32_bf16 v[56:59], a[188:191], a[148:151], v[56:59]
ds_read_b64_tr_b16 a[174:175], v23 offset:50016
v_min_u32 v29, 2, v0
v_mfma_f32_16x16x32_bf16 v[52:55], a[184:187], a[136:139], v[52:55]
v_lshlrev_b32 v29, 7, v29
buffer_load_dword a255, v29, s[88:91], s50 offen
v_mfma_f32_16x16x32_bf16 v[52:55], a[188:191], a[140:143], v[52:55]
v_mfma_f32_16x16x32_bf16 v[48:51], a[184:187], a[128:131], v[48:51]
v_mfma_f32_16x16x32_bf16 v[48:51], a[188:191], a[132:135], v[48:51]
s_waitcnt lgkmcnt(4)
v_mfma_f32_16x16x32_bf16 v[64:67], a[160:163], a[128:131], v[64:67]
ds_read_b64_tr_b16 a[176:177], v23 offset:41088
v_mfma_f32_16x16x32_bf16 v[64:67], a[164:167], a[132:135], v[64:67]
ds_read_b64_tr_b16 a[178:179], v23 offset:42880
v_mfma_f32_16x16x32_bf16 v[68:71], a[160:163], a[136:139], v[68:71]
ds_read_b64_tr_b16 a[180:181], v23 offset:48256
v_mfma_f32_16x16x32_bf16 v[68:71], a[164:167], a[140:143], v[68:71]
ds_read_b64_tr_b16 a[182:183], v23 offset:50048
v_mfma_f32_16x16x32_bf16 v[72:75], a[160:163], a[144:147], v[72:75]
ds_read_b128 a[96:99], v19 offset:0
v_mfma_f32_16x16x32_bf16 v[72:75], a[164:167], a[148:151], v[72:75]
ds_read_b128 a[100:103], v20 offset:0
v_mfma_f32_16x16x32_bf16 v[76:79], a[160:163], a[152:155], v[76:79]
ds_read_b128 a[104:107], v19 offset:2048
v_mfma_f32_16x16x32_bf16 v[76:79], a[164:167], a[156:159], v[76:79]
ds_read_b128 a[108:111], v20 offset:2048
s_waitcnt lgkmcnt(8)
v_mfma_f32_16x16x32_bf16 v[92:95], a[168:171], a[152:155], v[92:95]
ds_read_b64_tr_b16 a[184:185], v23 offset:41120
v_mfma_f32_16x16x32_bf16 v[92:95], a[172:175], a[156:159], v[92:95]
ds_read_b64_tr_b16 a[186:187], v23 offset:42912
v_mfma_f32_16x16x32_bf16 v[88:91], a[168:171], a[144:147], v[88:91]
ds_read_b64_tr_b16 a[188:189], v23 offset:48288
v_mfma_f32_16x16x32_bf16 v[88:91], a[172:175], a[148:151], v[88:91]
ds_read_b64_tr_b16 a[190:191], v23 offset:50080
v_mfma_f32_16x16x32_bf16 v[84:87], a[168:171], a[136:139], v[84:87]
ds_read_b128 a[112:115], v19 offset:4096
v_mfma_f32_16x16x32_bf16 v[84:87], a[172:175], a[140:143], v[84:87]
ds_read_b128 a[116:119], v20 offset:4096
v_mfma_f32_16x16x32_bf16 v[80:83], a[168:171], a[128:131], v[80:83]
ds_read_b128 a[120:123], v19 offset:6144
v_mfma_f32_16x16x32_bf16 v[80:83], a[172:175], a[132:135], v[80:83]
ds_read_b128 a[124:127], v20 offset:6144
s_waitcnt lgkmcnt(12)
v_mfma_f32_16x16x32_bf16 v[96:99], a[176:179], a[128:131], v[96:99]
ds_read_b64_tr_b16 a[160:161], v23 offset:41152
s_and_b32 s3, s2, 1
v_mfma_f32_16x16x32_bf16 v[96:99], a[180:183], a[132:135], v[96:99]
ds_read_b64_tr_b16 a[162:163], v23 offset:42944
s_lshr_b32 s51, s2, 3
v_mfma_f32_16x16x32_bf16 v[100:103], a[176:179], a[136:139], v[100:103]
ds_read_b64_tr_b16 a[164:165], v23 offset:48320
s_and_b32 s80, s2, 4
v_mfma_f32_16x16x32_bf16 v[100:103], a[180:183], a[140:143], v[100:103]
ds_read_b64_tr_b16 a[166:167], v23 offset:50112
s_lshl_b32 s80, s80, 1
v_mfma_f32_16x16x32_bf16 v[104:107], a[176:179], a[144:147], v[104:107]
s_and_b32 s52, s51, 7
v_mfma_f32_16x16x32_bf16 v[104:107], a[180:183], a[148:151], v[104:107]
v_mfma_f32_16x16x32_bf16 v[108:111], a[176:179], a[152:155], v[108:111]
v_mfma_f32_16x16x32_bf16 v[108:111], a[180:183], a[156:159], v[108:111]
s_waitcnt lgkmcnt(4)
v_mfma_f32_16x16x32_bf16 v[124:127], a[184:187], a[152:155], v[124:127]
ds_read_b64_tr_b16 a[168:169], v23 offset:55296
s_add_u32 s80, s80, s52
v_mfma_f32_16x16x32_bf16 v[124:127], a[188:191], a[156:159], v[124:127]
ds_read_b64_tr_b16 a[170:171], v23 offset:57088
s_and_b32 s81, s2, 2
v_mfma_f32_16x16x32_bf16 v[120:123], a[184:187], a[144:147], v[120:123]
ds_read_b64_tr_b16 a[172:173], v23 offset:62464
s_lshl_b32 s81, s81, 1
v_mfma_f32_16x16x32_bf16 v[120:123], a[188:191], a[148:151], v[120:123]
ds_read_b64_tr_b16 a[174:175], v23 offset:64256
s_add_u32 m0, s47, 0
v_mfma_f32_16x16x32_bf16 v[116:119], a[184:187], a[136:139], v[116:119]
buffer_load_dwordx4 v1, s[24:27], s43 offen offset:0 lds
s_lshr_b32 s52, s51, 3
v_mfma_f32_16x16x32_bf16 v[116:119], a[188:191], a[140:143], v[116:119]
s_add_u32 s81, s81, s52
v_mfma_f32_16x16x32_bf16 v[112:115], a[184:187], a[128:131], v[112:115]
buffer_load_dwordx4 v2, s[24:27], s43 offen offset:1024 lds
v_mfma_f32_16x16x32_bf16 v[112:115], a[188:191], a[132:135], v[112:115]
s_waitcnt lgkmcnt(4)
v_mfma_f32_16x16x32_bf16 v[128:131], a[160:163], a[128:131], v[128:131]
ds_read_b64_tr_b16 a[176:177], v23 offset:55328
s_lshr_b32 s52, s40, 1
v_mfma_f32_16x16x32_bf16 v[128:131], a[164:167], a[132:135], v[128:131]
ds_read_b64_tr_b16 a[178:179], v23 offset:57120
s_lshl_b32 s10, s3, 1
v_mfma_f32_16x16x32_bf16 v[132:135], a[160:163], a[136:139], v[132:135]
ds_read_b64_tr_b16 a[180:181], v23 offset:62496
s_add_u32 s10, s10, s52
v_mfma_f32_16x16x32_bf16 v[132:135], a[164:167], a[140:143], v[132:135]
ds_read_b64_tr_b16 a[182:183], v23 offset:64288
s_lshl_b32 s68, s80, 2
v_mfma_f32_16x16x32_bf16 v[136:139], a[160:163], a[144:147], v[136:139]
buffer_load_dwordx4 v3, s[24:27], s43 offen offset:2048 lds
s_and_b32 s50, s40, 1
v_mfma_f32_16x16x32_bf16 v[136:139], a[164:167], a[148:151], v[136:139]
v_mfma_f32_16x16x32_bf16 v[140:143], a[160:163], a[152:155], v[140:143]
v_mfma_f32_16x16x32_bf16 v[140:143], a[164:167], a[156:159], v[140:143]
s_waitcnt lgkmcnt(4)
v_mfma_f32_16x16x32_bf16 v[156:159], a[168:171], a[152:155], v[156:159]
ds_read_b64_tr_b16 a[184:185], v23 offset:55360
s_lshl_b32 s50, s50, 1
v_mfma_f32_16x16x32_bf16 v[156:159], a[172:175], a[156:159], v[156:159]
ds_read_b64_tr_b16 a[186:187], v23 offset:57152
s_add_u32 s68, s68, s50
v_mfma_f32_16x16x32_bf16 v[152:155], a[168:171], a[144:147], v[152:155]
ds_read_b64_tr_b16 a[188:189], v23 offset:62528
s_lshr_b32 s50, s40, 1
v_mfma_f32_16x16x32_bf16 v[152:155], a[172:175], a[148:151], v[152:155]
ds_read_b64_tr_b16 a[190:191], v23 offset:64320
s_add_u32 s68, s68, s50
v_mfma_f32_16x16x32_bf16 v[148:151], a[168:171], a[136:139], v[148:151]
buffer_load_dwordx4 v4, s[24:27], s43 offen offset:3072 lds
s_lshl_b32 s68, s68, 16
v_mfma_f32_16x16x32_bf16 v[148:151], a[172:175], a[140:143], v[148:151]
v_mfma_f32_16x16x32_bf16 v[144:147], a[168:171], a[128:131], v[144:147]
v_mfma_f32_16x16x32_bf16 v[144:147], a[172:175], a[132:135], v[144:147]
s_waitcnt lgkmcnt(4)
v_mfma_f32_16x16x32_bf16 v[160:163], a[176:179], a[128:131], v[160:163]
ds_read_b64_tr_b16 a[160:161], v23 offset:55392
s_lshl_b32 s50, s81, 1
v_mfma_f32_16x16x32_bf16 v[160:163], a[180:183], a[132:135], v[160:163]
ds_read_b64_tr_b16 a[162:163], v23 offset:57184
s_add_u32 s50, s50, s3
v_mfma_f32_16x16x32_bf16 v[164:167], a[176:179], a[136:139], v[164:167]
ds_read_b64_tr_b16 a[164:165], v23 offset:62560
s_lshl_b32 s50, s50, 7
v_mfma_f32_16x16x32_bf16 v[164:167], a[180:183], a[140:143], v[164:167]
ds_read_b64_tr_b16 a[166:167], v23 offset:64352
s_add_u32 m0, s47, 4096
v_mfma_f32_16x16x32_bf16 v[168:171], a[176:179], a[144:147], v[168:171]
buffer_load_dwordx4 v5, s[24:27], s43 offen offset:0 lds
s_add_u32 s68, s68, s50
v_mfma_f32_16x16x32_bf16 v[168:171], a[180:183], a[148:151], v[168:171]
s_mul_i32 s82, s80, 144
v_mfma_f32_16x16x32_bf16 v[172:175], a[176:179], a[152:155], v[172:175]
v_mfma_f32_16x16x32_bf16 v[172:175], a[180:183], a[156:159], v[172:175]
s_waitcnt lgkmcnt(4)
v_mfma_f32_16x16x32_bf16 v[188:191], a[184:187], a[152:155], v[188:191]
ds_read_b64_tr_b16 a[168:169], v23 offset:55424
s_mul_i32 s50, s10, 28
v_mfma_f32_16x16x32_bf16 v[188:191], a[188:191], a[156:159], v[188:191]
ds_read_b64_tr_b16 a[170:171], v23 offset:57216
s_add_u32 s82, s82, s50
v_mfma_f32_16x16x32_bf16 v[184:187], a[184:187], a[144:147], v[184:187]
ds_read_b64_tr_b16 a[172:173], v23 offset:62592
s_lshl_b32 s82, s82, 13
v_mfma_f32_16x16x32_bf16 v[184:187], a[188:191], a[148:151], v[184:187]
ds_read_b64_tr_b16 a[174:175], v23 offset:64384
s_and_b32 s50, s40, 1
v_mfma_f32_16x16x32_bf16 v[180:183], a[184:187], a[136:139], v[180:183]
buffer_load_dwordx4 v6, s[24:27], s43 offen offset:1024 lds
s_lshl_b32 s50, s50, 12
v_mfma_f32_16x16x32_bf16 v[180:183], a[188:191], a[140:143], v[180:183]
v_mfma_f32_16x16x32_bf16 v[176:179], a[184:187], a[128:131], v[176:179]
v_mfma_f32_16x16x32_bf16 v[176:179], a[188:191], a[132:135], v[176:179]
s_waitcnt lgkmcnt(4)
v_mfma_f32_16x16x32_bf16 v[192:195], a[160:163], a[128:131], v[192:195]
ds_read_b64_tr_b16 a[176:177], v23 offset:55456
s_add_u32 s82, s82, s50
v_mfma_f32_16x16x32_bf16 v[192:195], a[164:167], a[132:135], v[192:195]
ds_read_b64_tr_b16 a[178:179], v23 offset:57248
s_add_u32 s83, s82, 8192
v_mfma_f32_16x16x32_bf16 v[196:199], a[160:163], a[136:139], v[196:199]
ds_read_b64_tr_b16 a[180:181], v23 offset:62624
s_lshl_b32 s11, s2, 2
v_mfma_f32_16x16x32_bf16 v[196:199], a[164:167], a[140:143], v[196:199]
ds_read_b64_tr_b16 a[182:183], v23 offset:64416
s_add_u32 s11, s11, s40
v_mfma_f32_16x16x32_bf16 v[200:203], a[160:163], a[144:147], v[200:203]
buffer_load_dwordx4 v7, s[24:27], s43 offen offset:2048 lds
s_lshl_b32 s11, s11, 12
v_mfma_f32_16x16x32_bf16 v[200:203], a[164:167], a[148:151], v[200:203]
s_add_u32 s11, s11, 37748736
v_mfma_f32_16x16x32_bf16 v[204:207], a[160:163], a[152:155], v[204:207]
v_mfma_f32_16x16x32_bf16 v[204:207], a[164:167], a[156:159], v[204:207]
s_waitcnt lgkmcnt(4)
v_mfma_f32_16x16x32_bf16 v[220:223], a[168:171], a[152:155], v[220:223]
ds_read_b64_tr_b16 a[184:185], v23 offset:55488
v_mfma_f32_16x16x32_bf16 v[220:223], a[172:175], a[156:159], v[220:223]
ds_read_b64_tr_b16 a[186:187], v23 offset:57280
v_mfma_f32_16x16x32_bf16 v[216:219], a[168:171], a[144:147], v[216:219]
ds_read_b64_tr_b16 a[188:189], v23 offset:62656
v_mfma_f32_16x16x32_bf16 v[216:219], a[172:175], a[148:151], v[216:219]
ds_read_b64_tr_b16 a[190:191], v23 offset:64448
v_mfma_f32_16x16x32_bf16 v[212:215], a[168:171], a[136:139], v[212:215]
buffer_load_dwordx4 v8, s[24:27], s43 offen offset:3072 lds
s_add_u32 s43, s43, 128
v_mfma_f32_16x16x32_bf16 v[212:215], a[172:175], a[140:143], v[212:215]
v_mfma_f32_16x16x32_bf16 v[208:211], a[168:171], a[128:131], v[208:211]
v_mfma_f32_16x16x32_bf16 v[208:211], a[172:175], a[132:135], v[208:211]
s_waitcnt vmcnt(29) lgkmcnt(0)
s_barrier
v_mfma_f32_16x16x32_bf16 v[224:227], a[176:179], a[128:131], v[224:227]
ds_read_b64_tr_b16 a[160:161], v21 offset:0
v_mfma_f32_16x16x32_bf16 v[224:227], a[180:183], a[132:135], v[224:227]
ds_read_b64_tr_b16 a[162:163], v21 offset:768
v_mfma_f32_16x16x32_bf16 v[228:231], a[176:179], a[136:139], v[228:231]
ds_read_b64_tr_b16 a[164:165], v21 offset:6144
v_mfma_f32_16x16x32_bf16 v[228:231], a[180:183], a[140:143], v[228:231]
ds_read_b64_tr_b16 a[166:167], v21 offset:6912
s_add_u32 m0, s49, 40960
v_mfma_f32_16x16x32_bf16 v[232:235], a[176:179], a[144:147], v[232:235]
buffer_load_dwordx4 v12, s[32:35], s45 offen offset:0 lds
v_mfma_f32_16x16x32_bf16 v[232:235], a[180:183], a[148:151], v[232:235]
v_mfma_f32_16x16x32_bf16 v[236:239], a[176:179], a[152:155], v[236:239]
v_mfma_f32_16x16x32_bf16 v[236:239], a[180:183], a[156:159], v[236:239]
v_mfma_f32_16x16x32_bf16 v[252:255], a[184:187], a[152:155], v[252:255]
ds_read_b64_tr_b16 a[168:169], v22 offset:0
v_mfma_f32_16x16x32_bf16 v[252:255], a[188:191], a[156:159], v[252:255]
ds_read_b64_tr_b16 a[170:171], v22 offset:768
v_mfma_f32_16x16x32_bf16 v[248:251], a[184:187], a[144:147], v[248:251]
ds_read_b64_tr_b16 a[172:173], v22 offset:6144
v_mfma_f32_16x16x32_bf16 v[248:251], a[188:191], a[148:151], v[248:251]
ds_read_b64_tr_b16 a[174:175], v22 offset:6912
v_mfma_f32_16x16x32_bf16 v[244:247], a[184:187], a[136:139], v[244:247]
buffer_load_dwordx4 v13, s[32:35], s45 offen offset:1024 lds
v_mfma_f32_16x16x32_bf16 v[244:247], a[188:191], a[140:143], v[244:247]
v_mfma_f32_16x16x32_bf16 v[240:243], a[184:187], a[128:131], v[240:243]
v_mfma_f32_16x16x32_bf16 v[240:243], a[188:191], a[132:135], v[240:243]
s_waitcnt lgkmcnt(4)
v_mfma_f32_16x16x32_bf16 a[0:3], a[160:163], a[96:99], a[0:3]
ds_read_b64_tr_b16 a[176:177], v21 offset:64
s_mov_b32 s56, s8
v_mfma_f32_16x16x32_bf16 a[0:3], a[164:167], a[100:103], a[0:3]
ds_read_b64_tr_b16 a[178:179], v21 offset:832
s_mov_b32 s57, s9
v_mfma_f32_16x16x32_bf16 a[4:7], a[160:163], a[104:107], a[4:7]
ds_read_b64_tr_b16 a[180:181], v21 offset:6208
s_mov_b32 s58, 0x200000
v_mfma_f32_16x16x32_bf16 a[4:7], a[164:167], a[108:111], a[4:7]
ds_read_b64_tr_b16 a[182:183], v21 offset:6976
s_mov_b32 s59, 0x00020000
v_mfma_f32_16x16x32_bf16 a[8:11], a[160:163], a[112:115], a[8:11]
buffer_load_dwordx4 v14, s[32:35], s45 offen offset:2048 lds
s_and_b32 s50, s2, 1
v_mfma_f32_16x16x32_bf16 a[8:11], a[164:167], a[116:119], a[8:11]
s_lshl_b32 s50, s50, 6
v_mfma_f32_16x16x32_bf16 a[12:15], a[160:163], a[120:123], a[12:15]
buffer_load_dwordx4 v15, s[32:35], s45 offen offset:3072 lds
v_mfma_f32_16x16x32_bf16 a[12:15], a[164:167], a[124:127], a[12:15]
s_waitcnt lgkmcnt(4)
v_mfma_f32_16x16x32_bf16 a[28:31], a[168:171], a[120:123], a[28:31]
ds_read_b64_tr_b16 a[184:185], v22 offset:64
s_and_b32 s51, s2, 4
v_mfma_f32_16x16x32_bf16 a[28:31], a[172:175], a[124:127], a[28:31]
ds_read_b64_tr_b16 a[186:187], v22 offset:832
s_lshl_b32 s51, s51, 3
v_mfma_f32_16x16x32_bf16 a[24:27], a[168:171], a[112:115], a[24:27]
ds_read_b64_tr_b16 a[188:189], v22 offset:6208
s_add_u32 s50, s50, s51
v_mfma_f32_16x16x32_bf16 a[24:27], a[172:175], a[116:119], a[24:27]
ds_read_b64_tr_b16 a[190:191], v22 offset:6976
s_add_u32 m0, s49, 45056
v_mfma_f32_16x16x32_bf16 a[20:23], a[168:171], a[104:107], a[20:23]
buffer_load_dwordx4 v16, s[32:35], s45 offen offset:0 lds
s_lshr_b32 s51, s2, 3
v_mfma_f32_16x16x32_bf16 a[20:23], a[172:175], a[108:111], a[20:23]
s_add_u32 s50, s50, s51
s_lshl_b32 s50, s50, 2
v_mfma_f32_16x16x32_bf16 a[16:19], a[168:171], a[96:99], a[16:19]
v_mfma_f32_16x16x32_bf16 a[16:19], a[172:175], a[100:103], a[16:19]
s_waitcnt lgkmcnt(4)
v_mfma_f32_16x16x32_bf16 a[32:35], a[176:179], a[96:99], a[32:35]
ds_read_b64_tr_b16 a[160:161], v21 offset:128
s_add_u32 s50, s50, s40
v_mfma_f32_16x16x32_bf16 a[32:35], a[180:183], a[100:103], a[32:35]
ds_read_b64_tr_b16 a[162:163], v21 offset:896
s_mul_i32 s50, s50, 4096
v_mfma_f32_16x16x32_bf16 a[36:39], a[176:179], a[104:107], a[36:39]
ds_read_b64_tr_b16 a[164:165], v21 offset:6272
s_and_b32 s51, s2, 2
v_mfma_f32_16x16x32_bf16 a[36:39], a[180:183], a[108:111], a[36:39]
ds_read_b64_tr_b16 a[166:167], v21 offset:7040
s_lshl_b32 s51, s51, 9
v_mfma_f32_16x16x32_bf16 a[40:43], a[176:179], a[112:115], a[40:43]
buffer_load_dwordx4 v17, s[32:35], s45 offen offset:1024 lds
s_add_u32 s55, s50, s51
v_mfma_f32_16x16x32_bf16 a[40:43], a[180:183], a[116:119], a[40:43]
v_min_u32 v24, 7, v0
v_mfma_f32_16x16x32_bf16 a[44:47], a[176:179], a[120:123], a[44:47]
v_mfma_f32_16x16x32_bf16 a[44:47], a[180:183], a[124:127], a[44:47]
s_waitcnt lgkmcnt(4)
v_mfma_f32_16x16x32_bf16 a[60:63], a[184:187], a[120:123], a[60:63]
ds_read_b64_tr_b16 a[168:169], v22 offset:128
v_lshlrev_b32 v24, 7, v24
v_mfma_f32_16x16x32_bf16 a[60:63], a[188:191], a[124:127], a[60:63]
ds_read_b64_tr_b16 a[170:171], v22 offset:896
v_min_u32 v25, 15, v0
v_mfma_f32_16x16x32_bf16 a[56:59], a[184:187], a[112:115], a[56:59]
ds_read_b64_tr_b16 a[172:173], v22 offset:6272
v_lshrrev_b32 v26, 3, v25
v_mfma_f32_16x16x32_bf16 a[56:59], a[188:191], a[116:119], a[56:59]
ds_read_b64_tr_b16 a[174:175], v22 offset:7040
v_and_b32 v25, 7, v25
v_mfma_f32_16x16x32_bf16 a[52:55], a[184:187], a[104:107], a[52:55]
buffer_load_dwordx4 v18, s[32:35], s45 offen offset:2048 lds
s_add_u32 s45, s45, 458752
v_mfma_f32_16x16x32_bf16 a[52:55], a[188:191], a[108:111], a[52:55]
v_lshlrev_b32 v25, 7, v25
v_lshl_add_u32 v24, v26, 11, v25
v_mfma_f32_16x16x32_bf16 a[48:51], a[184:187], a[96:99], a[48:51]
v_mfma_f32_16x16x32_bf16 a[48:51], a[188:191], a[100:103], a[48:51]
s_waitcnt vmcnt(20) lgkmcnt(0)
s_barrier
v_mfma_f32_16x16x32_bf16 a[64:67], a[96:99], a[160:163], a[64:67]
ds_read_b64_tr_b16 a[176:177], v23 offset:0
v_mfma_f32_16x16x32_bf16 a[64:67], a[100:103], a[164:167], a[64:67]
ds_read_b64_tr_b16 a[178:179], v23 offset:1792
v_mfma_f32_16x16x32_bf16 a[68:71], a[104:107], a[160:163], a[68:71]
ds_read_b64_tr_b16 a[180:181], v23 offset:7168
v_mfma_f32_16x16x32_bf16 a[68:71], a[108:111], a[164:167], a[68:71]
ds_read_b64_tr_b16 a[182:183], v23 offset:8960
s_add_u32 m0, s48, 0
v_mfma_f32_16x16x32_bf16 a[72:75], a[112:115], a[160:163], a[72:75]
buffer_load_dwordx4 v9, s[28:31], s44 offen offset:0 lds
v_mfma_f32_16x16x32_bf16 a[72:75], a[116:119], a[164:167], a[72:75]
v_mfma_f32_16x16x32_bf16 a[76:79], a[120:123], a[160:163], a[76:79]
v_mfma_f32_16x16x32_bf16 a[76:79], a[124:127], a[164:167], a[76:79]
v_mfma_f32_16x16x32_bf16 a[92:95], a[120:123], a[168:171], a[92:95]
ds_read_b64_tr_b16 a[184:185], v23 offset:32
v_mfma_f32_16x16x32_bf16 a[92:95], a[124:127], a[172:175], a[92:95]
ds_read_b64_tr_b16 a[186:187], v23 offset:1824
v_mfma_f32_16x16x32_bf16 a[88:91], a[112:115], a[168:171], a[88:91]
ds_read_b64_tr_b16 a[188:189], v23 offset:7200
v_mfma_f32_16x16x32_bf16 a[88:91], a[116:119], a[172:175], a[88:91]
ds_read_b64_tr_b16 a[190:191], v23 offset:8992
v_mfma_f32_16x16x32_bf16 a[84:87], a[104:107], a[168:171], a[84:87]
buffer_load_dwordx4 v10, s[28:31], s44 offen offset:1024 lds
v_mfma_f32_16x16x32_bf16 a[84:87], a[108:111], a[172:175], a[84:87]
v_mfma_f32_16x16x32_bf16 a[80:83], a[96:99], a[168:171], a[80:83]
v_mfma_f32_16x16x32_bf16 a[80:83], a[100:103], a[172:175], a[80:83]
s_waitcnt lgkmcnt(4)
v_mfma_f32_16x16x32_bf16 v[32:35], a[176:179], a[96:99], v[32:35]
ds_read_b64_tr_b16 a[160:161], v23 offset:64
v_mfma_f32_16x16x32_bf16 v[32:35], a[180:183], a[100:103], v[32:35]
ds_read_b64_tr_b16 a[162:163], v23 offset:1856
v_mfma_f32_16x16x32_bf16 v[36:39], a[176:179], a[104:107], v[36:39]
ds_read_b64_tr_b16 a[164:165], v23 offset:7232
v_mfma_f32_16x16x32_bf16 v[36:39], a[180:183], a[108:111], v[36:39]
ds_read_b64_tr_b16 a[166:167], v23 offset:9024
v_mfma_f32_16x16x32_bf16 v[40:43], a[176:179], a[112:115], v[40:43]
buffer_load_dwordx4 v11, s[28:31], s44 offen offset:2048 lds
s_add_u32 s44, s44, 393216
v_mfma_f32_16x16x32_bf16 v[40:43], a[180:183], a[116:119], v[40:43]
v_mfma_f32_16x16x32_bf16 v[44:47], a[176:179], a[120:123], v[44:47]
v_mfma_f32_16x16x32_bf16 v[44:47], a[180:183], a[124:127], v[44:47]
s_waitcnt lgkmcnt(4)
v_mfma_f32_16x16x32_bf16 v[60:63], a[184:187], a[120:123], v[60:63]
ds_read_b64_tr_b16 a[168:169], v23 offset:96
v_mfma_f32_16x16x32_bf16 v[60:63], a[188:191], a[124:127], v[60:63]
ds_read_b64_tr_b16 a[170:171], v23 offset:1888
v_mfma_f32_16x16x32_bf16 v[56:59], a[184:187], a[112:115], v[56:59]
ds_read_b64_tr_b16 a[172:173], v23 offset:7264
v_mfma_f32_16x16x32_bf16 v[56:59], a[188:191], a[116:119], v[56:59]
ds_read_b64_tr_b16 a[174:175], v23 offset:9056
v_mfma_f32_16x16x32_bf16 v[52:55], a[184:187], a[104:107], v[52:55]
buffer_load_dword a255, v24, s[56:59], s55 offen
v_mfma_f32_16x16x32_bf16 v[52:55], a[188:191], a[108:111], v[52:55]
s_add_u32 s55, s55, 4096
v_mfma_f32_16x16x32_bf16 v[48:51], a[184:187], a[96:99], v[48:51]
v_lshlrev_b32 v29, 2, v0
v_mfma_f32_16x16x32_bf16 v[48:51], a[188:191], a[100:103], v[48:51]
buffer_load_dword v28, v29, s[64:67], 0 offen sc1
s_waitcnt lgkmcnt(4)
v_mfma_f32_16x16x32_bf16 v[64:67], a[160:163], a[96:99], v[64:67]
ds_read_b64_tr_b16 a[176:177], v23 offset:128
v_mfma_f32_16x16x32_bf16 v[64:67], a[164:167], a[100:103], v[64:67]
ds_read_b64_tr_b16 a[178:179], v23 offset:1920
v_mfma_f32_16x16x32_bf16 v[68:71], a[160:163], a[104:107], v[68:71]
ds_read_b64_tr_b16 a[180:181], v23 offset:7296
v_mfma_f32_16x16x32_bf16 v[68:71], a[164:167], a[108:111], v[68:71]
ds_read_b64_tr_b16 a[182:183], v23 offset:9088
v_mfma_f32_16x16x32_bf16 v[72:75], a[160:163], a[112:115], v[72:75]
ds_read_b128 a[128:131], v19 offset:32768
v_mfma_f32_16x16x32_bf16 v[72:75], a[164:167], a[116:119], v[72:75]
ds_read_b128 a[132:135], v20 offset:32768
v_mfma_f32_16x16x32_bf16 v[76:79], a[160:163], a[120:123], v[76:79]
ds_read_b128 a[136:139], v19 offset:34816
v_mfma_f32_16x16x32_bf16 v[76:79], a[164:167], a[124:127], v[76:79]
ds_read_b128 a[140:143], v20 offset:34816
s_waitcnt lgkmcnt(8)
v_mfma_f32_16x16x32_bf16 v[92:95], a[168:171], a[120:123], v[92:95]
ds_read_b64_tr_b16 a[184:185], v23 offset:160
v_mfma_f32_16x16x32_bf16 v[92:95], a[172:175], a[124:127], v[92:95]
ds_read_b64_tr_b16 a[186:187], v23 offset:1952
v_mfma_f32_16x16x32_bf16 v[88:91], a[168:171], a[112:115], v[88:91]
ds_read_b64_tr_b16 a[188:189], v23 offset:7328
v_mfma_f32_16x16x32_bf16 v[88:91], a[172:175], a[116:119], v[88:91]
ds_read_b64_tr_b16 a[190:191], v23 offset:9120
v_mfma_f32_16x16x32_bf16 v[84:87], a[168:171], a[104:107], v[84:87]
ds_read_b128 a[144:147], v19 offset:36864
v_mfma_f32_16x16x32_bf16 v[84:87], a[172:175], a[108:111], v[84:87]
ds_read_b128 a[148:151], v20 offset:36864
v_mfma_f32_16x16x32_bf16 v[80:83], a[168:171], a[96:99], v[80:83]
ds_read_b128 a[152:155], v19 offset:38912
v_mfma_f32_16x16x32_bf16 v[80:83], a[172:175], a[100:103], v[80:83]
ds_read_b128 a[156:159], v20 offset:38912
s_waitcnt lgkmcnt(12)
v_mfma_f32_16x16x32_bf16 v[96:99], a[176:179], a[96:99], v[96:99]
ds_read_b64_tr_b16 a[160:161], v23 offset:192
v_and_b32 v24, 15, v0
v_mfma_f32_16x16x32_bf16 v[96:99], a[180:183], a[100:103], v[96:99]
ds_read_b64_tr_b16 a[162:163], v23 offset:1984
v_lshrrev_b32 v25, 4, v0
v_mfma_f32_16x16x32_bf16 v[100:103], a[176:179], a[104:107], v[100:103]
ds_read_b64_tr_b16 a[164:165], v23 offset:7360
v_lshlrev_b32 v25, 2, v25
v_mfma_f32_16x16x32_bf16 v[100:103], a[180:183], a[108:111], v[100:103]
ds_read_b64_tr_b16 a[166:167], v23 offset:9152
v_add_u32 v26, 0, v25
v_mfma_f32_16x16x32_bf16 v[104:107], a[176:179], a[112:115], v[104:107]
v_cmp_le_u32 s[72:73], v26, v24
v_add_u32 v26, 1, v25
v_mfma_f32_16x16x32_bf16 v[104:107], a[180:183], a[116:119], v[104:107]
v_mfma_f32_16x16x32_bf16 v[108:111], a[176:179], a[120:123], v[108:111]
v_mfma_f32_16x16x32_bf16 v[108:111], a[180:183], a[124:127], v[108:111]
s_waitcnt lgkmcnt(4)
v_mfma_f32_16x16x32_bf16 v[124:127], a[184:187], a[120:123], v[124:127]
ds_read_b64_tr_b16 a[168:169], v23 offset:14336
v_cmp_le_u32 s[74:75], v26, v24
v_mfma_f32_16x16x32_bf16 v[124:127], a[188:191], a[124:127], v[124:127]
ds_read_b64_tr_b16 a[170:171], v23 offset:16128
v_add_u32 v26, 2, v25
v_mfma_f32_16x16x32_bf16 v[120:123], a[184:187], a[112:115], v[120:123]
ds_read_b64_tr_b16 a[172:173], v23 offset:21504
v_cmp_le_u32 s[76:77], v26, v24
v_mfma_f32_16x16x32_bf16 v[120:123], a[188:191], a[116:119], v[120:123]
ds_read_b64_tr_b16 a[174:175], v23 offset:23296
s_add_u32 m0, s47, 32768
v_mfma_f32_16x16x32_bf16 v[116:119], a[184:187], a[104:107], v[116:119]
buffer_load_dwordx4 v1, s[24:27], s43 offen offset:0 lds
v_add_u32 v26, 3, v25
v_mfma_f32_16x16x32_bf16 v[116:119], a[188:191], a[108:111], v[116:119]
v_cmp_le_u32 s[78:79], v26, v24
v_mov_b32 v24, 0xffff
v_mfma_f32_16x16x32_bf16 v[112:115], a[184:187], a[96:99], v[112:115]
buffer_load_dwordx4 v2, s[24:27], s43 offen offset:1024 lds
v_mfma_f32_16x16x32_bf16 v[112:115], a[188:191], a[100:103], v[112:115]
s_waitcnt lgkmcnt(4)
v_mfma_f32_16x16x32_bf16 v[128:131], a[160:163], a[96:99], v[128:131]
ds_read_b64_tr_b16 a[176:177], v23 offset:14368
v_mov_b32 v25, 0xffff0000
v_mfma_f32_16x16x32_bf16 v[128:131], a[164:167], a[100:103], v[128:131]
ds_read_b64_tr_b16 a[178:179], v23 offset:16160
v_cndmask_b32 v27, 0, v24, s[72:73]
v_mfma_f32_16x16x32_bf16 v[132:135], a[160:163], a[104:107], v[132:135]
ds_read_b64_tr_b16 a[180:181], v23 offset:21536
v_cndmask_b32 v26, 0, v25, s[74:75]
v_mfma_f32_16x16x32_bf16 v[132:135], a[164:167], a[108:111], v[132:135]
ds_read_b64_tr_b16 a[182:183], v23 offset:23328
v_or_b32 v27, v27, v26
v_mfma_f32_16x16x32_bf16 v[136:139], a[160:163], a[112:115], v[136:139]
buffer_load_dwordx4 v3, s[24:27], s43 offen offset:2048 lds
v_accvgpr_write_b32 a242, v27
v_mfma_f32_16x16x32_bf16 v[136:139], a[164:167], a[116:119], v[136:139]
v_not_b32 v27, v27
v_mfma_f32_16x16x32_bf16 v[140:143], a[160:163], a[120:123], v[140:143]
v_mfma_f32_16x16x32_bf16 v[140:143], a[164:167], a[124:127], v[140:143]
s_waitcnt lgkmcnt(4)
v_mfma_f32_16x16x32_bf16 v[156:159], a[168:171], a[120:123], v[156:159]
ds_read_b64_tr_b16 a[184:185], v23 offset:14400
v_accvgpr_write_b32 a244, v27
v_mfma_f32_16x16x32_bf16 v[156:159], a[172:175], a[124:127], v[156:159]
ds_read_b64_tr_b16 a[186:187], v23 offset:16192
v_cndmask_b32 v27, 0, v24, s[76:77]
v_mfma_f32_16x16x32_bf16 v[152:155], a[168:171], a[112:115], v[152:155]
ds_read_b64_tr_b16 a[188:189], v23 offset:21568
v_cndmask_b32 v26, 0, v25, s[78:79]
v_mfma_f32_16x16x32_bf16 v[152:155], a[172:175], a[116:119], v[152:155]
ds_read_b64_tr_b16 a[190:191], v23 offset:23360
v_or_b32 v27, v27, v26
v_mfma_f32_16x16x32_bf16 v[148:151], a[168:171], a[104:107], v[148:151]
buffer_load_dwordx4 v4, s[24:27], s43 offen offset:3072 lds
v_accvgpr_write_b32 a243, v27
v_mfma_f32_16x16x32_bf16 v[148:151], a[172:175], a[108:111], v[148:151]
v_not_b32 v27, v27
v_mfma_f32_16x16x32_bf16 v[144:147], a[168:171], a[96:99], v[144:147]
v_mfma_f32_16x16x32_bf16 v[144:147], a[172:175], a[100:103], v[144:147]
s_waitcnt lgkmcnt(4)
v_mfma_f32_16x16x32_bf16 v[160:163], a[176:179], a[96:99], v[160:163]
ds_read_b64_tr_b16 a[160:161], v23 offset:14432
v_accvgpr_write_b32 a245, v27
v_mfma_f32_16x16x32_bf16 v[160:163], a[180:183], a[100:103], v[160:163]
ds_read_b64_tr_b16 a[162:163], v23 offset:16224
v_lshrrev_b32 v24, 2, v0
v_mfma_f32_16x16x32_bf16 v[164:167], a[176:179], a[104:107], v[164:167]
ds_read_b64_tr_b16 a[164:165], v23 offset:21600
v_and_b32 v24, 7, v24
v_mfma_f32_16x16x32_bf16 v[164:167], a[180:183], a[108:111], v[164:167]
ds_read_b64_tr_b16 a[166:167], v23 offset:23392
s_add_u32 m0, s47, 36864
v_mfma_f32_16x16x32_bf16 v[168:171], a[176:179], a[112:115], v[168:171]
buffer_load_dwordx4 v5, s[24:27], s43 offen offset:0 lds
v_lshrrev_b32 v25, 5, v0
v_mfma_f32_16x16x32_bf16 v[168:171], a[180:183], a[116:119], v[168:171]
v_lshlrev_b32 v25, 11, v25
v_lshl_add_u32 v25, v24, 7, v25
v_mfma_f32_16x16x32_bf16 v[172:175], a[176:179], a[120:123], v[172:175]
v_mfma_f32_16x16x32_bf16 v[172:175], a[180:183], a[124:127], v[172:175]
s_waitcnt lgkmcnt(4)
v_mfma_f32_16x16x32_bf16 v[188:191], a[184:187], a[120:123], v[188:191]
ds_read_b64_tr_b16 a[168:169], v23 offset:14464
s_and_b32 s50, s40, 2
v_mfma_f32_16x16x32_bf16 v[188:191], a[188:191], a[124:127], v[188:191]
ds_read_b64_tr_b16 a[170:171], v23 offset:16256
s_lshl_b32 s50, s50, 13
v_mfma_f32_16x16x32_bf16 v[184:187], a[184:187], a[112:115], v[184:187]
ds_read_b64_tr_b16 a[172:173], v23 offset:21632
s_add_u32 s50, s50, 0x10000
v_mfma_f32_16x16x32_bf16 v[184:187], a[188:191], a[116:119], v[184:187]
ds_read_b64_tr_b16 a[174:175], v23 offset:23424
v_and_b32 v26, 3, v0
v_mfma_f32_16x16x32_bf16 v[180:183], a[184:187], a[104:107], v[180:183]
buffer_load_dwordx4 v6, s[24:27], s43 offen offset:1024 lds
v_lshl_add_u32 v25, v26, 3, v25
v_mfma_f32_16x16x32_bf16 v[180:183], a[188:191], a[108:111], v[180:183]
v_add_u32 v25, s50, v25
v_mfma_f32_16x16x32_bf16 v[176:179], a[184:187], a[96:99], v[176:179]
v_mfma_f32_16x16x32_bf16 v[176:179], a[188:191], a[100:103], v[176:179]
s_waitcnt lgkmcnt(4)
v_mfma_f32_16x16x32_bf16 v[192:195], a[160:163], a[96:99], v[192:195]
ds_read_b64_tr_b16 a[176:177], v23 offset:14496
v_lshrrev_b32 v24, 1, v24
v_mfma_f32_16x16x32_bf16 v[192:195], a[164:167], a[100:103], v[192:195]
ds_read_b64_tr_b16 a[178:179], v23 offset:16288
v_xor_b32 v26, 0, v24
v_mfma_f32_16x16x32_bf16 v[196:199], a[160:163], a[104:107], v[196:199]
ds_read_b64_tr_b16 a[180:181], v23 offset:21664
v_lshl_add_u32 v27, v26, 5, v25
v_mfma_f32_16x16x32_bf16 v[196:199], a[164:167], a[108:111], v[196:199]
ds_read_b64_tr_b16 a[182:183], v23 offset:23456
v_accvgpr_write_b32 a246, v27
v_mfma_f32_16x16x32_bf16 v[200:203], a[160:163], a[112:115], v[200:203]
buffer_load_dwordx4 v7, s[24:27], s43 offen offset:2048 lds
v_xor_b32 v26, 1, v24
v_mfma_f32_16x16x32_bf16 v[200:203], a[164:167], a[116:119], v[200:203]
v_lshl_add_u32 v27, v26, 5, v25
v_mfma_f32_16x16x32_bf16 v[204:207], a[160:163], a[120:123], v[204:207]
v_mfma_f32_16x16x32_bf16 v[204:207], a[164:167], a[124:127], v[204:207]
s_waitcnt lgkmcnt(4)
v_mfma_f32_16x16x32_bf16 v[220:223], a[168:171], a[120:123], v[220:223]
ds_read_b64_tr_b16 a[184:185], v23 offset:14528
v_accvgpr_write_b32 a247, v27
v_mfma_f32_16x16x32_bf16 v[220:223], a[172:175], a[124:127], v[220:223]
ds_read_b64_tr_b16 a[186:187], v23 offset:16320
v_xor_b32 v26, 2, v24
v_mfma_f32_16x16x32_bf16 v[216:219], a[168:171], a[112:115], v[216:219]
ds_read_b64_tr_b16 a[188:189], v23 offset:21696
v_lshl_add_u32 v27, v26, 5, v25
v_mfma_f32_16x16x32_bf16 v[216:219], a[172:175], a[116:119], v[216:219]
ds_read_b64_tr_b16 a[190:191], v23 offset:23488
v_accvgpr_write_b32 a248, v27
v_mfma_f32_16x16x32_bf16 v[212:215], a[168:171], a[104:107], v[212:215]
buffer_load_dwordx4 v8, s[24:27], s43 offen offset:3072 lds
s_add_u32 s43, s43, 128
v_mfma_f32_16x16x32_bf16 v[212:215], a[172:175], a[108:111], v[212:215]
v_xor_b32 v26, 3, v24
v_lshl_add_u32 v27, v26, 5, v25
v_mfma_f32_16x16x32_bf16 v[208:211], a[168:171], a[96:99], v[208:211]
v_accvgpr_write_b32 a249, v27
v_mfma_f32_16x16x32_bf16 v[208:211], a[172:175], a[100:103], v[208:211]
s_waitcnt vmcnt(30) lgkmcnt(0)
s_barrier
v_mfma_f32_16x16x32_bf16 v[224:227], a[176:179], a[96:99], v[224:227]
ds_read_b64_tr_b16 a[160:161], v21 offset:40960
v_mfma_f32_16x16x32_bf16 v[224:227], a[180:183], a[100:103], v[224:227]
ds_read_b64_tr_b16 a[162:163], v21 offset:41728
v_mfma_f32_16x16x32_bf16 v[228:231], a[176:179], a[104:107], v[228:231]
ds_read_b64_tr_b16 a[164:165], v21 offset:47104
v_mfma_f32_16x16x32_bf16 v[228:231], a[180:183], a[108:111], v[228:231]
ds_read_b64_tr_b16 a[166:167], v21 offset:47872
s_add_u32 m0, s49, 0
v_mfma_f32_16x16x32_bf16 v[232:235], a[176:179], a[112:115], v[232:235]
buffer_load_dwordx4 v12, s[32:35], s45 offen offset:0 lds
v_mfma_f32_16x16x32_bf16 v[232:235], a[180:183], a[116:119], v[232:235]
v_mfma_f32_16x16x32_bf16 v[236:239], a[176:179], a[120:123], v[236:239]
v_mfma_f32_16x16x32_bf16 v[236:239], a[180:183], a[124:127], v[236:239]
v_mfma_f32_16x16x32_bf16 v[252:255], a[184:187], a[120:123], v[252:255]
ds_read_b64_tr_b16 a[168:169], v22 offset:40960
v_mfma_f32_16x16x32_bf16 v[252:255], a[188:191], a[124:127], v[252:255]
ds_read_b64_tr_b16 a[170:171], v22 offset:41728
v_mfma_f32_16x16x32_bf16 v[248:251], a[184:187], a[112:115], v[248:251]
ds_read_b64_tr_b16 a[172:173], v22 offset:47104
v_mfma_f32_16x16x32_bf16 v[248:251], a[188:191], a[116:119], v[248:251]
ds_read_b64_tr_b16 a[174:175], v22 offset:47872
v_mfma_f32_16x16x32_bf16 v[244:247], a[184:187], a[104:107], v[244:247]
buffer_load_dwordx4 v13, s[32:35], s45 offen offset:1024 lds
v_mfma_f32_16x16x32_bf16 v[244:247], a[188:191], a[108:111], v[244:247]
v_mfma_f32_16x16x32_bf16 v[240:243], a[184:187], a[96:99], v[240:243]
v_mfma_f32_16x16x32_bf16 v[240:243], a[188:191], a[100:103], v[240:243]
s_waitcnt lgkmcnt(4)
v_mfma_f32_16x16x32_bf16 a[0:3], a[160:163], a[128:131], a[0:3]
ds_read_b64_tr_b16 a[176:177], v21 offset:41024
s_lshl_b32 s70, s40, 9
s_add_u32 s70, s70, 147456
v_mfma_f32_16x16x32_bf16 a[0:3], a[164:167], a[132:135], a[0:3]
ds_read_b64_tr_b16 a[178:179], v21 offset:41792
v_lshlrev_b32 v1, 4, v0
v_and_b32 v8, 15, v0
v_mfma_f32_16x16x32_bf16 a[4:7], a[160:163], a[136:139], a[4:7]
ds_read_b64_tr_b16 a[180:181], v21 offset:47168
v_lshlrev_b32 v8, 2, v8
v_add_u32 v3, s70, v8
v_mfma_f32_16x16x32_bf16 a[4:7], a[164:167], a[140:143], a[4:7]
ds_read_b64_tr_b16 a[182:183], v21 offset:47936
v_add_u32 v6, 149504, v8
v_lshrrev_b32 v8, 4, v0
v_mfma_f32_16x16x32_bf16 a[8:11], a[160:163], a[144:147], a[8:11]
buffer_load_dwordx4 v14, s[32:35], s45 offen offset:2048 lds
v_lshlrev_b32 v8, 4, v8
v_add_u32 v4, s70, v8
v_mfma_f32_16x16x32_bf16 a[8:11], a[164:167], a[148:151], a[8:11]
v_add_u32 v5, 149504, v8
v_mfma_f32_16x16x32_bf16 a[12:15], a[160:163], a[152:155], a[12:15]
buffer_load_dwordx4 v15, s[32:35], s45 offen offset:3072 lds
v_mfma_f32_16x16x32_bf16 a[12:15], a[164:167], a[156:159], a[12:15]
s_waitcnt lgkmcnt(4)
v_mfma_f32_16x16x32_bf16 a[28:31], a[168:171], a[152:155], a[28:31]
ds_read_b64_tr_b16 a[184:185], v22 offset:41024
v_lshrrev_b32 v8, 5, v0
v_and_b32 v2, 31, v0
v_mfma_f32_16x16x32_bf16 a[28:31], a[172:175], a[156:159], a[28:31]
ds_read_b64_tr_b16 a[186:187], v22 offset:41792
v_lshlrev_b32 v2, 4, v2
v_lshl_add_u32 v2, v8, 10, v2
v_mfma_f32_16x16x32_bf16 a[24:27], a[168:171], a[144:147], a[24:27]
ds_read_b64_tr_b16 a[188:189], v22 offset:47168
v_accvgpr_write_b32 a240, v2
v_mov_b32 v2, v23
v_mfma_f32_16x16x32_bf16 a[24:27], a[172:175], a[148:151], a[24:27]
ds_read_b64_tr_b16 a[190:191], v22 offset:47936
s_add_u32 m0, s49, 4096
s_lshl_b32 s52, s42, 7
v_mfma_f32_16x16x32_bf16 a[20:23], a[168:171], a[136:139], a[20:23]
buffer_load_dwordx4 v16, s[32:35], s45 offen offset:0 lds
s_lshl_b32 s53, s41, 4
s_add_u32 s52, s52, s53
v_mfma_f32_16x16x32_bf16 a[20:23], a[172:175], a[140:143], a[20:23]
s_lshl_b32 s53, s40, 2
s_add_u32 s52, s52, s53
v_mfma_f32_16x16x32_bf16 a[16:19], a[168:171], a[128:131], a[16:19]
v_mfma_f32_16x16x32_bf16 a[16:19], a[172:175], a[132:135], a[16:19]
s_waitcnt lgkmcnt(4)
v_mfma_f32_16x16x32_bf16 a[32:35], a[176:179], a[128:131], a[32:35]
ds_read_b64_tr_b16 a[160:161], v21 offset:41088
s_lshl_b32 s52, s52, 10
v_mfma_f32_16x16x32_bf16 a[32:35], a[180:183], a[132:135], a[32:35]
ds_read_b64_tr_b16 a[162:163], v21 offset:41856
s_add_u32 s60, s52, 20971520
v_mfma_f32_16x16x32_bf16 a[36:39], a[176:179], a[136:139], a[36:39]
ds_read_b64_tr_b16 a[164:165], v21 offset:47232
s_add_u32 s61, s52, 25165824
v_mfma_f32_16x16x32_bf16 a[36:39], a[180:183], a[140:143], a[36:39]
ds_read_b64_tr_b16 a[166:167], v21 offset:48000
s_lshl_b32 s71, s41, 1
v_mfma_f32_16x16x32_bf16 a[40:43], a[176:179], a[144:147], a[40:43]
buffer_load_dwordx4 v17, s[32:35], s45 offen offset:1024 lds
s_lshr_b32 s53, s40, 1
v_mfma_f32_16x16x32_bf16 a[40:43], a[180:183], a[148:151], a[40:43]
s_add_u32 s71, s71, s53
s_mul_i32 s71, s71, 1179648
v_mfma_f32_16x16x32_bf16 a[44:47], a[176:179], a[152:155], a[44:47]
s_and_b32 s53, s40, 1
s_lshl_b32 s53, s53, 12
v_mfma_f32_16x16x32_bf16 a[44:47], a[180:183], a[156:159], a[44:47]
s_add_u32 s71, s71, s53
s_add_u32 s69, s42, 112
s_waitcnt lgkmcnt(4)
v_mfma_f32_16x16x32_bf16 a[60:63], a[184:187], a[152:155], a[60:63]
ds_read_b64_tr_b16 a[168:169], v22 offset:41088
s_lshl_b32 s69, s69, 13
s_add_u32 s69, s69, s71
v_mfma_f32_16x16x32_bf16 a[60:63], a[188:191], a[156:159], a[60:63]
ds_read_b64_tr_b16 a[170:171], v22 offset:41856
s_mul_i32 s52, s42, 7
s_and_b32 s53, s52, 1
v_mfma_f32_16x16x32_bf16 a[56:59], a[184:187], a[144:147], a[56:59]
ds_read_b64_tr_b16 a[172:173], v22 offset:47232
s_lshr_b32 s52, s52, 1
s_lshl_b32 s52, s52, 13
v_mfma_f32_16x16x32_bf16 a[56:59], a[188:191], a[148:151], a[56:59]
ds_read_b64_tr_b16 a[174:175], v22 offset:48000
s_add_u32 s71, s71, s52
s_lshl_b32 s52, s53, 9
v_mfma_f32_16x16x32_bf16 a[52:55], a[184:187], a[136:139], a[52:55]
buffer_load_dwordx4 v18, s[32:35], s45 offen offset:2048 lds
s_add_u32 s45, s45, 458752
s_add_u32 s71, s71, s52
v_mfma_f32_16x16x32_bf16 a[52:55], a[188:191], a[140:143], a[52:55]
s_movk_i32 s52, 7680
s_cmp_eq_u32 s53, 0
s_cselect_b32 s0, 512, s52
s_cselect_b32 s1, s52, 512
v_mfma_f32_16x16x32_bf16 a[48:51], a[184:187], a[128:131], a[48:51]
v_mfma_f32_16x16x32_bf16 a[48:51], a[188:191], a[132:135], a[48:51]
s_waitcnt vmcnt(20) lgkmcnt(0)
s_barrier
s_waitcnt vmcnt(15)
v_cmp_gt_u32 vcc, 4, v28
s_cbranch_vccnz L_pl1_slow
L_pl1_ok:
v_mfma_f32_16x16x32_bf16 a[64:67], a[128:131], a[160:163], a[64:67]
ds_read_b64_tr_b16 a[176:177], v23 offset:40960
v_mfma_f32_16x16x32_bf16 a[64:67], a[132:135], a[164:167], a[64:67]
ds_read_b64_tr_b16 a[178:179], v23 offset:42752
v_mfma_f32_16x16x32_bf16 a[68:71], a[136:139], a[160:163], a[68:71]
ds_read_b64_tr_b16 a[180:181], v23 offset:48128
v_mfma_f32_16x16x32_bf16 a[68:71], a[140:143], a[164:167], a[68:71]
ds_read_b64_tr_b16 a[182:183], v23 offset:49920
s_add_u32 m0, s48, 40960
v_mfma_f32_16x16x32_bf16 a[72:75], a[144:147], a[160:163], a[72:75]
buffer_load_dwordx4 v9, s[28:31], s44 offen offset:0 lds
v_mfma_f32_16x16x32_bf16 a[72:75], a[148:151], a[164:167], a[72:75]
v_mfma_f32_16x16x32_bf16 a[76:79], a[152:155], a[160:163], a[76:79]
v_mfma_f32_16x16x32_bf16 a[76:79], a[156:159], a[164:167], a[76:79]
v_mfma_f32_16x16x32_bf16 a[92:95], a[152:155], a[168:171], a[92:95]
ds_read_b64_tr_b16 a[184:185], v23 offset:40992
v_mfma_f32_16x16x32_bf16 a[92:95], a[156:159], a[172:175], a[92:95]
ds_read_b64_tr_b16 a[186:187], v23 offset:42784
v_mfma_f32_16x16x32_bf16 a[88:91], a[144:147], a[168:171], a[88:91]
ds_read_b64_tr_b16 a[188:189], v23 offset:48160
v_mfma_f32_16x16x32_bf16 a[88:91], a[148:151], a[172:175], a[88:91]
ds_read_b64_tr_b16 a[190:191], v23 offset:49952
v_mfma_f32_16x16x32_bf16 a[84:87], a[136:139], a[168:171], a[84:87]
buffer_load_dwordx4 v10, s[28:31], s44 offen offset:1024 lds
v_mfma_f32_16x16x32_bf16 a[84:87], a[140:143], a[172:175], a[84:87]
v_mfma_f32_16x16x32_bf16 a[80:83], a[128:131], a[168:171], a[80:83]
v_mfma_f32_16x16x32_bf16 a[80:83], a[132:135], a[172:175], a[80:83]
s_waitcnt lgkmcnt(4)
v_mfma_f32_16x16x32_bf16 v[32:35], a[176:179], a[128:131], v[32:35]
ds_read_b64_tr_b16 a[160:161], v23 offset:41024
v_lshrrev_b32 v28, 1, v0
v_lshlrev_b32 v28, 7, v28
v_mfma_f32_16x16x32_bf16 v[32:35], a[180:183], a[132:135], v[32:35]
ds_read_b64_tr_b16 a[162:163], v23 offset:42816
v_and_b32 v24, 1, v0
v_lshl_add_u32 v28, v24, 3, v28
v_mfma_f32_16x16x32_bf16 v[36:39], a[176:179], a[136:139], v[36:39]
ds_read_b64_tr_b16 a[164:165], v23 offset:48192
v_lshlrev_b32 v24, 2, v0
s_lshl_b32 s50, s41, 2
v_mfma_f32_16x16x32_bf16 v[36:39], a[180:183], a[140:143], v[36:39]
ds_read_b64_tr_b16 a[166:167], v23 offset:49984
s_add_u32 s50, s50, s40
s_lshl_b32 s50, s50, 12
v_mfma_f32_16x16x32_bf16 v[40:43], a[176:179], a[144:147], v[40:43]
buffer_load_dwordx4 v11, s[28:31], s44 offen offset:2048 lds
s_add_u32 s44, s44, 393216
s_add_u32 s50, s50, 33554432
v_mfma_f32_16x16x32_bf16 v[40:43], a[180:183], a[148:151], v[40:43]
buffer_load_dwordx2 v[26:27], v28, s[36:39], s50 offen sc1
v_lshlrev_b32 v25, 3, v0
v_min_u32 v25, 312, v25
v_mfma_f32_16x16x32_bf16 v[44:47], a[176:179], a[152:155], v[44:47]
s_mul_i32 s51, s40, 320
v_add_u32 v25, s51, v25
v_cmp_le_u32 vcc, 832, v25
v_mfma_f32_16x16x32_bf16 v[44:47], a[180:183], a[156:159], v[44:47]
s_waitcnt lgkmcnt(4)
v_mfma_f32_16x16x32_bf16 v[60:63], a[184:187], a[152:155], v[60:63]
ds_read_b64_tr_b16 a[168:169], v23 offset:41056
v_add_u32 v28, 64, v25
v_cndmask_b32 v28, v25, v28, vcc
v_mfma_f32_16x16x32_bf16 v[60:63], a[188:191], a[156:159], v[60:63]
ds_read_b64_tr_b16 a[170:171], v23 offset:42848
s_mul_i32 s50, s42, 11264
s_add_u32 s50, s50, 34603008
v_mfma_f32_16x16x32_bf16 v[56:59], a[184:187], a[144:147], v[56:59]
ds_read_b64_tr_b16 a[172:173], v23 offset:48224
buffer_load_dwordx2 a[192:193], v28, s[36:39], s50 offen offset:0 sc1
buffer_load_dwordx2 a[194:195], v28, s[36:39], s50 offen offset:1408 sc1
v_mfma_f32_16x16x32_bf16 v[56:59], a[188:191], a[148:151], v[56:59]
ds_read_b64_tr_b16 a[174:175], v23 offset:50016
s_add_u32 s50, s50, 2816
buffer_load_dwordx2 a[196:197], v28, s[36:39], s50 offen offset:0 sc1
v_mfma_f32_16x16x32_bf16 v[52:55], a[184:187], a[136:139], v[52:55]
buffer_load_dwordx2 a[198:199], v28, s[36:39], s50 offen offset:1408 sc1
s_add_u32 s50, s50, 2816
buffer_load_dwordx2 a[200:201], v28, s[36:39], s50 offen offset:0 sc1
v_mfma_f32_16x16x32_bf16 v[52:55], a[188:191], a[140:143], v[52:55]
buffer_load_dwordx2 a[202:203], v28, s[36:39], s50 offen offset:1408 sc1
s_add_u32 s50, s50, 2816
buffer_load_dwordx2 a[204:205], v28, s[36:39], s50 offen offset:0 sc1
v_mfma_f32_16x16x32_bf16 v[48:51], a[184:187], a[128:131], v[48:51]
buffer_load_dwordx2 a[206:207], v28, s[36:39], s50 offen offset:1408 sc1
v_mfma_f32_16x16x32_bf16 v[48:51], a[188:191], a[132:135], v[48:51]
s_waitcnt lgkmcnt(4)
v_mfma_f32_16x16x32_bf16 v[64:67], a[160:163], a[128:131], v[64:67]
ds_read_b64_tr_b16 a[176:177], v23 offset:41088
s_mov_b32 s28, s16
v_mfma_f32_16x16x32_bf16 v[64:67], a[164:167], a[132:135], v[64:67]
ds_read_b64_tr_b16 a[178:179], v23 offset:42880
s_mov_b32 s29, s17
v_mfma_f32_16x16x32_bf16 v[68:71], a[160:163], a[136:139], v[68:71]
ds_read_b64_tr_b16 a[180:181], v23 offset:48256
s_mov_b32 s30, 0x700000
v_mfma_f32_16x16x32_bf16 v[68:71], a[164:167], a[140:143], v[68:71]
ds_read_b64_tr_b16 a[182:183], v23 offset:50048
s_mov_b32 s31, 0x00020000
v_mfma_f32_16x16x32_bf16 v[72:75], a[160:163], a[144:147], v[72:75]
ds_read_b128 a[96:99], v19 offset:0
v_lshrrev_b32 v8, 3, v0
v_mfma_f32_16x16x32_bf16 v[72:75], a[164:167], a[148:151], v[72:75]
ds_read_b128 a[100:103], v20 offset:0
v_and_b32 v9, 6, v8
v_mfma_f32_16x16x32_bf16 v[76:79], a[160:163], a[152:155], v[76:79]
ds_read_b128 a[104:107], v19 offset:2048
v_mfma_f32_16x16x32_bf16 v[76:79], a[164:167], a[156:159], v[76:79]
ds_read_b128 a[108:111], v20 offset:2048
s_waitcnt lgkmcnt(8)
v_mfma_f32_16x16x32_bf16 v[92:95], a[168:171], a[152:155], v[92:95]
ds_read_b64_tr_b16 a[184:185], v23 offset:41120
v_and_b32 v7, 7, v0
v_mfma_f32_16x16x32_bf16 v[92:95], a[172:175], a[156:159], v[92:95]
ds_read_b64_tr_b16 a[186:187], v23 offset:42912
v_xor_b32 v9, v9, v7
v_mfma_f32_16x16x32_bf16 v[88:91], a[168:171], a[144:147], v[88:91]
ds_read_b64_tr_b16 a[188:189], v23 offset:48288
v_lshlrev_b32 v9, 4, v9
v_mfma_f32_16x16x32_bf16 v[88:91], a[172:175], a[148:151], v[88:91]
ds_read_b64_tr_b16 a[190:191], v23 offset:50080
v_lshl_add_u32 v9, v8, 11, v9
v_mfma_f32_16x16x32_bf16 v[84:87], a[168:171], a[136:139], v[84:87]
ds_read_b128 a[112:115], v19 offset:4096
s_lshl_b32 s50, s81, 1
v_mfma_f32_16x16x32_bf16 v[84:87], a[172:175], a[140:143], v[84:87]
ds_read_b128 a[116:119], v20 offset:4096
s_and_b32 s51, s40, 1
v_mfma_f32_16x16x32_bf16 v[80:83], a[168:171], a[128:131], v[80:83]
ds_read_b128 a[120:123], v19 offset:6144
s_add_u32 s50, s50, s51
v_mfma_f32_16x16x32_bf16 v[80:83], a[172:175], a[132:135], v[80:83]
ds_read_b128 a[124:127], v20 offset:6144
s_waitcnt lgkmcnt(12)
v_mfma_f32_16x16x32_bf16 v[96:99], a[176:179], a[128:131], v[96:99]
ds_read_b64_tr_b16 a[160:161], v23 offset:41152
s_lshl_b32 s50, s50, 7
v_mfma_f32_16x16x32_bf16 v[96:99], a[180:183], a[132:135], v[96:99]
ds_read_b64_tr_b16 a[162:163], v23 offset:42944
v_add_u32 v7, s50, v9
v_mfma_f32_16x16x32_bf16 v[100:103], a[176:179], a[136:139], v[100:103]
ds_read_b64_tr_b16 a[164:165], v23 offset:48320
s_mul_i32 s84, s10, 1835008
v_mfma_f32_16x16x32_bf16 v[100:103], a[180:183], a[140:143], v[100:103]
ds_read_b64_tr_b16 a[166:167], v23 offset:50112
s_xor_b32 s51, s51, s3
v_mfma_f32_16x16x32_bf16 v[104:107], a[176:179], a[144:147], v[104:107]
s_xor_b32 s51, s51, 1
s_and_b32 s85, s40, 2
v_mfma_f32_16x16x32_bf16 v[104:107], a[180:183], a[148:151], v[104:107]
v_mfma_f32_16x16x32_bf16 v[108:111], a[176:179], a[152:155], v[108:111]
v_mfma_f32_16x16x32_bf16 v[108:111], a[180:183], a[156:159], v[108:111]
s_waitcnt lgkmcnt(8)
v_mfma_f32_16x16x32_bf16 v[124:127], a[184:187], a[152:155], v[124:127]
ds_read_b64_tr_b16 a[168:169], v23 offset:55296
s_add_u32 s85, s85, s51
v_mfma_f32_16x16x32_bf16 v[124:127], a[188:191], a[156:159], v[124:127]
ds_read_b64_tr_b16 a[170:171], v23 offset:57088
s_lshl_b32 s85, s85, 13
v_mfma_f32_16x16x32_bf16 v[120:123], a[184:187], a[144:147], v[120:123]
ds_read_b64_tr_b16 a[172:173], v23 offset:62464
s_add_u32 s50, s40, 0
v_mfma_f32_16x16x32_bf16 v[120:123], a[188:191], a[148:151], v[120:123]
ds_read_b64_tr_b16 a[174:175], v23 offset:64256
s_cmp_lt_u32 s50, 4
s_cselect_b32 s50, 0xf149f2ca, 0
v_mfma_f32_16x16x32_bf16 v[116:119], a[184:187], a[136:139], v[116:119]
s_cmp_eq_u32 s41, 0
s_cselect_b32 s64, s50, 0
s_add_u32 s50, s40, 1
v_mfma_f32_16x16x32_bf16 v[116:119], a[188:191], a[140:143], v[116:119]
s_cmp_lt_u32 s50, 4
s_cselect_b32 s50, 0xf149f2ca, 0
v_mfma_f32_16x16x32_bf16 v[112:115], a[184:187], a[128:131], v[112:115]
v_mfma_f32_16x16x32_bf16 v[112:115], a[188:191], a[132:135], v[112:115]
s_waitcnt lgkmcnt(4)
v_mfma_f32_16x16x32_bf16 v[128:131], a[160:163], a[128:131], v[128:131]
ds_read_b64_tr_b16 a[176:177], v23 offset:55328
s_cmp_eq_u32 s41, 0
s_cselect_b32 s65, s50, 0
v_mfma_f32_16x16x32_bf16 v[128:131], a[164:167], a[132:135], v[128:131]
ds_read_b64_tr_b16 a[178:179], v23 offset:57120
s_add_u32 s50, s40, 2
v_mfma_f32_16x16x32_bf16 v[132:135], a[160:163], a[136:139], v[132:135]
ds_read_b64_tr_b16 a[180:181], v23 offset:62496
s_cmp_lt_u32 s50, 4
s_cselect_b32 s50, 0xf149f2ca, 0
v_mfma_f32_16x16x32_bf16 v[132:135], a[164:167], a[140:143], v[132:135]
ds_read_b64_tr_b16 a[182:183], v23 offset:64288
s_cmp_eq_u32 s41, 0
s_cselect_b32 s66, s50, 0
v_mfma_f32_16x16x32_bf16 v[136:139], a[160:163], a[144:147], v[136:139]
s_add_u32 s50, s40, 3
s_cmp_lt_u32 s50, 4
s_cselect_b32 s50, 0xf149f2ca, 0
v_mfma_f32_16x16x32_bf16 v[136:139], a[164:167], a[148:151], v[136:139]
s_cmp_eq_u32 s41, 0
s_cselect_b32 s67, s50, 0
v_mfma_f32_16x16x32_bf16 v[140:143], a[160:163], a[152:155], v[140:143]
v_mfma_f32_16x16x32_bf16 v[140:143], a[164:167], a[156:159], v[140:143]
s_waitcnt lgkmcnt(4)
v_mfma_f32_16x16x32_bf16 v[156:159], a[168:171], a[152:155], v[156:159]
ds_read_b64_tr_b16 a[184:185], v23 offset:55360
v_mfma_f32_16x16x32_bf16 v[156:159], a[172:175], a[156:159], v[156:159]
ds_read_b64_tr_b16 a[186:187], v23 offset:57152
v_mfma_f32_16x16x32_bf16 v[152:155], a[168:171], a[144:147], v[152:155]
ds_read_b64_tr_b16 a[188:189], v23 offset:62528
v_mfma_f32_16x16x32_bf16 v[152:155], a[172:175], a[148:151], v[152:155]
ds_read_b64_tr_b16 a[190:191], v23 offset:64320
v_mfma_f32_16x16x32_bf16 v[148:151], a[168:171], a[136:139], v[148:151]
v_mfma_f32_16x16x32_bf16 v[148:151], a[172:175], a[140:143], v[148:151]
v_mfma_f32_16x16x32_bf16 v[144:147], a[168:171], a[128:131], v[144:147]
v_mfma_f32_16x16x32_bf16 v[144:147], a[172:175], a[132:135], v[144:147]
s_waitcnt lgkmcnt(4)
v_mfma_f32_16x16x32_bf16 v[160:163], a[176:179], a[128:131], v[160:163]
ds_read_b64_tr_b16 a[160:161], v23 offset:55392
v_add_u32 v24, s70, v24
v_mfma_f32_16x16x32_bf16 v[160:163], a[180:183], a[132:135], v[160:163]
ds_read_b64_tr_b16 a[162:163], v23 offset:57184
v_add_u32 v25, 149504, v25
v_mfma_f32_16x16x32_bf16 v[164:167], a[176:179], a[136:139], v[164:167]
ds_read_b64_tr_b16 a[164:165], v23 offset:62560
s_waitcnt vmcnt(0)
ds_write_b32 v24, v26
v_mfma_f32_16x16x32_bf16 v[164:167], a[180:183], a[140:143], v[164:167]
ds_read_b64_tr_b16 a[166:167], v23 offset:64352
ds_write_b32 v24, v27 offset:256
v_mfma_f32_16x16x32_bf16 v[168:171], a[176:179], a[144:147], v[168:171]
v_accvgpr_read_b32 v28, a192
v_accvgpr_read_b32 v29, a193
v_mfma_f32_16x16x32_bf16 v[168:171], a[180:183], a[148:151], v[168:171]
v_accvgpr_read_b32 v30, a194
v_accvgpr_read_b32 v31, a195
v_mfma_f32_16x16x32_bf16 v[172:175], a[176:179], a[152:155], v[172:175]
v_add_f32 v28, v28, v30
v_mfma_f32_16x16x32_bf16 v[172:175], a[180:183], a[156:159], v[172:175]
s_waitcnt lgkmcnt(6)
v_mfma_f32_16x16x32_bf16 v[188:191], a[184:187], a[152:155], v[188:191]
ds_read_b64_tr_b16 a[168:169], v23 offset:55424
v_add_f32 v29, v29, v31
v_mfma_f32_16x16x32_bf16 v[188:191], a[188:191], a[156:159], v[188:191]
ds_read_b64_tr_b16 a[170:171], v23 offset:57216
v_accvgpr_read_b32 v30, a196
v_mfma_f32_16x16x32_bf16 v[184:187], a[184:187], a[144:147], v[184:187]
ds_read_b64_tr_b16 a[172:173], v23 offset:62592
v_accvgpr_read_b32 v31, a197
v_mfma_f32_16x16x32_bf16 v[184:187], a[188:191], a[148:151], v[184:187]
ds_read_b64_tr_b16 a[174:175], v23 offset:64384
v_add_f32 v28, v28, v30
v_mfma_f32_16x16x32_bf16 v[180:183], a[184:187], a[136:139], v[180:183]
v_add_f32 v29, v29, v31
v_accvgpr_read_b32 v30, a198
v_mfma_f32_16x16x32_bf16 v[180:183], a[188:191], a[140:143], v[180:183]
v_accvgpr_read_b32 v31, a199
v_add_f32 v28, v28, v30
v_mfma_f32_16x16x32_bf16 v[176:179], a[184:187], a[128:131], v[176:179]
v_add_f32 v29, v29, v31
v_accvgpr_read_b32 v30, a200
v_mfma_f32_16x16x32_bf16 v[176:179], a[188:191], a[132:135], v[176:179]
s_waitcnt lgkmcnt(5)
v_mfma_f32_16x16x32_bf16 v[192:195], a[160:163], a[128:131], v[192:195]
ds_read_b64_tr_b16 a[176:177], v23 offset:55456
v_accvgpr_read_b32 v31, a201
v_mfma_f32_16x16x32_bf16 v[192:195], a[164:167], a[132:135], v[192:195]
ds_read_b64_tr_b16 a[178:179], v23 offset:57248
v_add_f32 v28, v28, v30
v_mfma_f32_16x16x32_bf16 v[196:199], a[160:163], a[136:139], v[196:199]
ds_read_b64_tr_b16 a[180:181], v23 offset:62624
v_add_f32 v29, v29, v31
v_mfma_f32_16x16x32_bf16 v[196:199], a[164:167], a[140:143], v[196:199]
ds_read_b64_tr_b16 a[182:183], v23 offset:64416
v_accvgpr_read_b32 v30, a202
v_mfma_f32_16x16x32_bf16 v[200:203], a[160:163], a[144:147], v[200:203]
v_accvgpr_read_b32 v31, a203
v_add_f32 v28, v28, v30
v_mfma_f32_16x16x32_bf16 v[200:203], a[164:167], a[148:151], v[200:203]
v_add_f32 v29, v29, v31
v_accvgpr_read_b32 v30, a204
v_mfma_f32_16x16x32_bf16 v[204:207], a[160:163], a[152:155], v[204:207]
v_accvgpr_read_b32 v31, a205
v_add_f32 v28, v28, v30
v_mfma_f32_16x16x32_bf16 v[204:207], a[164:167], a[156:159], v[204:207]
s_waitcnt lgkmcnt(4)
v_mfma_f32_16x16x32_bf16 v[220:223], a[168:171], a[152:155], v[220:223]
ds_read_b64_tr_b16 a[184:185], v23 offset:55488
v_add_f32 v29, v29, v31
v_mfma_f32_16x16x32_bf16 v[220:223], a[172:175], a[156:159], v[220:223]
ds_read_b64_tr_b16 a[186:187], v23 offset:57280
v_accvgpr_read_b32 v30, a206
v_mfma_f32_16x16x32_bf16 v[216:219], a[168:171], a[144:147], v[216:219]
ds_read_b64_tr_b16 a[188:189], v23 offset:62656
v_accvgpr_read_b32 v31, a207
v_mfma_f32_16x16x32_bf16 v[216:219], a[172:175], a[148:151], v[216:219]
ds_read_b64_tr_b16 a[190:191], v23 offset:64448
v_add_f32 v28, v28, v30
v_mfma_f32_16x16x32_bf16 v[212:215], a[168:171], a[136:139], v[212:215]
v_add_f32 v29, v29, v31
ds_write_b64 v25, v[28:29]
v_mfma_f32_16x16x32_bf16 v[212:215], a[172:175], a[140:143], v[212:215]
s_mov_b32 s56, s22
s_mov_b32 s57, s23
v_mfma_f32_16x16x32_bf16 v[208:211], a[168:171], a[128:131], v[208:211]
s_mov_b32 s58, 0x10000000
s_mov_b32 s59, 0x00020000
v_mfma_f32_16x16x32_bf16 v[208:211], a[172:175], a[132:135], v[208:211]
s_cmp_eq_u32 s41, 7
s_cselect_b32 s58, 0, s58
s_waitcnt lgkmcnt(0)
s_barrier
v_mfma_f32_16x16x32_bf16 v[224:227], a[176:179], a[128:131], v[224:227]
ds_read_b64_tr_b16 a[160:161], v21 offset:128
v_mfma_f32_16x16x32_bf16 v[224:227], a[180:183], a[132:135], v[224:227]
ds_read_b64_tr_b16 a[162:163], v21 offset:896
v_mfma_f32_16x16x32_bf16 v[228:231], a[176:179], a[136:139], v[228:231]
ds_read_b64_tr_b16 a[164:165], v21 offset:6272
v_mfma_f32_16x16x32_bf16 v[228:231], a[180:183], a[140:143], v[228:231]
ds_read_b64_tr_b16 a[166:167], v21 offset:7040
s_add_u32 m0, s49, 40960
v_mfma_f32_16x16x32_bf16 v[232:235], a[176:179], a[144:147], v[232:235]
buffer_load_dwordx4 v12, s[32:35], s45 offen offset:0 lds
v_mfma_f32_16x16x32_bf16 v[232:235], a[180:183], a[148:151], v[232:235]
v_mfma_f32_16x16x32_bf16 v[236:239], a[176:179], a[152:155], v[236:239]
v_mfma_f32_16x16x32_bf16 v[236:239], a[180:183], a[156:159], v[236:239]
v_mfma_f32_16x16x32_bf16 v[252:255], a[184:187], a[152:155], v[252:255]
ds_read_b64_tr_b16 a[168:169], v22 offset:128
v_mfma_f32_16x16x32_bf16 v[252:255], a[188:191], a[156:159], v[252:255]
ds_read_b64_tr_b16 a[170:171], v22 offset:896
v_mfma_f32_16x16x32_bf16 v[248:251], a[184:187], a[144:147], v[248:251]
ds_read_b64_tr_b16 a[172:173], v22 offset:6272
v_mfma_f32_16x16x32_bf16 v[248:251], a[188:191], a[148:151], v[248:251]
ds_read_b64_tr_b16 a[174:175], v22 offset:7040
v_mfma_f32_16x16x32_bf16 v[244:247], a[184:187], a[136:139], v[244:247]
buffer_load_dwordx4 v13, s[32:35], s45 offen offset:1024 lds
v_mfma_f32_16x16x32_bf16 v[244:247], a[188:191], a[140:143], v[244:247]
v_mov_b32 v30, v21
v_mfma_f32_16x16x32_bf16 v[240:243], a[184:187], a[128:131], v[240:243]
v_mov_b32 v31, v22
v_mfma_f32_16x16x32_bf16 v[240:243], a[188:191], a[132:135], v[240:243]
L_epi:
s_waitcnt lgkmcnt(4)
v_mfma_f32_16x16x32_bf16 a[64:67], a[96:99], a[160:163], a[64:67]
ds_read_b64_tr_b16 a[176:177], v30 offset:64
v_mfma_f32_16x16x32_bf16 a[64:67], a[100:103], a[164:167], a[64:67]
ds_read_b64_tr_b16 a[178:179], v30 offset:832
v_mfma_f32_16x16x32_bf16 a[68:71], a[104:107], a[160:163], a[68:71]
ds_read_b64_tr_b16 a[180:181], v30 offset:6208
v_mfma_f32_16x16x32_bf16 a[68:71], a[108:111], a[164:167], a[68:71]
ds_read_b64_tr_b16 a[182:183], v30 offset:6976
v_mfma_f32_16x16x32_bf16 a[72:75], a[112:115], a[160:163], a[72:75]
ds_read_b128 a[128:131], v19 offset:32768
buffer_load_dwordx4 v14, s[32:35], s45 offen offset:2048 lds
v_mfma_f32_16x16x32_bf16 a[72:75], a[116:119], a[164:167], a[72:75]
ds_read_b128 a[132:135], v20 offset:32768
v_mfma_f32_16x16x32_bf16 a[76:79], a[120:123], a[160:163], a[76:79]
ds_read_b128 a[136:139], v19 offset:34816
buffer_load_dwordx4 v15, s[32:35], s45 offen offset:3072 lds
v_mfma_f32_16x16x32_bf16 a[76:79], a[124:127], a[164:167], a[76:79]
ds_read_b128 a[140:143], v20 offset:34816
s_waitcnt lgkmcnt(8)
v_mfma_f32_16x16x32_bf16 a[92:95], a[120:123], a[168:171], a[92:95]
ds_read_b64_tr_b16 a[184:185], v31 offset:64
v_mfma_f32_16x16x32_bf16 a[92:95], a[124:127], a[172:175], a[92:95]
ds_read_b64_tr_b16 a[186:187], v31 offset:832
v_mfma_f32_16x16x32_bf16 a[88:91], a[112:115], a[168:171], a[88:91]
ds_read_b64_tr_b16 a[188:189], v31 offset:6208
v_mfma_f32_16x16x32_bf16 a[88:91], a[116:119], a[172:175], a[88:91]
ds_read_b64_tr_b16 a[190:191], v31 offset:6976
s_add_u32 m0, s49, 45056
v_mfma_f32_16x16x32_bf16 a[84:87], a[104:107], a[168:171], a[84:87]
ds_read_b128 a[144:147], v19 offset:36864
buffer_load_dwordx4 v16, s[32:35], s45 offen offset:0 lds
v_mfma_f32_16x16x32_bf16 a[84:87], a[108:111], a[172:175], a[84:87]
ds_read_b128 a[148:151], v20 offset:36864
v_mfma_f32_16x16x32_bf16 a[80:83], a[96:99], a[168:171], a[80:83]
ds_read_b128 a[152:155], v19 offset:38912
v_mfma_f32_16x16x32_bf16 a[80:83], a[100:103], a[172:175], a[80:83]
ds_read_b128 a[156:159], v20 offset:38912
s_waitcnt lgkmcnt(0)
s_barrier
v_mfma_f32_16x16x32_bf16 a[32:35], a[176:179], a[96:99], a[32:35]
ds_read_b64_tr_b16 a[160:161], v30 offset:41088
s_lshr_b32 s50, s80, 1
v_mfma_f32_16x16x32_bf16 a[32:35], a[180:183], a[100:103], a[32:35]
ds_read_b64_tr_b16 a[162:163], v30 offset:41856
s_lshl_b32 s50, s50, 5
v_mfma_f32_16x16x32_bf16 a[36:39], a[176:179], a[104:107], a[36:39]
ds_read_b64_tr_b16 a[164:165], v30 offset:47232
s_lshl_b32 s51, s10, 3
v_mfma_f32_16x16x32_bf16 a[36:39], a[180:183], a[108:111], a[36:39]
ds_read_b64_tr_b16 a[166:167], v30 offset:48000
s_add_u32 s50, s50, s51
v_mfma_f32_16x16x32_bf16 a[40:43], a[176:179], a[112:115], a[40:43]
buffer_load_dwordx4 v17, s[32:35], s45 offen offset:1024 lds
s_lshl_b32 s50, s50, 9
v_mfma_f32_16x16x32_bf16 a[40:43], a[180:183], a[116:119], a[40:43]
s_and_b32 s51, s80, 1
v_mfma_f32_16x16x32_bf16 a[44:47], a[176:179], a[120:123], a[44:47]
v_mfma_f32_16x16x32_bf16 a[44:47], a[180:183], a[124:127], a[44:47]
v_mfma_f32_16x16x32_bf16 a[60:63], a[184:187], a[120:123], a[60:63]
ds_read_b64_tr_b16 a[168:169], v31 offset:41088
s_lshl_b32 s51, s51, 1
v_mfma_f32_16x16x32_bf16 a[60:63], a[188:191], a[124:127], a[60:63]
ds_read_b64_tr_b16 a[170:171], v31 offset:41856
s_and_b32 s52, s40, 1
v_mfma_f32_16x16x32_bf16 a[56:59], a[184:187], a[112:115], a[56:59]
ds_read_b64_tr_b16 a[172:173], v31 offset:47232
s_add_u32 s51, s51, s52
v_mfma_f32_16x16x32_bf16 a[56:59], a[188:191], a[116:119], a[56:59]
ds_read_b64_tr_b16 a[174:175], v31 offset:48000
s_lshl_b32 s51, s51, 7
v_mfma_f32_16x16x32_bf16 a[52:55], a[184:187], a[104:107], a[52:55]
buffer_load_dwordx4 v18, s[32:35], s45 offen offset:2048 lds
s_add_u32 s45, s45, 458752
v_mfma_f32_16x16x32_bf16 a[52:55], a[188:191], a[108:111], a[52:55]
s_add_u32 s50, s50, s51
s_add_u32 s62, s50, 35651588
v_mfma_f32_16x16x32_bf16 a[48:51], a[184:187], a[96:99], a[48:51]
v_mfma_f32_16x16x32_bf16 a[48:51], a[188:191], a[100:103], a[48:51]
s_waitcnt lgkmcnt(4)
v_mfma_f32_16x16x32_bf16 a[64:67], a[128:131], a[160:163], a[64:67]
ds_read_b64_tr_b16 a[176:177], v30 offset:41024
v_mfma_f32_16x16x32_bf16 a[64:67], a[132:135], a[164:167], a[64:67]
ds_read_b64_tr_b16 a[178:179], v30 offset:41792
v_mfma_f32_16x16x32_bf16 a[68:71], a[136:139], a[160:163], a[68:71]
ds_read_b64_tr_b16 a[180:181], v30 offset:47168
v_mfma_f32_16x16x32_bf16 a[68:71], a[140:143], a[164:167], a[68:71]
ds_read_b64_tr_b16 a[182:183], v30 offset:47936
v_mfma_f32_16x16x32_bf16 a[72:75], a[144:147], a[160:163], a[72:75]
ds_read_b32 v28, v6 offset:256
v_mfma_f32_16x16x32_bf16 a[72:75], a[148:151], a[164:167], a[72:75]
ds_read_b32 v29, v6 offset:320
v_mfma_f32_16x16x32_bf16 a[76:79], a[152:155], a[160:163], a[76:79]
ds_read_b128 v[8:11], v4
v_mfma_f32_16x16x32_bf16 a[76:79], a[156:159], a[164:167], a[76:79]
s_waitcnt lgkmcnt(7)
v_mfma_f32_16x16x32_bf16 a[92:95], a[152:155], a[168:171], a[92:95]
ds_read_b64_tr_b16 a[184:185], v31 offset:41024
v_mfma_f32_16x16x32_bf16 a[92:95], a[156:159], a[172:175], a[92:95]
ds_read_b64_tr_b16 a[186:187], v31 offset:41792
v_mfma_f32_16x16x32_bf16 a[88:91], a[144:147], a[168:171], a[88:91]
ds_read_b64_tr_b16 a[188:189], v31 offset:47168
v_mfma_f32_16x16x32_bf16 a[88:91], a[148:151], a[172:175], a[88:91]
ds_read_b64_tr_b16 a[190:191], v31 offset:47936
v_mfma_f32_16x16x32_bf16 a[84:87], a[136:139], a[168:171], a[84:87]
ds_read_b128 v[12:15], v4 offset:256
v_mfma_f32_16x16x32_bf16 a[84:87], a[140:143], a[172:175], a[84:87]
s_waitcnt lgkmcnt(6)
s_lshl_b32 s50, s40, 12
v_mfma_f32_16x16x32_bf16 a[80:83], a[128:131], a[168:171], a[80:83]
v_add_u32 v6, s50, v1
v_mfma_f32_16x16x32_bf16 a[80:83], a[132:135], a[172:175], a[80:83]
v_mfma_f32_16x16x32_bf16 a[32:35], a[176:179], a[128:131], a[32:35]
ds_read_b64_tr_b16 a[160:161], v30 offset:0
v_accvgpr_read_b32 v16, a64
v_accvgpr_read_b32 v17, a65
v_mfma_f32_16x16x32_bf16 a[32:35], a[180:183], a[132:135], a[32:35]
ds_read_b64_tr_b16 a[162:163], v30 offset:768
v_accvgpr_read_b32 v18, a66
v_accvgpr_read_b32 v19, a67
v_mfma_f32_16x16x32_bf16 a[36:39], a[176:179], a[136:139], a[36:39]
ds_read_b64_tr_b16 a[164:165], v30 offset:6144
s_waitcnt lgkmcnt(3)
v_fmac_f32 v16, v8, v28
v_fmac_f32 v17, v9, v28
v_mfma_f32_16x16x32_bf16 a[36:39], a[180:183], a[140:143], a[36:39]
ds_read_b64_tr_b16 a[166:167], v30 offset:6912
v_fmac_f32 v18, v10, v28
v_fmac_f32 v19, v11, v28
v_mfma_f32_16x16x32_bf16 a[40:43], a[176:179], a[144:147], a[40:43]
v_mul_f32 v16, v16, v12
v_mul_f32 v17, v17, v13
v_mul_f32 v18, v18, v14
v_mfma_f32_16x16x32_bf16 a[40:43], a[180:183], a[148:151], a[40:43]
v_mul_f32 v19, v19, v15
v_cvt_pk_bf16_f32 v20, v16, v17
v_cvt_pk_bf16_f32 v21, v18, v19
v_mfma_f32_16x16x32_bf16 a[44:47], a[176:179], a[152:155], a[44:47]
v_accvgpr_read_b32 v16, a80
v_accvgpr_read_b32 v17, a81
v_accvgpr_read_b32 v18, a82
v_mfma_f32_16x16x32_bf16 a[44:47], a[180:183], a[156:159], a[44:47]
v_accvgpr_read_b32 v19, a83
v_mfma_f32_16x16x32_bf16 a[60:63], a[184:187], a[152:155], a[60:63]
ds_read_b64_tr_b16 a[168:169], v31 offset:0
v_fmac_f32 v16, v8, v29
v_fmac_f32 v17, v9, v29
v_mfma_f32_16x16x32_bf16 a[60:63], a[188:191], a[156:159], a[60:63]
ds_read_b64_tr_b16 a[170:171], v31 offset:768
v_fmac_f32 v18, v10, v29
v_fmac_f32 v19, v11, v29
v_mfma_f32_16x16x32_bf16 a[56:59], a[184:187], a[144:147], a[56:59]
ds_read_b64_tr_b16 a[172:173], v31 offset:6144
v_mul_f32 v16, v16, v12
v_mul_f32 v17, v17, v13
v_mfma_f32_16x16x32_bf16 a[56:59], a[188:191], a[148:151], a[56:59]
ds_read_b64_tr_b16 a[174:175], v31 offset:6912
v_mul_f32 v18, v18, v14
v_mul_f32 v19, v19, v15
v_mfma_f32_16x16x32_bf16 a[52:55], a[184:187], a[136:139], a[52:55]
ds_read_b128 v[8:11], v4 offset:64
ds_read_b128 v[12:15], v4 offset:320
v_cvt_pk_bf16_f32 v24, v16, v17
v_mfma_f32_16x16x32_bf16 a[52:55], a[188:191], a[140:143], a[52:55]
v_cvt_pk_bf16_f32 v25, v18, v19
v_accvgpr_read_b32 v16, a68
v_accvgpr_read_b32 v17, a69
v_mfma_f32_16x16x32_bf16 a[48:51], a[184:187], a[128:131], a[48:51]
v_accvgpr_read_b32 v18, a70
v_accvgpr_read_b32 v19, a71
s_waitcnt lgkmcnt(0)
v_fmac_f32 v16, v8, v28
v_mfma_f32_16x16x32_bf16 a[48:51], a[188:191], a[132:135], a[48:51]
v_fmac_f32 v17, v9, v28
v_fmac_f32 v18, v10, v28
v_mfma_f32_16x16x32_bf16 a[0:3], a[160:163], a[96:99], a[0:3]
ds_read_b64_tr_b16 a[176:177], v30 offset:40960
v_fmac_f32 v19, v11, v28
v_mul_f32 v16, v16, v12
v_mfma_f32_16x16x32_bf16 a[0:3], a[164:167], a[100:103], a[0:3]
ds_read_b64_tr_b16 a[178:179], v30 offset:41728
v_mul_f32 v17, v17, v13
v_mul_f32 v18, v18, v14
v_mfma_f32_16x16x32_bf16 a[4:7], a[160:163], a[104:107], a[4:7]
ds_read_b64_tr_b16 a[180:181], v30 offset:47104
v_mul_f32 v19, v19, v15
v_cvt_pk_bf16_f32 v22, v16, v17
v_mfma_f32_16x16x32_bf16 a[4:7], a[164:167], a[108:111], a[4:7]
ds_read_b64_tr_b16 a[182:183], v30 offset:47872
v_cvt_pk_bf16_f32 v23, v18, v19
v_accvgpr_read_b32 v16, a84
v_mfma_f32_16x16x32_bf16 a[8:11], a[160:163], a[112:115], a[8:11]
v_accvgpr_read_b32 v17, a85
v_accvgpr_read_b32 v18, a86
v_accvgpr_read_b32 v19, a87
v_mfma_f32_16x16x32_bf16 a[8:11], a[164:167], a[116:119], a[8:11]
v_fmac_f32 v16, v8, v29
v_fmac_f32 v17, v9, v29
v_fmac_f32 v18, v10, v29
v_mfma_f32_16x16x32_bf16 a[12:15], a[160:163], a[120:123], a[12:15]
v_fmac_f32 v19, v11, v29
v_mul_f32 v16, v16, v12
v_mul_f32 v17, v17, v13
v_mfma_f32_16x16x32_bf16 a[12:15], a[164:167], a[124:127], a[12:15]
v_mul_f32 v18, v18, v14
v_mul_f32 v19, v19, v15
v_mfma_f32_16x16x32_bf16 a[28:31], a[168:171], a[120:123], a[28:31]
ds_read_b64_tr_b16 a[184:185], v31 offset:40960
ds_read_b128 v[8:11], v4 offset:128
ds_read_b128 v[12:15], v4 offset:384
v_mfma_f32_16x16x32_bf16 a[28:31], a[172:175], a[124:127], a[28:31]
ds_read_b64_tr_b16 a[186:187], v31 offset:41728
v_cvt_pk_bf16_f32 v26, v16, v17
v_cvt_pk_bf16_f32 v27, v18, v19
v_mfma_f32_16x16x32_bf16 a[24:27], a[168:171], a[112:115], a[24:27]
ds_read_b64_tr_b16 a[188:189], v31 offset:47104
buffer_store_dwordx4 v[20:23], v1, s[56:59], s61 offen offset:0 sc1
ds_write_b128 v6, v[20:23] offset:49152
v_mfma_f32_16x16x32_bf16 a[24:27], a[172:175], a[116:119], a[24:27]
ds_read_b64_tr_b16 a[190:191], v31 offset:47872
buffer_store_dwordx4 v[24:27], v1, s[56:59], s61 offen offset:1024 sc1
ds_write_b128 v6, v[24:27] offset:50176
v_mfma_f32_16x16x32_bf16 a[20:23], a[168:171], a[104:107], a[20:23]
v_accvgpr_read_b32 v16, a72
v_accvgpr_read_b32 v17, a73
v_accvgpr_read_b32 v18, a74
v_mfma_f32_16x16x32_bf16 a[20:23], a[172:175], a[108:111], a[20:23]
v_accvgpr_read_b32 v19, a75
s_waitcnt lgkmcnt(5)
v_fmac_f32 v16, v8, v28
v_fmac_f32 v17, v9, v28
v_mfma_f32_16x16x32_bf16 a[16:19], a[168:171], a[96:99], a[16:19]
v_fmac_f32 v18, v10, v28
v_fmac_f32 v19, v11, v28
v_mul_f32 v16, v16, v12
v_mfma_f32_16x16x32_bf16 a[16:19], a[172:175], a[100:103], a[16:19]
v_mul_f32 v17, v17, v13
v_mul_f32 v18, v18, v14
v_mul_f32 v19, v19, v15
v_mfma_f32_16x16x32_bf16 a[0:3], a[176:179], a[128:131], a[0:3]
ds_read_b64_tr_b16 a[160:161], v2 offset:0
v_cvt_pk_bf16_f32 v20, v16, v17
v_cvt_pk_bf16_f32 v21, v18, v19
v_mfma_f32_16x16x32_bf16 a[0:3], a[180:183], a[132:135], a[0:3]
ds_read_b64_tr_b16 a[162:163], v2 offset:1792
v_accvgpr_read_b32 v16, a88
v_accvgpr_read_b32 v17, a89
v_mfma_f32_16x16x32_bf16 a[4:7], a[176:179], a[136:139], a[4:7]
ds_read_b64_tr_b16 a[164:165], v2 offset:7168
v_accvgpr_read_b32 v18, a90
v_accvgpr_read_b32 v19, a91
v_mfma_f32_16x16x32_bf16 a[4:7], a[180:183], a[140:143], a[4:7]
ds_read_b64_tr_b16 a[166:167], v2 offset:8960
v_fmac_f32 v16, v8, v29
v_fmac_f32 v17, v9, v29
v_mfma_f32_16x16x32_bf16 a[8:11], a[176:179], a[144:147], a[8:11]
v_fmac_f32 v18, v10, v29
v_fmac_f32 v19, v11, v29
v_mul_f32 v16, v16, v12
v_mfma_f32_16x16x32_bf16 a[8:11], a[180:183], a[148:151], a[8:11]
v_mul_f32 v17, v17, v13
v_mul_f32 v18, v18, v14
v_mul_f32 v19, v19, v15
v_mfma_f32_16x16x32_bf16 a[12:15], a[176:179], a[152:155], a[12:15]
ds_read_b128 v[8:11], v4 offset:192
ds_read_b128 v[12:15], v4 offset:448
v_cvt_pk_bf16_f32 v24, v16, v17
v_mfma_f32_16x16x32_bf16 a[12:15], a[180:183], a[156:159], a[12:15]
v_cvt_pk_bf16_f32 v25, v18, v19
v_accvgpr_read_b32 v16, a76
s_waitcnt lgkmcnt(7)
v_mfma_f32_16x16x32_bf16 a[28:31], a[184:187], a[152:155], a[28:31]
ds_read_b64_tr_b16 a[168:169], v2 offset:32
v_accvgpr_read_b32 v17, a77
v_accvgpr_read_b32 v18, a78
v_mfma_f32_16x16x32_bf16 a[28:31], a[188:191], a[156:159], a[28:31]
ds_read_b64_tr_b16 a[170:171], v2 offset:1824
v_accvgpr_read_b32 v19, a79
s_waitcnt lgkmcnt(2)
v_fmac_f32 v16, v8, v28
v_mfma_f32_16x16x32_bf16 a[24:27], a[184:187], a[144:147], a[24:27]
ds_read_b64_tr_b16 a[172:173], v2 offset:7200
v_fmac_f32 v17, v9, v28
v_fmac_f32 v18, v10, v28
v_mfma_f32_16x16x32_bf16 a[24:27], a[188:191], a[148:151], a[24:27]
ds_read_b64_tr_b16 a[174:175], v2 offset:8992
v_fmac_f32 v19, v11, v28
v_mul_f32 v16, v16, v12
v_mfma_f32_16x16x32_bf16 a[20:23], a[184:187], a[136:139], a[20:23]
v_mul_f32 v17, v17, v13
v_mul_f32 v18, v18, v14
v_mul_f32 v19, v19, v15
v_mfma_f32_16x16x32_bf16 a[20:23], a[188:191], a[140:143], a[20:23]
v_cvt_pk_bf16_f32 v22, v16, v17
v_cvt_pk_bf16_f32 v23, v18, v19
v_accvgpr_read_b32 v16, a92
v_mfma_f32_16x16x32_bf16 a[16:19], a[184:187], a[128:131], a[16:19]
v_accvgpr_read_b32 v17, a93
v_accvgpr_read_b32 v18, a94
v_accvgpr_read_b32 v19, a95
v_mfma_f32_16x16x32_bf16 a[16:19], a[188:191], a[132:135], a[16:19]
v_fmac_f32 v16, v8, v29
v_mfma_f32_16x16x32_bf16 v[32:35], a[160:163], a[96:99], v[32:35]
ds_read_b64_tr_b16 a[176:177], v2 offset:64
v_fmac_f32 v17, v9, v29
v_fmac_f32 v18, v10, v29
v_fmac_f32 v19, v11, v29
v_mfma_f32_16x16x32_bf16 v[32:35], a[164:167], a[100:103], v[32:35]
ds_read_b64_tr_b16 a[178:179], v2 offset:1856
v_mul_f32 v16, v16, v12
v_mul_f32 v17, v17, v13
v_mul_f32 v18, v18, v14
v_mfma_f32_16x16x32_bf16 v[36:39], a[160:163], a[104:107], v[36:39]
ds_read_b64_tr_b16 a[180:181], v2 offset:7232
v_mul_f32 v19, v19, v15
ds_read_b32 v8, v3 offset:0
ds_read_b32 v9, v3 offset:256
v_mfma_f32_16x16x32_bf16 v[36:39], a[164:167], a[108:111], v[36:39]
ds_read_b64_tr_b16 a[182:183], v2 offset:9024
ds_read_b32 v10, v3 offset:64
ds_read_b32 v11, v3 offset:320
ds_read_b32 v12, v3 offset:128
v_mfma_f32_16x16x32_bf16 v[40:43], a[160:163], a[112:115], v[40:43]
ds_read_b32 v13, v3 offset:384
ds_read_b32 v14, v3 offset:192
ds_read_b32 v15, v3 offset:448
v_cvt_pk_bf16_f32 v26, v16, v17
v_mfma_f32_16x16x32_bf16 v[40:43], a[164:167], a[116:119], v[40:43]
v_cvt_pk_bf16_f32 v27, v18, v19
buffer_store_dwordx4 v[20:23], v1, s[56:59], s61 offen offset:2048 sc1
ds_write_b128 v6, v[20:23] offset:51200
buffer_store_dwordx4 v[24:27], v1, s[56:59], s61 offen offset:3072 sc1
v_mfma_f32_16x16x32_bf16 v[44:47], a[160:163], a[120:123], v[44:47]
ds_write_b128 v6, v[24:27] offset:52224
v_mfma_f32_16x16x32_bf16 v[44:47], a[164:167], a[124:127], v[44:47]
s_waitcnt lgkmcnt(14)
v_mfma_f32_16x16x32_bf16 v[60:63], a[168:171], a[120:123], v[60:63]
ds_read_b64_tr_b16 a[184:185], v2 offset:96
ds_read_b128 v[16:19], v5 offset:128
ds_read_b128 v[20:23], v5 offset:192
v_mfma_f32_16x16x32_bf16 v[60:63], a[172:175], a[124:127], v[60:63]
ds_read_b64_tr_b16 a[186:187], v2 offset:1888
v_accvgpr_read_b32 v24, a32
v_accvgpr_read_b32 v25, a33
v_mfma_f32_16x16x32_bf16 v[56:59], a[168:171], a[112:115], v[56:59]
ds_read_b64_tr_b16 a[188:189], v2 offset:7264
v_accvgpr_read_b32 v26, a34
v_accvgpr_read_b32 v27, a35
v_mfma_f32_16x16x32_bf16 v[56:59], a[172:175], a[116:119], v[56:59]
ds_read_b64_tr_b16 a[190:191], v2 offset:9056
v_accvgpr_read_b32 v28, a48
v_accvgpr_read_b32 v29, a49
v_mfma_f32_16x16x32_bf16 v[52:55], a[168:171], a[104:107], v[52:55]
v_accvgpr_read_b32 v30, a50
v_accvgpr_read_b32 v31, a51
s_waitcnt lgkmcnt(3)
v_fmac_f32 v24, v16, v8
v_mfma_f32_16x16x32_bf16 v[52:55], a[172:175], a[108:111], v[52:55]
v_fmac_f32 v25, v17, v8
v_fmac_f32 v26, v18, v8
v_fmac_f32 v27, v19, v8
v_mfma_f32_16x16x32_bf16 v[48:51], a[168:171], a[96:99], v[48:51]
v_fmac_f32 v28, v20, v8
v_fmac_f32 v29, v21, v8
v_fmac_f32 v30, v22, v8
v_mfma_f32_16x16x32_bf16 v[48:51], a[172:175], a[100:103], v[48:51]
v_fmac_f32 v31, v23, v8
v_mul_f32 v24, v24, v9
v_mul_f32 v25, v25, v9
v_mfma_f32_16x16x32_bf16 v[64:67], a[176:179], a[96:99], v[64:67]
ds_read_b64_tr_b16 a[160:161], v2 offset:128
v_mul_f32 v26, v26, v9
v_mul_f32 v27, v27, v9
v_mfma_f32_16x16x32_bf16 v[64:67], a[180:183], a[100:103], v[64:67]
ds_read_b64_tr_b16 a[162:163], v2 offset:1920
v_mul_f32 v28, v28, v9
v_mul_f32 v29, v29, v9
v_mfma_f32_16x16x32_bf16 v[68:71], a[176:179], a[104:107], v[68:71]
ds_read_b64_tr_b16 a[164:165], v2 offset:7296
v_mul_f32 v30, v30, v9
v_mul_f32 v31, v31, v9
v_mfma_f32_16x16x32_bf16 v[68:71], a[180:183], a[108:111], v[68:71]
ds_read_b64_tr_b16 a[166:167], v2 offset:9088
v_cvt_pk_bf16_f32 v24, v24, v25
v_cvt_pk_bf16_f32 v25, v26, v27
v_mfma_f32_16x16x32_bf16 v[72:75], a[176:179], a[112:115], v[72:75]
v_cvt_pk_bf16_f32 v26, v28, v29
v_cvt_pk_bf16_f32 v27, v30, v31
buffer_store_dwordx4 v[24:27], v1, s[56:59], s60 offen offset:0 sc1
v_mfma_f32_16x16x32_bf16 v[72:75], a[180:183], a[116:119], v[72:75]
ds_write_b128 v6, v[24:27] offset:16384
v_accvgpr_read_b32 v24, a36
v_accvgpr_read_b32 v25, a37
v_mfma_f32_16x16x32_bf16 v[76:79], a[176:179], a[120:123], v[76:79]
v_accvgpr_read_b32 v26, a38
v_accvgpr_read_b32 v27, a39
v_accvgpr_read_b32 v28, a52
v_mfma_f32_16x16x32_bf16 v[76:79], a[180:183], a[124:127], v[76:79]
v_accvgpr_read_b32 v29, a53
v_accvgpr_read_b32 v30, a54
v_accvgpr_read_b32 v31, a55
s_waitcnt lgkmcnt(5)
v_mfma_f32_16x16x32_bf16 v[92:95], a[184:187], a[120:123], v[92:95]
ds_read_b64_tr_b16 a[168:169], v2 offset:160
v_fmac_f32 v24, v16, v10
v_fmac_f32 v25, v17, v10
v_fmac_f32 v26, v18, v10
v_mfma_f32_16x16x32_bf16 v[92:95], a[188:191], a[124:127], v[92:95]
ds_read_b64_tr_b16 a[170:171], v2 offset:1952
v_fmac_f32 v27, v19, v10
v_fmac_f32 v28, v20, v10
v_fmac_f32 v29, v21, v10
v_mfma_f32_16x16x32_bf16 v[88:91], a[184:187], a[112:115], v[88:91]
ds_read_b64_tr_b16 a[172:173], v2 offset:7328
v_fmac_f32 v30, v22, v10
v_fmac_f32 v31, v23, v10
v_mul_f32 v24, v24, v11
v_mfma_f32_16x16x32_bf16 v[88:91], a[188:191], a[116:119], v[88:91]
ds_read_b64_tr_b16 a[174:175], v2 offset:9120
v_mul_f32 v25, v25, v11
v_mul_f32 v26, v26, v11
v_mul_f32 v27, v27, v11
v_mfma_f32_16x16x32_bf16 v[84:87], a[184:187], a[104:107], v[84:87]
v_mul_f32 v28, v28, v11
v_mul_f32 v29, v29, v11
v_mul_f32 v30, v30, v11
v_mul_f32 v31, v31, v11
v_mfma_f32_16x16x32_bf16 v[84:87], a[188:191], a[108:111], v[84:87]
v_cvt_pk_bf16_f32 v24, v24, v25
v_cvt_pk_bf16_f32 v25, v26, v27
v_cvt_pk_bf16_f32 v26, v28, v29
v_cvt_pk_bf16_f32 v27, v30, v31
v_mfma_f32_16x16x32_bf16 v[80:83], a[184:187], a[96:99], v[80:83]
buffer_store_dwordx4 v[24:27], v1, s[56:59], s60 offen offset:1024 sc1
v_mfma_f32_16x16x32_bf16 v[80:83], a[188:191], a[100:103], v[80:83]
s_waitcnt lgkmcnt(5)
v_mfma_f32_16x16x32_bf16 v[96:99], a[160:163], a[96:99], v[96:99]
ds_read_b64_tr_b16 a[176:177], v2 offset:192
ds_write_b128 v6, v[24:27] offset:17408
v_accvgpr_read_b32 v24, a40
v_mfma_f32_16x16x32_bf16 v[96:99], a[164:167], a[100:103], v[96:99]
ds_read_b64_tr_b16 a[178:179], v2 offset:1984
v_accvgpr_read_b32 v25, a41
v_accvgpr_read_b32 v26, a42
v_mfma_f32_16x16x32_bf16 v[100:103], a[160:163], a[104:107], v[100:103]
ds_read_b64_tr_b16 a[180:181], v2 offset:7360
v_accvgpr_read_b32 v27, a43
v_accvgpr_read_b32 v28, a56
v_mfma_f32_16x16x32_bf16 v[100:103], a[164:167], a[108:111], v[100:103]
ds_read_b64_tr_b16 a[182:183], v2 offset:9152
v_accvgpr_read_b32 v29, a57
v_accvgpr_read_b32 v30, a58
v_mfma_f32_16x16x32_bf16 v[104:107], a[160:163], a[112:115], v[104:107]
v_accvgpr_read_b32 v31, a59
v_fmac_f32 v24, v16, v12
v_fmac_f32 v25, v17, v12
v_mfma_f32_16x16x32_bf16 v[104:107], a[164:167], a[116:119], v[104:107]
v_fmac_f32 v26, v18, v12
v_fmac_f32 v27, v19, v12
v_fmac_f32 v28, v20, v12
v_mfma_f32_16x16x32_bf16 v[108:111], a[160:163], a[120:123], v[108:111]
v_fmac_f32 v29, v21, v12
v_fmac_f32 v30, v22, v12
v_fmac_f32 v31, v23, v12
v_mfma_f32_16x16x32_bf16 v[108:111], a[164:167], a[124:127], v[108:111]
v_mul_f32 v24, v24, v13
v_mul_f32 v25, v25, v13
v_mul_f32 v26, v26, v13
s_waitcnt lgkmcnt(5)
v_mfma_f32_16x16x32_bf16 v[124:127], a[168:171], a[120:123], v[124:127]
ds_read_b64_tr_b16 a[184:185], v2 offset:14336
v_mul_f32 v27, v27, v13
v_mul_f32 v28, v28, v13
v_mfma_f32_16x16x32_bf16 v[124:127], a[172:175], a[124:127], v[124:127]
ds_read_b64_tr_b16 a[186:187], v2 offset:16128
v_mul_f32 v29, v29, v13
v_mul_f32 v30, v30, v13
v_mfma_f32_16x16x32_bf16 v[120:123], a[168:171], a[112:115], v[120:123]
ds_read_b64_tr_b16 a[188:189], v2 offset:21504
v_mul_f32 v31, v31, v13
v_cvt_pk_bf16_f32 v24, v24, v25
v_mfma_f32_16x16x32_bf16 v[120:123], a[172:175], a[116:119], v[120:123]
ds_read_b64_tr_b16 a[190:191], v2 offset:23296
v_cvt_pk_bf16_f32 v25, v26, v27
v_cvt_pk_bf16_f32 v26, v28, v29
v_mfma_f32_16x16x32_bf16 v[116:119], a[168:171], a[104:107], v[116:119]
v_cvt_pk_bf16_f32 v27, v30, v31
buffer_store_dwordx4 v[24:27], v1, s[56:59], s60 offen offset:2048 sc1
ds_write_b128 v6, v[24:27] offset:18432
v_mfma_f32_16x16x32_bf16 v[116:119], a[172:175], a[108:111], v[116:119]
v_accvgpr_read_b32 v24, a44
v_accvgpr_read_b32 v25, a45
v_accvgpr_read_b32 v26, a46
v_mfma_f32_16x16x32_bf16 v[112:115], a[168:171], a[96:99], v[112:115]
v_accvgpr_read_b32 v27, a47
v_accvgpr_read_b32 v28, a60
v_accvgpr_read_b32 v29, a61
v_mfma_f32_16x16x32_bf16 v[112:115], a[172:175], a[100:103], v[112:115]
v_accvgpr_read_b32 v30, a62
v_accvgpr_read_b32 v31, a63
v_fmac_f32 v24, v16, v14
s_waitcnt lgkmcnt(5)
v_mfma_f32_16x16x32_bf16 v[128:131], a[176:179], a[96:99], v[128:131]
ds_read_b64_tr_b16 a[160:161], v2 offset:14368
v_fmac_f32 v25, v17, v14
v_fmac_f32 v26, v18, v14
v_fmac_f32 v27, v19, v14
v_mfma_f32_16x16x32_bf16 v[128:131], a[180:183], a[100:103], v[128:131]
ds_read_b64_tr_b16 a[162:163], v2 offset:16160
v_fmac_f32 v28, v20, v14
v_fmac_f32 v29, v21, v14
v_fmac_f32 v30, v22, v14
v_mfma_f32_16x16x32_bf16 v[132:135], a[176:179], a[104:107], v[132:135]
ds_read_b64_tr_b16 a[164:165], v2 offset:21536
v_fmac_f32 v31, v23, v14
v_mul_f32 v24, v24, v15
v_mul_f32 v25, v25, v15
v_mfma_f32_16x16x32_bf16 v[132:135], a[180:183], a[108:111], v[132:135]
ds_read_b64_tr_b16 a[166:167], v2 offset:23328
v_mul_f32 v26, v26, v15
v_mul_f32 v27, v27, v15
v_mul_f32 v28, v28, v15
v_mfma_f32_16x16x32_bf16 v[136:139], a[176:179], a[112:115], v[136:139]
v_mul_f32 v29, v29, v15
v_mul_f32 v30, v30, v15
v_mul_f32 v31, v31, v15
v_cvt_pk_bf16_f32 v24, v24, v25
v_mfma_f32_16x16x32_bf16 v[136:139], a[180:183], a[116:119], v[136:139]
v_cvt_pk_bf16_f32 v25, v26, v27
v_cvt_pk_bf16_f32 v26, v28, v29
v_cvt_pk_bf16_f32 v27, v30, v31
buffer_store_dwordx4 v[24:27], v1, s[56:59], s60 offen offset:3072 sc1
v_mfma_f32_16x16x32_bf16 v[140:143], a[176:179], a[120:123], v[140:143]
ds_write_b128 v6, v[24:27] offset:19456
v_mfma_f32_16x16x32_bf16 v[140:143], a[180:183], a[124:127], v[140:143]
s_waitcnt lgkmcnt(6)
v_mfma_f32_16x16x32_bf16 v[156:159], a[184:187], a[120:123], v[156:159]
ds_read_b64_tr_b16 a[168:169], v2 offset:14400
v_mul_f32 v9, 0x3e8293ee, v9
v_mul_f32 v11, 0x3e8293ee, v11
v_mfma_f32_16x16x32_bf16 v[156:159], a[188:191], a[124:127], v[156:159]
ds_read_b64_tr_b16 a[170:171], v2 offset:16192
v_mul_f32 v13, 0x3e8293ee, v13
v_mul_f32 v15, 0x3e8293ee, v15
v_mfma_f32_16x16x32_bf16 v[152:155], a[184:187], a[112:115], v[152:155]
ds_read_b64_tr_b16 a[172:173], v2 offset:21568
ds_read_b128 v[16:19], v5 offset:0
ds_read_b128 v[20:23], v5 offset:64
v_mfma_f32_16x16x32_bf16 v[152:155], a[188:191], a[116:119], v[152:155]
ds_read_b64_tr_b16 a[174:175], v2 offset:23360
v_accvgpr_read_b32 v24, a0
v_accvgpr_read_b32 v25, a1
v_mfma_f32_16x16x32_bf16 v[148:151], a[184:187], a[104:107], v[148:151]
v_accvgpr_read_b32 v26, a2
v_accvgpr_read_b32 v27, a3
v_accvgpr_read_b32 v28, a16
v_mfma_f32_16x16x32_bf16 v[148:151], a[188:191], a[108:111], v[148:151]
v_accvgpr_read_b32 v29, a17
v_accvgpr_read_b32 v30, a18
v_accvgpr_read_b32 v31, a19
v_mfma_f32_16x16x32_bf16 v[144:147], a[184:187], a[96:99], v[144:147]
s_waitcnt lgkmcnt(1)
v_fmac_f32 v24, v16, v8
v_fmac_f32 v25, v17, v8
v_fmac_f32 v26, v18, v8
v_mfma_f32_16x16x32_bf16 v[144:147], a[188:191], a[100:103], v[144:147]
v_mfma_f32_16x16x32_bf16 v[160:163], a[160:163], a[96:99], v[160:163]
ds_read_b64_tr_b16 a[176:177], v2 offset:14432
v_fmac_f32 v27, v19, v8
v_fmac_f32 v28, v20, v8
v_mfma_f32_16x16x32_bf16 v[160:163], a[164:167], a[100:103], v[160:163]
ds_read_b64_tr_b16 a[178:179], v2 offset:16224
v_fmac_f32 v29, v21, v8
v_fmac_f32 v30, v22, v8
v_mfma_f32_16x16x32_bf16 v[164:167], a[160:163], a[104:107], v[164:167]
ds_read_b64_tr_b16 a[180:181], v2 offset:21600
v_fmac_f32 v31, v23, v8
v_mul_f32 v24, v24, v9
v_mfma_f32_16x16x32_bf16 v[164:167], a[164:167], a[108:111], v[164:167]
ds_read_b64_tr_b16 a[182:183], v2 offset:23392
v_mul_f32 v25, v25, v9
v_mul_f32 v26, v26, v9
v_mfma_f32_16x16x32_bf16 v[168:171], a[160:163], a[112:115], v[168:171]
v_mul_f32 v27, v27, v9
v_mul_f32 v28, v28, v9
v_mul_f32 v29, v29, v9
v_mfma_f32_16x16x32_bf16 v[168:171], a[164:167], a[116:119], v[168:171]
v_mul_f32 v30, v30, v9
v_mul_f32 v31, v31, v9
v_cvt_pk_bf16_f32 v24, v24, v25
v_mfma_f32_16x16x32_bf16 v[172:175], a[160:163], a[120:123], v[172:175]
v_cvt_pk_bf16_f32 v25, v26, v27
v_cvt_pk_bf16_f32 v26, v28, v29
v_cvt_pk_bf16_f32 v27, v30, v31
v_mfma_f32_16x16x32_bf16 v[172:175], a[164:167], a[124:127], v[172:175]
v_accvgpr_write_b32 a224, v24
v_accvgpr_write_b32 a225, v25
v_accvgpr_write_b32 a226, v26
s_waitcnt lgkmcnt(4)
v_mfma_f32_16x16x32_bf16 v[188:191], a[168:171], a[120:123], v[188:191]
ds_read_b64_tr_b16 a[184:185], v2 offset:14464
v_accvgpr_write_b32 a227, v27
v_accvgpr_read_b32 v24, a4
v_accvgpr_read_b32 v25, a5
v_mfma_f32_16x16x32_bf16 v[188:191], a[172:175], a[124:127], v[188:191]
ds_read_b64_tr_b16 a[186:187], v2 offset:16256
v_accvgpr_read_b32 v26, a6
v_accvgpr_read_b32 v27, a7
v_accvgpr_read_b32 v28, a20
v_mfma_f32_16x16x32_bf16 v[184:187], a[168:171], a[112:115], v[184:187]
ds_read_b64_tr_b16 a[188:189], v2 offset:21632
v_accvgpr_read_b32 v29, a21
v_accvgpr_read_b32 v30, a22
v_accvgpr_read_b32 v31, a23
v_mfma_f32_16x16x32_bf16 v[184:187], a[172:175], a[116:119], v[184:187]
ds_read_b64_tr_b16 a[190:191], v2 offset:23424
v_fmac_f32 v24, v16, v10
v_fmac_f32 v25, v17, v10
v_fmac_f32 v26, v18, v10
v_mfma_f32_16x16x32_bf16 v[180:183], a[168:171], a[104:107], v[180:183]
v_fmac_f32 v27, v19, v10
v_fmac_f32 v28, v20, v10
v_fmac_f32 v29, v21, v10
v_fmac_f32 v30, v22, v10
v_mfma_f32_16x16x32_bf16 v[180:183], a[172:175], a[108:111], v[180:183]
v_fmac_f32 v31, v23, v10
v_mul_f32 v24, v24, v11
v_mul_f32 v25, v25, v11
v_cmp_eq_u32 vcc, 0, v0
v_mfma_f32_16x16x32_bf16 v[176:179], a[168:171], a[96:99], v[176:179]
v_bfrev_b32 v4, 1
v_cndmask_b32_e64 v4, v4, 0, vcc
v_accvgpr_write_b32 a241, 1
s_waitcnt vmcnt(0)
buffer_store_dword a241, v4, s[36:39], s63 offen sc1
v_mfma_f32_16x16x32_bf16 v[176:179], a[172:175], a[100:103], v[176:179]
s_waitcnt lgkmcnt(4)
v_mfma_f32_16x16x32_bf16 v[192:195], a[176:179], a[96:99], v[192:195]
ds_read_b64_tr_b16 a[160:161], v2 offset:14496
v_mul_f32 v26, v26, v11
v_mul_f32 v27, v27, v11
v_mfma_f32_16x16x32_bf16 v[192:195], a[180:183], a[100:103], v[192:195]
ds_read_b64_tr_b16 a[162:163], v2 offset:16288
v_mul_f32 v28, v28, v11
v_mul_f32 v29, v29, v11
v_mfma_f32_16x16x32_bf16 v[196:199], a[176:179], a[104:107], v[196:199]
ds_read_b64_tr_b16 a[164:165], v2 offset:21664
v_mul_f32 v30, v30, v11
v_mul_f32 v31, v31, v11
v_mfma_f32_16x16x32_bf16 v[196:199], a[180:183], a[108:111], v[196:199]
ds_read_b64_tr_b16 a[166:167], v2 offset:23456
v_cvt_pk_bf16_f32 v24, v24, v25
v_cvt_pk_bf16_f32 v25, v26, v27
v_mfma_f32_16x16x32_bf16 v[200:203], a[176:179], a[112:115], v[200:203]
v_cvt_pk_bf16_f32 v26, v28, v29
v_cvt_pk_bf16_f32 v27, v30, v31
v_accvgpr_write_b32 a228, v24
v_mfma_f32_16x16x32_bf16 v[200:203], a[180:183], a[116:119], v[200:203]
v_accvgpr_write_b32 a229, v25
v_accvgpr_write_b32 a230, v26
v_accvgpr_write_b32 a231, v27
v_mfma_f32_16x16x32_bf16 v[204:207], a[176:179], a[120:123], v[204:207]
v_accvgpr_read_b32 v24, a8
v_accvgpr_read_b32 v25, a9
v_accvgpr_read_b32 v26, a10
v_mfma_f32_16x16x32_bf16 v[204:207], a[180:183], a[124:127], v[204:207]
v_accvgpr_read_b32 v27, a11
v_accvgpr_read_b32 v28, a24
v_accvgpr_read_b32 v29, a25
s_waitcnt lgkmcnt(4)
v_mfma_f32_16x16x32_bf16 v[220:223], a[184:187], a[120:123], v[220:223]
ds_read_b64_tr_b16 a[168:169], v2 offset:14528
v_accvgpr_read_b32 v30, a26
v_accvgpr_read_b32 v31, a27
v_fmac_f32 v24, v16, v12
v_mfma_f32_16x16x32_bf16 v[220:223], a[188:191], a[124:127], v[220:223]
ds_read_b64_tr_b16 a[170:171], v2 offset:16320
v_fmac_f32 v25, v17, v12
v_fmac_f32 v26, v18, v12
v_fmac_f32 v27, v19, v12
v_mfma_f32_16x16x32_bf16 v[216:219], a[184:187], a[112:115], v[216:219]
ds_read_b64_tr_b16 a[172:173], v2 offset:21696
v_fmac_f32 v28, v20, v12
v_fmac_f32 v29, v21, v12
v_fmac_f32 v30, v22, v12
v_mfma_f32_16x16x32_bf16 v[216:219], a[188:191], a[116:119], v[216:219]
ds_read_b64_tr_b16 a[174:175], v2 offset:23488
v_fmac_f32 v31, v23, v12
v_mul_f32 v24, v24, v13
v_mul_f32 v25, v25, v13
v_mfma_f32_16x16x32_bf16 v[212:215], a[184:187], a[104:107], v[212:215]
v_mul_f32 v26, v26, v13
v_mul_f32 v27, v27, v13
v_mul_f32 v28, v28, v13
v_mul_f32 v29, v29, v13
v_mfma_f32_16x16x32_bf16 v[212:215], a[188:191], a[108:111], v[212:215]
v_mul_f32 v30, v30, v13
v_mul_f32 v31, v31, v13
v_cvt_pk_bf16_f32 v24, v24, v25
s_sub_u32 s52, s63, 16384
v_mfma_f32_16x16x32_bf16 v[208:211], a[184:187], a[96:99], v[208:211]
s_cmp_eq_u32 s41, 0
s_cselect_b32 s52, s63, s52
v_mov_b32 v3, 0
buffer_load_dword v4, v3, s[36:39], s52 offen sc1
v_mfma_f32_16x16x32_bf16 v[208:211], a[188:191], a[100:103], v[208:211]
s_waitcnt lgkmcnt(0)
s_barrier
v_mfma_f32_16x16x32_bf16 v[224:227], a[160:163], a[96:99], v[224:227]
ds_read_b64_tr_b16 a[176:177], v2 offset:40960
v_cvt_pk_bf16_f32 v25, v26, v27
v_cvt_pk_bf16_f32 v26, v28, v29
v_cvt_pk_bf16_f32 v27, v30, v31
v_mfma_f32_16x16x32_bf16 v[224:227], a[164:167], a[100:103], v[224:227]
ds_read_b64_tr_b16 a[178:179], v2 offset:42752
v_accvgpr_write_b32 a232, v24
v_accvgpr_write_b32 a233, v25
v_accvgpr_write_b32 a234, v26
v_mfma_f32_16x16x32_bf16 v[228:231], a[160:163], a[104:107], v[228:231]
ds_read_b64_tr_b16 a[180:181], v2 offset:48128
v_accvgpr_write_b32 a235, v27
v_accvgpr_read_b32 v24, a12
v_accvgpr_read_b32 v25, a13
v_mfma_f32_16x16x32_bf16 v[228:231], a[164:167], a[108:111], v[228:231]
ds_read_b64_tr_b16 a[182:183], v2 offset:49920
v_accvgpr_read_b32 v26, a14
v_accvgpr_read_b32 v27, a15
v_accvgpr_read_b32 v28, a28
v_mfma_f32_16x16x32_bf16 v[232:235], a[160:163], a[112:115], v[232:235]
v_accvgpr_read_b32 v29, a29
v_accvgpr_read_b32 v30, a30
v_accvgpr_read_b32 v31, a31
v_fmac_f32 v24, v16, v14
v_mfma_f32_16x16x32_bf16 v[232:235], a[164:167], a[116:119], v[232:235]
v_fmac_f32 v25, v17, v14
v_fmac_f32 v26, v18, v14
v_fmac_f32 v27, v19, v14
s_add_u32 m0, s85, 65536
v_mfma_f32_16x16x32_bf16 v[236:239], a[160:163], a[120:123], v[236:239]
buffer_load_dwordx4 v7, s[28:31], s84 offen offset:0 lds
s_add_u32 s84, s84, 15360
buffer_load_dwordx4 v7, s[28:31], s84 offen offset:1024 lds
s_add_u32 s84, s84, 15360
v_mfma_f32_16x16x32_bf16 v[236:239], a[164:167], a[124:127], v[236:239]
buffer_load_dwordx4 v7, s[28:31], s84 offen offset:2048 lds
s_add_u32 s84, s84, 15360
buffer_load_dwordx4 v7, s[28:31], s84 offen offset:3072 lds
s_add_u32 s84, s84, 19456
v_mfma_f32_16x16x32_bf16 v[252:255], a[168:171], a[120:123], v[252:255]
ds_read_b64_tr_b16 a[184:185], v2 offset:55296
v_fmac_f32 v28, v20, v14
v_fmac_f32 v29, v21, v14
v_fmac_f32 v30, v22, v14
v_fmac_f32 v31, v23, v14
v_mfma_f32_16x16x32_bf16 v[252:255], a[172:175], a[124:127], v[252:255]
ds_read_b64_tr_b16 a[186:187], v2 offset:57088
v_mul_f32 v24, v24, v15
v_mul_f32 v25, v25, v15
v_mul_f32 v26, v26, v15
v_mul_f32 v27, v27, v15
v_mfma_f32_16x16x32_bf16 v[248:251], a[168:171], a[112:115], v[248:251]
ds_read_b64_tr_b16 a[188:189], v2 offset:62464
v_mul_f32 v28, v28, v15
v_mul_f32 v29, v29, v15
v_mul_f32 v30, v30, v15
v_mul_f32 v31, v31, v15
v_mfma_f32_16x16x32_bf16 v[248:251], a[172:175], a[116:119], v[248:251]
ds_read_b64_tr_b16 a[190:191], v2 offset:64256
v_cvt_pk_bf16_f32 v24, v24, v25
v_cvt_pk_bf16_f32 v25, v26, v27
v_cvt_pk_bf16_f32 v26, v28, v29
v_cvt_pk_bf16_f32 v27, v30, v31
v_mfma_f32_16x16x32_bf16 v[244:247], a[168:171], a[104:107], v[244:247]
v_accvgpr_write_b32 a236, v24
v_accvgpr_write_b32 a237, v25
v_accvgpr_write_b32 a238, v26
v_accvgpr_write_b32 a239, v27
s_add_u32 m0, s85, 69632
v_mfma_f32_16x16x32_bf16 v[244:247], a[172:175], a[108:111], v[244:247]
buffer_load_dwordx4 v7, s[28:31], s84 offen offset:0 lds
s_add_u32 s84, s84, 15360
buffer_load_dwordx4 v7, s[28:31], s84 offen offset:1024 lds
s_add_u32 s84, s84, 15360
buffer_load_dwordx4 v7, s[28:31], s84 offen offset:2048 lds
v_mfma_f32_16x16x32_bf16 v[240:243], a[168:171], a[96:99], v[240:243]
s_add_u32 s84, s84, 15360
buffer_load_dwordx4 v7, s[28:31], s84 offen offset:3072 lds
s_add_u32 s84, s84, 19456
v_mfma_f32_16x16x32_bf16 v[240:243], a[172:175], a[100:103], v[240:243]
s_waitcnt lgkmcnt(4)
v_mfma_f32_16x16x32_bf16 v[32:35], a[176:179], a[128:131], v[32:35]
ds_read_b64_tr_b16 a[160:161], v2 offset:40992
s_waitcnt vmcnt(8)
v_cmp_ne_u32 vcc, 1, v4
s_cbranch_vccnz L_pl2_slow
L_pl2_ok:
v_accvgpr_read_b32 v4, a240
v_mfma_f32_16x16x32_bf16 v[32:35], a[180:183], a[132:135], v[32:35]
ds_read_b64_tr_b16 a[162:163], v2 offset:42784
s_sub_u32 s60, s60, 16384
s_sub_u32 s61, s61, 16384
v_mfma_f32_16x16x32_bf16 v[36:39], a[176:179], a[136:139], v[36:39]
ds_read_b64_tr_b16 a[164:165], v2 offset:48160
s_cmp_eq_u32 s41, 0
s_cselect_b64 vcc, -1, 0
v_bfrev_b32 v3, 1
v_mfma_f32_16x16x32_bf16 v[36:39], a[180:183], a[140:143], v[36:39]
ds_read_b64_tr_b16 a[166:167], v2 offset:49952
v_cndmask_b32 v3, v1, v3, vcc
s_lshl_b32 s51, s40, 12
v_mfma_f32_16x16x32_bf16 v[40:43], a[176:179], a[144:147], v[40:43]
ds_read_b128 v[24:27], v5 offset:384
ds_read_b128 v[28:31], v5 offset:832
v_mul_f32 v16, 0xc0b504f3, v9
v_mfma_f32_16x16x32_bf16 v[40:43], a[180:183], a[148:151], v[40:43]
v_mul_f32 v17, 0x407af233, v9
v_mul_f32 v17, v17, v17
v_rcp_f32 v17, v17
v_mfma_f32_16x16x32_bf16 v[44:47], a[176:179], a[152:155], v[44:47]
v_mul_f32 v18, 0xc0b504f3, v11
v_mul_f32 v19, 0x407af233, v11
v_mul_f32 v19, v19, v19
v_mfma_f32_16x16x32_bf16 v[44:47], a[180:183], a[156:159], v[44:47]
s_waitcnt lgkmcnt(6)
v_mfma_f32_16x16x32_bf16 v[156:159], a[184:187], a[152:155], v[156:159]
ds_read_b64_tr_b16 a[168:169], v2 offset:55328
s_add_u32 m0, s51, 0
s_nop 0
buffer_load_dwordx4 v3, s[36:39], s60 offen offset:0 sc1 lds
v_mfma_f32_16x16x32_bf16 v[156:159], a[188:191], a[156:159], v[156:159]
ds_read_b64_tr_b16 a[170:171], v2 offset:57120
buffer_load_dwordx4 v3, s[36:39], s60 offen offset:1024 sc1 lds
buffer_load_dwordx4 v3, s[36:39], s60 offen offset:2048 sc1 lds
v_mfma_f32_16x16x32_bf16 v[152:155], a[184:187], a[144:147], v[152:155]
ds_read_b64_tr_b16 a[172:173], v2 offset:62496
buffer_load_dwordx4 v3, s[36:39], s60 offen offset:3072 sc1 lds
s_add_u32 m0, s51, 32768
v_mfma_f32_16x16x32_bf16 v[152:155], a[188:191], a[148:151], v[152:155]
ds_read_b64_tr_b16 a[174:175], v2 offset:64288
buffer_load_dwordx4 v3, s[36:39], s61 offen offset:0 sc1 lds
buffer_load_dwordx4 v3, s[36:39], s61 offen offset:1024 sc1 lds
v_mfma_f32_16x16x32_bf16 v[148:151], a[184:187], a[136:139], v[148:151]
buffer_load_dwordx4 v3, s[36:39], s61 offen offset:2048 sc1 lds
buffer_load_dwordx4 v3, s[36:39], s61 offen offset:3072 sc1 lds
v_rcp_f32 v19, v19
v_mfma_f32_16x16x32_bf16 v[148:151], a[188:191], a[140:143], v[148:151]
v_mul_f32 v20, 0xc0b504f3, v13
v_mul_f32 v21, 0x407af233, v13
v_mul_f32 v21, v21, v21
v_mfma_f32_16x16x32_bf16 v[144:147], a[184:187], a[128:131], v[144:147]
v_rcp_f32 v21, v21
v_mul_f32 v22, 0xc0b504f3, v15
v_mul_f32 v23, 0x407af233, v15
v_mfma_f32_16x16x32_bf16 v[144:147], a[188:191], a[132:135], v[144:147]
v_mul_f32 v23, v23, v23
v_rcp_f32 v23, v23
s_mov_b32 s49, s71
s_waitcnt lgkmcnt(4)
v_pk_fma_f32 v[32:33], v[24:25], v[8:9], v[32:33] op_sel_hi:[1,0,1]
s_nop 2
v_pk_fma_f32 v[144:145], v[28:29], v[8:9], v[144:145] op_sel_hi:[1,0,1]
v_pk_fma_f32 v[34:35], v[26:27], v[8:9], v[34:35] op_sel_hi:[1,0,1]
v_pk_fma_f32 v[146:147], v[30:31], v[8:9], v[146:147] op_sel_hi:[1,0,1]
v_pk_fma_f32 v[36:37], v[24:25], v[10:11], v[36:37] op_sel_hi:[1,0,1]
v_pk_fma_f32 v[148:149], v[28:29], v[10:11], v[148:149] op_sel_hi:[1,0,1]
v_pk_fma_f32 v[38:39], v[26:27], v[10:11], v[38:39] op_sel_hi:[1,0,1]
v_pk_fma_f32 v[150:151], v[30:31], v[10:11], v[150:151] op_sel_hi:[1,0,1]
v_pk_fma_f32 v[40:41], v[24:25], v[12:13], v[40:41] op_sel_hi:[1,0,1]
v_pk_fma_f32 v[152:153], v[28:29], v[12:13], v[152:153] op_sel_hi:[1,0,1]
v_pk_fma_f32 v[42:43], v[26:27], v[12:13], v[42:43] op_sel_hi:[1,0,1]
v_pk_fma_f32 v[154:155], v[30:31], v[12:13], v[154:155] op_sel_hi:[1,0,1]
v_pk_fma_f32 v[44:45], v[24:25], v[14:15], v[44:45] op_sel_hi:[1,0,1]
v_pk_fma_f32 v[156:157], v[28:29], v[14:15], v[156:157] op_sel_hi:[1,0,1]
v_pk_fma_f32 v[46:47], v[26:27], v[14:15], v[46:47] op_sel_hi:[1,0,1]
v_pk_fma_f32 v[158:159], v[30:31], v[14:15], v[158:159] op_sel_hi:[1,0,1]
ds_read_b128 v[24:27], v5 offset:448
ds_read_b128 v[28:31], v5 offset:896
v_pk_mul_f32 v[144:145], v[144:145], v[32:33]
v_pk_mul_f32 v[146:147], v[146:147], v[34:35]
v_pk_mul_f32 v[32:33], v[32:33], v[16:17] op_sel_hi:[1,0]
v_pk_mul_f32 v[34:35], v[34:35], v[16:17] op_sel_hi:[1,0]
v_pk_mul_f32 v[148:149], v[148:149], v[36:37]
v_pk_mul_f32 v[150:151], v[150:151], v[38:39]
v_pk_mul_f32 v[36:37], v[36:37], v[18:19] op_sel_hi:[1,0]
v_pk_mul_f32 v[38:39], v[38:39], v[18:19] op_sel_hi:[1,0]
v_pk_mul_f32 v[152:153], v[152:153], v[40:41]
v_pk_mul_f32 v[154:155], v[154:155], v[42:43]
v_pk_mul_f32 v[40:41], v[40:41], v[20:21] op_sel_hi:[1,0]
v_pk_mul_f32 v[42:43], v[42:43], v[20:21] op_sel_hi:[1,0]
v_pk_mul_f32 v[156:157], v[156:157], v[44:45]
v_pk_mul_f32 v[158:159], v[158:159], v[46:47]
v_pk_mul_f32 v[44:45], v[44:45], v[22:23] op_sel_hi:[1,0]
v_pk_mul_f32 v[46:47], v[46:47], v[22:23] op_sel_hi:[1,0]
v_exp_f32 v32, v32
v_exp_f32 v33, v33
v_exp_f32 v34, v34
v_exp_f32 v35, v35
v_exp_f32 v36, v36
v_exp_f32 v37, v37
v_exp_f32 v38, v38
v_exp_f32 v39, v39
v_mfma_f32_16x16x32_bf16 v[48:51], a[160:163], a[128:131], v[48:51]
ds_read_b64_tr_b16 a[176:177], v2 offset:41024
v_mfma_f32_16x16x32_bf16 v[48:51], a[164:167], a[132:135], v[48:51]
ds_read_b64_tr_b16 a[178:179], v2 offset:42816
v_mfma_f32_16x16x32_bf16 v[52:55], a[160:163], a[136:139], v[52:55]
ds_read_b64_tr_b16 a[180:181], v2 offset:48192
v_mfma_f32_16x16x32_bf16 v[52:55], a[164:167], a[140:143], v[52:55]
ds_read_b64_tr_b16 a[182:183], v2 offset:49984
v_mfma_f32_16x16x32_bf16 v[56:59], a[160:163], a[144:147], v[56:59]
v_exp_f32 v40, v40
v_mfma_f32_16x16x32_bf16 v[56:59], a[164:167], a[148:151], v[56:59]
v_exp_f32 v41, v41
v_mfma_f32_16x16x32_bf16 v[60:63], a[160:163], a[152:155], v[60:63]
v_exp_f32 v42, v42
v_mfma_f32_16x16x32_bf16 v[60:63], a[164:167], a[156:159], v[60:63]
v_exp_f32 v43, v43
s_waitcnt lgkmcnt(6)
v_mfma_f32_16x16x32_bf16 v[172:175], a[168:171], a[152:155], v[172:175]
ds_read_b64_tr_b16 a[184:185], v2 offset:55360
v_mfma_f32_16x16x32_bf16 v[172:175], a[172:175], a[156:159], v[172:175]
ds_read_b64_tr_b16 a[186:187], v2 offset:57152
v_mfma_f32_16x16x32_bf16 v[168:171], a[168:171], a[144:147], v[168:171]
ds_read_b64_tr_b16 a[188:189], v2 offset:62528
v_mfma_f32_16x16x32_bf16 v[168:171], a[172:175], a[148:151], v[168:171]
ds_read_b64_tr_b16 a[190:191], v2 offset:64320
v_mfma_f32_16x16x32_bf16 v[164:167], a[168:171], a[136:139], v[164:167]
v_exp_f32 v44, v44
v_mfma_f32_16x16x32_bf16 v[164:167], a[172:175], a[140:143], v[164:167]
v_exp_f32 v45, v45
v_mfma_f32_16x16x32_bf16 v[160:163], a[168:171], a[128:131], v[160:163]
v_exp_f32 v46, v46
v_mfma_f32_16x16x32_bf16 v[160:163], a[172:175], a[132:135], v[160:163]
v_exp_f32 v47, v47
v_pk_fma_f32 v[32:33], v[32:33], v[16:17], v[16:17] op_sel:[0,1,1] op_sel_hi:[1,1,1]
v_pk_fma_f32 v[34:35], v[34:35], v[16:17], v[16:17] op_sel:[0,1,1] op_sel_hi:[1,1,1]
v_pk_fma_f32 v[36:37], v[36:37], v[18:19], v[18:19] op_sel:[0,1,1] op_sel_hi:[1,1,1]
v_pk_fma_f32 v[38:39], v[38:39], v[18:19], v[18:19] op_sel:[0,1,1] op_sel_hi:[1,1,1]
v_pk_fma_f32 v[40:41], v[40:41], v[20:21], v[20:21] op_sel:[0,1,1] op_sel_hi:[1,1,1]
v_pk_fma_f32 v[42:43], v[42:43], v[20:21], v[20:21] op_sel:[0,1,1] op_sel_hi:[1,1,1]
v_pk_fma_f32 v[44:45], v[44:45], v[22:23], v[22:23] op_sel:[0,1,1] op_sel_hi:[1,1,1]
v_pk_fma_f32 v[46:47], v[46:47], v[22:23], v[22:23] op_sel:[0,1,1] op_sel_hi:[1,1,1]
v_rcp_f32 v32, v32
v_rcp_f32 v33, v33
v_rcp_f32 v34, v34
v_rcp_f32 v35, v35
v_rcp_f32 v36, v36
v_rcp_f32 v37, v37
v_rcp_f32 v38, v38
v_rcp_f32 v39, v39
v_rcp_f32 v40, v40
v_rcp_f32 v41, v41
v_rcp_f32 v42, v42
v_rcp_f32 v43, v43
v_rcp_f32 v44, v44
v_rcp_f32 v45, v45
v_rcp_f32 v46, v46
v_rcp_f32 v47, v47
v_pk_mul_f32 v[144:145], v[144:145], v[32:33]
v_pk_mul_f32 v[146:147], v[146:147], v[34:35]
v_pk_mul_f32 v[148:149], v[148:149], v[36:37]
v_pk_mul_f32 v[150:151], v[150:151], v[38:39]
v_pk_mul_f32 v[152:153], v[152:153], v[40:41]
v_pk_mul_f32 v[154:155], v[154:155], v[42:43]
v_pk_mul_f32 v[156:157], v[156:157], v[44:45]
v_pk_mul_f32 v[158:159], v[158:159], v[46:47]
v_cvt_pk_bf16_f32 v32, v144, v145
v_cvt_pk_bf16_f32 v33, v146, v147
v_cvt_pk_bf16_f32 v34, v148, v149
v_cvt_pk_bf16_f32 v35, v150, v151
v_cvt_pk_bf16_f32 v40, v152, v153
v_cvt_pk_bf16_f32 v41, v154, v155
v_cvt_pk_bf16_f32 v42, v156, v157
v_cvt_pk_bf16_f32 v43, v158, v159
v_permlane32_swap_b32 v32, v34
v_permlane32_swap_b32 v33, v35
v_permlane32_swap_b32 v40, v42
v_permlane32_swap_b32 v41, v43
buffer_store_dwordx4 v[32:35], v4, s[36:39], s49 offen offset:0 sc1
buffer_store_dwordx4 v[40:43], v4, s[36:39], s49 offen offset:2048 sc1
s_add_u32 s49, s49, s0
s_waitcnt lgkmcnt(8)
v_pk_fma_f32 v[48:49], v[24:25], v[8:9], v[48:49] op_sel_hi:[1,0,1]
v_pk_fma_f32 v[160:161], v[28:29], v[8:9], v[160:161] op_sel_hi:[1,0,1]
v_pk_fma_f32 v[50:51], v[26:27], v[8:9], v[50:51] op_sel_hi:[1,0,1]
v_pk_fma_f32 v[162:163], v[30:31], v[8:9], v[162:163] op_sel_hi:[1,0,1]
v_pk_fma_f32 v[52:53], v[24:25], v[10:11], v[52:53] op_sel_hi:[1,0,1]
v_pk_fma_f32 v[164:165], v[28:29], v[10:11], v[164:165] op_sel_hi:[1,0,1]
v_pk_fma_f32 v[54:55], v[26:27], v[10:11], v[54:55] op_sel_hi:[1,0,1]
v_pk_fma_f32 v[166:167], v[30:31], v[10:11], v[166:167] op_sel_hi:[1,0,1]
v_pk_fma_f32 v[56:57], v[24:25], v[12:13], v[56:57] op_sel_hi:[1,0,1]
v_pk_fma_f32 v[168:169], v[28:29], v[12:13], v[168:169] op_sel_hi:[1,0,1]
v_pk_fma_f32 v[58:59], v[26:27], v[12:13], v[58:59] op_sel_hi:[1,0,1]
v_pk_fma_f32 v[170:171], v[30:31], v[12:13], v[170:171] op_sel_hi:[1,0,1]
v_pk_fma_f32 v[60:61], v[24:25], v[14:15], v[60:61] op_sel_hi:[1,0,1]
v_pk_fma_f32 v[172:173], v[28:29], v[14:15], v[172:173] op_sel_hi:[1,0,1]
v_pk_fma_f32 v[62:63], v[26:27], v[14:15], v[62:63] op_sel_hi:[1,0,1]
v_pk_fma_f32 v[174:175], v[30:31], v[14:15], v[174:175] op_sel_hi:[1,0,1]
ds_read_b128 v[24:27], v5 offset:512
ds_read_b128 v[28:31], v5 offset:960
v_pk_mul_f32 v[160:161], v[160:161], v[48:49]
v_pk_mul_f32 v[162:163], v[162:163], v[50:51]
v_pk_mul_f32 v[48:49], v[48:49], v[16:17] op_sel_hi:[1,0]
v_pk_mul_f32 v[50:51], v[50:51], v[16:17] op_sel_hi:[1,0]
v_pk_mul_f32 v[164:165], v[164:165], v[52:53]
v_pk_mul_f32 v[166:167], v[166:167], v[54:55]
v_pk_mul_f32 v[52:53], v[52:53], v[18:19] op_sel_hi:[1,0]
v_pk_mul_f32 v[54:55], v[54:55], v[18:19] op_sel_hi:[1,0]
v_pk_mul_f32 v[168:169], v[168:169], v[56:57]
v_pk_mul_f32 v[170:171], v[170:171], v[58:59]
v_pk_mul_f32 v[56:57], v[56:57], v[20:21] op_sel_hi:[1,0]
v_pk_mul_f32 v[58:59], v[58:59], v[20:21] op_sel_hi:[1,0]
v_pk_mul_f32 v[172:173], v[172:173], v[60:61]
v_pk_mul_f32 v[174:175], v[174:175], v[62:63]
v_pk_mul_f32 v[60:61], v[60:61], v[22:23] op_sel_hi:[1,0]
v_pk_mul_f32 v[62:63], v[62:63], v[22:23] op_sel_hi:[1,0]
v_exp_f32 v48, v48
v_exp_f32 v49, v49
v_exp_f32 v50, v50
v_exp_f32 v51, v51
v_exp_f32 v52, v52
v_exp_f32 v53, v53
v_exp_f32 v54, v54
v_exp_f32 v55, v55
s_waitcnt lgkmcnt(6)
v_mfma_f32_16x16x32_bf16 v[64:67], a[176:179], a[128:131], v[64:67]
ds_read_b64_tr_b16 a[160:161], v2 offset:41056
v_mfma_f32_16x16x32_bf16 v[64:67], a[180:183], a[132:135], v[64:67]
ds_read_b64_tr_b16 a[162:163], v2 offset:42848
v_mfma_f32_16x16x32_bf16 v[68:71], a[176:179], a[136:139], v[68:71]
ds_read_b64_tr_b16 a[164:165], v2 offset:48224
v_mfma_f32_16x16x32_bf16 v[68:71], a[180:183], a[140:143], v[68:71]
ds_read_b64_tr_b16 a[166:167], v2 offset:50016
v_mfma_f32_16x16x32_bf16 v[72:75], a[176:179], a[144:147], v[72:75]
v_exp_f32 v56, v56
v_mfma_f32_16x16x32_bf16 v[72:75], a[180:183], a[148:151], v[72:75]
v_exp_f32 v57, v57
v_mfma_f32_16x16x32_bf16 v[76:79], a[176:179], a[152:155], v[76:79]
v_exp_f32 v58, v58
v_mfma_f32_16x16x32_bf16 v[76:79], a[180:183], a[156:159], v[76:79]
v_exp_f32 v59, v59
s_waitcnt lgkmcnt(6)
v_mfma_f32_16x16x32_bf16 v[188:191], a[184:187], a[152:155], v[188:191]
ds_read_b64_tr_b16 a[168:169], v2 offset:55392
v_mfma_f32_16x16x32_bf16 v[188:191], a[188:191], a[156:159], v[188:191]
ds_read_b64_tr_b16 a[170:171], v2 offset:57184
v_mfma_f32_16x16x32_bf16 v[184:187], a[184:187], a[144:147], v[184:187]
ds_read_b64_tr_b16 a[172:173], v2 offset:62560
v_mfma_f32_16x16x32_bf16 v[184:187], a[188:191], a[148:151], v[184:187]
ds_read_b64_tr_b16 a[174:175], v2 offset:64352
v_mfma_f32_16x16x32_bf16 v[180:183], a[184:187], a[136:139], v[180:183]
v_exp_f32 v60, v60
v_mfma_f32_16x16x32_bf16 v[180:183], a[188:191], a[140:143], v[180:183]
v_exp_f32 v61, v61
v_mfma_f32_16x16x32_bf16 v[176:179], a[184:187], a[128:131], v[176:179]
v_exp_f32 v62, v62
v_mfma_f32_16x16x32_bf16 v[176:179], a[188:191], a[132:135], v[176:179]
v_exp_f32 v63, v63
v_pk_fma_f32 v[48:49], v[48:49], v[16:17], v[16:17] op_sel:[0,1,1] op_sel_hi:[1,1,1]
v_pk_fma_f32 v[50:51], v[50:51], v[16:17], v[16:17] op_sel:[0,1,1] op_sel_hi:[1,1,1]
v_pk_fma_f32 v[52:53], v[52:53], v[18:19], v[18:19] op_sel:[0,1,1] op_sel_hi:[1,1,1]
v_pk_fma_f32 v[54:55], v[54:55], v[18:19], v[18:19] op_sel:[0,1,1] op_sel_hi:[1,1,1]
v_pk_fma_f32 v[56:57], v[56:57], v[20:21], v[20:21] op_sel:[0,1,1] op_sel_hi:[1,1,1]
v_pk_fma_f32 v[58:59], v[58:59], v[20:21], v[20:21] op_sel:[0,1,1] op_sel_hi:[1,1,1]
v_pk_fma_f32 v[60:61], v[60:61], v[22:23], v[22:23] op_sel:[0,1,1] op_sel_hi:[1,1,1]
v_pk_fma_f32 v[62:63], v[62:63], v[22:23], v[22:23] op_sel:[0,1,1] op_sel_hi:[1,1,1]
v_rcp_f32 v48, v48
v_rcp_f32 v49, v49
v_rcp_f32 v50, v50
v_rcp_f32 v51, v51
v_rcp_f32 v52, v52
v_rcp_f32 v53, v53
v_rcp_f32 v54, v54
v_rcp_f32 v55, v55
v_rcp_f32 v56, v56
v_rcp_f32 v57, v57
v_rcp_f32 v58, v58
v_rcp_f32 v59, v59
v_rcp_f32 v60, v60
v_rcp_f32 v61, v61
v_rcp_f32 v62, v62
v_rcp_f32 v63, v63
v_pk_mul_f32 v[160:161], v[160:161], v[48:49]
v_pk_mul_f32 v[162:163], v[162:163], v[50:51]
v_pk_mul_f32 v[164:165], v[164:165], v[52:53]
v_pk_mul_f32 v[166:167], v[166:167], v[54:55]
v_pk_mul_f32 v[168:169], v[168:169], v[56:57]
v_pk_mul_f32 v[170:171], v[170:171], v[58:59]
v_pk_mul_f32 v[172:173], v[172:173], v[60:61]
v_pk_mul_f32 v[174:175], v[174:175], v[62:63]
v_cvt_pk_bf16_f32 v48, v160, v161
v_cvt_pk_bf16_f32 v49, v162, v163
v_cvt_pk_bf16_f32 v50, v164, v165
v_cvt_pk_bf16_f32 v51, v166, v167
v_cvt_pk_bf16_f32 v56, v168, v169
v_cvt_pk_bf16_f32 v57, v170, v171
v_cvt_pk_bf16_f32 v58, v172, v173
v_cvt_pk_bf16_f32 v59, v174, v175
v_permlane32_swap_b32 v48, v50
v_permlane32_swap_b32 v49, v51
v_permlane32_swap_b32 v56, v58
v_permlane32_swap_b32 v57, v59
buffer_store_dwordx4 v[48:51], v4, s[36:39], s49 offen offset:0 sc1
buffer_store_dwordx4 v[56:59], v4, s[36:39], s49 offen offset:2048 sc1
s_add_u32 s49, s49, s1
s_waitcnt lgkmcnt(8)
v_pk_fma_f32 v[64:65], v[24:25], v[8:9], v[64:65] op_sel_hi:[1,0,1]
v_pk_fma_f32 v[176:177], v[28:29], v[8:9], v[176:177] op_sel_hi:[1,0,1]
v_pk_fma_f32 v[66:67], v[26:27], v[8:9], v[66:67] op_sel_hi:[1,0,1]
v_pk_fma_f32 v[178:179], v[30:31], v[8:9], v[178:179] op_sel_hi:[1,0,1]
v_pk_fma_f32 v[68:69], v[24:25], v[10:11], v[68:69] op_sel_hi:[1,0,1]
v_pk_fma_f32 v[180:181], v[28:29], v[10:11], v[180:181] op_sel_hi:[1,0,1]
v_pk_fma_f32 v[70:71], v[26:27], v[10:11], v[70:71] op_sel_hi:[1,0,1]
v_pk_fma_f32 v[182:183], v[30:31], v[10:11], v[182:183] op_sel_hi:[1,0,1]
v_pk_fma_f32 v[72:73], v[24:25], v[12:13], v[72:73] op_sel_hi:[1,0,1]
v_pk_fma_f32 v[184:185], v[28:29], v[12:13], v[184:185] op_sel_hi:[1,0,1]
v_pk_fma_f32 v[74:75], v[26:27], v[12:13], v[74:75] op_sel_hi:[1,0,1]
v_pk_fma_f32 v[186:187], v[30:31], v[12:13], v[186:187] op_sel_hi:[1,0,1]
v_pk_fma_f32 v[76:77], v[24:25], v[14:15], v[76:77] op_sel_hi:[1,0,1]
v_pk_fma_f32 v[188:189], v[28:29], v[14:15], v[188:189] op_sel_hi:[1,0,1]
v_pk_fma_f32 v[78:79], v[26:27], v[14:15], v[78:79] op_sel_hi:[1,0,1]
v_pk_fma_f32 v[190:191], v[30:31], v[14:15], v[190:191] op_sel_hi:[1,0,1]
ds_read_b128 v[24:27], v5 offset:576
ds_read_b128 v[28:31], v5 offset:1024
v_pk_mul_f32 v[176:177], v[176:177], v[64:65]
v_pk_mul_f32 v[178:179], v[178:179], v[66:67]
v_pk_mul_f32 v[64:65], v[64:65], v[16:17] op_sel_hi:[1,0]
v_pk_mul_f32 v[66:67], v[66:67], v[16:17] op_sel_hi:[1,0]
v_pk_mul_f32 v[180:181], v[180:181], v[68:69]
v_pk_mul_f32 v[182:183], v[182:183], v[70:71]
v_pk_mul_f32 v[68:69], v[68:69], v[18:19] op_sel_hi:[1,0]
v_pk_mul_f32 v[70:71], v[70:71], v[18:19] op_sel_hi:[1,0]
v_pk_mul_f32 v[184:185], v[184:185], v[72:73]
v_pk_mul_f32 v[186:187], v[186:187], v[74:75]
v_pk_mul_f32 v[72:73], v[72:73], v[20:21] op_sel_hi:[1,0]
v_pk_mul_f32 v[74:75], v[74:75], v[20:21] op_sel_hi:[1,0]
v_pk_mul_f32 v[188:189], v[188:189], v[76:77]
v_pk_mul_f32 v[190:191], v[190:191], v[78:79]
v_pk_mul_f32 v[76:77], v[76:77], v[22:23] op_sel_hi:[1,0]
v_pk_mul_f32 v[78:79], v[78:79], v[22:23] op_sel_hi:[1,0]
v_exp_f32 v64, v64
v_exp_f32 v65, v65
v_exp_f32 v66, v66
v_exp_f32 v67, v67
v_exp_f32 v68, v68
v_exp_f32 v69, v69
v_exp_f32 v70, v70
v_exp_f32 v71, v71
s_waitcnt vmcnt(4) lgkmcnt(2)
s_barrier
v_mfma_f32_16x16x32_bf16 v[80:83], a[160:163], a[128:131], v[80:83]
ds_read_b64_tr_b16 a[176:177], v2 offset:41088
v_exp_f32 v72, v72
v_mfma_f32_16x16x32_bf16 v[80:83], a[164:167], a[132:135], v[80:83]
ds_read_b64_tr_b16 a[178:179], v2 offset:42880
v_exp_f32 v73, v73
v_mfma_f32_16x16x32_bf16 v[84:87], a[160:163], a[136:139], v[84:87]
ds_read_b64_tr_b16 a[180:181], v2 offset:48256
v_exp_f32 v74, v74
v_mfma_f32_16x16x32_bf16 v[84:87], a[164:167], a[140:143], v[84:87]
ds_read_b64_tr_b16 a[182:183], v2 offset:50048
v_exp_f32 v75, v75
v_mfma_f32_16x16x32_bf16 v[88:91], a[160:163], a[144:147], v[88:91]
ds_read_b128 a[0:3], v6 offset:0
ds_read_b128 a[4:7], v6 offset:1024
v_mfma_f32_16x16x32_bf16 v[88:91], a[164:167], a[148:151], v[88:91]
v_mfma_f32_16x16x32_bf16 v[92:95], a[160:163], a[152:155], v[92:95]
v_mfma_f32_16x16x32_bf16 v[92:95], a[164:167], a[156:159], v[92:95]
v_mfma_f32_16x16x32_bf16 v[204:207], a[168:171], a[152:155], v[204:207]
ds_read_b64_tr_b16 a[184:185], v2 offset:55424
v_exp_f32 v76, v76
v_mfma_f32_16x16x32_bf16 v[204:207], a[172:175], a[156:159], v[204:207]
ds_read_b64_tr_b16 a[186:187], v2 offset:57216
v_exp_f32 v77, v77
v_mfma_f32_16x16x32_bf16 v[200:203], a[168:171], a[144:147], v[200:203]
ds_read_b64_tr_b16 a[188:189], v2 offset:62592
v_exp_f32 v78, v78
v_mfma_f32_16x16x32_bf16 v[200:203], a[172:175], a[148:151], v[200:203]
ds_read_b64_tr_b16 a[190:191], v2 offset:64384
v_exp_f32 v79, v79
v_mfma_f32_16x16x32_bf16 v[196:199], a[168:171], a[136:139], v[196:199]
ds_read_b128 a[8:11], v6 offset:2048
ds_read_b128 a[12:15], v6 offset:3072
v_mfma_f32_16x16x32_bf16 v[196:199], a[172:175], a[140:143], v[196:199]
v_mfma_f32_16x16x32_bf16 v[192:195], a[168:171], a[128:131], v[192:195]
v_mfma_f32_16x16x32_bf16 v[192:195], a[172:175], a[132:135], v[192:195]
v_pk_fma_f32 v[64:65], v[64:65], v[16:17], v[16:17] op_sel:[0,1,1] op_sel_hi:[1,1,1]
v_pk_fma_f32 v[66:67], v[66:67], v[16:17], v[16:17] op_sel:[0,1,1] op_sel_hi:[1,1,1]
v_pk_fma_f32 v[68:69], v[68:69], v[18:19], v[18:19] op_sel:[0,1,1] op_sel_hi:[1,1,1]
v_pk_fma_f32 v[70:71], v[70:71], v[18:19], v[18:19] op_sel:[0,1,1] op_sel_hi:[1,1,1]
v_pk_fma_f32 v[72:73], v[72:73], v[20:21], v[20:21] op_sel:[0,1,1] op_sel_hi:[1,1,1]
v_pk_fma_f32 v[74:75], v[74:75], v[20:21], v[20:21] op_sel:[0,1,1] op_sel_hi:[1,1,1]
v_pk_fma_f32 v[76:77], v[76:77], v[22:23], v[22:23] op_sel:[0,1,1] op_sel_hi:[1,1,1]
v_pk_fma_f32 v[78:79], v[78:79], v[22:23], v[22:23] op_sel:[0,1,1] op_sel_hi:[1,1,1]
v_rcp_f32 v64, v64
v_rcp_f32 v65, v65
v_rcp_f32 v66, v66
v_rcp_f32 v67, v67
v_rcp_f32 v68, v68
v_rcp_f32 v69, v69
v_rcp_f32 v70, v70
v_rcp_f32 v71, v71
v_rcp_f32 v72, v72
v_rcp_f32 v73, v73
v_rcp_f32 v74, v74
v_rcp_f32 v75, v75
v_rcp_f32 v76, v76
v_rcp_f32 v77, v77
v_rcp_f32 v78, v78
v_rcp_f32 v79, v79
v_pk_mul_f32 v[176:177], v[176:177], v[64:65]
v_pk_mul_f32 v[178:179], v[178:179], v[66:67]
v_pk_mul_f32 v[180:181], v[180:181], v[68:69]
v_pk_mul_f32 v[182:183], v[182:183], v[70:71]
v_pk_mul_f32 v[184:185], v[184:185], v[72:73]
v_pk_mul_f32 v[186:187], v[186:187], v[74:75]
v_pk_mul_f32 v[188:189], v[188:189], v[76:77]
v_pk_mul_f32 v[190:191], v[190:191], v[78:79]
v_cvt_pk_bf16_f32 v64, v176, v177
v_cvt_pk_bf16_f32 v65, v178, v179
v_cvt_pk_bf16_f32 v66, v180, v181
v_cvt_pk_bf16_f32 v67, v182, v183
v_cvt_pk_bf16_f32 v72, v184, v185
v_cvt_pk_bf16_f32 v73, v186, v187
v_cvt_pk_bf16_f32 v74, v188, v189
v_cvt_pk_bf16_f32 v75, v190, v191
v_permlane32_swap_b32 v64, v66
v_permlane32_swap_b32 v65, v67
v_permlane32_swap_b32 v72, v74
v_permlane32_swap_b32 v73, v75
buffer_store_dwordx4 v[64:67], v4, s[36:39], s49 offen offset:0 sc1
buffer_store_dwordx4 v[72:75], v4, s[36:39], s49 offen offset:2048 sc1
s_add_u32 s49, s49, s0
s_waitcnt lgkmcnt(12)
v_pk_fma_f32 v[80:81], v[24:25], v[8:9], v[80:81] op_sel_hi:[1,0,1]
v_pk_fma_f32 v[192:193], v[28:29], v[8:9], v[192:193] op_sel_hi:[1,0,1]
v_pk_fma_f32 v[82:83], v[26:27], v[8:9], v[82:83] op_sel_hi:[1,0,1]
v_pk_fma_f32 v[194:195], v[30:31], v[8:9], v[194:195] op_sel_hi:[1,0,1]
v_pk_fma_f32 v[84:85], v[24:25], v[10:11], v[84:85] op_sel_hi:[1,0,1]
v_pk_fma_f32 v[196:197], v[28:29], v[10:11], v[196:197] op_sel_hi:[1,0,1]
v_pk_fma_f32 v[86:87], v[26:27], v[10:11], v[86:87] op_sel_hi:[1,0,1]
v_pk_fma_f32 v[198:199], v[30:31], v[10:11], v[198:199] op_sel_hi:[1,0,1]
v_pk_fma_f32 v[88:89], v[24:25], v[12:13], v[88:89] op_sel_hi:[1,0,1]
v_pk_fma_f32 v[200:201], v[28:29], v[12:13], v[200:201] op_sel_hi:[1,0,1]
v_pk_fma_f32 v[90:91], v[26:27], v[12:13], v[90:91] op_sel_hi:[1,0,1]
v_pk_fma_f32 v[202:203], v[30:31], v[12:13], v[202:203] op_sel_hi:[1,0,1]
v_pk_fma_f32 v[92:93], v[24:25], v[14:15], v[92:93] op_sel_hi:[1,0,1]
v_pk_fma_f32 v[204:205], v[28:29], v[14:15], v[204:205] op_sel_hi:[1,0,1]
v_pk_fma_f32 v[94:95], v[26:27], v[14:15], v[94:95] op_sel_hi:[1,0,1]
v_pk_fma_f32 v[206:207], v[30:31], v[14:15], v[206:207] op_sel_hi:[1,0,1]
ds_read_b128 v[24:27], v5 offset:640
ds_read_b128 v[28:31], v5 offset:1088
v_pk_mul_f32 v[192:193], v[192:193], v[80:81]
v_pk_mul_f32 v[194:195], v[194:195], v[82:83]
v_pk_mul_f32 v[80:81], v[80:81], v[16:17] op_sel_hi:[1,0]
v_pk_mul_f32 v[82:83], v[82:83], v[16:17] op_sel_hi:[1,0]
v_pk_mul_f32 v[196:197], v[196:197], v[84:85]
v_pk_mul_f32 v[198:199], v[198:199], v[86:87]
v_pk_mul_f32 v[84:85], v[84:85], v[18:19] op_sel_hi:[1,0]
v_pk_mul_f32 v[86:87], v[86:87], v[18:19] op_sel_hi:[1,0]
v_pk_mul_f32 v[200:201], v[200:201], v[88:89]
v_pk_mul_f32 v[202:203], v[202:203], v[90:91]
v_pk_mul_f32 v[88:89], v[88:89], v[20:21] op_sel_hi:[1,0]
v_pk_mul_f32 v[90:91], v[90:91], v[20:21] op_sel_hi:[1,0]
v_pk_mul_f32 v[204:205], v[204:205], v[92:93]
v_pk_mul_f32 v[206:207], v[206:207], v[94:95]
v_pk_mul_f32 v[92:93], v[92:93], v[22:23] op_sel_hi:[1,0]
v_pk_mul_f32 v[94:95], v[94:95], v[22:23] op_sel_hi:[1,0]
v_exp_f32 v80, v80
v_exp_f32 v81, v81
v_exp_f32 v82, v82
v_exp_f32 v83, v83
v_exp_f32 v84, v84
v_exp_f32 v85, v85
v_exp_f32 v86, v86
v_exp_f32 v87, v87
s_waitcnt lgkmcnt(10)
v_mfma_f32_16x16x32_bf16 v[96:99], a[176:179], a[128:131], v[96:99]
ds_read_b64_tr_b16 a[160:161], v2 offset:41120
v_exp_f32 v88, v88
v_mfma_f32_16x16x32_bf16 v[96:99], a[180:183], a[132:135], v[96:99]
ds_read_b64_tr_b16 a[162:163], v2 offset:42912
v_exp_f32 v89, v89
v_mfma_f32_16x16x32_bf16 v[100:103], a[176:179], a[136:139], v[100:103]
ds_read_b64_tr_b16 a[164:165], v2 offset:48288
v_exp_f32 v90, v90
v_mfma_f32_16x16x32_bf16 v[100:103], a[180:183], a[140:143], v[100:103]
ds_read_b64_tr_b16 a[166:167], v2 offset:50080
v_exp_f32 v91, v91
v_mfma_f32_16x16x32_bf16 v[104:107], a[176:179], a[144:147], v[104:107]
ds_read_b128 a[16:19], v6 offset:4096
ds_read_b128 a[20:23], v6 offset:5120
v_mfma_f32_16x16x32_bf16 v[104:107], a[180:183], a[148:151], v[104:107]
v_mov_b32 v144, s64
v_mov_b32 v145, s64
v_mfma_f32_16x16x32_bf16 v[108:111], a[176:179], a[152:155], v[108:111]
v_mov_b32 v146, s64
v_mov_b32 v147, s64
v_mfma_f32_16x16x32_bf16 v[108:111], a[180:183], a[156:159], v[108:111]
s_waitcnt lgkmcnt(10)
v_mfma_f32_16x16x32_bf16 v[220:223], a[184:187], a[152:155], v[220:223]
ds_read_b64_tr_b16 a[168:169], v2 offset:55456
v_exp_f32 v92, v92
v_mfma_f32_16x16x32_bf16 v[220:223], a[188:191], a[156:159], v[220:223]
ds_read_b64_tr_b16 a[170:171], v2 offset:57248
v_exp_f32 v93, v93
v_mfma_f32_16x16x32_bf16 v[216:219], a[184:187], a[144:147], v[216:219]
ds_read_b64_tr_b16 a[172:173], v2 offset:62624
v_exp_f32 v94, v94
v_mfma_f32_16x16x32_bf16 v[216:219], a[188:191], a[148:151], v[216:219]
ds_read_b64_tr_b16 a[174:175], v2 offset:64416
v_exp_f32 v95, v95
v_mfma_f32_16x16x32_bf16 v[212:215], a[184:187], a[136:139], v[212:215]
ds_read_b128 a[24:27], v6 offset:6144
ds_read_b128 a[28:31], v6 offset:7168
v_mfma_f32_16x16x32_bf16 v[212:215], a[188:191], a[140:143], v[212:215]
v_mov_b32 v148, s65
v_mov_b32 v149, s65
v_mfma_f32_16x16x32_bf16 v[208:211], a[184:187], a[128:131], v[208:211]
v_mov_b32 v150, s65
v_mov_b32 v151, s65
v_mfma_f32_16x16x32_bf16 v[208:211], a[188:191], a[132:135], v[208:211]
v_pk_fma_f32 v[80:81], v[80:81], v[16:17], v[16:17] op_sel:[0,1,1] op_sel_hi:[1,1,1]
v_pk_fma_f32 v[82:83], v[82:83], v[16:17], v[16:17] op_sel:[0,1,1] op_sel_hi:[1,1,1]
v_pk_fma_f32 v[84:85], v[84:85], v[18:19], v[18:19] op_sel:[0,1,1] op_sel_hi:[1,1,1]
v_pk_fma_f32 v[86:87], v[86:87], v[18:19], v[18:19] op_sel:[0,1,1] op_sel_hi:[1,1,1]
v_pk_fma_f32 v[88:89], v[88:89], v[20:21], v[20:21] op_sel:[0,1,1] op_sel_hi:[1,1,1]
v_pk_fma_f32 v[90:91], v[90:91], v[20:21], v[20:21] op_sel:[0,1,1] op_sel_hi:[1,1,1]
v_pk_fma_f32 v[92:93], v[92:93], v[22:23], v[22:23] op_sel:[0,1,1] op_sel_hi:[1,1,1]
v_pk_fma_f32 v[94:95], v[94:95], v[22:23], v[22:23] op_sel:[0,1,1] op_sel_hi:[1,1,1]
v_rcp_f32 v80, v80
v_rcp_f32 v81, v81
v_rcp_f32 v82, v82
v_rcp_f32 v83, v83
v_rcp_f32 v84, v84
v_rcp_f32 v85, v85
v_rcp_f32 v86, v86
v_rcp_f32 v87, v87
v_rcp_f32 v88, v88
v_rcp_f32 v89, v89
v_rcp_f32 v90, v90
v_rcp_f32 v91, v91
v_rcp_f32 v92, v92
v_rcp_f32 v93, v93
v_rcp_f32 v94, v94
v_rcp_f32 v95, v95
v_pk_mul_f32 v[192:193], v[192:193], v[80:81]
v_pk_mul_f32 v[194:195], v[194:195], v[82:83]
v_pk_mul_f32 v[196:197], v[196:197], v[84:85]
v_pk_mul_f32 v[198:199], v[198:199], v[86:87]
v_pk_mul_f32 v[200:201], v[200:201], v[88:89]
v_pk_mul_f32 v[202:203], v[202:203], v[90:91]
v_pk_mul_f32 v[204:205], v[204:205], v[92:93]
v_pk_mul_f32 v[206:207], v[206:207], v[94:95]
v_cvt_pk_bf16_f32 v80, v192, v193
v_cvt_pk_bf16_f32 v81, v194, v195
v_cvt_pk_bf16_f32 v82, v196, v197
v_cvt_pk_bf16_f32 v83, v198, v199
v_cvt_pk_bf16_f32 v88, v200, v201
v_cvt_pk_bf16_f32 v89, v202, v203
v_cvt_pk_bf16_f32 v90, v204, v205
v_cvt_pk_bf16_f32 v91, v206, v207
v_permlane32_swap_b32 v80, v82
v_permlane32_swap_b32 v81, v83
v_permlane32_swap_b32 v88, v90
v_permlane32_swap_b32 v89, v91
buffer_store_dwordx4 v[80:83], v4, s[36:39], s49 offen offset:0 sc1
buffer_store_dwordx4 v[88:91], v4, s[36:39], s49 offen offset:2048 sc1
s_add_u32 s49, s49, s1
s_waitcnt lgkmcnt(12)
v_pk_fma_f32 v[96:97], v[24:25], v[8:9], v[96:97] op_sel_hi:[1,0,1]
v_pk_fma_f32 v[208:209], v[28:29], v[8:9], v[208:209] op_sel_hi:[1,0,1]
v_pk_fma_f32 v[98:99], v[26:27], v[8:9], v[98:99] op_sel_hi:[1,0,1]
v_pk_fma_f32 v[210:211], v[30:31], v[8:9], v[210:211] op_sel_hi:[1,0,1]
v_pk_fma_f32 v[100:101], v[24:25], v[10:11], v[100:101] op_sel_hi:[1,0,1]
v_pk_fma_f32 v[212:213], v[28:29], v[10:11], v[212:213] op_sel_hi:[1,0,1]
v_pk_fma_f32 v[102:103], v[26:27], v[10:11], v[102:103] op_sel_hi:[1,0,1]
v_pk_fma_f32 v[214:215], v[30:31], v[10:11], v[214:215] op_sel_hi:[1,0,1]
v_pk_fma_f32 v[104:105], v[24:25], v[12:13], v[104:105] op_sel_hi:[1,0,1]
v_pk_fma_f32 v[216:217], v[28:29], v[12:13], v[216:217] op_sel_hi:[1,0,1]
v_pk_fma_f32 v[106:107], v[26:27], v[12:13], v[106:107] op_sel_hi:[1,0,1]
v_pk_fma_f32 v[218:219], v[30:31], v[12:13], v[218:219] op_sel_hi:[1,0,1]
v_pk_fma_f32 v[108:109], v[24:25], v[14:15], v[108:109] op_sel_hi:[1,0,1]
v_pk_fma_f32 v[220:221], v[28:29], v[14:15], v[220:221] op_sel_hi:[1,0,1]
v_pk_fma_f32 v[110:111], v[26:27], v[14:15], v[110:111] op_sel_hi:[1,0,1]
v_pk_fma_f32 v[222:223], v[30:31], v[14:15], v[222:223] op_sel_hi:[1,0,1]
ds_read_b128 v[24:27], v5 offset:704
ds_read_b128 v[28:31], v5 offset:1152
v_pk_mul_f32 v[208:209], v[208:209], v[96:97]
v_pk_mul_f32 v[210:211], v[210:211], v[98:99]
v_pk_mul_f32 v[96:97], v[96:97], v[16:17] op_sel_hi:[1,0]
v_pk_mul_f32 v[98:99], v[98:99], v[16:17] op_sel_hi:[1,0]
v_pk_mul_f32 v[212:213], v[212:213], v[100:101]
v_pk_mul_f32 v[214:215], v[214:215], v[102:103]
v_pk_mul_f32 v[100:101], v[100:101], v[18:19] op_sel_hi:[1,0]
v_pk_mul_f32 v[102:103], v[102:103], v[18:19] op_sel_hi:[1,0]
v_pk_mul_f32 v[216:217], v[216:217], v[104:105]
v_pk_mul_f32 v[218:219], v[218:219], v[106:107]
v_pk_mul_f32 v[104:105], v[104:105], v[20:21] op_sel_hi:[1,0]
v_pk_mul_f32 v[106:107], v[106:107], v[20:21] op_sel_hi:[1,0]
v_pk_mul_f32 v[220:221], v[220:221], v[108:109]
v_pk_mul_f32 v[222:223], v[222:223], v[110:111]
v_pk_mul_f32 v[108:109], v[108:109], v[22:23] op_sel_hi:[1,0]
v_pk_mul_f32 v[110:111], v[110:111], v[22:23] op_sel_hi:[1,0]
v_exp_f32 v96, v96
v_exp_f32 v97, v97
v_exp_f32 v98, v98
v_exp_f32 v99, v99
v_exp_f32 v100, v100
v_exp_f32 v101, v101
v_exp_f32 v102, v102
v_exp_f32 v103, v103
s_waitcnt lgkmcnt(10)
v_mfma_f32_16x16x32_bf16 v[112:115], a[160:163], a[128:131], v[112:115]
ds_read_b64_tr_b16 a[176:177], v2 offset:41152
v_exp_f32 v104, v104
v_mfma_f32_16x16x32_bf16 v[112:115], a[164:167], a[132:135], v[112:115]
ds_read_b64_tr_b16 a[178:179], v2 offset:42944
v_exp_f32 v105, v105
v_mfma_f32_16x16x32_bf16 v[116:119], a[160:163], a[136:139], v[116:119]
ds_read_b64_tr_b16 a[180:181], v2 offset:48320
v_exp_f32 v106, v106
v_mfma_f32_16x16x32_bf16 v[116:119], a[164:167], a[140:143], v[116:119]
ds_read_b64_tr_b16 a[182:183], v2 offset:50112
v_exp_f32 v107, v107
v_mfma_f32_16x16x32_bf16 v[120:123], a[160:163], a[144:147], v[120:123]
ds_read_b128 a[32:35], v6 offset:8192
ds_read_b128 a[36:39], v6 offset:9216
v_mfma_f32_16x16x32_bf16 v[120:123], a[164:167], a[148:151], v[120:123]
v_mov_b32 v152, s66
v_mov_b32 v153, s66
v_mfma_f32_16x16x32_bf16 v[124:127], a[160:163], a[152:155], v[124:127]
v_mov_b32 v154, s66
v_mov_b32 v155, s66
v_mfma_f32_16x16x32_bf16 v[124:127], a[164:167], a[156:159], v[124:127]
s_waitcnt lgkmcnt(10)
v_mfma_f32_16x16x32_bf16 v[236:239], a[168:171], a[152:155], v[236:239]
ds_read_b64_tr_b16 a[184:185], v2 offset:55488
v_exp_f32 v108, v108
v_mfma_f32_16x16x32_bf16 v[236:239], a[172:175], a[156:159], v[236:239]
ds_read_b64_tr_b16 a[186:187], v2 offset:57280
v_exp_f32 v109, v109
v_mfma_f32_16x16x32_bf16 v[232:235], a[168:171], a[144:147], v[232:235]
ds_read_b64_tr_b16 a[188:189], v2 offset:62656
v_exp_f32 v110, v110
v_mfma_f32_16x16x32_bf16 v[232:235], a[172:175], a[148:151], v[232:235]
ds_read_b64_tr_b16 a[190:191], v2 offset:64448
v_exp_f32 v111, v111
v_mfma_f32_16x16x32_bf16 v[228:231], a[168:171], a[136:139], v[228:231]
ds_read_b128 a[40:43], v6 offset:10240
ds_read_b128 a[44:47], v6 offset:11264
v_mfma_f32_16x16x32_bf16 v[228:231], a[172:175], a[140:143], v[228:231]
v_mov_b32 v156, s67
v_mov_b32 v157, s67
v_mfma_f32_16x16x32_bf16 v[224:227], a[168:171], a[128:131], v[224:227]
v_mov_b32 v158, s67
v_mov_b32 v159, s67
v_mfma_f32_16x16x32_bf16 v[224:227], a[172:175], a[132:135], v[224:227]
v_pk_fma_f32 v[96:97], v[96:97], v[16:17], v[16:17] op_sel:[0,1,1] op_sel_hi:[1,1,1]
v_pk_fma_f32 v[98:99], v[98:99], v[16:17], v[16:17] op_sel:[0,1,1] op_sel_hi:[1,1,1]
v_pk_fma_f32 v[100:101], v[100:101], v[18:19], v[18:19] op_sel:[0,1,1] op_sel_hi:[1,1,1]
v_pk_fma_f32 v[102:103], v[102:103], v[18:19], v[18:19] op_sel:[0,1,1] op_sel_hi:[1,1,1]
v_pk_fma_f32 v[104:105], v[104:105], v[20:21], v[20:21] op_sel:[0,1,1] op_sel_hi:[1,1,1]
v_pk_fma_f32 v[106:107], v[106:107], v[20:21], v[20:21] op_sel:[0,1,1] op_sel_hi:[1,1,1]
v_pk_fma_f32 v[108:109], v[108:109], v[22:23], v[22:23] op_sel:[0,1,1] op_sel_hi:[1,1,1]
v_pk_fma_f32 v[110:111], v[110:111], v[22:23], v[22:23] op_sel:[0,1,1] op_sel_hi:[1,1,1]
v_rcp_f32 v96, v96
v_rcp_f32 v97, v97
v_rcp_f32 v98, v98
v_rcp_f32 v99, v99
v_rcp_f32 v100, v100
v_rcp_f32 v101, v101
v_rcp_f32 v102, v102
v_rcp_f32 v103, v103
v_rcp_f32 v104, v104
v_rcp_f32 v105, v105
v_rcp_f32 v106, v106
v_rcp_f32 v107, v107
v_rcp_f32 v108, v108
v_rcp_f32 v109, v109
v_rcp_f32 v110, v110
v_rcp_f32 v111, v111
v_pk_mul_f32 v[208:209], v[208:209], v[96:97]
v_pk_mul_f32 v[210:211], v[210:211], v[98:99]
v_pk_mul_f32 v[212:213], v[212:213], v[100:101]
v_pk_mul_f32 v[214:215], v[214:215], v[102:103]
v_pk_mul_f32 v[216:217], v[216:217], v[104:105]
v_pk_mul_f32 v[218:219], v[218:219], v[106:107]
v_pk_mul_f32 v[220:221], v[220:221], v[108:109]
v_pk_mul_f32 v[222:223], v[222:223], v[110:111]
v_cvt_pk_bf16_f32 v96, v208, v209
v_cvt_pk_bf16_f32 v97, v210, v211
v_cvt_pk_bf16_f32 v98, v212, v213
v_cvt_pk_bf16_f32 v99, v214, v215
v_cvt_pk_bf16_f32 v104, v216, v217
v_cvt_pk_bf16_f32 v105, v218, v219
v_cvt_pk_bf16_f32 v106, v220, v221
v_cvt_pk_bf16_f32 v107, v222, v223
v_permlane32_swap_b32 v96, v98
v_permlane32_swap_b32 v97, v99
v_permlane32_swap_b32 v104, v106
v_permlane32_swap_b32 v105, v107
buffer_store_dwordx4 v[96:99], v4, s[36:39], s49 offen offset:0 sc1
buffer_store_dwordx4 v[104:107], v4, s[36:39], s49 offen offset:2048 sc1
s_add_u32 s49, s49, s0
s_waitcnt lgkmcnt(12)
v_pk_fma_f32 v[112:113], v[24:25], v[8:9], v[112:113] op_sel_hi:[1,0,1]
v_pk_fma_f32 v[224:225], v[28:29], v[8:9], v[224:225] op_sel_hi:[1,0,1]
v_pk_fma_f32 v[114:115], v[26:27], v[8:9], v[114:115] op_sel_hi:[1,0,1]
v_pk_fma_f32 v[226:227], v[30:31], v[8:9], v[226:227] op_sel_hi:[1,0,1]
v_pk_fma_f32 v[116:117], v[24:25], v[10:11], v[116:117] op_sel_hi:[1,0,1]
v_pk_fma_f32 v[228:229], v[28:29], v[10:11], v[228:229] op_sel_hi:[1,0,1]
v_pk_fma_f32 v[118:119], v[26:27], v[10:11], v[118:119] op_sel_hi:[1,0,1]
v_pk_fma_f32 v[230:231], v[30:31], v[10:11], v[230:231] op_sel_hi:[1,0,1]
v_pk_fma_f32 v[120:121], v[24:25], v[12:13], v[120:121] op_sel_hi:[1,0,1]
v_pk_fma_f32 v[232:233], v[28:29], v[12:13], v[232:233] op_sel_hi:[1,0,1]
v_pk_fma_f32 v[122:123], v[26:27], v[12:13], v[122:123] op_sel_hi:[1,0,1]
v_pk_fma_f32 v[234:235], v[30:31], v[12:13], v[234:235] op_sel_hi:[1,0,1]
v_pk_fma_f32 v[124:125], v[24:25], v[14:15], v[124:125] op_sel_hi:[1,0,1]
v_pk_fma_f32 v[236:237], v[28:29], v[14:15], v[236:237] op_sel_hi:[1,0,1]
v_pk_fma_f32 v[126:127], v[26:27], v[14:15], v[126:127] op_sel_hi:[1,0,1]
v_pk_fma_f32 v[238:239], v[30:31], v[14:15], v[238:239] op_sel_hi:[1,0,1]
ds_read_b128 v[24:27], v5 offset:768
ds_read_b128 v[28:31], v5 offset:1216
v_pk_mul_f32 v[224:225], v[224:225], v[112:113]
v_pk_mul_f32 v[226:227], v[226:227], v[114:115]
v_pk_mul_f32 v[112:113], v[112:113], v[16:17] op_sel_hi:[1,0]
v_pk_mul_f32 v[114:115], v[114:115], v[16:17] op_sel_hi:[1,0]
v_pk_mul_f32 v[228:229], v[228:229], v[116:117]
v_pk_mul_f32 v[230:231], v[230:231], v[118:119]
v_pk_mul_f32 v[116:117], v[116:117], v[18:19] op_sel_hi:[1,0]
v_pk_mul_f32 v[118:119], v[118:119], v[18:19] op_sel_hi:[1,0]
v_pk_mul_f32 v[232:233], v[232:233], v[120:121]
v_pk_mul_f32 v[234:235], v[234:235], v[122:123]
v_pk_mul_f32 v[120:121], v[120:121], v[20:21] op_sel_hi:[1,0]
v_pk_mul_f32 v[122:123], v[122:123], v[20:21] op_sel_hi:[1,0]
v_pk_mul_f32 v[236:237], v[236:237], v[124:125]
v_pk_mul_f32 v[238:239], v[238:239], v[126:127]
v_pk_mul_f32 v[124:125], v[124:125], v[22:23] op_sel_hi:[1,0]
v_pk_mul_f32 v[126:127], v[126:127], v[22:23] op_sel_hi:[1,0]
v_exp_f32 v112, v112
v_exp_f32 v113, v113
v_exp_f32 v114, v114
v_exp_f32 v115, v115
v_exp_f32 v116, v116
v_exp_f32 v117, v117
v_exp_f32 v118, v118
v_exp_f32 v119, v119
s_waitcnt lgkmcnt(4)
s_barrier
v_mfma_f32_16x16x32_bf16 v[128:131], a[176:179], a[128:131], v[128:131]
v_exp_f32 v120, v120
v_mfma_f32_16x16x32_bf16 v[128:131], a[180:183], a[132:135], v[128:131]
v_exp_f32 v121, v121
v_mfma_f32_16x16x32_bf16 v[132:135], a[176:179], a[136:139], v[132:135]
v_exp_f32 v122, v122
v_mfma_f32_16x16x32_bf16 v[132:135], a[180:183], a[140:143], v[132:135]
v_exp_f32 v123, v123
v_mfma_f32_16x16x32_bf16 v[136:139], a[176:179], a[144:147], v[136:139]
ds_read_b128 a[48:51], v6 offset:12288
v_mfma_f32_16x16x32_bf16 v[136:139], a[180:183], a[148:151], v[136:139]
ds_read_b128 a[52:55], v6 offset:13312
v_mfma_f32_16x16x32_bf16 v[140:143], a[176:179], a[152:155], v[140:143]
v_mfma_f32_16x16x32_bf16 v[140:143], a[180:183], a[156:159], v[140:143]
v_mfma_f32_16x16x32_bf16 v[252:255], a[184:187], a[152:155], v[252:255]
v_exp_f32 v124, v124
v_mfma_f32_16x16x32_bf16 v[252:255], a[188:191], a[156:159], v[252:255]
v_exp_f32 v125, v125
v_mfma_f32_16x16x32_bf16 v[248:251], a[184:187], a[144:147], v[248:251]
v_exp_f32 v126, v126
v_mfma_f32_16x16x32_bf16 v[248:251], a[188:191], a[148:151], v[248:251]
v_exp_f32 v127, v127
v_mfma_f32_16x16x32_bf16 v[244:247], a[184:187], a[136:139], v[244:247]
ds_read_b128 a[56:59], v6 offset:14336
v_mfma_f32_16x16x32_bf16 v[244:247], a[188:191], a[140:143], v[244:247]
ds_read_b128 a[60:63], v6 offset:15360
v_mfma_f32_16x16x32_bf16 v[240:243], a[184:187], a[128:131], v[240:243]
ds_read_b128 a[64:67], v6 offset:16384
v_mfma_f32_16x16x32_bf16 v[240:243], a[188:191], a[132:135], v[240:243]
v_pk_fma_f32 v[112:113], v[112:113], v[16:17], v[16:17] op_sel:[0,1,1] op_sel_hi:[1,1,1]
v_pk_fma_f32 v[114:115], v[114:115], v[16:17], v[16:17] op_sel:[0,1,1] op_sel_hi:[1,1,1]
v_pk_fma_f32 v[116:117], v[116:117], v[18:19], v[18:19] op_sel:[0,1,1] op_sel_hi:[1,1,1]
v_pk_fma_f32 v[118:119], v[118:119], v[18:19], v[18:19] op_sel:[0,1,1] op_sel_hi:[1,1,1]
v_pk_fma_f32 v[120:121], v[120:121], v[20:21], v[20:21] op_sel:[0,1,1] op_sel_hi:[1,1,1]
v_pk_fma_f32 v[122:123], v[122:123], v[20:21], v[20:21] op_sel:[0,1,1] op_sel_hi:[1,1,1]
v_pk_fma_f32 v[124:125], v[124:125], v[22:23], v[22:23] op_sel:[0,1,1] op_sel_hi:[1,1,1]
v_pk_fma_f32 v[126:127], v[126:127], v[22:23], v[22:23] op_sel:[0,1,1] op_sel_hi:[1,1,1]
v_rcp_f32 v112, v112
v_rcp_f32 v113, v113
v_rcp_f32 v114, v114
v_rcp_f32 v115, v115
v_rcp_f32 v116, v116
v_rcp_f32 v117, v117
v_rcp_f32 v118, v118
v_rcp_f32 v119, v119
v_rcp_f32 v120, v120
v_rcp_f32 v121, v121
v_rcp_f32 v122, v122
v_rcp_f32 v123, v123
v_rcp_f32 v124, v124
v_rcp_f32 v125, v125
v_rcp_f32 v126, v126
v_rcp_f32 v127, v127
v_pk_mul_f32 v[224:225], v[224:225], v[112:113]
v_pk_mul_f32 v[226:227], v[226:227], v[114:115]
v_pk_mul_f32 v[228:229], v[228:229], v[116:117]
v_pk_mul_f32 v[230:231], v[230:231], v[118:119]
v_pk_mul_f32 v[232:233], v[232:233], v[120:121]
v_pk_mul_f32 v[234:235], v[234:235], v[122:123]
v_pk_mul_f32 v[236:237], v[236:237], v[124:125]
v_pk_mul_f32 v[238:239], v[238:239], v[126:127]
v_cvt_pk_bf16_f32 v112, v224, v225
v_cvt_pk_bf16_f32 v113, v226, v227
v_cvt_pk_bf16_f32 v114, v228, v229
v_cvt_pk_bf16_f32 v115, v230, v231
v_cvt_pk_bf16_f32 v120, v232, v233
v_cvt_pk_bf16_f32 v121, v234, v235
v_cvt_pk_bf16_f32 v122, v236, v237
v_cvt_pk_bf16_f32 v123, v238, v239
v_permlane32_swap_b32 v112, v114
v_permlane32_swap_b32 v113, v115
v_permlane32_swap_b32 v120, v122
v_permlane32_swap_b32 v121, v123
buffer_store_dwordx4 v[112:115], v4, s[36:39], s49 offen offset:0 sc1
buffer_store_dwordx4 v[120:123], v4, s[36:39], s49 offen offset:2048 sc1
s_add_u32 s49, s49, s1
s_waitcnt lgkmcnt(5)
v_pk_fma_f32 v[128:129], v[24:25], v[8:9], v[128:129] op_sel_hi:[1,0,1]
v_pk_fma_f32 v[240:241], v[28:29], v[8:9], v[240:241] op_sel_hi:[1,0,1]
v_pk_fma_f32 v[130:131], v[26:27], v[8:9], v[130:131] op_sel_hi:[1,0,1]
v_pk_fma_f32 v[242:243], v[30:31], v[8:9], v[242:243] op_sel_hi:[1,0,1]
v_pk_fma_f32 v[132:133], v[24:25], v[10:11], v[132:133] op_sel_hi:[1,0,1]
v_pk_fma_f32 v[244:245], v[28:29], v[10:11], v[244:245] op_sel_hi:[1,0,1]
v_pk_fma_f32 v[134:135], v[26:27], v[10:11], v[134:135] op_sel_hi:[1,0,1]
v_pk_fma_f32 v[246:247], v[30:31], v[10:11], v[246:247] op_sel_hi:[1,0,1]
v_pk_fma_f32 v[136:137], v[24:25], v[12:13], v[136:137] op_sel_hi:[1,0,1]
v_pk_fma_f32 v[248:249], v[28:29], v[12:13], v[248:249] op_sel_hi:[1,0,1]
v_pk_fma_f32 v[138:139], v[26:27], v[12:13], v[138:139] op_sel_hi:[1,0,1]
v_pk_fma_f32 v[250:251], v[30:31], v[12:13], v[250:251] op_sel_hi:[1,0,1]
v_pk_fma_f32 v[140:141], v[24:25], v[14:15], v[140:141] op_sel_hi:[1,0,1]
v_pk_fma_f32 v[252:253], v[28:29], v[14:15], v[252:253] op_sel_hi:[1,0,1]
v_pk_fma_f32 v[142:143], v[26:27], v[14:15], v[142:143] op_sel_hi:[1,0,1]
v_pk_fma_f32 v[254:255], v[30:31], v[14:15], v[254:255] op_sel_hi:[1,0,1]
v_pk_mul_f32 v[240:241], v[240:241], v[128:129]
v_pk_mul_f32 v[242:243], v[242:243], v[130:131]
v_pk_mul_f32 v[128:129], v[128:129], v[16:17] op_sel_hi:[1,0]
v_pk_mul_f32 v[130:131], v[130:131], v[16:17] op_sel_hi:[1,0]
v_pk_mul_f32 v[244:245], v[244:245], v[132:133]
v_pk_mul_f32 v[246:247], v[246:247], v[134:135]
v_pk_mul_f32 v[132:133], v[132:133], v[18:19] op_sel_hi:[1,0]
v_pk_mul_f32 v[134:135], v[134:135], v[18:19] op_sel_hi:[1,0]
v_pk_mul_f32 v[248:249], v[248:249], v[136:137]
v_pk_mul_f32 v[250:251], v[250:251], v[138:139]
v_pk_mul_f32 v[136:137], v[136:137], v[20:21] op_sel_hi:[1,0]
v_pk_mul_f32 v[138:139], v[138:139], v[20:21] op_sel_hi:[1,0]
v_pk_mul_f32 v[252:253], v[252:253], v[140:141]
v_pk_mul_f32 v[254:255], v[254:255], v[142:143]
v_pk_mul_f32 v[140:141], v[140:141], v[22:23] op_sel_hi:[1,0]
v_pk_mul_f32 v[142:143], v[142:143], v[22:23] op_sel_hi:[1,0]
v_exp_f32 v128, v128
v_mfma_f32_16x16x32_bf16 v[32:35], a[0:3], a[224:227], v[144:147]
v_exp_f32 v129, v129
v_mfma_f32_16x16x32_bf16 v[36:39], a[4:7], a[224:227], v[144:147]
v_exp_f32 v130, v130
v_mfma_f32_16x16x32_bf16 v[40:43], a[8:11], a[224:227], v[144:147]
v_exp_f32 v131, v131
v_mfma_f32_16x16x32_bf16 v[44:47], a[12:15], a[224:227], v[144:147]
v_exp_f32 v132, v132
v_mfma_f32_16x16x32_bf16 v[48:51], a[16:19], a[224:227], v[148:151]
v_exp_f32 v133, v133
v_mfma_f32_16x16x32_bf16 v[52:55], a[20:23], a[224:227], v[148:151]
v_exp_f32 v134, v134
v_mfma_f32_16x16x32_bf16 v[56:59], a[24:27], a[224:227], v[148:151]
v_exp_f32 v135, v135
v_mfma_f32_16x16x32_bf16 v[60:63], a[28:31], a[224:227], v[148:151]
v_exp_f32 v136, v136
v_mfma_f32_16x16x32_bf16 v[64:67], a[32:35], a[224:227], v[152:155]
v_exp_f32 v137, v137
v_mfma_f32_16x16x32_bf16 v[68:71], a[36:39], a[224:227], v[152:155]
v_exp_f32 v138, v138
v_mfma_f32_16x16x32_bf16 v[72:75], a[40:43], a[224:227], v[152:155]
v_exp_f32 v139, v139
v_mfma_f32_16x16x32_bf16 v[76:79], a[44:47], a[224:227], v[152:155]
v_exp_f32 v140, v140
s_waitcnt lgkmcnt(4)
v_mfma_f32_16x16x32_bf16 v[80:83], a[48:51], a[224:227], v[156:159]
v_exp_f32 v141, v141
s_waitcnt lgkmcnt(3)
v_mfma_f32_16x16x32_bf16 v[84:87], a[52:55], a[224:227], v[156:159]
v_exp_f32 v142, v142
s_waitcnt lgkmcnt(2)
v_mfma_f32_16x16x32_bf16 v[88:91], a[56:59], a[224:227], v[156:159]
v_exp_f32 v143, v143
s_waitcnt lgkmcnt(1)
v_mfma_f32_16x16x32_bf16 v[92:95], a[60:63], a[224:227], v[156:159]
v_pk_fma_f32 v[128:129], v[128:129], v[16:17], v[16:17] op_sel:[0,1,1] op_sel_hi:[1,1,1]
v_pk_fma_f32 v[130:131], v[130:131], v[16:17], v[16:17] op_sel:[0,1,1] op_sel_hi:[1,1,1]
v_pk_fma_f32 v[132:133], v[132:133], v[18:19], v[18:19] op_sel:[0,1,1] op_sel_hi:[1,1,1]
v_pk_fma_f32 v[134:135], v[134:135], v[18:19], v[18:19] op_sel:[0,1,1] op_sel_hi:[1,1,1]
v_pk_fma_f32 v[136:137], v[136:137], v[20:21], v[20:21] op_sel:[0,1,1] op_sel_hi:[1,1,1]
v_pk_fma_f32 v[138:139], v[138:139], v[20:21], v[20:21] op_sel:[0,1,1] op_sel_hi:[1,1,1]
v_pk_fma_f32 v[140:141], v[140:141], v[22:23], v[22:23] op_sel:[0,1,1] op_sel_hi:[1,1,1]
v_pk_fma_f32 v[142:143], v[142:143], v[22:23], v[22:23] op_sel:[0,1,1] op_sel_hi:[1,1,1]
v_rcp_f32 v128, v128
s_waitcnt lgkmcnt(0)
v_mfma_f32_16x16x32_bf16 v[96:99], a[64:67], a[224:227], 0
v_rcp_f32 v129, v129
v_rcp_f32 v130, v130
v_rcp_f32 v131, v131
v_rcp_f32 v132, v132
v_rcp_f32 v133, v133
v_rcp_f32 v134, v134
v_rcp_f32 v135, v135
v_rcp_f32 v136, v136
v_rcp_f32 v137, v137
v_rcp_f32 v138, v138
v_rcp_f32 v139, v139
v_rcp_f32 v140, v140
v_rcp_f32 v141, v141
v_rcp_f32 v142, v142
v_rcp_f32 v143, v143
v_pk_mul_f32 v[240:241], v[240:241], v[128:129]
v_pk_mul_f32 v[242:243], v[242:243], v[130:131]
v_pk_mul_f32 v[244:245], v[244:245], v[132:133]
v_pk_mul_f32 v[246:247], v[246:247], v[134:135]
v_pk_mul_f32 v[248:249], v[248:249], v[136:137]
v_pk_mul_f32 v[250:251], v[250:251], v[138:139]
v_pk_mul_f32 v[252:253], v[252:253], v[140:141]
v_pk_mul_f32 v[254:255], v[254:255], v[142:143]
v_cvt_pk_bf16_f32 v128, v240, v241
v_cvt_pk_bf16_f32 v129, v242, v243
v_cvt_pk_bf16_f32 v130, v244, v245
v_cvt_pk_bf16_f32 v131, v246, v247
v_cvt_pk_bf16_f32 v136, v248, v249
v_cvt_pk_bf16_f32 v137, v250, v251
v_cvt_pk_bf16_f32 v138, v252, v253
v_cvt_pk_bf16_f32 v139, v254, v255
v_permlane32_swap_b32 v128, v130
v_permlane32_swap_b32 v129, v131
v_permlane32_swap_b32 v136, v138
v_permlane32_swap_b32 v137, v139
buffer_store_dwordx4 v[128:131], v4, s[36:39], s49 offen offset:0 sc1
buffer_store_dwordx4 v[136:139], v4, s[36:39], s49 offen offset:2048 sc1
v_max3_f32 v164, v36, v37, v38
ds_read_b128 a[68:71], v6 offset:17408
v_max3_f32 v165, v39, v40, v41
ds_read_b128 a[72:75], v6 offset:18432
v_max3_f32 v166, v42, v43, v44
ds_read_b128 a[76:79], v6 offset:19456
v_max3_f32 v167, v45, v46, v47
v_mfma_f32_16x16x32_bf16 v[176:179], a[4:7], a[228:231], v[144:147]
ds_read_b128 a[144:147], v6 offset:49152
v_max3_f32 v164, v164, v48, v49
ds_read_b128 a[148:151], v6 offset:50176
v_max3_f32 v165, v165, v50, v51
ds_read_b128 a[80:83], v6 offset:32768
v_max3_f32 v166, v166, v52, v53
ds_read_b128 a[84:87], v6 offset:33792
v_max3_f32 v167, v167, v54, v55
v_mfma_f32_16x16x32_bf16 v[180:183], a[8:11], a[228:231], v[144:147]
ds_read_b128 a[88:91], v6 offset:34816
v_cndmask_b32 v32, v32, v96, s[72:73]
ds_read_b128 a[92:95], v6 offset:35840
v_cndmask_b32 v33, v33, v97, s[74:75]
v_mov_b32 v168, 0x3f803f80
v_cndmask_b32 v34, v34, v98, s[76:77]
v_accvgpr_write_b32 a176, v168
v_cndmask_b32 v35, v35, v99, s[78:79]
v_mfma_f32_16x16x32_bf16 v[184:187], a[12:15], a[228:231], v[144:147]
v_accvgpr_write_b32 a177, v168
v_max3_f32 v164, v164, v56, v57
v_accvgpr_write_b32 a178, v168
v_max3_f32 v165, v165, v58, v59
v_accvgpr_write_b32 a179, v168
v_max3_f32 v166, v166, v60, v61
v_accvgpr_read_b32 v160, a242
v_max3_f32 v167, v167, v62, v63
v_mfma_f32_16x16x32_bf16 v[188:191], a[16:19], a[228:231], v[148:151]
v_accvgpr_read_b32 v161, a243
v_max3_f32 v164, v164, v64, v65
v_accvgpr_read_b32 v162, a244
v_max3_f32 v165, v165, v66, v67
v_accvgpr_read_b32 v163, a245
v_max3_f32 v166, v166, v68, v69
v_cmp_eq_u32 vcc, 0, v0
v_max3_f32 v167, v167, v70, v71
v_mfma_f32_16x16x32_bf16 v[192:195], a[20:23], a[228:231], v[148:151]
v_bfrev_b32 v24, 1
v_max3_f32 v164, v164, v72, v73
v_cndmask_b32_e64 v24, v24, 0, vcc
v_max3_f32 v165, v165, v74, v75
v_mov_b32 v25, 1
v_max3_f32 v166, v166, v76, v77
v_max3_f32 v167, v167, v78, v79
v_max3_f32 v164, v164, v80, v81
v_max3_f32 v165, v165, v82, v83
v_max3_f32 v166, v166, v84, v85
v_max3_f32 v167, v167, v86, v87
v_max3_f32 v164, v164, v88, v89
v_max3_f32 v165, v165, v90, v91
v_max3_f32 v166, v166, v92, v93
v_max3_f32 v167, v167, v94, v95
v_max3_f32 v164, v164, v32, v33
v_max3_f32 v165, v165, v34, v35
v_max_f32 v166, v166, v167
v_max3_f32 v164, v164, v165, v166
v_mov_b32 v165, v164
v_mov_b32 v134, 0
v_mov_b32 v135, 0
v_permlane16_swap_b32 v164, v165
v_max_f32 v164, v164, v165
v_mov_b32 v165, v164
s_nop 0
s_nop 0
v_permlane32_swap_b32 v164, v165
v_max_f32 v164, v164, v165
v_pk_add_f32 v[32:33], v[32:33], v[164:165] op_sel_hi:[1,0] neg_lo:[0,1] neg_hi:[0,1]
v_pk_add_f32 v[34:35], v[34:35], v[164:165] op_sel_hi:[1,0] neg_lo:[0,1] neg_hi:[0,1]
v_pk_add_f32 v[36:37], v[36:37], v[164:165] op_sel_hi:[1,0] neg_lo:[0,1] neg_hi:[0,1]
v_pk_add_f32 v[38:39], v[38:39], v[164:165] op_sel_hi:[1,0] neg_lo:[0,1] neg_hi:[0,1]
v_pk_add_f32 v[40:41], v[40:41], v[164:165] op_sel_hi:[1,0] neg_lo:[0,1] neg_hi:[0,1]
v_pk_add_f32 v[42:43], v[42:43], v[164:165] op_sel_hi:[1,0] neg_lo:[0,1] neg_hi:[0,1]
v_pk_add_f32 v[44:45], v[44:45], v[164:165] op_sel_hi:[1,0] neg_lo:[0,1] neg_hi:[0,1]
v_pk_add_f32 v[46:47], v[46:47], v[164:165] op_sel_hi:[1,0] neg_lo:[0,1] neg_hi:[0,1]
v_pk_add_f32 v[48:49], v[48:49], v[164:165] op_sel_hi:[1,0] neg_lo:[0,1] neg_hi:[0,1]
v_pk_add_f32 v[50:51], v[50:51], v[164:165] op_sel_hi:[1,0] neg_lo:[0,1] neg_hi:[0,1]
v_pk_add_f32 v[52:53], v[52:53], v[164:165] op_sel_hi:[1,0] neg_lo:[0,1] neg_hi:[0,1]
v_pk_add_f32 v[54:55], v[54:55], v[164:165] op_sel_hi:[1,0] neg_lo:[0,1] neg_hi:[0,1]
v_pk_add_f32 v[56:57], v[56:57], v[164:165] op_sel_hi:[1,0] neg_lo:[0,1] neg_hi:[0,1]
v_pk_add_f32 v[58:59], v[58:59], v[164:165] op_sel_hi:[1,0] neg_lo:[0,1] neg_hi:[0,1]
v_pk_add_f32 v[60:61], v[60:61], v[164:165] op_sel_hi:[1,0] neg_lo:[0,1] neg_hi:[0,1]
v_pk_add_f32 v[62:63], v[62:63], v[164:165] op_sel_hi:[1,0] neg_lo:[0,1] neg_hi:[0,1]
v_pk_add_f32 v[64:65], v[64:65], v[164:165] op_sel_hi:[1,0] neg_lo:[0,1] neg_hi:[0,1]
v_pk_add_f32 v[66:67], v[66:67], v[164:165] op_sel_hi:[1,0] neg_lo:[0,1] neg_hi:[0,1]
v_pk_add_f32 v[68:69], v[68:69], v[164:165] op_sel_hi:[1,0] neg_lo:[0,1] neg_hi:[0,1]
v_pk_add_f32 v[70:71], v[70:71], v[164:165] op_sel_hi:[1,0] neg_lo:[0,1] neg_hi:[0,1]
v_pk_add_f32 v[72:73], v[72:73], v[164:165] op_sel_hi:[1,0] neg_lo:[0,1] neg_hi:[0,1]
v_pk_add_f32 v[74:75], v[74:75], v[164:165] op_sel_hi:[1,0] neg_lo:[0,1] neg_hi:[0,1]
v_pk_add_f32 v[76:77], v[76:77], v[164:165] op_sel_hi:[1,0] neg_lo:[0,1] neg_hi:[0,1]
v_pk_add_f32 v[78:79], v[78:79], v[164:165] op_sel_hi:[1,0] neg_lo:[0,1] neg_hi:[0,1]
v_pk_add_f32 v[80:81], v[80:81], v[164:165] op_sel_hi:[1,0] neg_lo:[0,1] neg_hi:[0,1]
v_pk_add_f32 v[82:83], v[82:83], v[164:165] op_sel_hi:[1,0] neg_lo:[0,1] neg_hi:[0,1]
v_pk_add_f32 v[84:85], v[84:85], v[164:165] op_sel_hi:[1,0] neg_lo:[0,1] neg_hi:[0,1]
v_pk_add_f32 v[86:87], v[86:87], v[164:165] op_sel_hi:[1,0] neg_lo:[0,1] neg_hi:[0,1]
v_pk_add_f32 v[88:89], v[88:89], v[164:165] op_sel_hi:[1,0] neg_lo:[0,1] neg_hi:[0,1]
v_pk_add_f32 v[90:91], v[90:91], v[164:165] op_sel_hi:[1,0] neg_lo:[0,1] neg_hi:[0,1]
v_pk_add_f32 v[92:93], v[92:93], v[164:165] op_sel_hi:[1,0] neg_lo:[0,1] neg_hi:[0,1]
v_pk_add_f32 v[94:95], v[94:95], v[164:165] op_sel_hi:[1,0] neg_lo:[0,1] neg_hi:[0,1]
v_exp_f32 v32, v32
ds_read_b128 a[96:99], v6 offset:36864
v_exp_f32 v33, v33
v_mfma_f32_16x16x32_bf16 v[196:199], a[24:27], a[228:231], v[148:151]
ds_read_b128 a[100:103], v6 offset:37888
v_exp_f32 v34, v34
ds_read_b128 a[104:107], v6 offset:38912
v_exp_f32 v35, v35
v_mfma_f32_16x16x32_bf16 v[200:203], a[28:31], a[228:231], v[148:151]
v_exp_f32 v36, v36
ds_read_b128 a[108:111], v6 offset:39936
v_exp_f32 v37, v37
v_mfma_f32_16x16x32_bf16 v[204:207], a[32:35], a[228:231], v[152:155]
ds_read_b128 a[112:115], v6 offset:40960
v_exp_f32 v38, v38
ds_read_b128 a[116:119], v6 offset:41984
v_exp_f32 v39, v39
v_mfma_f32_16x16x32_bf16 v[208:211], a[36:39], a[228:231], v[152:155]
v_cvt_pk_bf16_f32 v32, v32, v33
v_cvt_pk_bf16_f32 v33, v34, v35
v_mfma_f32_16x16x32_bf16 v[212:215], a[40:43], a[228:231], v[152:155]
v_and_b32 v132, v32, v160
v_and_b32 v133, v33, v161
v_mfma_f32_16x16x32_bf16 v[216:219], a[44:47], a[228:231], v[152:155]
v_and_b32 v100, v32, v162
v_and_b32 v101, v33, v163
v_mfma_f32_16x16x32_bf16 v[220:223], a[48:51], a[228:231], v[156:159]
v_exp_f32 v40, v40
ds_read_b128 a[120:123], v6 offset:43008
v_exp_f32 v41, v41
s_waitcnt lgkmcnt(11)
v_mfma_f32_16x16x32_bf16 v[244:247], a[144:147], v[132:135], 0
ds_read_b128 a[124:127], v6 offset:44032
v_exp_f32 v42, v42
ds_read_b128 a[128:131], v6 offset:45056
v_exp_f32 v43, v43
v_mfma_f32_16x16x32_bf16 v[248:251], a[148:151], v[132:135], 0
ds_read_b128 a[132:135], v6 offset:46080
v_cvt_pk_bf16_f32 v102, v36, v37
v_cvt_pk_bf16_f32 v103, v38, v39
v_mfma_f32_16x16x32_bf16 v[252:255], a[176:179], v[132:135], 0
v_exp_f32 v44, v44
ds_read_b128 a[136:139], v6 offset:47104
v_exp_f32 v45, v45
s_waitcnt lgkmcnt(13)
v_mfma_f32_16x16x32_bf16 v[244:247], a[80:83], v[100:103], v[244:247]
ds_read_b128 a[140:143], v6 offset:48128
v_exp_f32 v46, v46
ds_read_b128 a[152:155], v6 offset:51200
v_exp_f32 v47, v47
v_mfma_f32_16x16x32_bf16 v[248:251], a[84:87], v[100:103], v[248:251]
v_cvt_pk_bf16_f32 v104, v40, v41
v_cvt_pk_bf16_f32 v105, v42, v43
v_mfma_f32_16x16x32_bf16 v[252:255], a[176:179], v[100:103], v[252:255]
v_exp_f32 v48, v48
ds_read_b128 a[156:159], v6 offset:52224
v_exp_f32 v49, v49
v_mfma_f32_16x16x32_bf16 v[224:227], a[52:55], a[228:231], v[156:159]
v_accvgpr_read_b32 v12, a246
v_exp_f32 v50, v50
v_accvgpr_read_b32 v13, a247
v_exp_f32 v51, v51
v_mfma_f32_16x16x32_bf16 v[228:231], a[56:59], a[228:231], v[156:159]
v_cvt_pk_bf16_f32 v106, v44, v45
v_cvt_pk_bf16_f32 v107, v46, v47
v_mfma_f32_16x16x32_bf16 v[232:235], a[60:63], a[228:231], v[156:159]
v_exp_f32 v52, v52
v_accvgpr_read_b32 v14, a248
v_exp_f32 v53, v53
s_waitcnt lgkmcnt(14)
v_mfma_f32_16x16x32_bf16 v[244:247], a[88:91], v[104:107], v[244:247]
v_accvgpr_read_b32 v15, a249
v_exp_f32 v54, v54
v_and_b32 v26, 7, v0
v_exp_f32 v55, v55
v_mfma_f32_16x16x32_bf16 v[248:251], a[92:95], v[104:107], v[248:251]
v_lshlrev_b32 v26, 9, v26
v_cvt_pk_bf16_f32 v108, v48, v49
v_cvt_pk_bf16_f32 v109, v50, v51
v_mfma_f32_16x16x32_bf16 v[252:255], a[176:179], v[104:107], v[252:255]
v_exp_f32 v56, v56
s_waitcnt vmcnt(0)
v_exp_f32 v57, v57
v_mfma_f32_16x16x32_bf16 v[236:239], a[64:67], a[228:231], 0
buffer_store_dword v25, v24, s[36:39], s63 offen offset:4 sc1
v_exp_f32 v58, v58
v_exp_f32 v59, v59
v_mfma_f32_16x16x32_bf16 v[240:243], a[68:71], a[228:231], 0
v_cvt_pk_bf16_f32 v110, v52, v53
v_cvt_pk_bf16_f32 v111, v54, v55
v_exp_f32 v60, v60
s_add_u32 m0, s85, 98304
v_exp_f32 v61, v61
s_waitcnt lgkmcnt(12)
v_mfma_f32_16x16x32_bf16 v[244:247], a[96:99], v[108:111], v[244:247]
buffer_load_dwordx4 v7, s[28:31], s84 offen offset:0 lds
v_exp_f32 v62, v62
v_exp_f32 v63, v63
v_mfma_f32_16x16x32_bf16 v[248:251], a[100:103], v[108:111], v[248:251]
v_cvt_pk_bf16_f32 v112, v56, v57
v_cvt_pk_bf16_f32 v113, v58, v59
v_mfma_f32_16x16x32_bf16 v[252:255], a[176:179], v[108:111], v[252:255]
v_exp_f32 v64, v64
s_add_u32 s84, s84, 15360
v_exp_f32 v65, v65
buffer_load_dwordx4 v7, s[28:31], s84 offen offset:1024 lds
v_exp_f32 v66, v66
v_exp_f32 v67, v67
v_cvt_pk_bf16_f32 v114, v60, v61
v_cvt_pk_bf16_f32 v115, v62, v63
v_exp_f32 v68, v68
s_add_u32 s84, s84, 15360
v_exp_f32 v69, v69
s_waitcnt lgkmcnt(10)
v_mfma_f32_16x16x32_bf16 v[244:247], a[104:107], v[112:115], v[244:247]
buffer_load_dwordx4 v7, s[28:31], s84 offen offset:2048 lds
v_exp_f32 v70, v70
v_exp_f32 v71, v71
v_mfma_f32_16x16x32_bf16 v[248:251], a[108:111], v[112:115], v[248:251]
v_cvt_pk_bf16_f32 v116, v64, v65
v_cvt_pk_bf16_f32 v117, v66, v67
v_mfma_f32_16x16x32_bf16 v[252:255], a[176:179], v[112:115], v[252:255]
v_exp_f32 v72, v72
s_add_u32 s84, s84, 15360
v_exp_f32 v73, v73
buffer_load_dwordx4 v7, s[28:31], s84 offen offset:3072 lds
v_exp_f32 v74, v74
v_exp_f32 v75, v75
v_cvt_pk_bf16_f32 v118, v68, v69
v_cvt_pk_bf16_f32 v119, v70, v71
v_exp_f32 v76, v76
s_add_u32 s84, s84, 19456
v_exp_f32 v77, v77
s_waitcnt lgkmcnt(8)
v_mfma_f32_16x16x32_bf16 v[244:247], a[112:115], v[116:119], v[244:247]
s_add_u32 m0, s85, 102400
v_exp_f32 v78, v78
v_exp_f32 v79, v79
v_mfma_f32_16x16x32_bf16 v[248:251], a[116:119], v[116:119], v[248:251]
v_cvt_pk_bf16_f32 v120, v72, v73
v_cvt_pk_bf16_f32 v121, v74, v75
v_mfma_f32_16x16x32_bf16 v[252:255], a[176:179], v[116:119], v[252:255]
v_exp_f32 v80, v80
buffer_load_dwordx4 v7, s[28:31], s84 offen offset:0 lds
v_exp_f32 v81, v81
s_add_u32 s84, s84, 15360
v_exp_f32 v82, v82
v_exp_f32 v83, v83
v_cvt_pk_bf16_f32 v122, v76, v77
v_cvt_pk_bf16_f32 v123, v78, v79
v_exp_f32 v84, v84
buffer_load_dwordx4 v7, s[28:31], s84 offen offset:1024 lds
v_exp_f32 v85, v85
s_waitcnt lgkmcnt(6)
v_mfma_f32_16x16x32_bf16 v[244:247], a[120:123], v[120:123], v[244:247]
s_add_u32 s84, s84, 15360
v_exp_f32 v86, v86
v_exp_f32 v87, v87
v_mfma_f32_16x16x32_bf16 v[248:251], a[124:127], v[120:123], v[248:251]
v_cvt_pk_bf16_f32 v124, v80, v81
v_cvt_pk_bf16_f32 v125, v82, v83
v_mfma_f32_16x16x32_bf16 v[252:255], a[176:179], v[120:123], v[252:255]
v_exp_f32 v88, v88
buffer_load_dwordx4 v7, s[28:31], s84 offen offset:2048 lds
v_exp_f32 v89, v89
s_add_u32 s84, s84, 15360
v_exp_f32 v90, v90
v_exp_f32 v91, v91
v_cvt_pk_bf16_f32 v126, v84, v85
v_cvt_pk_bf16_f32 v127, v86, v87
v_exp_f32 v92, v92
buffer_load_dwordx4 v7, s[28:31], s84 offen offset:3072 lds
v_exp_f32 v93, v93
s_waitcnt lgkmcnt(4)
v_mfma_f32_16x16x32_bf16 v[244:247], a[128:131], v[124:127], v[244:247]
s_add_u32 s84, s84, 19456
v_exp_f32 v94, v94
v_exp_f32 v95, v95
v_mfma_f32_16x16x32_bf16 v[248:251], a[132:135], v[124:127], v[248:251]
v_cvt_pk_bf16_f32 v128, v88, v89
v_cvt_pk_bf16_f32 v129, v90, v91
v_mfma_f32_16x16x32_bf16 v[252:255], a[176:179], v[124:127], v[252:255]
v_cvt_pk_bf16_f32 v130, v92, v93
v_cvt_pk_bf16_f32 v131, v94, v95
s_waitcnt lgkmcnt(2)
s_nop 0
v_mfma_f32_16x16x32_bf16 v[244:247], a[136:139], v[128:131], v[244:247]
v_mfma_f32_16x16x32_bf16 v[248:251], a[140:143], v[128:131], v[248:251]
v_mfma_f32_16x16x32_bf16 v[252:255], a[176:179], v[128:131], v[252:255]
v_max3_f32 v164, v180, v181, v182
s_waitcnt lgkmcnt(0)
v_max3_f32 v165, v183, v184, v185
s_barrier
v_max3_f32 v166, v186, v187, v188
v_max3_f32 v167, v189, v190, v191
v_mfma_f32_16x16x32_bf16 v[32:35], a[8:11], a[232:235], v[144:147]
v_max3_f32 v164, v164, v192, v193
v_max3_f32 v165, v165, v194, v195
v_max3_f32 v166, v166, v196, v197
v_max3_f32 v167, v167, v198, v199
v_mfma_f32_16x16x32_bf16 v[36:39], a[12:15], a[232:235], v[144:147]
v_cndmask_b32 v176, v176, v240, s[72:73]
v_cndmask_b32 v177, v177, v241, s[74:75]
v_cndmask_b32 v178, v178, v242, s[76:77]
v_rcp_f32 v252, v252
v_cndmask_b32 v179, v179, v243, s[78:79]
v_mfma_f32_16x16x32_bf16 v[40:43], a[16:19], a[232:235], v[148:151]
v_mul_f32 v244, v244, v252
v_max3_f32 v164, v164, v200, v201
v_mul_f32 v245, v245, v252
v_max3_f32 v165, v165, v202, v203
v_mul_f32 v246, v246, v252
v_max3_f32 v166, v166, v204, v205
v_mul_f32 v247, v247, v252
v_max3_f32 v167, v167, v206, v207
v_mfma_f32_16x16x32_bf16 v[44:47], a[20:23], a[232:235], v[148:151]
v_mul_f32 v248, v248, v252
v_max3_f32 v164, v164, v208, v209
v_mul_f32 v249, v249, v252
v_max3_f32 v165, v165, v210, v211
v_mul_f32 v250, v250, v252
v_max3_f32 v166, v166, v212, v213
v_mul_f32 v251, v251, v252
v_max3_f32 v167, v167, v214, v215
v_mfma_f32_16x16x32_bf16 v[48:51], a[24:27], a[232:235], v[148:151]
v_cvt_pk_bf16_f32 v168, v244, v245
v_max3_f32 v164, v164, v216, v217
v_cvt_pk_bf16_f32 v169, v246, v247
v_max3_f32 v165, v165, v218, v219
v_cvt_pk_bf16_f32 v170, v248, v249
v_max3_f32 v166, v166, v220, v221
v_cvt_pk_bf16_f32 v171, v250, v251
v_max3_f32 v167, v167, v222, v223
v_permlane32_swap_b32 v168, v170
v_max3_f32 v164, v164, v224, v225
v_permlane32_swap_b32 v169, v171
v_max3_f32 v165, v165, v226, v227
buffer_store_dwordx4 v[168:171], v1, s[36:39], s69 offen offset:0 sc1
v_max3_f32 v166, v166, v228, v229
v_max3_f32 v167, v167, v230, v231
v_max3_f32 v164, v164, v232, v233
v_max3_f32 v165, v165, v234, v235
v_max3_f32 v166, v166, v236, v237
v_max3_f32 v167, v167, v238, v239
v_max3_f32 v164, v164, v176, v177
v_max3_f32 v165, v165, v178, v179
v_max_f32 v166, v166, v167
v_max3_f32 v164, v164, v165, v166
v_mov_b32 v165, v164
v_mov_b32 v100, 0
v_mov_b32 v101, 0
v_permlane16_swap_b32 v164, v165
v_max_f32 v164, v164, v165
v_mov_b32 v165, v164
s_nop 0
s_nop 0
v_permlane32_swap_b32 v164, v165
v_max_f32 v164, v164, v165
v_pk_add_f32 v[176:177], v[176:177], v[164:165] op_sel_hi:[1,0] neg_lo:[0,1] neg_hi:[0,1]
v_pk_add_f32 v[178:179], v[178:179], v[164:165] op_sel_hi:[1,0] neg_lo:[0,1] neg_hi:[0,1]
v_pk_add_f32 v[180:181], v[180:181], v[164:165] op_sel_hi:[1,0] neg_lo:[0,1] neg_hi:[0,1]
v_pk_add_f32 v[182:183], v[182:183], v[164:165] op_sel_hi:[1,0] neg_lo:[0,1] neg_hi:[0,1]
v_pk_add_f32 v[184:185], v[184:185], v[164:165] op_sel_hi:[1,0] neg_lo:[0,1] neg_hi:[0,1]
v_pk_add_f32 v[186:187], v[186:187], v[164:165] op_sel_hi:[1,0] neg_lo:[0,1] neg_hi:[0,1]
v_pk_add_f32 v[188:189], v[188:189], v[164:165] op_sel_hi:[1,0] neg_lo:[0,1] neg_hi:[0,1]
v_pk_add_f32 v[190:191], v[190:191], v[164:165] op_sel_hi:[1,0] neg_lo:[0,1] neg_hi:[0,1]
v_pk_add_f32 v[192:193], v[192:193], v[164:165] op_sel_hi:[1,0] neg_lo:[0,1] neg_hi:[0,1]
v_pk_add_f32 v[194:195], v[194:195], v[164:165] op_sel_hi:[1,0] neg_lo:[0,1] neg_hi:[0,1]
v_pk_add_f32 v[196:197], v[196:197], v[164:165] op_sel_hi:[1,0] neg_lo:[0,1] neg_hi:[0,1]
v_pk_add_f32 v[198:199], v[198:199], v[164:165] op_sel_hi:[1,0] neg_lo:[0,1] neg_hi:[0,1]
v_pk_add_f32 v[200:201], v[200:201], v[164:165] op_sel_hi:[1,0] neg_lo:[0,1] neg_hi:[0,1]
v_pk_add_f32 v[202:203], v[202:203], v[164:165] op_sel_hi:[1,0] neg_lo:[0,1] neg_hi:[0,1]
v_pk_add_f32 v[204:205], v[204:205], v[164:165] op_sel_hi:[1,0] neg_lo:[0,1] neg_hi:[0,1]
v_pk_add_f32 v[206:207], v[206:207], v[164:165] op_sel_hi:[1,0] neg_lo:[0,1] neg_hi:[0,1]
v_pk_add_f32 v[208:209], v[208:209], v[164:165] op_sel_hi:[1,0] neg_lo:[0,1] neg_hi:[0,1]
v_pk_add_f32 v[210:211], v[210:211], v[164:165] op_sel_hi:[1,0] neg_lo:[0,1] neg_hi:[0,1]
v_pk_add_f32 v[212:213], v[212:213], v[164:165] op_sel_hi:[1,0] neg_lo:[0,1] neg_hi:[0,1]
v_pk_add_f32 v[214:215], v[214:215], v[164:165] op_sel_hi:[1,0] neg_lo:[0,1] neg_hi:[0,1]
v_pk_add_f32 v[216:217], v[216:217], v[164:165] op_sel_hi:[1,0] neg_lo:[0,1] neg_hi:[0,1]
v_pk_add_f32 v[218:219], v[218:219], v[164:165] op_sel_hi:[1,0] neg_lo:[0,1] neg_hi:[0,1]
v_pk_add_f32 v[220:221], v[220:221], v[164:165] op_sel_hi:[1,0] neg_lo:[0,1] neg_hi:[0,1]
v_pk_add_f32 v[222:223], v[222:223], v[164:165] op_sel_hi:[1,0] neg_lo:[0,1] neg_hi:[0,1]
v_pk_add_f32 v[224:225], v[224:225], v[164:165] op_sel_hi:[1,0] neg_lo:[0,1] neg_hi:[0,1]
v_pk_add_f32 v[226:227], v[226:227], v[164:165] op_sel_hi:[1,0] neg_lo:[0,1] neg_hi:[0,1]
v_pk_add_f32 v[228:229], v[228:229], v[164:165] op_sel_hi:[1,0] neg_lo:[0,1] neg_hi:[0,1]
v_pk_add_f32 v[230:231], v[230:231], v[164:165] op_sel_hi:[1,0] neg_lo:[0,1] neg_hi:[0,1]
v_pk_add_f32 v[232:233], v[232:233], v[164:165] op_sel_hi:[1,0] neg_lo:[0,1] neg_hi:[0,1]
v_pk_add_f32 v[234:235], v[234:235], v[164:165] op_sel_hi:[1,0] neg_lo:[0,1] neg_hi:[0,1]
v_pk_add_f32 v[236:237], v[236:237], v[164:165] op_sel_hi:[1,0] neg_lo:[0,1] neg_hi:[0,1]
v_pk_add_f32 v[238:239], v[238:239], v[164:165] op_sel_hi:[1,0] neg_lo:[0,1] neg_hi:[0,1]
v_exp_f32 v176, v176
s_add_u32 m0, s85, 131072
v_exp_f32 v177, v177
v_mfma_f32_16x16x32_bf16 v[52:55], a[28:31], a[232:235], v[148:151]
buffer_load_dwordx4 v7, s[28:31], s84 offen offset:0 lds
v_exp_f32 v178, v178
v_exp_f32 v179, v179
v_mfma_f32_16x16x32_bf16 v[56:59], a[32:35], a[232:235], v[152:155]
v_exp_f32 v180, v180
s_add_u32 s84, s84, 15360
v_exp_f32 v181, v181
v_mfma_f32_16x16x32_bf16 v[60:63], a[36:39], a[232:235], v[152:155]
buffer_load_dwordx4 v7, s[28:31], s84 offen offset:1024 lds
v_exp_f32 v182, v182
v_exp_f32 v183, v183
v_mfma_f32_16x16x32_bf16 v[64:67], a[40:43], a[232:235], v[152:155]
v_cvt_pk_bf16_f32 v176, v176, v177
v_cvt_pk_bf16_f32 v177, v178, v179
v_mfma_f32_16x16x32_bf16 v[68:71], a[44:47], a[232:235], v[152:155]
v_and_b32 v134, v176, v160
v_and_b32 v135, v177, v161
v_mfma_f32_16x16x32_bf16 v[72:75], a[48:51], a[232:235], v[156:159]
v_and_b32 v102, v176, v162
v_and_b32 v103, v177, v163
v_mfma_f32_16x16x32_bf16 v[76:79], a[52:55], a[232:235], v[156:159]
v_exp_f32 v184, v184
s_add_u32 s84, s84, 15360
v_exp_f32 v185, v185
v_mfma_f32_16x16x32_bf16 v[244:247], a[80:83], v[100:103], 0
buffer_load_dwordx4 v7, s[28:31], s84 offen offset:2048 lds
v_exp_f32 v186, v186
v_exp_f32 v187, v187
v_mfma_f32_16x16x32_bf16 v[248:251], a[84:87], v[100:103], 0
v_cvt_pk_bf16_f32 v104, v180, v181
v_cvt_pk_bf16_f32 v105, v182, v183
v_mfma_f32_16x16x32_bf16 v[252:255], a[176:179], v[100:103], 0
v_exp_f32 v188, v188
s_add_u32 s84, s84, 15360
v_exp_f32 v189, v189
v_mfma_f32_16x16x32_bf16 v[80:83], a[56:59], a[232:235], v[156:159]
buffer_load_dwordx4 v7, s[28:31], s84 offen offset:3072 lds
v_exp_f32 v190, v190
s_add_u32 s84, s84, 19456
v_exp_f32 v191, v191
v_mfma_f32_16x16x32_bf16 v[84:87], a[60:63], a[232:235], v[156:159]
v_cvt_pk_bf16_f32 v106, v184, v185
v_cvt_pk_bf16_f32 v107, v186, v187
v_mfma_f32_16x16x32_bf16 v[88:91], a[64:67], a[232:235], 0
v_exp_f32 v192, v192
s_add_u32 m0, s85, 135168
v_exp_f32 v193, v193
v_mfma_f32_16x16x32_bf16 v[244:247], a[88:91], v[104:107], v[244:247]
buffer_load_dwordx4 v7, s[28:31], s84 offen offset:0 lds
v_exp_f32 v194, v194
v_exp_f32 v195, v195
v_mfma_f32_16x16x32_bf16 v[248:251], a[92:95], v[104:107], v[248:251]
v_cvt_pk_bf16_f32 v108, v188, v189
v_cvt_pk_bf16_f32 v109, v190, v191
v_mfma_f32_16x16x32_bf16 v[252:255], a[176:179], v[104:107], v[252:255]
v_exp_f32 v196, v196
s_add_u32 s84, s84, 15360
v_exp_f32 v197, v197
v_mfma_f32_16x16x32_bf16 v[92:95], a[68:71], a[232:235], 0
buffer_load_dwordx4 v7, s[28:31], s84 offen offset:1024 lds
v_exp_f32 v198, v198
v_exp_f32 v199, v199
v_mfma_f32_16x16x32_bf16 v[96:99], a[72:75], a[232:235], 0
v_cvt_pk_bf16_f32 v110, v192, v193
v_cvt_pk_bf16_f32 v111, v194, v195
v_exp_f32 v200, v200
s_add_u32 s84, s84, 15360
v_exp_f32 v201, v201
v_mfma_f32_16x16x32_bf16 v[244:247], a[96:99], v[108:111], v[244:247]
buffer_load_dwordx4 v7, s[28:31], s84 offen offset:2048 lds
v_exp_f32 v202, v202
v_exp_f32 v203, v203
v_mfma_f32_16x16x32_bf16 v[248:251], a[100:103], v[108:111], v[248:251]
v_cvt_pk_bf16_f32 v112, v196, v197
v_cvt_pk_bf16_f32 v113, v198, v199
v_mfma_f32_16x16x32_bf16 v[252:255], a[176:179], v[108:111], v[252:255]
v_exp_f32 v204, v204
s_add_u32 s84, s84, 15360
v_exp_f32 v205, v205
buffer_load_dwordx4 v7, s[28:31], s84 offen offset:3072 lds
v_exp_f32 v206, v206
s_add_u32 s84, s84, 19456
v_exp_f32 v207, v207
v_cvt_pk_bf16_f32 v114, v200, v201
v_cvt_pk_bf16_f32 v115, v202, v203
v_exp_f32 v208, v208
s_add_u32 m0, s85, 0
v_exp_f32 v209, v209
v_mfma_f32_16x16x32_bf16 v[244:247], a[104:107], v[112:115], v[244:247]
buffer_load_dwordx4 v7, s[28:31], s84 offen offset:0 lds
v_exp_f32 v210, v210
v_exp_f32 v211, v211
v_mfma_f32_16x16x32_bf16 v[248:251], a[108:111], v[112:115], v[248:251]
v_cvt_pk_bf16_f32 v116, v204, v205
v_cvt_pk_bf16_f32 v117, v206, v207
v_mfma_f32_16x16x32_bf16 v[252:255], a[176:179], v[112:115], v[252:255]
v_exp_f32 v212, v212
s_add_u32 s84, s84, 15360
v_exp_f32 v213, v213
buffer_load_dwordx4 v7, s[28:31], s84 offen offset:1024 lds
v_exp_f32 v214, v214
v_exp_f32 v215, v215
v_cvt_pk_bf16_f32 v118, v208, v209
v_cvt_pk_bf16_f32 v119, v210, v211
v_exp_f32 v216, v216
s_add_u32 s84, s84, 15360
v_exp_f32 v217, v217
v_mfma_f32_16x16x32_bf16 v[244:247], a[112:115], v[116:119], v[244:247]
buffer_load_dwordx4 v7, s[28:31], s84 offen offset:2048 lds
v_exp_f32 v218, v218
v_exp_f32 v219, v219
v_mfma_f32_16x16x32_bf16 v[248:251], a[116:119], v[116:119], v[248:251]
v_cvt_pk_bf16_f32 v120, v212, v213
v_cvt_pk_bf16_f32 v121, v214, v215
v_mfma_f32_16x16x32_bf16 v[252:255], a[176:179], v[116:119], v[252:255]
v_exp_f32 v220, v220
s_add_u32 s84, s84, 15360
v_exp_f32 v221, v221
buffer_load_dwordx4 v7, s[28:31], s84 offen offset:3072 lds
v_exp_f32 v222, v222
s_add_u32 s84, s84, 19456
v_exp_f32 v223, v223
v_cvt_pk_bf16_f32 v122, v216, v217
v_cvt_pk_bf16_f32 v123, v218, v219
v_exp_f32 v224, v224
s_add_u32 m0, s85, 4096
v_exp_f32 v225, v225
v_mfma_f32_16x16x32_bf16 v[244:247], a[120:123], v[120:123], v[244:247]
buffer_load_dwordx4 v7, s[28:31], s84 offen offset:0 lds
v_exp_f32 v226, v226
v_exp_f32 v227, v227
v_mfma_f32_16x16x32_bf16 v[248:251], a[124:127], v[120:123], v[248:251]
v_cvt_pk_bf16_f32 v124, v220, v221
v_cvt_pk_bf16_f32 v125, v222, v223
v_mfma_f32_16x16x32_bf16 v[252:255], a[176:179], v[120:123], v[252:255]
v_exp_f32 v228, v228
s_add_u32 s84, s84, 15360
v_exp_f32 v229, v229
buffer_load_dwordx4 v7, s[28:31], s84 offen offset:1024 lds
v_exp_f32 v230, v230
v_exp_f32 v231, v231
v_cvt_pk_bf16_f32 v126, v224, v225
v_cvt_pk_bf16_f32 v127, v226, v227
v_exp_f32 v232, v232
s_add_u32 s84, s84, 15360
v_exp_f32 v233, v233
v_mfma_f32_16x16x32_bf16 v[244:247], a[128:131], v[124:127], v[244:247]
buffer_load_dwordx4 v7, s[28:31], s84 offen offset:2048 lds
v_exp_f32 v234, v234
v_exp_f32 v235, v235
v_mfma_f32_16x16x32_bf16 v[248:251], a[132:135], v[124:127], v[248:251]
v_cvt_pk_bf16_f32 v128, v228, v229
v_cvt_pk_bf16_f32 v129, v230, v231
v_mfma_f32_16x16x32_bf16 v[252:255], a[176:179], v[124:127], v[252:255]
v_exp_f32 v236, v236
s_add_u32 s84, s84, 15360
v_exp_f32 v237, v237
buffer_load_dwordx4 v7, s[28:31], s84 offen offset:3072 lds
v_exp_f32 v238, v238
s_add_u32 s84, s84, 19456
v_exp_f32 v239, v239
v_cvt_pk_bf16_f32 v130, v232, v233
v_cvt_pk_bf16_f32 v131, v234, v235
v_cvt_pk_bf16_f32 v132, v236, v237
v_cvt_pk_bf16_f32 v133, v238, v239
v_mfma_f32_16x16x32_bf16 v[244:247], a[136:139], v[128:131], v[244:247]
v_mfma_f32_16x16x32_bf16 v[248:251], a[140:143], v[128:131], v[248:251]
v_mfma_f32_16x16x32_bf16 v[252:255], a[176:179], v[128:131], v[252:255]
v_mfma_f32_16x16x32_bf16 v[244:247], a[144:147], v[132:135], v[244:247]
v_mfma_f32_16x16x32_bf16 v[248:251], a[148:151], v[132:135], v[248:251]
v_mfma_f32_16x16x32_bf16 v[252:255], a[176:179], v[132:135], v[252:255]
v_max3_f32 v164, v36, v37, v38
buffer_load_dword v27, v26, s[36:39], s62 offen sc1
v_max3_f32 v165, v39, v40, v41
v_max3_f32 v166, v42, v43, v44
v_max3_f32 v167, v45, v46, v47
v_mfma_f32_16x16x32_bf16 v[176:179], a[12:15], a[236:239], v[144:147]
v_max3_f32 v164, v164, v48, v49
v_max3_f32 v165, v165, v50, v51
v_max3_f32 v166, v166, v52, v53
v_max3_f32 v167, v167, v54, v55
v_mfma_f32_16x16x32_bf16 v[180:183], a[16:19], a[236:239], v[148:151]
v_cndmask_b32 v32, v32, v96, s[72:73]
v_cndmask_b32 v33, v33, v97, s[74:75]
v_cndmask_b32 v34, v34, v98, s[76:77]
v_rcp_f32 v252, v252
v_cndmask_b32 v35, v35, v99, s[78:79]
v_mfma_f32_16x16x32_bf16 v[184:187], a[20:23], a[236:239], v[148:151]
v_mul_f32 v244, v244, v252
v_max3_f32 v164, v164, v56, v57
v_mul_f32 v245, v245, v252
v_max3_f32 v165, v165, v58, v59
v_mul_f32 v246, v246, v252
v_max3_f32 v166, v166, v60, v61
v_mul_f32 v247, v247, v252
v_max3_f32 v167, v167, v62, v63
v_mfma_f32_16x16x32_bf16 v[188:191], a[24:27], a[236:239], v[148:151]
v_mul_f32 v248, v248, v252
v_max3_f32 v164, v164, v64, v65
v_mul_f32 v249, v249, v252
v_max3_f32 v165, v165, v66, v67
v_mul_f32 v250, v250, v252
v_max3_f32 v166, v166, v68, v69
v_mul_f32 v251, v251, v252
v_max3_f32 v167, v167, v70, v71
v_mfma_f32_16x16x32_bf16 v[192:195], a[28:31], a[236:239], v[148:151]
v_cvt_pk_bf16_f32 v172, v244, v245
v_max3_f32 v164, v164, v72, v73
v_cvt_pk_bf16_f32 v173, v246, v247
v_max3_f32 v165, v165, v74, v75
v_cvt_pk_bf16_f32 v174, v248, v249
v_max3_f32 v166, v166, v76, v77
v_cvt_pk_bf16_f32 v175, v250, v251
v_max3_f32 v167, v167, v78, v79
v_permlane32_swap_b32 v172, v174
v_max3_f32 v164, v164, v80, v81
v_permlane32_swap_b32 v173, v175
v_max3_f32 v165, v165, v82, v83
buffer_store_dwordx4 v[172:175], v1, s[36:39], s69 offen offset:1024 sc1
v_max3_f32 v166, v166, v84, v85
v_max3_f32 v167, v167, v86, v87
v_max3_f32 v164, v164, v88, v89
v_max3_f32 v165, v165, v90, v91
v_max3_f32 v166, v166, v92, v93
v_max3_f32 v167, v167, v94, v95
v_max3_f32 v164, v164, v32, v33
v_max3_f32 v165, v165, v34, v35
v_max_f32 v166, v166, v167
v_max3_f32 v164, v164, v165, v166
v_mov_b32 v165, v164
v_mov_b32 v134, 0
v_mov_b32 v135, 0
v_permlane16_swap_b32 v164, v165
v_max_f32 v164, v164, v165
v_mov_b32 v165, v164
s_nop 0
s_nop 0
v_permlane32_swap_b32 v164, v165
v_max_f32 v164, v164, v165
v_pk_add_f32 v[32:33], v[32:33], v[164:165] op_sel_hi:[1,0] neg_lo:[0,1] neg_hi:[0,1]
v_pk_add_f32 v[34:35], v[34:35], v[164:165] op_sel_hi:[1,0] neg_lo:[0,1] neg_hi:[0,1]
v_pk_add_f32 v[36:37], v[36:37], v[164:165] op_sel_hi:[1,0] neg_lo:[0,1] neg_hi:[0,1]
v_pk_add_f32 v[38:39], v[38:39], v[164:165] op_sel_hi:[1,0] neg_lo:[0,1] neg_hi:[0,1]
v_pk_add_f32 v[40:41], v[40:41], v[164:165] op_sel_hi:[1,0] neg_lo:[0,1] neg_hi:[0,1]
v_pk_add_f32 v[42:43], v[42:43], v[164:165] op_sel_hi:[1,0] neg_lo:[0,1] neg_hi:[0,1]
v_pk_add_f32 v[44:45], v[44:45], v[164:165] op_sel_hi:[1,0] neg_lo:[0,1] neg_hi:[0,1]
v_pk_add_f32 v[46:47], v[46:47], v[164:165] op_sel_hi:[1,0] neg_lo:[0,1] neg_hi:[0,1]
v_pk_add_f32 v[48:49], v[48:49], v[164:165] op_sel_hi:[1,0] neg_lo:[0,1] neg_hi:[0,1]
v_pk_add_f32 v[50:51], v[50:51], v[164:165] op_sel_hi:[1,0] neg_lo:[0,1] neg_hi:[0,1]
v_pk_add_f32 v[52:53], v[52:53], v[164:165] op_sel_hi:[1,0] neg_lo:[0,1] neg_hi:[0,1]
v_pk_add_f32 v[54:55], v[54:55], v[164:165] op_sel_hi:[1,0] neg_lo:[0,1] neg_hi:[0,1]
v_pk_add_f32 v[56:57], v[56:57], v[164:165] op_sel_hi:[1,0] neg_lo:[0,1] neg_hi:[0,1]
v_pk_add_f32 v[58:59], v[58:59], v[164:165] op_sel_hi:[1,0] neg_lo:[0,1] neg_hi:[0,1]
v_pk_add_f32 v[60:61], v[60:61], v[164:165] op_sel_hi:[1,0] neg_lo:[0,1] neg_hi:[0,1]
v_pk_add_f32 v[62:63], v[62:63], v[164:165] op_sel_hi:[1,0] neg_lo:[0,1] neg_hi:[0,1]
v_pk_add_f32 v[64:65], v[64:65], v[164:165] op_sel_hi:[1,0] neg_lo:[0,1] neg_hi:[0,1]
v_pk_add_f32 v[66:67], v[66:67], v[164:165] op_sel_hi:[1,0] neg_lo:[0,1] neg_hi:[0,1]
v_pk_add_f32 v[68:69], v[68:69], v[164:165] op_sel_hi:[1,0] neg_lo:[0,1] neg_hi:[0,1]
v_pk_add_f32 v[70:71], v[70:71], v[164:165] op_sel_hi:[1,0] neg_lo:[0,1] neg_hi:[0,1]
v_pk_add_f32 v[72:73], v[72:73], v[164:165] op_sel_hi:[1,0] neg_lo:[0,1] neg_hi:[0,1]
v_pk_add_f32 v[74:75], v[74:75], v[164:165] op_sel_hi:[1,0] neg_lo:[0,1] neg_hi:[0,1]
v_pk_add_f32 v[76:77], v[76:77], v[164:165] op_sel_hi:[1,0] neg_lo:[0,1] neg_hi:[0,1]
v_pk_add_f32 v[78:79], v[78:79], v[164:165] op_sel_hi:[1,0] neg_lo:[0,1] neg_hi:[0,1]
v_pk_add_f32 v[80:81], v[80:81], v[164:165] op_sel_hi:[1,0] neg_lo:[0,1] neg_hi:[0,1]
v_pk_add_f32 v[82:83], v[82:83], v[164:165] op_sel_hi:[1,0] neg_lo:[0,1] neg_hi:[0,1]
v_pk_add_f32 v[84:85], v[84:85], v[164:165] op_sel_hi:[1,0] neg_lo:[0,1] neg_hi:[0,1]
v_pk_add_f32 v[86:87], v[86:87], v[164:165] op_sel_hi:[1,0] neg_lo:[0,1] neg_hi:[0,1]
v_pk_add_f32 v[88:89], v[88:89], v[164:165] op_sel_hi:[1,0] neg_lo:[0,1] neg_hi:[0,1]
v_pk_add_f32 v[90:91], v[90:91], v[164:165] op_sel_hi:[1,0] neg_lo:[0,1] neg_hi:[0,1]
v_pk_add_f32 v[92:93], v[92:93], v[164:165] op_sel_hi:[1,0] neg_lo:[0,1] neg_hi:[0,1]
v_pk_add_f32 v[94:95], v[94:95], v[164:165] op_sel_hi:[1,0] neg_lo:[0,1] neg_hi:[0,1]
v_exp_f32 v32, v32
s_add_u32 m0, s85, 32768
v_exp_f32 v33, v33
v_mfma_f32_16x16x32_bf16 v[196:199], a[32:35], a[236:239], v[152:155]
buffer_load_dwordx4 v7, s[28:31], s84 offen offset:0 lds
v_exp_f32 v34, v34
v_exp_f32 v35, v35
v_mfma_f32_16x16x32_bf16 v[200:203], a[36:39], a[236:239], v[152:155]
v_exp_f32 v36, v36
s_add_u32 s84, s84, 15360
v_exp_f32 v37, v37
v_mfma_f32_16x16x32_bf16 v[204:207], a[40:43], a[236:239], v[152:155]
buffer_load_dwordx4 v7, s[28:31], s84 offen offset:1024 lds
v_exp_f32 v38, v38
s_add_u32 s84, s84, 15360
v_exp_f32 v39, v39
v_mfma_f32_16x16x32_bf16 v[208:211], a[44:47], a[236:239], v[152:155]
v_cvt_pk_bf16_f32 v32, v32, v33
v_cvt_pk_bf16_f32 v33, v34, v35
v_mfma_f32_16x16x32_bf16 v[212:215], a[48:51], a[236:239], v[156:159]
v_and_b32 v132, v32, v160
v_and_b32 v133, v33, v161
v_mfma_f32_16x16x32_bf16 v[216:219], a[52:55], a[236:239], v[156:159]
v_and_b32 v100, v32, v162
v_and_b32 v101, v33, v163
v_mfma_f32_16x16x32_bf16 v[220:223], a[56:59], a[236:239], v[156:159]
v_exp_f32 v40, v40
buffer_load_dwordx4 v7, s[28:31], s84 offen offset:2048 lds
v_exp_f32 v41, v41
v_mfma_f32_16x16x32_bf16 v[244:247], a[152:155], v[132:135], 0
s_add_u32 s84, s84, 15360
v_exp_f32 v42, v42
v_exp_f32 v43, v43
v_mfma_f32_16x16x32_bf16 v[248:251], a[156:159], v[132:135], 0
v_cvt_pk_bf16_f32 v102, v36, v37
v_cvt_pk_bf16_f32 v103, v38, v39
v_mfma_f32_16x16x32_bf16 v[252:255], a[176:179], v[132:135], 0
v_exp_f32 v44, v44
buffer_load_dwordx4 v7, s[28:31], s84 offen offset:3072 lds
v_exp_f32 v45, v45
v_mfma_f32_16x16x32_bf16 v[244:247], a[88:91], v[100:103], v[244:247]
s_add_u32 s84, s84, 19456
v_exp_f32 v46, v46
s_add_u32 m0, s85, 36864
v_exp_f32 v47, v47
v_mfma_f32_16x16x32_bf16 v[248:251], a[92:95], v[100:103], v[248:251]
v_cvt_pk_bf16_f32 v104, v40, v41
v_cvt_pk_bf16_f32 v105, v42, v43
v_mfma_f32_16x16x32_bf16 v[252:255], a[176:179], v[100:103], v[252:255]
v_exp_f32 v48, v48
buffer_load_dwordx4 v7, s[28:31], s84 offen offset:0 lds
v_exp_f32 v49, v49
v_mfma_f32_16x16x32_bf16 v[224:227], a[60:63], a[236:239], v[156:159]
s_add_u32 s84, s84, 15360
v_exp_f32 v50, v50
v_exp_f32 v51, v51
v_mfma_f32_16x16x32_bf16 v[228:231], a[64:67], a[236:239], 0
v_cvt_pk_bf16_f32 v106, v44, v45
v_cvt_pk_bf16_f32 v107, v46, v47
v_mfma_f32_16x16x32_bf16 v[232:235], a[68:71], a[236:239], 0
v_exp_f32 v52, v52
buffer_load_dwordx4 v7, s[28:31], s84 offen offset:1024 lds
v_exp_f32 v53, v53
v_mfma_f32_16x16x32_bf16 v[244:247], a[96:99], v[104:107], v[244:247]
s_add_u32 s84, s84, 15360
v_exp_f32 v54, v54
buffer_load_dwordx4 v7, s[28:31], s84 offen offset:2048 lds
v_exp_f32 v55, v55
v_mfma_f32_16x16x32_bf16 v[248:251], a[100:103], v[104:107], v[248:251]
v_cvt_pk_bf16_f32 v108, v48, v49
v_cvt_pk_bf16_f32 v109, v50, v51
v_mfma_f32_16x16x32_bf16 v[252:255], a[176:179], v[104:107], v[252:255]
v_exp_f32 v56, v56
s_add_u32 s84, s84, 15360
v_exp_f32 v57, v57
v_mfma_f32_16x16x32_bf16 v[236:239], a[72:75], a[236:239], 0
buffer_load_dwordx4 v7, s[28:31], s84 offen offset:3072 lds
v_exp_f32 v58, v58
s_add_u32 s84, s84, 19456
v_exp_f32 v59, v59
v_mfma_f32_16x16x32_bf16 v[240:243], a[76:79], a[236:239], 0
v_cvt_pk_bf16_f32 v110, v52, v53
v_cvt_pk_bf16_f32 v111, v54, v55
v_exp_f32 v60, v60
s_waitcnt vmcnt(9)
v_exp_f32 v61, v61
v_mfma_f32_16x16x32_bf16 v[244:247], a[104:107], v[108:111], v[244:247]
v_cmp_ne_u32 vcc, 1, v27
s_cbranch_vccnz L_pl3_slow
L_pl3_ok:
v_exp_f32 v62, v62
v_exp_f32 v63, v63
v_mfma_f32_16x16x32_bf16 v[248:251], a[108:111], v[108:111], v[248:251]
v_cvt_pk_bf16_f32 v112, v56, v57
v_cvt_pk_bf16_f32 v113, v58, v59
v_mfma_f32_16x16x32_bf16 v[252:255], a[176:179], v[108:111], v[252:255]
v_exp_f32 v64, v64
buffer_load_dwordx4 a[192:195], v1, s[36:39], s82 offen offset:0 sc1
v_exp_f32 v65, v65
v_exp_f32 v66, v66
v_exp_f32 v67, v67
v_cvt_pk_bf16_f32 v114, v60, v61
v_cvt_pk_bf16_f32 v115, v62, v63
v_exp_f32 v68, v68
buffer_load_dwordx4 a[196:199], v1, s[36:39], s83 offen offset:0 sc1
v_exp_f32 v69, v69
v_mfma_f32_16x16x32_bf16 v[244:247], a[112:115], v[112:115], v[244:247]
v_exp_f32 v70, v70
v_exp_f32 v71, v71
v_mfma_f32_16x16x32_bf16 v[248:251], a[116:119], v[112:115], v[248:251]
v_cvt_pk_bf16_f32 v116, v64, v65
v_cvt_pk_bf16_f32 v117, v66, v67
v_mfma_f32_16x16x32_bf16 v[252:255], a[176:179], v[112:115], v[252:255]
v_exp_f32 v72, v72
buffer_load_dwordx4 a[200:203], v1, s[36:39], s82 offen offset:1024 sc1
v_exp_f32 v73, v73
v_exp_f32 v74, v74
v_exp_f32 v75, v75
v_cvt_pk_bf16_f32 v118, v68, v69
v_cvt_pk_bf16_f32 v119, v70, v71
v_exp_f32 v76, v76
buffer_load_dwordx4 a[204:207], v1, s[36:39], s83 offen offset:1024 sc1
v_exp_f32 v77, v77
v_mfma_f32_16x16x32_bf16 v[244:247], a[120:123], v[116:119], v[244:247]
buffer_load_dwordx4 a[208:211], v1, s[36:39], s82 offen offset:2048 sc1
v_exp_f32 v78, v78
v_exp_f32 v79, v79
v_mfma_f32_16x16x32_bf16 v[248:251], a[124:127], v[116:119], v[248:251]
v_cvt_pk_bf16_f32 v120, v72, v73
v_cvt_pk_bf16_f32 v121, v74, v75
v_mfma_f32_16x16x32_bf16 v[252:255], a[176:179], v[116:119], v[252:255]
v_exp_f32 v80, v80
buffer_load_dwordx4 a[212:215], v1, s[36:39], s83 offen offset:2048 sc1
v_exp_f32 v81, v81
v_exp_f32 v82, v82
v_exp_f32 v83, v83
v_cvt_pk_bf16_f32 v122, v76, v77
v_cvt_pk_bf16_f32 v123, v78, v79
v_exp_f32 v84, v84
buffer_load_dwordx4 a[216:219], v1, s[36:39], s82 offen offset:3072 sc1
v_exp_f32 v85, v85
v_mfma_f32_16x16x32_bf16 v[244:247], a[128:131], v[120:123], v[244:247]
v_exp_f32 v86, v86
v_exp_f32 v87, v87
v_mfma_f32_16x16x32_bf16 v[248:251], a[132:135], v[120:123], v[248:251]
v_cvt_pk_bf16_f32 v124, v80, v81
v_cvt_pk_bf16_f32 v125, v82, v83
v_mfma_f32_16x16x32_bf16 v[252:255], a[176:179], v[120:123], v[252:255]
v_exp_f32 v88, v88
s_add_u32 s82, s82, 16384
v_exp_f32 v89, v89
v_exp_f32 v90, v90
v_exp_f32 v91, v91
v_cvt_pk_bf16_f32 v126, v84, v85
v_cvt_pk_bf16_f32 v127, v86, v87
v_exp_f32 v92, v92
buffer_load_dwordx4 a[220:223], v1, s[36:39], s83 offen offset:3072 sc1
v_exp_f32 v93, v93
v_mfma_f32_16x16x32_bf16 v[244:247], a[136:139], v[124:127], v[244:247]
s_add_u32 s83, s83, 16384
v_exp_f32 v94, v94
v_exp_f32 v95, v95
v_mfma_f32_16x16x32_bf16 v[248:251], a[140:143], v[124:127], v[248:251]
v_cvt_pk_bf16_f32 v128, v88, v89
v_cvt_pk_bf16_f32 v129, v90, v91
v_mfma_f32_16x16x32_bf16 v[252:255], a[176:179], v[124:127], v[252:255]
v_cvt_pk_bf16_f32 v130, v92, v93
v_cvt_pk_bf16_f32 v131, v94, v95
s_nop 1
v_mfma_f32_16x16x32_bf16 v[244:247], a[144:147], v[128:131], v[244:247]
v_mfma_f32_16x16x32_bf16 v[248:251], a[148:151], v[128:131], v[248:251]
v_mfma_f32_16x16x32_bf16 v[252:255], a[176:179], v[128:131], v[252:255]
v_max3_f32 v164, v180, v181, v182
buffer_load_dwordx4 a[0:3], v1, s[36:39], s82 offen offset:0 sc1
v_max3_f32 v165, v183, v184, v185
v_max3_f32 v166, v186, v187, v188
v_max3_f32 v167, v189, v190, v191
v_max3_f32 v164, v164, v192, v193
v_max3_f32 v165, v165, v194, v195
v_max3_f32 v166, v166, v196, v197
v_max3_f32 v167, v167, v198, v199
v_cndmask_b32 v176, v176, v240, s[72:73]
v_cndmask_b32 v177, v177, v241, s[74:75]
v_cndmask_b32 v178, v178, v242, s[76:77]
v_rcp_f32 v252, v252
v_cndmask_b32 v179, v179, v243, s[78:79]
v_mul_f32 v244, v244, v252
v_max3_f32 v164, v164, v200, v201
v_mul_f32 v245, v245, v252
v_max3_f32 v165, v165, v202, v203
v_mul_f32 v246, v246, v252
v_max3_f32 v166, v166, v204, v205
v_mul_f32 v247, v247, v252
v_max3_f32 v167, v167, v206, v207
v_mul_f32 v248, v248, v252
v_max3_f32 v164, v164, v208, v209
v_mul_f32 v249, v249, v252
v_max3_f32 v165, v165, v210, v211
v_mul_f32 v250, v250, v252
v_max3_f32 v166, v166, v212, v213
v_mul_f32 v251, v251, v252
v_max3_f32 v167, v167, v214, v215
v_cvt_pk_bf16_f32 v168, v244, v245
v_max3_f32 v164, v164, v216, v217
v_cvt_pk_bf16_f32 v169, v246, v247
v_max3_f32 v165, v165, v218, v219
v_cvt_pk_bf16_f32 v170, v248, v249
v_max3_f32 v166, v166, v220, v221
v_cvt_pk_bf16_f32 v171, v250, v251
v_max3_f32 v167, v167, v222, v223
v_permlane32_swap_b32 v168, v170
v_max3_f32 v164, v164, v224, v225
v_permlane32_swap_b32 v169, v171
v_max3_f32 v165, v165, v226, v227
buffer_store_dwordx4 v[168:171], v1, s[36:39], s69 offen offset:2048 sc1
v_max3_f32 v166, v166, v228, v229
v_max3_f32 v167, v167, v230, v231
v_max3_f32 v164, v164, v232, v233
v_max3_f32 v165, v165, v234, v235
v_max3_f32 v166, v166, v236, v237
v_max3_f32 v167, v167, v238, v239
v_max3_f32 v164, v164, v176, v177
v_max3_f32 v165, v165, v178, v179
v_max_f32 v166, v166, v167
v_max3_f32 v164, v164, v165, v166
v_mov_b32 v165, v164
v_mov_b32 v100, 0
v_mov_b32 v101, 0
v_permlane16_swap_b32 v164, v165
v_max_f32 v164, v164, v165
v_mov_b32 v165, v164
s_nop 0
s_nop 0
v_permlane32_swap_b32 v164, v165
v_max_f32 v164, v164, v165
v_pk_add_f32 v[176:177], v[176:177], v[164:165] op_sel_hi:[1,0] neg_lo:[0,1] neg_hi:[0,1]
v_pk_add_f32 v[178:179], v[178:179], v[164:165] op_sel_hi:[1,0] neg_lo:[0,1] neg_hi:[0,1]
v_pk_add_f32 v[180:181], v[180:181], v[164:165] op_sel_hi:[1,0] neg_lo:[0,1] neg_hi:[0,1]
v_pk_add_f32 v[182:183], v[182:183], v[164:165] op_sel_hi:[1,0] neg_lo:[0,1] neg_hi:[0,1]
v_pk_add_f32 v[184:185], v[184:185], v[164:165] op_sel_hi:[1,0] neg_lo:[0,1] neg_hi:[0,1]
v_pk_add_f32 v[186:187], v[186:187], v[164:165] op_sel_hi:[1,0] neg_lo:[0,1] neg_hi:[0,1]
v_pk_add_f32 v[188:189], v[188:189], v[164:165] op_sel_hi:[1,0] neg_lo:[0,1] neg_hi:[0,1]
v_pk_add_f32 v[190:191], v[190:191], v[164:165] op_sel_hi:[1,0] neg_lo:[0,1] neg_hi:[0,1]
v_pk_add_f32 v[192:193], v[192:193], v[164:165] op_sel_hi:[1,0] neg_lo:[0,1] neg_hi:[0,1]
v_pk_add_f32 v[194:195], v[194:195], v[164:165] op_sel_hi:[1,0] neg_lo:[0,1] neg_hi:[0,1]
v_pk_add_f32 v[196:197], v[196:197], v[164:165] op_sel_hi:[1,0] neg_lo:[0,1] neg_hi:[0,1]
v_pk_add_f32 v[198:199], v[198:199], v[164:165] op_sel_hi:[1,0] neg_lo:[0,1] neg_hi:[0,1]
v_pk_add_f32 v[200:201], v[200:201], v[164:165] op_sel_hi:[1,0] neg_lo:[0,1] neg_hi:[0,1]
v_pk_add_f32 v[202:203], v[202:203], v[164:165] op_sel_hi:[1,0] neg_lo:[0,1] neg_hi:[0,1]
v_pk_add_f32 v[204:205], v[204:205], v[164:165] op_sel_hi:[1,0] neg_lo:[0,1] neg_hi:[0,1]
v_pk_add_f32 v[206:207], v[206:207], v[164:165] op_sel_hi:[1,0] neg_lo:[0,1] neg_hi:[0,1]
v_pk_add_f32 v[208:209], v[208:209], v[164:165] op_sel_hi:[1,0] neg_lo:[0,1] neg_hi:[0,1]
v_pk_add_f32 v[210:211], v[210:211], v[164:165] op_sel_hi:[1,0] neg_lo:[0,1] neg_hi:[0,1]
v_pk_add_f32 v[212:213], v[212:213], v[164:165] op_sel_hi:[1,0] neg_lo:[0,1] neg_hi:[0,1]
v_pk_add_f32 v[214:215], v[214:215], v[164:165] op_sel_hi:[1,0] neg_lo:[0,1] neg_hi:[0,1]
v_pk_add_f32 v[216:217], v[216:217], v[164:165] op_sel_hi:[1,0] neg_lo:[0,1] neg_hi:[0,1]
v_pk_add_f32 v[218:219], v[218:219], v[164:165] op_sel_hi:[1,0] neg_lo:[0,1] neg_hi:[0,1]
v_pk_add_f32 v[220:221], v[220:221], v[164:165] op_sel_hi:[1,0] neg_lo:[0,1] neg_hi:[0,1]
v_pk_add_f32 v[222:223], v[222:223], v[164:165] op_sel_hi:[1,0] neg_lo:[0,1] neg_hi:[0,1]
v_pk_add_f32 v[224:225], v[224:225], v[164:165] op_sel_hi:[1,0] neg_lo:[0,1] neg_hi:[0,1]
v_pk_add_f32 v[226:227], v[226:227], v[164:165] op_sel_hi:[1,0] neg_lo:[0,1] neg_hi:[0,1]
v_pk_add_f32 v[228:229], v[228:229], v[164:165] op_sel_hi:[1,0] neg_lo:[0,1] neg_hi:[0,1]
v_pk_add_f32 v[230:231], v[230:231], v[164:165] op_sel_hi:[1,0] neg_lo:[0,1] neg_hi:[0,1]
v_pk_add_f32 v[232:233], v[232:233], v[164:165] op_sel_hi:[1,0] neg_lo:[0,1] neg_hi:[0,1]
v_pk_add_f32 v[234:235], v[234:235], v[164:165] op_sel_hi:[1,0] neg_lo:[0,1] neg_hi:[0,1]
v_pk_add_f32 v[236:237], v[236:237], v[164:165] op_sel_hi:[1,0] neg_lo:[0,1] neg_hi:[0,1]
v_pk_add_f32 v[238:239], v[238:239], v[164:165] op_sel_hi:[1,0] neg_lo:[0,1] neg_hi:[0,1]
v_exp_f32 v176, v176
buffer_load_dwordx4 a[4:7], v1, s[36:39], s83 offen offset:0 sc1
v_exp_f32 v177, v177
v_exp_f32 v178, v178
v_exp_f32 v179, v179
v_exp_f32 v180, v180
buffer_load_dwordx4 a[8:11], v1, s[36:39], s82 offen offset:1024 sc1
v_exp_f32 v181, v181
v_exp_f32 v182, v182
v_exp_f32 v183, v183
v_cvt_pk_bf16_f32 v176, v176, v177
v_cvt_pk_bf16_f32 v177, v178, v179
v_and_b32 v134, v176, v160
v_and_b32 v135, v177, v161
v_and_b32 v102, v176, v162
v_and_b32 v103, v177, v163
v_exp_f32 v184, v184
buffer_load_dwordx4 a[12:15], v1, s[36:39], s83 offen offset:1024 sc1
v_exp_f32 v185, v185
v_mfma_f32_16x16x32_bf16 v[244:247], a[88:91], v[100:103], 0
v_exp_f32 v186, v186
v_exp_f32 v187, v187
v_mfma_f32_16x16x32_bf16 v[248:251], a[92:95], v[100:103], 0
v_cvt_pk_bf16_f32 v104, v180, v181
v_cvt_pk_bf16_f32 v105, v182, v183
v_mfma_f32_16x16x32_bf16 v[252:255], a[176:179], v[100:103], 0
v_exp_f32 v188, v188
buffer_load_dwordx4 a[16:19], v1, s[36:39], s82 offen offset:2048 sc1
v_exp_f32 v189, v189
v_exp_f32 v190, v190
v_exp_f32 v191, v191
v_cvt_pk_bf16_f32 v106, v184, v185
v_cvt_pk_bf16_f32 v107, v186, v187
v_exp_f32 v192, v192
buffer_load_dwordx4 a[20:23], v1, s[36:39], s83 offen offset:2048 sc1
v_exp_f32 v193, v193
v_mfma_f32_16x16x32_bf16 v[244:247], a[96:99], v[104:107], v[244:247]
buffer_load_dwordx4 a[24:27], v1, s[36:39], s82 offen offset:3072 sc1
v_exp_f32 v194, v194
v_exp_f32 v195, v195
v_mfma_f32_16x16x32_bf16 v[248:251], a[100:103], v[104:107], v[248:251]
v_cvt_pk_bf16_f32 v108, v188, v189
v_cvt_pk_bf16_f32 v109, v190, v191
v_mfma_f32_16x16x32_bf16 v[252:255], a[176:179], v[104:107], v[252:255]
v_exp_f32 v196, v196
s_add_u32 s82, s82, 16384
v_exp_f32 v197, v197
v_exp_f32 v198, v198
v_exp_f32 v199, v199
v_cvt_pk_bf16_f32 v110, v192, v193
v_cvt_pk_bf16_f32 v111, v194, v195
v_exp_f32 v200, v200
buffer_load_dwordx4 a[28:31], v1, s[36:39], s83 offen offset:3072 sc1
v_exp_f32 v201, v201
v_mfma_f32_16x16x32_bf16 v[244:247], a[104:107], v[108:111], v[244:247]
v_exp_f32 v202, v202
v_exp_f32 v203, v203
v_mfma_f32_16x16x32_bf16 v[248:251], a[108:111], v[108:111], v[248:251]
v_cvt_pk_bf16_f32 v112, v196, v197
v_cvt_pk_bf16_f32 v113, v198, v199
v_mfma_f32_16x16x32_bf16 v[252:255], a[176:179], v[108:111], v[252:255]
v_exp_f32 v204, v204
s_add_u32 s83, s83, 16384
v_exp_f32 v205, v205
v_exp_f32 v206, v206
v_exp_f32 v207, v207
v_cvt_pk_bf16_f32 v114, v200, v201
v_cvt_pk_bf16_f32 v115, v202, v203
v_exp_f32 v208, v208
buffer_load_dwordx4 a[32:35], v1, s[36:39], s82 offen offset:0 sc1
v_exp_f32 v209, v209
v_mfma_f32_16x16x32_bf16 v[244:247], a[112:115], v[112:115], v[244:247]
v_exp_f32 v210, v210
v_exp_f32 v211, v211
v_mfma_f32_16x16x32_bf16 v[248:251], a[116:119], v[112:115], v[248:251]
v_cvt_pk_bf16_f32 v116, v204, v205
v_cvt_pk_bf16_f32 v117, v206, v207
v_mfma_f32_16x16x32_bf16 v[252:255], a[176:179], v[112:115], v[252:255]
v_exp_f32 v212, v212
buffer_load_dwordx4 a[36:39], v1, s[36:39], s83 offen offset:0 sc1
v_exp_f32 v213, v213
v_exp_f32 v214, v214
v_exp_f32 v215, v215
v_cvt_pk_bf16_f32 v118, v208, v209
v_cvt_pk_bf16_f32 v119, v210, v211
v_exp_f32 v216, v216
buffer_load_dwordx4 a[40:43], v1, s[36:39], s82 offen offset:1024 sc1
v_exp_f32 v217, v217
v_mfma_f32_16x16x32_bf16 v[244:247], a[120:123], v[116:119], v[244:247]
buffer_load_dwordx4 a[44:47], v1, s[36:39], s83 offen offset:1024 sc1
v_exp_f32 v218, v218
v_exp_f32 v219, v219
v_mfma_f32_16x16x32_bf16 v[248:251], a[124:127], v[116:119], v[248:251]
v_cvt_pk_bf16_f32 v120, v212, v213
v_cvt_pk_bf16_f32 v121, v214, v215
v_mfma_f32_16x16x32_bf16 v[252:255], a[176:179], v[116:119], v[252:255]
v_exp_f32 v220, v220
buffer_load_dwordx4 a[48:51], v1, s[36:39], s82 offen offset:2048 sc1
v_exp_f32 v221, v221
v_exp_f32 v222, v222
v_exp_f32 v223, v223
v_cvt_pk_bf16_f32 v122, v216, v217
v_cvt_pk_bf16_f32 v123, v218, v219
v_exp_f32 v224, v224
buffer_load_dwordx4 a[52:55], v1, s[36:39], s83 offen offset:2048 sc1
v_exp_f32 v225, v225
v_mfma_f32_16x16x32_bf16 v[244:247], a[128:131], v[120:123], v[244:247]
v_exp_f32 v226, v226
v_exp_f32 v227, v227
v_mfma_f32_16x16x32_bf16 v[248:251], a[132:135], v[120:123], v[248:251]
v_cvt_pk_bf16_f32 v124, v220, v221
v_cvt_pk_bf16_f32 v125, v222, v223
v_mfma_f32_16x16x32_bf16 v[252:255], a[176:179], v[120:123], v[252:255]
v_exp_f32 v228, v228
buffer_load_dwordx4 a[56:59], v1, s[36:39], s82 offen offset:3072 sc1
v_exp_f32 v229, v229
v_exp_f32 v230, v230
v_exp_f32 v231, v231
v_cvt_pk_bf16_f32 v126, v224, v225
v_cvt_pk_bf16_f32 v127, v226, v227
v_exp_f32 v232, v232
s_add_u32 s82, s82, 16384
v_exp_f32 v233, v233
v_mfma_f32_16x16x32_bf16 v[244:247], a[136:139], v[124:127], v[244:247]
v_exp_f32 v234, v234
v_exp_f32 v235, v235
v_mfma_f32_16x16x32_bf16 v[248:251], a[140:143], v[124:127], v[248:251]
v_cvt_pk_bf16_f32 v128, v228, v229
v_cvt_pk_bf16_f32 v129, v230, v231
v_mfma_f32_16x16x32_bf16 v[252:255], a[176:179], v[124:127], v[252:255]
v_exp_f32 v236, v236
buffer_load_dwordx4 a[60:63], v1, s[36:39], s83 offen offset:3072 sc1
v_exp_f32 v237, v237
s_add_u32 s83, s83, 16384
v_exp_f32 v238, v238
v_exp_f32 v239, v239
v_cvt_pk_bf16_f32 v130, v232, v233
v_cvt_pk_bf16_f32 v131, v234, v235
v_cvt_pk_bf16_f32 v132, v236, v237
v_cvt_pk_bf16_f32 v133, v238, v239
v_mfma_f32_16x16x32_bf16 v[244:247], a[144:147], v[128:131], v[244:247]
v_mfma_f32_16x16x32_bf16 v[248:251], a[148:151], v[128:131], v[248:251]
v_mfma_f32_16x16x32_bf16 v[252:255], a[176:179], v[128:131], v[252:255]
v_mfma_f32_16x16x32_bf16 v[244:247], a[152:155], v[132:135], v[244:247]
v_mfma_f32_16x16x32_bf16 v[248:251], a[156:159], v[132:135], v[248:251]
v_mfma_f32_16x16x32_bf16 v[252:255], a[176:179], v[132:135], v[252:255]
ds_read_b64_tr_b16 a[224:225], v12 offset:0
ds_read_b64_tr_b16 a[226:227], v12 offset:1024
ds_read_b64_tr_b16 a[228:229], v12 offset:4096
ds_read_b64_tr_b16 a[230:231], v12 offset:5120
ds_read_b64_tr_b16 a[232:233], v13 offset:0
ds_read_b64_tr_b16 a[234:235], v13 offset:1024
ds_read_b64_tr_b16 a[236:237], v13 offset:4096
ds_read_b64_tr_b16 a[238:239], v13 offset:5120
v_rcp_f32 v252, v252
s_nop 0
v_mul_f32 v244, v244, v252
v_mul_f32 v245, v245, v252
v_mul_f32 v246, v246, v252
v_mul_f32 v247, v247, v252
v_mul_f32 v248, v248, v252
v_mul_f32 v249, v249, v252
v_mul_f32 v250, v250, v252
v_mul_f32 v251, v251, v252
v_cvt_pk_bf16_f32 v172, v244, v245
v_cvt_pk_bf16_f32 v173, v246, v247
v_cvt_pk_bf16_f32 v174, v248, v249
v_cvt_pk_bf16_f32 v175, v250, v251
s_nop 0
v_permlane32_swap_b32 v172, v174
v_permlane32_swap_b32 v173, v175
buffer_store_dwordx4 v[172:175], v1, s[36:39], s69 offen offset:3072 sc1
s_waitcnt vmcnt(18) lgkmcnt(4)
v_mfma_f32_16x16x32_bf16 v[128:131], a[224:227], a[192:195], 0
ds_read_b64_tr_b16 a[240:241], v14 offset:0
v_mfma_f32_16x16x32_bf16 v[128:131], a[228:231], a[196:199], v[128:131]
ds_read_b64_tr_b16 a[242:243], v14 offset:1024
v_mfma_f32_16x16x32_bf16 v[132:135], a[224:227], a[200:203], 0
ds_read_b64_tr_b16 a[244:245], v14 offset:4096
v_mfma_f32_16x16x32_bf16 v[132:135], a[228:231], a[204:207], v[132:135]
ds_read_b64_tr_b16 a[246:247], v14 offset:5120
v_mfma_f32_16x16x32_bf16 v[136:139], a[224:227], a[208:211], 0
buffer_load_dwordx4 a[64:67], v1, s[36:39], s82 offen offset:0 sc1
v_mfma_f32_16x16x32_bf16 v[136:139], a[228:231], a[212:215], v[136:139]
v_mfma_f32_16x16x32_bf16 v[140:143], a[224:227], a[216:219], 0
buffer_load_dwordx4 a[68:71], v1, s[36:39], s83 offen offset:0 sc1
v_mfma_f32_16x16x32_bf16 v[140:143], a[228:231], a[220:223], v[140:143]
s_waitcnt lgkmcnt(4)
v_mfma_f32_16x16x32_bf16 v[156:159], a[232:235], a[216:219], 0
ds_read_b64_tr_b16 a[248:249], v15 offset:0
v_add_u32 v16, 0x10000, v12
v_mfma_f32_16x16x32_bf16 v[156:159], a[236:239], a[220:223], v[156:159]
ds_read_b64_tr_b16 a[250:251], v15 offset:1024
v_subrev_u32 v8, 0x10000, v12
v_mfma_f32_16x16x32_bf16 v[152:155], a[232:235], a[208:211], 0
ds_read_b64_tr_b16 a[252:253], v15 offset:4096
v_add_u32 v17, 0x10000, v13
v_mfma_f32_16x16x32_bf16 v[152:155], a[236:239], a[212:215], v[152:155]
ds_read_b64_tr_b16 a[254:255], v15 offset:5120
v_subrev_u32 v9, 0x10000, v13
v_mfma_f32_16x16x32_bf16 v[148:151], a[232:235], a[200:203], 0
buffer_load_dwordx4 a[72:75], v1, s[36:39], s82 offen offset:1024 sc1
v_add_u32 v18, 0x10000, v14
v_mfma_f32_16x16x32_bf16 v[148:151], a[236:239], a[204:207], v[148:151]
v_subrev_u32 v10, 0x10000, v14
v_mfma_f32_16x16x32_bf16 v[144:147], a[232:235], a[192:195], 0
buffer_load_dwordx4 a[76:79], v1, s[36:39], s83 offen offset:1024 sc1
v_mfma_f32_16x16x32_bf16 v[144:147], a[236:239], a[196:199], v[144:147]
s_waitcnt lgkmcnt(4)
v_mfma_f32_16x16x32_bf16 v[160:163], a[240:243], a[192:195], 0
ds_read_b64_tr_b16 a[224:225], v12 offset:8192
v_add_u32 v19, 0x10000, v15
v_mfma_f32_16x16x32_bf16 v[160:163], a[244:247], a[196:199], v[160:163]
ds_read_b64_tr_b16 a[226:227], v12 offset:9216
v_subrev_u32 v11, 0x10000, v15
v_mfma_f32_16x16x32_bf16 v[164:167], a[240:243], a[200:203], 0
ds_read_b64_tr_b16 a[228:229], v12 offset:12288
s_mov_b32 s56, s18
v_mfma_f32_16x16x32_bf16 v[164:167], a[244:247], a[204:207], v[164:167]
ds_read_b64_tr_b16 a[230:231], v12 offset:13312
s_mov_b32 s57, s19
v_mfma_f32_16x16x32_bf16 v[168:171], a[240:243], a[208:211], 0
buffer_load_dwordx4 a[80:83], v1, s[36:39], s82 offen offset:2048 sc1
s_mov_b32 s58, 0x400000
v_mfma_f32_16x16x32_bf16 v[168:171], a[244:247], a[212:215], v[168:171]
s_mov_b32 s59, 0x00020000
s_mov_b32 s32, s8
v_mfma_f32_16x16x32_bf16 v[172:175], a[240:243], a[216:219], 0
buffer_load_dwordx4 a[84:87], v1, s[36:39], s83 offen offset:2048 sc1
v_mfma_f32_16x16x32_bf16 v[172:175], a[244:247], a[220:223], v[172:175]
s_waitcnt lgkmcnt(4)
v_mfma_f32_16x16x32_bf16 v[188:191], a[248:251], a[216:219], 0
ds_read_b64_tr_b16 a[232:233], v13 offset:8192
s_mov_b32 s33, s9
v_mfma_f32_16x16x32_bf16 v[188:191], a[252:255], a[220:223], v[188:191]
ds_read_b64_tr_b16 a[234:235], v13 offset:9216
s_mov_b32 s34, 0x200000
v_mfma_f32_16x16x32_bf16 v[184:187], a[248:251], a[208:211], 0
ds_read_b64_tr_b16 a[236:237], v13 offset:12288
s_mov_b32 s35, 0x00020000
v_mfma_f32_16x16x32_bf16 v[184:187], a[252:255], a[212:215], v[184:187]
ds_read_b64_tr_b16 a[238:239], v13 offset:13312
v_lshrrev_b32 v21, 3, v0
v_mfma_f32_16x16x32_bf16 v[180:183], a[248:251], a[200:203], 0
buffer_load_dwordx4 a[88:91], v1, s[36:39], s82 offen offset:3072 sc1
s_add_u32 s82, s82, 16384
v_mfma_f32_16x16x32_bf16 v[180:183], a[252:255], a[204:207], v[180:183]
v_and_b32 v23, 7, v0
v_lshlrev_b32 v20, 4, v23
v_mfma_f32_16x16x32_bf16 v[176:179], a[248:251], a[192:195], 0
buffer_load_dwordx4 a[92:95], v1, s[36:39], s83 offen offset:3072 sc1
s_add_u32 s83, s83, 16384
v_mfma_f32_16x16x32_bf16 v[176:179], a[252:255], a[196:199], v[176:179]
v_lshl_add_u32 v20, v21, 11, v20
s_waitcnt vmcnt(8)
buffer_store_dword v25, v24, s[36:39], s63 offen offset:8 sc1
s_add_u32 s62, s62, 4
s_waitcnt lgkmcnt(4)
v_mfma_f32_16x16x32_bf16 v[192:195], a[224:227], a[192:195], 0
ds_read_b64_tr_b16 a[240:241], v14 offset:8192
v_mfma_f32_16x16x32_bf16 v[192:195], a[228:231], a[196:199], v[192:195]
ds_read_b64_tr_b16 a[242:243], v14 offset:9216
v_mfma_f32_16x16x32_bf16 v[196:199], a[224:227], a[200:203], 0
ds_read_b64_tr_b16 a[244:245], v14 offset:12288
v_mfma_f32_16x16x32_bf16 v[196:199], a[228:231], a[204:207], v[196:199]
ds_read_b64_tr_b16 a[246:247], v14 offset:13312
v_mfma_f32_16x16x32_bf16 v[200:203], a[224:227], a[208:211], 0
buffer_load_dwordx4 a[96:99], v1, s[36:39], s82 offen offset:0 sc1
v_mfma_f32_16x16x32_bf16 v[200:203], a[228:231], a[212:215], v[200:203]
v_mfma_f32_16x16x32_bf16 v[204:207], a[224:227], a[216:219], 0
buffer_load_dwordx4 a[100:103], v1, s[36:39], s83 offen offset:0 sc1
v_mfma_f32_16x16x32_bf16 v[204:207], a[228:231], a[220:223], v[204:207]
s_waitcnt lgkmcnt(4)
v_mfma_f32_16x16x32_bf16 v[220:223], a[232:235], a[216:219], 0
ds_read_b64_tr_b16 a[248:249], v15 offset:8192
v_mfma_f32_16x16x32_bf16 v[220:223], a[236:239], a[220:223], v[220:223]
ds_read_b64_tr_b16 a[250:251], v15 offset:9216
v_mfma_f32_16x16x32_bf16 v[216:219], a[232:235], a[208:211], 0
ds_read_b64_tr_b16 a[252:253], v15 offset:12288
v_mfma_f32_16x16x32_bf16 v[216:219], a[236:239], a[212:215], v[216:219]
ds_read_b64_tr_b16 a[254:255], v15 offset:13312
v_mfma_f32_16x16x32_bf16 v[212:215], a[232:235], a[200:203], 0
buffer_load_dwordx4 a[104:107], v1, s[36:39], s82 offen offset:1024 sc1
v_mfma_f32_16x16x32_bf16 v[212:215], a[236:239], a[204:207], v[212:215]
v_mfma_f32_16x16x32_bf16 v[208:211], a[232:235], a[192:195], 0
buffer_load_dwordx4 a[108:111], v1, s[36:39], s83 offen offset:1024 sc1
v_mfma_f32_16x16x32_bf16 v[208:211], a[236:239], a[196:199], v[208:211]
s_waitcnt lgkmcnt(0)
s_barrier
v_mfma_f32_16x16x32_bf16 v[224:227], a[240:243], a[192:195], 0
ds_read_b64_tr_b16 a[224:225], v12 offset:32768
v_mfma_f32_16x16x32_bf16 v[224:227], a[244:247], a[196:199], v[224:227]
ds_read_b64_tr_b16 a[226:227], v12 offset:33792
v_mfma_f32_16x16x32_bf16 v[228:231], a[240:243], a[200:203], 0
ds_read_b64_tr_b16 a[228:229], v12 offset:36864
v_mfma_f32_16x16x32_bf16 v[228:231], a[244:247], a[204:207], v[228:231]
ds_read_b64_tr_b16 a[230:231], v12 offset:37888
v_mfma_f32_16x16x32_bf16 v[232:235], a[240:243], a[208:211], 0
buffer_load_dwordx4 a[112:115], v1, s[36:39], s82 offen offset:2048 sc1
v_mfma_f32_16x16x32_bf16 v[232:235], a[244:247], a[212:215], v[232:235]
v_mfma_f32_16x16x32_bf16 v[236:239], a[240:243], a[216:219], 0
buffer_load_dwordx4 a[116:119], v1, s[36:39], s83 offen offset:2048 sc1
v_mfma_f32_16x16x32_bf16 v[236:239], a[244:247], a[220:223], v[236:239]
v_mfma_f32_16x16x32_bf16 v[252:255], a[248:251], a[216:219], 0
ds_read_b64_tr_b16 a[232:233], v13 offset:32768
v_mfma_f32_16x16x32_bf16 v[252:255], a[252:255], a[220:223], v[252:255]
ds_read_b64_tr_b16 a[234:235], v13 offset:33792
v_mfma_f32_16x16x32_bf16 v[248:251], a[248:251], a[208:211], 0
ds_read_b64_tr_b16 a[236:237], v13 offset:36864
v_mfma_f32_16x16x32_bf16 v[248:251], a[252:255], a[212:215], v[248:251]
ds_read_b64_tr_b16 a[238:239], v13 offset:37888
v_mfma_f32_16x16x32_bf16 v[244:247], a[248:251], a[200:203], 0
buffer_load_dwordx4 a[120:123], v1, s[36:39], s82 offen offset:3072 sc1
s_add_u32 s82, s82, 16384
v_mfma_f32_16x16x32_bf16 v[244:247], a[252:255], a[204:207], v[244:247]
v_mfma_f32_16x16x32_bf16 v[240:243], a[248:251], a[192:195], 0
v_mfma_f32_16x16x32_bf16 v[240:243], a[252:255], a[196:199], v[240:243]
s_waitcnt lgkmcnt(4)
v_mfma_f32_16x16x32_bf16 v[128:131], a[224:227], a[0:3], v[128:131]
ds_read_b64_tr_b16 a[240:241], v14 offset:32768
v_mfma_f32_16x16x32_bf16 v[128:131], a[228:231], a[4:7], v[128:131]
ds_read_b64_tr_b16 a[242:243], v14 offset:33792
v_mfma_f32_16x16x32_bf16 v[132:135], a[224:227], a[8:11], v[132:135]
ds_read_b64_tr_b16 a[244:245], v14 offset:36864
v_mfma_f32_16x16x32_bf16 v[132:135], a[228:231], a[12:15], v[132:135]
ds_read_b64_tr_b16 a[246:247], v14 offset:37888
v_mfma_f32_16x16x32_bf16 v[136:139], a[224:227], a[16:19], v[136:139]
buffer_load_dwordx4 a[124:127], v1, s[36:39], s83 offen offset:3072 sc1
s_add_u32 s83, s83, 16384
v_mfma_f32_16x16x32_bf16 v[136:139], a[228:231], a[20:23], v[136:139]
s_add_u32 m0, s85, 65536
v_mfma_f32_16x16x32_bf16 v[140:143], a[224:227], a[24:27], v[140:143]
buffer_load_dwordx4 v7, s[28:31], s84 offen offset:0 lds
s_add_u32 s84, s84, 15360
v_mfma_f32_16x16x32_bf16 v[140:143], a[228:231], a[28:31], v[140:143]
s_waitcnt lgkmcnt(4)
v_mfma_f32_16x16x32_bf16 v[156:159], a[232:235], a[24:27], v[156:159]
ds_read_b64_tr_b16 a[248:249], v15 offset:32768
v_mfma_f32_16x16x32_bf16 v[156:159], a[236:239], a[28:31], v[156:159]
ds_read_b64_tr_b16 a[250:251], v15 offset:33792
v_mfma_f32_16x16x32_bf16 v[152:155], a[232:235], a[16:19], v[152:155]
ds_read_b64_tr_b16 a[252:253], v15 offset:36864
v_mfma_f32_16x16x32_bf16 v[152:155], a[236:239], a[20:23], v[152:155]
ds_read_b64_tr_b16 a[254:255], v15 offset:37888
v_mfma_f32_16x16x32_bf16 v[148:151], a[232:235], a[8:11], v[148:151]
buffer_load_dwordx4 v7, s[28:31], s84 offen offset:1024 lds
s_add_u32 s84, s84, 15360
v_mfma_f32_16x16x32_bf16 v[148:151], a[236:239], a[12:15], v[148:151]
v_mfma_f32_16x16x32_bf16 v[144:147], a[232:235], a[0:3], v[144:147]
buffer_load_dwordx4 v7, s[28:31], s84 offen offset:2048 lds
s_add_u32 s84, s84, 15360
v_mfma_f32_16x16x32_bf16 v[144:147], a[236:239], a[4:7], v[144:147]
s_waitcnt lgkmcnt(4)
v_mfma_f32_16x16x32_bf16 v[160:163], a[240:243], a[0:3], v[160:163]
ds_read_b64_tr_b16 a[224:225], v12 offset:40960
v_mfma_f32_16x16x32_bf16 v[160:163], a[244:247], a[4:7], v[160:163]
ds_read_b64_tr_b16 a[226:227], v12 offset:41984
v_mfma_f32_16x16x32_bf16 v[164:167], a[240:243], a[8:11], v[164:167]
ds_read_b64_tr_b16 a[228:229], v12 offset:45056
v_mfma_f32_16x16x32_bf16 v[164:167], a[244:247], a[12:15], v[164:167]
ds_read_b64_tr_b16 a[230:231], v12 offset:46080
v_mfma_f32_16x16x32_bf16 v[168:171], a[240:243], a[16:19], v[168:171]
buffer_load_dwordx4 v7, s[28:31], s84 offen offset:3072 lds
s_add_u32 s84, s84, 19456
v_mfma_f32_16x16x32_bf16 v[168:171], a[244:247], a[20:23], v[168:171]
s_add_u32 m0, s85, 69632
v_mfma_f32_16x16x32_bf16 v[172:175], a[240:243], a[24:27], v[172:175]
buffer_load_dwordx4 v7, s[28:31], s84 offen offset:0 lds
s_add_u32 s84, s84, 15360
v_mfma_f32_16x16x32_bf16 v[172:175], a[244:247], a[28:31], v[172:175]
s_waitcnt lgkmcnt(4)
v_mfma_f32_16x16x32_bf16 v[188:191], a[248:251], a[24:27], v[188:191]
ds_read_b64_tr_b16 a[232:233], v13 offset:40960
v_mfma_f32_16x16x32_bf16 v[188:191], a[252:255], a[28:31], v[188:191]
ds_read_b64_tr_b16 a[234:235], v13 offset:41984
v_mfma_f32_16x16x32_bf16 v[184:187], a[248:251], a[16:19], v[184:187]
ds_read_b64_tr_b16 a[236:237], v13 offset:45056
v_mfma_f32_16x16x32_bf16 v[184:187], a[252:255], a[20:23], v[184:187]
ds_read_b64_tr_b16 a[238:239], v13 offset:46080
v_mfma_f32_16x16x32_bf16 v[180:183], a[248:251], a[8:11], v[180:183]
buffer_load_dwordx4 v7, s[28:31], s84 offen offset:1024 lds
s_add_u32 s84, s84, 15360
v_mfma_f32_16x16x32_bf16 v[180:183], a[252:255], a[12:15], v[180:183]
v_mfma_f32_16x16x32_bf16 v[176:179], a[248:251], a[0:3], v[176:179]
buffer_load_dwordx4 v7, s[28:31], s84 offen offset:2048 lds
s_add_u32 s84, s84, 15360
v_mfma_f32_16x16x32_bf16 v[176:179], a[252:255], a[4:7], v[176:179]
s_waitcnt lgkmcnt(4)
v_mfma_f32_16x16x32_bf16 v[192:195], a[224:227], a[0:3], v[192:195]
ds_read_b64_tr_b16 a[240:241], v14 offset:40960
v_mfma_f32_16x16x32_bf16 v[192:195], a[228:231], a[4:7], v[192:195]
ds_read_b64_tr_b16 a[242:243], v14 offset:41984
v_mfma_f32_16x16x32_bf16 v[196:199], a[224:227], a[8:11], v[196:199]
ds_read_b64_tr_b16 a[244:245], v14 offset:45056
v_mfma_f32_16x16x32_bf16 v[196:199], a[228:231], a[12:15], v[196:199]
ds_read_b64_tr_b16 a[246:247], v14 offset:46080
v_mfma_f32_16x16x32_bf16 v[200:203], a[224:227], a[16:19], v[200:203]
buffer_load_dwordx4 v7, s[28:31], s84 offen offset:3072 lds
s_add_u32 s84, s84, 19456
v_mfma_f32_16x16x32_bf16 v[200:203], a[228:231], a[20:23], v[200:203]
v_mfma_f32_16x16x32_bf16 v[204:207], a[224:227], a[24:27], v[204:207]
buffer_load_dwordx4 a[192:195], v1, s[36:39], s82 offen offset:0 sc1
v_mfma_f32_16x16x32_bf16 v[204:207], a[228:231], a[28:31], v[204:207]
s_waitcnt lgkmcnt(4)
v_mfma_f32_16x16x32_bf16 v[220:223], a[232:235], a[24:27], v[220:223]
ds_read_b64_tr_b16 a[248:249], v15 offset:40960
v_mfma_f32_16x16x32_bf16 v[220:223], a[236:239], a[28:31], v[220:223]
ds_read_b64_tr_b16 a[250:251], v15 offset:41984
v_mfma_f32_16x16x32_bf16 v[216:219], a[232:235], a[16:19], v[216:219]
ds_read_b64_tr_b16 a[252:253], v15 offset:45056
v_mfma_f32_16x16x32_bf16 v[216:219], a[236:239], a[20:23], v[216:219]
ds_read_b64_tr_b16 a[254:255], v15 offset:46080
v_mfma_f32_16x16x32_bf16 v[212:215], a[232:235], a[8:11], v[212:215]
buffer_load_dwordx4 a[196:199], v1, s[36:39], s83 offen offset:0 sc1
v_mfma_f32_16x16x32_bf16 v[212:215], a[236:239], a[12:15], v[212:215]
v_mfma_f32_16x16x32_bf16 v[208:211], a[232:235], a[0:3], v[208:211]
buffer_load_dwordx4 a[200:203], v1, s[36:39], s82 offen offset:1024 sc1
v_mfma_f32_16x16x32_bf16 v[208:211], a[236:239], a[4:7], v[208:211]
s_waitcnt lgkmcnt(0)
s_barrier
v_mfma_f32_16x16x32_bf16 v[224:227], a[240:243], a[0:3], v[224:227]
ds_read_b64_tr_b16 a[224:225], v16 offset:0
v_mfma_f32_16x16x32_bf16 v[224:227], a[244:247], a[4:7], v[224:227]
ds_read_b64_tr_b16 a[226:227], v16 offset:1024
v_mfma_f32_16x16x32_bf16 v[228:231], a[240:243], a[8:11], v[228:231]
ds_read_b64_tr_b16 a[228:229], v16 offset:4096
v_mfma_f32_16x16x32_bf16 v[228:231], a[244:247], a[12:15], v[228:231]
ds_read_b64_tr_b16 a[230:231], v16 offset:5120
v_mfma_f32_16x16x32_bf16 v[232:235], a[240:243], a[16:19], v[232:235]
buffer_load_dwordx4 a[204:207], v1, s[36:39], s83 offen offset:1024 sc1
v_mfma_f32_16x16x32_bf16 v[232:235], a[244:247], a[20:23], v[232:235]
v_mfma_f32_16x16x32_bf16 v[236:239], a[240:243], a[24:27], v[236:239]
v_mfma_f32_16x16x32_bf16 v[236:239], a[244:247], a[28:31], v[236:239]
v_mfma_f32_16x16x32_bf16 v[252:255], a[248:251], a[24:27], v[252:255]
ds_read_b64_tr_b16 a[232:233], v17 offset:0
v_mfma_f32_16x16x32_bf16 v[252:255], a[252:255], a[28:31], v[252:255]
ds_read_b64_tr_b16 a[234:235], v17 offset:1024
v_mfma_f32_16x16x32_bf16 v[248:251], a[248:251], a[16:19], v[248:251]
ds_read_b64_tr_b16 a[236:237], v17 offset:4096
v_mfma_f32_16x16x32_bf16 v[248:251], a[252:255], a[20:23], v[248:251]
ds_read_b64_tr_b16 a[238:239], v17 offset:5120
v_mfma_f32_16x16x32_bf16 v[244:247], a[248:251], a[8:11], v[244:247]
buffer_load_dwordx4 a[208:211], v1, s[36:39], s82 offen offset:2048 sc1
v_mfma_f32_16x16x32_bf16 v[244:247], a[252:255], a[12:15], v[244:247]
v_mfma_f32_16x16x32_bf16 v[240:243], a[248:251], a[0:3], v[240:243]
buffer_load_dwordx4 a[212:215], v1, s[36:39], s83 offen offset:2048 sc1
v_mfma_f32_16x16x32_bf16 v[240:243], a[252:255], a[4:7], v[240:243]
s_waitcnt lgkmcnt(4)
v_mfma_f32_16x16x32_bf16 v[128:131], a[224:227], a[32:35], v[128:131]
ds_read_b64_tr_b16 a[240:241], v18 offset:0
v_mfma_f32_16x16x32_bf16 v[128:131], a[228:231], a[36:39], v[128:131]
ds_read_b64_tr_b16 a[242:243], v18 offset:1024
v_mfma_f32_16x16x32_bf16 v[132:135], a[224:227], a[40:43], v[132:135]
ds_read_b64_tr_b16 a[244:245], v18 offset:4096
v_mfma_f32_16x16x32_bf16 v[132:135], a[228:231], a[44:47], v[132:135]
ds_read_b64_tr_b16 a[246:247], v18 offset:5120
v_mfma_f32_16x16x32_bf16 v[136:139], a[224:227], a[48:51], v[136:139]
buffer_load_dwordx4 a[216:219], v1, s[36:39], s82 offen offset:3072 sc1
s_add_u32 s82, s82, 16384
v_mfma_f32_16x16x32_bf16 v[136:139], a[228:231], a[52:55], v[136:139]
v_mfma_f32_16x16x32_bf16 v[140:143], a[224:227], a[56:59], v[140:143]
buffer_load_dwordx4 a[220:223], v1, s[36:39], s83 offen offset:3072 sc1
s_add_u32 s83, s83, 16384
v_mfma_f32_16x16x32_bf16 v[140:143], a[228:231], a[60:63], v[140:143]
s_waitcnt lgkmcnt(4)
v_mfma_f32_16x16x32_bf16 v[156:159], a[232:235], a[56:59], v[156:159]
ds_read_b64_tr_b16 a[248:249], v19 offset:0
v_mfma_f32_16x16x32_bf16 v[156:159], a[236:239], a[60:63], v[156:159]
ds_read_b64_tr_b16 a[250:251], v19 offset:1024
v_mfma_f32_16x16x32_bf16 v[152:155], a[232:235], a[48:51], v[152:155]
ds_read_b64_tr_b16 a[252:253], v19 offset:4096
v_mfma_f32_16x16x32_bf16 v[152:155], a[236:239], a[52:55], v[152:155]
ds_read_b64_tr_b16 a[254:255], v19 offset:5120
s_add_u32 m0, s85, 98304
v_mfma_f32_16x16x32_bf16 v[148:151], a[232:235], a[40:43], v[148:151]
buffer_load_dwordx4 v7, s[28:31], s84 offen offset:0 lds
s_add_u32 s84, s84, 15360
v_mfma_f32_16x16x32_bf16 v[148:151], a[236:239], a[44:47], v[148:151]
v_mfma_f32_16x16x32_bf16 v[144:147], a[232:235], a[32:35], v[144:147]
buffer_load_dwordx4 v7, s[28:31], s84 offen offset:1024 lds
s_add_u32 s84, s84, 15360
v_mfma_f32_16x16x32_bf16 v[144:147], a[236:239], a[36:39], v[144:147]
s_waitcnt lgkmcnt(4)
v_mfma_f32_16x16x32_bf16 v[160:163], a[240:243], a[32:35], v[160:163]
ds_read_b64_tr_b16 a[224:225], v16 offset:8192
v_mfma_f32_16x16x32_bf16 v[160:163], a[244:247], a[36:39], v[160:163]
ds_read_b64_tr_b16 a[226:227], v16 offset:9216
v_mfma_f32_16x16x32_bf16 v[164:167], a[240:243], a[40:43], v[164:167]
ds_read_b64_tr_b16 a[228:229], v16 offset:12288
v_mfma_f32_16x16x32_bf16 v[164:167], a[244:247], a[44:47], v[164:167]
ds_read_b64_tr_b16 a[230:231], v16 offset:13312
v_mfma_f32_16x16x32_bf16 v[168:171], a[240:243], a[48:51], v[168:171]
buffer_load_dwordx4 v7, s[28:31], s84 offen offset:2048 lds
s_add_u32 s84, s84, 15360
v_mfma_f32_16x16x32_bf16 v[168:171], a[244:247], a[52:55], v[168:171]
v_mfma_f32_16x16x32_bf16 v[172:175], a[240:243], a[56:59], v[172:175]
buffer_load_dwordx4 v7, s[28:31], s84 offen offset:3072 lds
s_add_u32 s84, s84, 19456
v_mfma_f32_16x16x32_bf16 v[172:175], a[244:247], a[60:63], v[172:175]
s_waitcnt lgkmcnt(4)
v_mfma_f32_16x16x32_bf16 v[188:191], a[248:251], a[56:59], v[188:191]
ds_read_b64_tr_b16 a[232:233], v17 offset:8192
v_mfma_f32_16x16x32_bf16 v[188:191], a[252:255], a[60:63], v[188:191]
ds_read_b64_tr_b16 a[234:235], v17 offset:9216
v_mfma_f32_16x16x32_bf16 v[184:187], a[248:251], a[48:51], v[184:187]
ds_read_b64_tr_b16 a[236:237], v17 offset:12288
v_mfma_f32_16x16x32_bf16 v[184:187], a[252:255], a[52:55], v[184:187]
ds_read_b64_tr_b16 a[238:239], v17 offset:13312
s_add_u32 m0, s85, 102400
v_mfma_f32_16x16x32_bf16 v[180:183], a[248:251], a[40:43], v[180:183]
buffer_load_dwordx4 v7, s[28:31], s84 offen offset:0 lds
s_add_u32 s84, s84, 15360
v_mfma_f32_16x16x32_bf16 v[180:183], a[252:255], a[44:47], v[180:183]
v_mfma_f32_16x16x32_bf16 v[176:179], a[248:251], a[32:35], v[176:179]
buffer_load_dwordx4 v7, s[28:31], s84 offen offset:1024 lds
s_add_u32 s84, s84, 15360
v_mfma_f32_16x16x32_bf16 v[176:179], a[252:255], a[36:39], v[176:179]
s_waitcnt lgkmcnt(4)
v_mfma_f32_16x16x32_bf16 v[192:195], a[224:227], a[32:35], v[192:195]
ds_read_b64_tr_b16 a[240:241], v18 offset:8192
v_mfma_f32_16x16x32_bf16 v[192:195], a[228:231], a[36:39], v[192:195]
ds_read_b64_tr_b16 a[242:243], v18 offset:9216
v_mfma_f32_16x16x32_bf16 v[196:199], a[224:227], a[40:43], v[196:199]
ds_read_b64_tr_b16 a[244:245], v18 offset:12288
v_mfma_f32_16x16x32_bf16 v[196:199], a[228:231], a[44:47], v[196:199]
ds_read_b64_tr_b16 a[246:247], v18 offset:13312
v_mfma_f32_16x16x32_bf16 v[200:203], a[224:227], a[48:51], v[200:203]
buffer_load_dwordx4 v7, s[28:31], s84 offen offset:2048 lds
s_add_u32 s84, s84, 15360
v_mfma_f32_16x16x32_bf16 v[200:203], a[228:231], a[52:55], v[200:203]
v_mfma_f32_16x16x32_bf16 v[204:207], a[224:227], a[56:59], v[204:207]
buffer_load_dwordx4 v7, s[28:31], s84 offen offset:3072 lds
s_add_u32 s84, s84, 19456
v_mfma_f32_16x16x32_bf16 v[204:207], a[228:231], a[60:63], v[204:207]
s_waitcnt lgkmcnt(4)
v_mfma_f32_16x16x32_bf16 v[220:223], a[232:235], a[56:59], v[220:223]
ds_read_b64_tr_b16 a[248:249], v19 offset:8192
v_mfma_f32_16x16x32_bf16 v[220:223], a[236:239], a[60:63], v[220:223]
ds_read_b64_tr_b16 a[250:251], v19 offset:9216
v_mfma_f32_16x16x32_bf16 v[216:219], a[232:235], a[48:51], v[216:219]
ds_read_b64_tr_b16 a[252:253], v19 offset:12288
v_mfma_f32_16x16x32_bf16 v[216:219], a[236:239], a[52:55], v[216:219]
ds_read_b64_tr_b16 a[254:255], v19 offset:13312
v_mfma_f32_16x16x32_bf16 v[212:215], a[232:235], a[40:43], v[212:215]
buffer_load_dwordx4 a[0:3], v1, s[36:39], s82 offen offset:0 sc1
v_mfma_f32_16x16x32_bf16 v[212:215], a[236:239], a[44:47], v[212:215]
v_mfma_f32_16x16x32_bf16 v[208:211], a[232:235], a[32:35], v[208:211]
buffer_load_dwordx4 a[4:7], v1, s[36:39], s83 offen offset:0 sc1
v_mfma_f32_16x16x32_bf16 v[208:211], a[236:239], a[36:39], v[208:211]
s_waitcnt lgkmcnt(0)
s_barrier
v_mfma_f32_16x16x32_bf16 v[224:227], a[240:243], a[32:35], v[224:227]
ds_read_b64_tr_b16 a[224:225], v8 offset:0
v_mfma_f32_16x16x32_bf16 v[224:227], a[244:247], a[36:39], v[224:227]
ds_read_b64_tr_b16 a[226:227], v8 offset:1024
v_mfma_f32_16x16x32_bf16 v[228:231], a[240:243], a[40:43], v[228:231]
ds_read_b64_tr_b16 a[228:229], v8 offset:4096
v_mfma_f32_16x16x32_bf16 v[228:231], a[244:247], a[44:47], v[228:231]
ds_read_b64_tr_b16 a[230:231], v8 offset:5120
v_mfma_f32_16x16x32_bf16 v[232:235], a[240:243], a[48:51], v[232:235]
buffer_load_dwordx4 a[8:11], v1, s[36:39], s82 offen offset:1024 sc1
v_mfma_f32_16x16x32_bf16 v[232:235], a[244:247], a[52:55], v[232:235]
v_mfma_f32_16x16x32_bf16 v[236:239], a[240:243], a[56:59], v[236:239]
v_mfma_f32_16x16x32_bf16 v[236:239], a[244:247], a[60:63], v[236:239]
v_mfma_f32_16x16x32_bf16 v[252:255], a[248:251], a[56:59], v[252:255]
ds_read_b64_tr_b16 a[232:233], v9 offset:0
v_mfma_f32_16x16x32_bf16 v[252:255], a[252:255], a[60:63], v[252:255]
ds_read_b64_tr_b16 a[234:235], v9 offset:1024
v_mfma_f32_16x16x32_bf16 v[248:251], a[248:251], a[48:51], v[248:251]
ds_read_b64_tr_b16 a[236:237], v9 offset:4096
v_mfma_f32_16x16x32_bf16 v[248:251], a[252:255], a[52:55], v[248:251]
ds_read_b64_tr_b16 a[238:239], v9 offset:5120
v_mfma_f32_16x16x32_bf16 v[244:247], a[248:251], a[40:43], v[244:247]
buffer_load_dwordx4 a[12:15], v1, s[36:39], s83 offen offset:1024 sc1
v_mfma_f32_16x16x32_bf16 v[244:247], a[252:255], a[44:47], v[244:247]
v_mfma_f32_16x16x32_bf16 v[240:243], a[248:251], a[32:35], v[240:243]
buffer_load_dwordx4 a[16:19], v1, s[36:39], s82 offen offset:2048 sc1
v_mfma_f32_16x16x32_bf16 v[240:243], a[252:255], a[36:39], v[240:243]
s_waitcnt vmcnt(38) lgkmcnt(4)
v_mfma_f32_16x16x32_bf16 v[128:131], a[224:227], a[64:67], v[128:131]
ds_read_b64_tr_b16 a[240:241], v10 offset:0
v_mfma_f32_16x16x32_bf16 v[128:131], a[228:231], a[68:71], v[128:131]
ds_read_b64_tr_b16 a[242:243], v10 offset:1024
v_mfma_f32_16x16x32_bf16 v[132:135], a[224:227], a[72:75], v[132:135]
ds_read_b64_tr_b16 a[244:245], v10 offset:4096
v_mfma_f32_16x16x32_bf16 v[132:135], a[228:231], a[76:79], v[132:135]
ds_read_b64_tr_b16 a[246:247], v10 offset:5120
v_mfma_f32_16x16x32_bf16 v[136:139], a[224:227], a[80:83], v[136:139]
buffer_load_dwordx4 a[20:23], v1, s[36:39], s83 offen offset:2048 sc1
v_mfma_f32_16x16x32_bf16 v[136:139], a[228:231], a[84:87], v[136:139]
v_mfma_f32_16x16x32_bf16 v[140:143], a[224:227], a[88:91], v[140:143]
buffer_load_dwordx4 a[24:27], v1, s[36:39], s82 offen offset:3072 sc1
s_add_u32 s82, s82, 16384
v_mfma_f32_16x16x32_bf16 v[140:143], a[228:231], a[92:95], v[140:143]
s_waitcnt lgkmcnt(4)
v_mfma_f32_16x16x32_bf16 v[156:159], a[232:235], a[88:91], v[156:159]
ds_read_b64_tr_b16 a[248:249], v11 offset:0
v_mfma_f32_16x16x32_bf16 v[156:159], a[236:239], a[92:95], v[156:159]
ds_read_b64_tr_b16 a[250:251], v11 offset:1024
v_mfma_f32_16x16x32_bf16 v[152:155], a[232:235], a[80:83], v[152:155]
ds_read_b64_tr_b16 a[252:253], v11 offset:4096
v_mfma_f32_16x16x32_bf16 v[152:155], a[236:239], a[84:87], v[152:155]
ds_read_b64_tr_b16 a[254:255], v11 offset:5120
v_mfma_f32_16x16x32_bf16 v[148:151], a[232:235], a[72:75], v[148:151]
buffer_load_dwordx4 a[28:31], v1, s[36:39], s83 offen offset:3072 sc1
s_add_u32 s83, s83, 16384
v_mfma_f32_16x16x32_bf16 v[148:151], a[236:239], a[76:79], v[148:151]
s_add_u32 m0, s85, 131072
v_mfma_f32_16x16x32_bf16 v[144:147], a[232:235], a[64:67], v[144:147]
buffer_load_dwordx4 v7, s[28:31], s84 offen offset:0 lds
s_add_u32 s84, s84, 15360
v_mfma_f32_16x16x32_bf16 v[144:147], a[236:239], a[68:71], v[144:147]
s_waitcnt lgkmcnt(4)
v_mfma_f32_16x16x32_bf16 v[160:163], a[240:243], a[64:67], v[160:163]
ds_read_b64_tr_b16 a[224:225], v8 offset:8192
v_mfma_f32_16x16x32_bf16 v[160:163], a[244:247], a[68:71], v[160:163]
ds_read_b64_tr_b16 a[226:227], v8 offset:9216
v_mfma_f32_16x16x32_bf16 v[164:167], a[240:243], a[72:75], v[164:167]
ds_read_b64_tr_b16 a[228:229], v8 offset:12288
v_mfma_f32_16x16x32_bf16 v[164:167], a[244:247], a[76:79], v[164:167]
ds_read_b64_tr_b16 a[230:231], v8 offset:13312
v_mfma_f32_16x16x32_bf16 v[168:171], a[240:243], a[80:83], v[168:171]
buffer_load_dwordx4 v7, s[28:31], s84 offen offset:1024 lds
s_add_u32 s84, s84, 15360
v_mfma_f32_16x16x32_bf16 v[168:171], a[244:247], a[84:87], v[168:171]
v_mfma_f32_16x16x32_bf16 v[172:175], a[240:243], a[88:91], v[172:175]
buffer_load_dwordx4 v7, s[28:31], s84 offen offset:2048 lds
s_add_u32 s84, s84, 15360
v_mfma_f32_16x16x32_bf16 v[172:175], a[244:247], a[92:95], v[172:175]
s_waitcnt lgkmcnt(4)
v_mfma_f32_16x16x32_bf16 v[188:191], a[248:251], a[88:91], v[188:191]
ds_read_b64_tr_b16 a[232:233], v9 offset:8192
v_mfma_f32_16x16x32_bf16 v[188:191], a[252:255], a[92:95], v[188:191]
ds_read_b64_tr_b16 a[234:235], v9 offset:9216
v_mfma_f32_16x16x32_bf16 v[184:187], a[248:251], a[80:83], v[184:187]
ds_read_b64_tr_b16 a[236:237], v9 offset:12288
v_mfma_f32_16x16x32_bf16 v[184:187], a[252:255], a[84:87], v[184:187]
ds_read_b64_tr_b16 a[238:239], v9 offset:13312
v_mfma_f32_16x16x32_bf16 v[180:183], a[248:251], a[72:75], v[180:183]
buffer_load_dwordx4 v7, s[28:31], s84 offen offset:3072 lds
s_add_u32 s84, s84, 19456
v_mfma_f32_16x16x32_bf16 v[180:183], a[252:255], a[76:79], v[180:183]
s_add_u32 m0, s85, 135168
v_mfma_f32_16x16x32_bf16 v[176:179], a[248:251], a[64:67], v[176:179]
buffer_load_dwordx4 v7, s[28:31], s84 offen offset:0 lds
s_add_u32 s84, s84, 15360
v_mfma_f32_16x16x32_bf16 v[176:179], a[252:255], a[68:71], v[176:179]
s_waitcnt lgkmcnt(4)
v_mfma_f32_16x16x32_bf16 v[192:195], a[224:227], a[64:67], v[192:195]
ds_read_b64_tr_b16 a[240:241], v10 offset:8192
v_mfma_f32_16x16x32_bf16 v[192:195], a[228:231], a[68:71], v[192:195]
ds_read_b64_tr_b16 a[242:243], v10 offset:9216
v_mfma_f32_16x16x32_bf16 v[196:199], a[224:227], a[72:75], v[196:199]
ds_read_b64_tr_b16 a[244:245], v10 offset:12288
v_mfma_f32_16x16x32_bf16 v[196:199], a[228:231], a[76:79], v[196:199]
ds_read_b64_tr_b16 a[246:247], v10 offset:13312
v_mfma_f32_16x16x32_bf16 v[200:203], a[224:227], a[80:83], v[200:203]
buffer_load_dwordx4 v7, s[28:31], s84 offen offset:1024 lds
s_add_u32 s84, s84, 15360
v_mfma_f32_16x16x32_bf16 v[200:203], a[228:231], a[84:87], v[200:203]
v_mfma_f32_16x16x32_bf16 v[204:207], a[224:227], a[88:91], v[204:207]
buffer_load_dwordx4 v7, s[28:31], s84 offen offset:2048 lds
s_add_u32 s84, s84, 15360
v_mfma_f32_16x16x32_bf16 v[204:207], a[228:231], a[92:95], v[204:207]
s_waitcnt lgkmcnt(4)
v_mfma_f32_16x16x32_bf16 v[220:223], a[232:235], a[88:91], v[220:223]
ds_read_b64_tr_b16 a[248:249], v11 offset:8192
v_mfma_f32_16x16x32_bf16 v[220:223], a[236:239], a[92:95], v[220:223]
ds_read_b64_tr_b16 a[250:251], v11 offset:9216
v_mfma_f32_16x16x32_bf16 v[216:219], a[232:235], a[80:83], v[216:219]
ds_read_b64_tr_b16 a[252:253], v11 offset:12288
v_mfma_f32_16x16x32_bf16 v[216:219], a[236:239], a[84:87], v[216:219]
ds_read_b64_tr_b16 a[254:255], v11 offset:13312
v_mfma_f32_16x16x32_bf16 v[212:215], a[232:235], a[72:75], v[212:215]
buffer_load_dwordx4 v7, s[28:31], s84 offen offset:3072 lds
s_add_u32 s84, s84, 19456
v_mfma_f32_16x16x32_bf16 v[212:215], a[236:239], a[76:79], v[212:215]
v_mfma_f32_16x16x32_bf16 v[208:211], a[232:235], a[64:67], v[208:211]
v_mfma_f32_16x16x32_bf16 v[208:211], a[236:239], a[68:71], v[208:211]
s_waitcnt lgkmcnt(0)
s_barrier
v_mfma_f32_16x16x32_bf16 v[224:227], a[240:243], a[64:67], v[224:227]
ds_read_b64_tr_b16 a[224:225], v8 offset:32768
v_mfma_f32_16x16x32_bf16 v[224:227], a[244:247], a[68:71], v[224:227]
ds_read_b64_tr_b16 a[226:227], v8 offset:33792
v_mfma_f32_16x16x32_bf16 v[228:231], a[240:243], a[72:75], v[228:231]
ds_read_b64_tr_b16 a[228:229], v8 offset:36864
v_mfma_f32_16x16x32_bf16 v[228:231], a[244:247], a[76:79], v[228:231]
ds_read_b64_tr_b16 a[230:231], v8 offset:37888
v_mfma_f32_16x16x32_bf16 v[232:235], a[240:243], a[80:83], v[232:235]
buffer_load_dwordx4 a[32:35], v1, s[36:39], s82 offen offset:0 sc1
v_mfma_f32_16x16x32_bf16 v[232:235], a[244:247], a[84:87], v[232:235]
v_mfma_f32_16x16x32_bf16 v[236:239], a[240:243], a[88:91], v[236:239]
buffer_load_dwordx4 a[36:39], v1, s[36:39], s83 offen offset:0 sc1
v_mfma_f32_16x16x32_bf16 v[236:239], a[244:247], a[92:95], v[236:239]
v_mfma_f32_16x16x32_bf16 v[252:255], a[248:251], a[88:91], v[252:255]
ds_read_b64_tr_b16 a[232:233], v9 offset:32768
v_mfma_f32_16x16x32_bf16 v[252:255], a[252:255], a[92:95], v[252:255]
ds_read_b64_tr_b16 a[234:235], v9 offset:33792
v_mfma_f32_16x16x32_bf16 v[248:251], a[248:251], a[80:83], v[248:251]
ds_read_b64_tr_b16 a[236:237], v9 offset:36864
v_mfma_f32_16x16x32_bf16 v[248:251], a[252:255], a[84:87], v[248:251]
ds_read_b64_tr_b16 a[238:239], v9 offset:37888
v_mfma_f32_16x16x32_bf16 v[244:247], a[248:251], a[72:75], v[244:247]
buffer_load_dwordx4 a[40:43], v1, s[36:39], s82 offen offset:1024 sc1
v_mfma_f32_16x16x32_bf16 v[244:247], a[252:255], a[76:79], v[244:247]
v_mfma_f32_16x16x32_bf16 v[240:243], a[248:251], a[64:67], v[240:243]
buffer_load_dwordx4 a[44:47], v1, s[36:39], s83 offen offset:1024 sc1
v_mfma_f32_16x16x32_bf16 v[240:243], a[252:255], a[68:71], v[240:243]
s_waitcnt vmcnt(44) lgkmcnt(4)
v_mfma_f32_16x16x32_bf16 v[128:131], a[224:227], a[96:99], v[128:131]
ds_read_b64_tr_b16 a[240:241], v10 offset:32768
v_mfma_f32_16x16x32_bf16 v[128:131], a[228:231], a[100:103], v[128:131]
ds_read_b64_tr_b16 a[242:243], v10 offset:33792
v_mfma_f32_16x16x32_bf16 v[132:135], a[224:227], a[104:107], v[132:135]
ds_read_b64_tr_b16 a[244:245], v10 offset:36864
v_mfma_f32_16x16x32_bf16 v[132:135], a[228:231], a[108:111], v[132:135]
ds_read_b64_tr_b16 a[246:247], v10 offset:37888
v_mfma_f32_16x16x32_bf16 v[136:139], a[224:227], a[112:115], v[136:139]
buffer_load_dwordx4 a[48:51], v1, s[36:39], s82 offen offset:2048 sc1
v_mfma_f32_16x16x32_bf16 v[136:139], a[228:231], a[116:119], v[136:139]
v_mfma_f32_16x16x32_bf16 v[140:143], a[224:227], a[120:123], v[140:143]
buffer_load_dwordx4 a[52:55], v1, s[36:39], s83 offen offset:2048 sc1
v_mfma_f32_16x16x32_bf16 v[140:143], a[228:231], a[124:127], v[140:143]
s_waitcnt lgkmcnt(4)
v_mfma_f32_16x16x32_bf16 v[156:159], a[232:235], a[120:123], v[156:159]
ds_read_b64_tr_b16 a[248:249], v11 offset:32768
v_mfma_f32_16x16x32_bf16 v[156:159], a[236:239], a[124:127], v[156:159]
ds_read_b64_tr_b16 a[250:251], v11 offset:33792
v_mfma_f32_16x16x32_bf16 v[152:155], a[232:235], a[112:115], v[152:155]
ds_read_b64_tr_b16 a[252:253], v11 offset:36864
v_mfma_f32_16x16x32_bf16 v[152:155], a[236:239], a[116:119], v[152:155]
ds_read_b64_tr_b16 a[254:255], v11 offset:37888
v_mfma_f32_16x16x32_bf16 v[148:151], a[232:235], a[104:107], v[148:151]
buffer_load_dwordx4 a[56:59], v1, s[36:39], s82 offen offset:3072 sc1
s_add_u32 s82, s82, 16384
v_mfma_f32_16x16x32_bf16 v[148:151], a[236:239], a[108:111], v[148:151]
v_mfma_f32_16x16x32_bf16 v[144:147], a[232:235], a[96:99], v[144:147]
buffer_load_dwordx4 a[60:63], v1, s[36:39], s83 offen offset:3072 sc1
s_add_u32 s83, s83, 16384
v_mfma_f32_16x16x32_bf16 v[144:147], a[236:239], a[100:103], v[144:147]
s_waitcnt lgkmcnt(4)
v_mfma_f32_16x16x32_bf16 v[160:163], a[240:243], a[96:99], v[160:163]
ds_read_b64_tr_b16 a[224:225], v8 offset:40960
v_mfma_f32_16x16x32_bf16 v[160:163], a[244:247], a[100:103], v[160:163]
ds_read_b64_tr_b16 a[226:227], v8 offset:41984
v_mfma_f32_16x16x32_bf16 v[164:167], a[240:243], a[104:107], v[164:167]
ds_read_b64_tr_b16 a[228:229], v8 offset:45056
v_mfma_f32_16x16x32_bf16 v[164:167], a[244:247], a[108:111], v[164:167]
ds_read_b64_tr_b16 a[230:231], v8 offset:46080
s_add_u32 m0, s85, 0
v_mfma_f32_16x16x32_bf16 v[168:171], a[240:243], a[112:115], v[168:171]
buffer_load_dwordx4 v7, s[28:31], s84 offen offset:0 lds
s_add_u32 s84, s84, 15360
v_mfma_f32_16x16x32_bf16 v[168:171], a[244:247], a[116:119], v[168:171]
v_mfma_f32_16x16x32_bf16 v[172:175], a[240:243], a[120:123], v[172:175]
buffer_load_dwordx4 v7, s[28:31], s84 offen offset:1024 lds
s_add_u32 s84, s84, 15360
v_mfma_f32_16x16x32_bf16 v[172:175], a[244:247], a[124:127], v[172:175]
s_waitcnt lgkmcnt(4)
v_mfma_f32_16x16x32_bf16 v[188:191], a[248:251], a[120:123], v[188:191]
ds_read_b64_tr_b16 a[232:233], v9 offset:40960
v_mfma_f32_16x16x32_bf16 v[188:191], a[252:255], a[124:127], v[188:191]
ds_read_b64_tr_b16 a[234:235], v9 offset:41984
v_mfma_f32_16x16x32_bf16 v[184:187], a[248:251], a[112:115], v[184:187]
ds_read_b64_tr_b16 a[236:237], v9 offset:45056
v_mfma_f32_16x16x32_bf16 v[184:187], a[252:255], a[116:119], v[184:187]
ds_read_b64_tr_b16 a[238:239], v9 offset:46080
v_mfma_f32_16x16x32_bf16 v[180:183], a[248:251], a[104:107], v[180:183]
buffer_load_dwordx4 v7, s[28:31], s84 offen offset:2048 lds
s_add_u32 s84, s84, 15360
v_mfma_f32_16x16x32_bf16 v[180:183], a[252:255], a[108:111], v[180:183]
v_mfma_f32_16x16x32_bf16 v[176:179], a[248:251], a[96:99], v[176:179]
buffer_load_dwordx4 v7, s[28:31], s84 offen offset:3072 lds
s_add_u32 s84, s84, 19456
v_mfma_f32_16x16x32_bf16 v[176:179], a[252:255], a[100:103], v[176:179]
s_waitcnt lgkmcnt(4)
v_mfma_f32_16x16x32_bf16 v[192:195], a[224:227], a[96:99], v[192:195]
ds_read_b64_tr_b16 a[240:241], v10 offset:40960
v_mfma_f32_16x16x32_bf16 v[192:195], a[228:231], a[100:103], v[192:195]
ds_read_b64_tr_b16 a[242:243], v10 offset:41984
v_mfma_f32_16x16x32_bf16 v[196:199], a[224:227], a[104:107], v[196:199]
ds_read_b64_tr_b16 a[244:245], v10 offset:45056
v_mfma_f32_16x16x32_bf16 v[196:199], a[228:231], a[108:111], v[196:199]
ds_read_b64_tr_b16 a[246:247], v10 offset:46080
s_add_u32 m0, s85, 4096
v_mfma_f32_16x16x32_bf16 v[200:203], a[224:227], a[112:115], v[200:203]
buffer_load_dwordx4 v7, s[28:31], s84 offen offset:0 lds
s_add_u32 s84, s84, 15360
v_mfma_f32_16x16x32_bf16 v[200:203], a[228:231], a[116:119], v[200:203]
v_mfma_f32_16x16x32_bf16 v[204:207], a[224:227], a[120:123], v[204:207]
buffer_load_dwordx4 v7, s[28:31], s84 offen offset:1024 lds
s_add_u32 s84, s84, 15360
v_mfma_f32_16x16x32_bf16 v[204:207], a[228:231], a[124:127], v[204:207]
s_waitcnt lgkmcnt(4)
v_mfma_f32_16x16x32_bf16 v[220:223], a[232:235], a[120:123], v[220:223]
ds_read_b64_tr_b16 a[248:249], v11 offset:40960
v_mfma_f32_16x16x32_bf16 v[220:223], a[236:239], a[124:127], v[220:223]
ds_read_b64_tr_b16 a[250:251], v11 offset:41984
v_mfma_f32_16x16x32_bf16 v[216:219], a[232:235], a[112:115], v[216:219]
ds_read_b64_tr_b16 a[252:253], v11 offset:45056
v_mfma_f32_16x16x32_bf16 v[216:219], a[236:239], a[116:119], v[216:219]
ds_read_b64_tr_b16 a[254:255], v11 offset:46080
v_mfma_f32_16x16x32_bf16 v[212:215], a[232:235], a[104:107], v[212:215]
buffer_load_dwordx4 v7, s[28:31], s84 offen offset:2048 lds
s_add_u32 s84, s84, 15360
v_mfma_f32_16x16x32_bf16 v[212:215], a[236:239], a[108:111], v[212:215]
v_mfma_f32_16x16x32_bf16 v[208:211], a[232:235], a[96:99], v[208:211]
v_mfma_f32_16x16x32_bf16 v[208:211], a[236:239], a[100:103], v[208:211]
s_waitcnt vmcnt(47) lgkmcnt(0)
s_barrier
v_mfma_f32_16x16x32_bf16 v[224:227], a[240:243], a[96:99], v[224:227]
ds_read_b64_tr_b16 a[224:225], v12 offset:0
v_mfma_f32_16x16x32_bf16 v[224:227], a[244:247], a[100:103], v[224:227]
ds_read_b64_tr_b16 a[226:227], v12 offset:1024
v_mfma_f32_16x16x32_bf16 v[228:231], a[240:243], a[104:107], v[228:231]
ds_read_b64_tr_b16 a[228:229], v12 offset:4096
v_mfma_f32_16x16x32_bf16 v[228:231], a[244:247], a[108:111], v[228:231]
ds_read_b64_tr_b16 a[230:231], v12 offset:5120
v_mfma_f32_16x16x32_bf16 v[232:235], a[240:243], a[112:115], v[232:235]
buffer_load_dwordx4 v7, s[28:31], s84 offen offset:3072 lds
s_add_u32 s84, s84, 19456
v_mfma_f32_16x16x32_bf16 v[232:235], a[244:247], a[116:119], v[232:235]
v_mfma_f32_16x16x32_bf16 v[236:239], a[240:243], a[120:123], v[236:239]
buffer_load_dwordx4 a[64:67], v1, s[36:39], s82 offen offset:0 sc1
v_mfma_f32_16x16x32_bf16 v[236:239], a[244:247], a[124:127], v[236:239]
v_mfma_f32_16x16x32_bf16 v[252:255], a[248:251], a[120:123], v[252:255]
ds_read_b64_tr_b16 a[232:233], v13 offset:0
v_mfma_f32_16x16x32_bf16 v[252:255], a[252:255], a[124:127], v[252:255]
ds_read_b64_tr_b16 a[234:235], v13 offset:1024
v_mfma_f32_16x16x32_bf16 v[248:251], a[248:251], a[112:115], v[248:251]
ds_read_b64_tr_b16 a[236:237], v13 offset:4096
v_mfma_f32_16x16x32_bf16 v[248:251], a[252:255], a[116:119], v[248:251]
ds_read_b64_tr_b16 a[238:239], v13 offset:5120
v_mfma_f32_16x16x32_bf16 v[244:247], a[248:251], a[104:107], v[244:247]
buffer_load_dwordx4 a[68:71], v1, s[36:39], s83 offen offset:0 sc1
v_mfma_f32_16x16x32_bf16 v[244:247], a[252:255], a[108:111], v[244:247]
v_mfma_f32_16x16x32_bf16 v[240:243], a[248:251], a[96:99], v[240:243]
buffer_load_dwordx4 a[72:75], v1, s[36:39], s82 offen offset:1024 sc1
v_mfma_f32_16x16x32_bf16 v[240:243], a[252:255], a[100:103], v[240:243]
s_waitcnt vmcnt(43) lgkmcnt(4)
v_mfma_f32_16x16x32_bf16 v[128:131], a[224:227], a[192:195], v[128:131]
ds_read_b64_tr_b16 a[240:241], v14 offset:0
v_mfma_f32_16x16x32_bf16 v[128:131], a[228:231], a[196:199], v[128:131]
ds_read_b64_tr_b16 a[242:243], v14 offset:1024
v_mfma_f32_16x16x32_bf16 v[132:135], a[224:227], a[200:203], v[132:135]
ds_read_b64_tr_b16 a[244:245], v14 offset:4096
v_mfma_f32_16x16x32_bf16 v[132:135], a[228:231], a[204:207], v[132:135]
ds_read_b64_tr_b16 a[246:247], v14 offset:5120
v_mfma_f32_16x16x32_bf16 v[136:139], a[224:227], a[208:211], v[136:139]
buffer_load_dwordx4 a[76:79], v1, s[36:39], s83 offen offset:1024 sc1
v_mfma_f32_16x16x32_bf16 v[136:139], a[228:231], a[212:215], v[136:139]
v_mfma_f32_16x16x32_bf16 v[140:143], a[224:227], a[216:219], v[140:143]
buffer_load_dwordx4 a[80:83], v1, s[36:39], s82 offen offset:2048 sc1
v_mfma_f32_16x16x32_bf16 v[140:143], a[228:231], a[220:223], v[140:143]
s_waitcnt lgkmcnt(4)
v_mfma_f32_16x16x32_bf16 v[156:159], a[232:235], a[216:219], v[156:159]
ds_read_b64_tr_b16 a[248:249], v15 offset:0
v_mfma_f32_16x16x32_bf16 v[156:159], a[236:239], a[220:223], v[156:159]
ds_read_b64_tr_b16 a[250:251], v15 offset:1024
v_mfma_f32_16x16x32_bf16 v[152:155], a[232:235], a[208:211], v[152:155]
ds_read_b64_tr_b16 a[252:253], v15 offset:4096
v_mfma_f32_16x16x32_bf16 v[152:155], a[236:239], a[212:215], v[152:155]
ds_read_b64_tr_b16 a[254:255], v15 offset:5120
v_mfma_f32_16x16x32_bf16 v[148:151], a[232:235], a[200:203], v[148:151]
buffer_load_dwordx4 a[84:87], v1, s[36:39], s83 offen offset:2048 sc1
v_mfma_f32_16x16x32_bf16 v[148:151], a[236:239], a[204:207], v[148:151]
v_mfma_f32_16x16x32_bf16 v[144:147], a[232:235], a[192:195], v[144:147]
buffer_load_dwordx4 a[88:91], v1, s[36:39], s82 offen offset:3072 sc1
s_add_u32 s82, s82, 16384
v_mfma_f32_16x16x32_bf16 v[144:147], a[236:239], a[196:199], v[144:147]
s_waitcnt lgkmcnt(4)
v_mfma_f32_16x16x32_bf16 v[160:163], a[240:243], a[192:195], v[160:163]
ds_read_b64_tr_b16 a[224:225], v12 offset:8192
v_mfma_f32_16x16x32_bf16 v[160:163], a[244:247], a[196:199], v[160:163]
ds_read_b64_tr_b16 a[226:227], v12 offset:9216
v_mfma_f32_16x16x32_bf16 v[164:167], a[240:243], a[200:203], v[164:167]
ds_read_b64_tr_b16 a[228:229], v12 offset:12288
v_mfma_f32_16x16x32_bf16 v[164:167], a[244:247], a[204:207], v[164:167]
ds_read_b64_tr_b16 a[230:231], v12 offset:13312
v_mfma_f32_16x16x32_bf16 v[168:171], a[240:243], a[208:211], v[168:171]
buffer_load_dwordx4 a[92:95], v1, s[36:39], s83 offen offset:3072 sc1
s_add_u32 s83, s83, 16384
v_mfma_f32_16x16x32_bf16 v[168:171], a[244:247], a[212:215], v[168:171]
s_add_u32 m0, s85, 32768
v_mfma_f32_16x16x32_bf16 v[172:175], a[240:243], a[216:219], v[172:175]
buffer_load_dwordx4 v7, s[28:31], s84 offen offset:0 lds
s_add_u32 s84, s84, 15360
v_mfma_f32_16x16x32_bf16 v[172:175], a[244:247], a[220:223], v[172:175]
s_waitcnt lgkmcnt(4)
v_mfma_f32_16x16x32_bf16 v[188:191], a[248:251], a[216:219], v[188:191]
ds_read_b64_tr_b16 a[232:233], v13 offset:8192
v_mfma_f32_16x16x32_bf16 v[188:191], a[252:255], a[220:223], v[188:191]
ds_read_b64_tr_b16 a[234:235], v13 offset:9216
v_mfma_f32_16x16x32_bf16 v[184:187], a[248:251], a[208:211], v[184:187]
ds_read_b64_tr_b16 a[236:237], v13 offset:12288
v_mfma_f32_16x16x32_bf16 v[184:187], a[252:255], a[212:215], v[184:187]
ds_read_b64_tr_b16 a[238:239], v13 offset:13312
v_mfma_f32_16x16x32_bf16 v[180:183], a[248:251], a[200:203], v[180:183]
buffer_load_dwordx4 v7, s[28:31], s84 offen offset:1024 lds
s_add_u32 s84, s84, 15360
v_mfma_f32_16x16x32_bf16 v[180:183], a[252:255], a[204:207], v[180:183]
v_mfma_f32_16x16x32_bf16 v[176:179], a[248:251], a[192:195], v[176:179]
buffer_load_dwordx4 v7, s[28:31], s84 offen offset:2048 lds
s_add_u32 s84, s84, 15360
v_mfma_f32_16x16x32_bf16 v[176:179], a[252:255], a[196:199], v[176:179]
s_waitcnt lgkmcnt(4)
v_mfma_f32_16x16x32_bf16 v[192:195], a[224:227], a[192:195], v[192:195]
ds_read_b64_tr_b16 a[240:241], v14 offset:8192
v_mfma_f32_16x16x32_bf16 v[192:195], a[228:231], a[196:199], v[192:195]
ds_read_b64_tr_b16 a[242:243], v14 offset:9216
v_mfma_f32_16x16x32_bf16 v[196:199], a[224:227], a[200:203], v[196:199]
ds_read_b64_tr_b16 a[244:245], v14 offset:12288
v_mfma_f32_16x16x32_bf16 v[196:199], a[228:231], a[204:207], v[196:199]
ds_read_b64_tr_b16 a[246:247], v14 offset:13312
v_mfma_f32_16x16x32_bf16 v[200:203], a[224:227], a[208:211], v[200:203]
buffer_load_dwordx4 v7, s[28:31], s84 offen offset:3072 lds
s_add_u32 s84, s84, 19456
v_mfma_f32_16x16x32_bf16 v[200:203], a[228:231], a[212:215], v[200:203]
v_mfma_f32_16x16x32_bf16 v[204:207], a[224:227], a[216:219], v[204:207]
v_mfma_f32_16x16x32_bf16 v[204:207], a[228:231], a[220:223], v[204:207]
s_waitcnt lgkmcnt(4)
v_mfma_f32_16x16x32_bf16 v[220:223], a[232:235], a[216:219], v[220:223]
ds_read_b64_tr_b16 a[248:249], v15 offset:8192
v_mfma_f32_16x16x32_bf16 v[220:223], a[236:239], a[220:223], v[220:223]
ds_read_b64_tr_b16 a[250:251], v15 offset:9216
v_mfma_f32_16x16x32_bf16 v[216:219], a[232:235], a[208:211], v[216:219]
ds_read_b64_tr_b16 a[252:253], v15 offset:12288
v_mfma_f32_16x16x32_bf16 v[216:219], a[236:239], a[212:215], v[216:219]
ds_read_b64_tr_b16 a[254:255], v15 offset:13312
s_add_u32 m0, s85, 36864
v_mfma_f32_16x16x32_bf16 v[212:215], a[232:235], a[200:203], v[212:215]
buffer_load_dwordx4 v7, s[28:31], s84 offen offset:0 lds
s_add_u32 s84, s84, 15360
v_mfma_f32_16x16x32_bf16 v[212:215], a[236:239], a[204:207], v[212:215]
v_mfma_f32_16x16x32_bf16 v[208:211], a[232:235], a[192:195], v[208:211]
buffer_load_dwordx4 v7, s[28:31], s84 offen offset:1024 lds
s_add_u32 s84, s84, 15360
v_mfma_f32_16x16x32_bf16 v[208:211], a[236:239], a[196:199], v[208:211]
s_waitcnt vmcnt(46) lgkmcnt(0)
s_barrier
v_mfma_f32_16x16x32_bf16 v[224:227], a[240:243], a[192:195], v[224:227]
ds_read_b64_tr_b16 a[224:225], v12 offset:32768
v_mfma_f32_16x16x32_bf16 v[224:227], a[244:247], a[196:199], v[224:227]
ds_read_b64_tr_b16 a[226:227], v12 offset:33792
v_mfma_f32_16x16x32_bf16 v[228:231], a[240:243], a[200:203], v[228:231]
ds_read_b64_tr_b16 a[228:229], v12 offset:36864
v_mfma_f32_16x16x32_bf16 v[228:231], a[244:247], a[204:207], v[228:231]
ds_read_b64_tr_b16 a[230:231], v12 offset:37888
v_mfma_f32_16x16x32_bf16 v[232:235], a[240:243], a[208:211], v[232:235]
buffer_load_dwordx4 v7, s[28:31], s84 offen offset:2048 lds
s_add_u32 s84, s84, 15360
v_mfma_f32_16x16x32_bf16 v[232:235], a[244:247], a[212:215], v[232:235]
v_mfma_f32_16x16x32_bf16 v[236:239], a[240:243], a[216:219], v[236:239]
buffer_load_dwordx4 v7, s[28:31], s84 offen offset:3072 lds
s_add_u32 s84, s84, 19456
v_mfma_f32_16x16x32_bf16 v[236:239], a[244:247], a[220:223], v[236:239]
v_mfma_f32_16x16x32_bf16 v[252:255], a[248:251], a[216:219], v[252:255]
ds_read_b64_tr_b16 a[232:233], v13 offset:32768
v_mfma_f32_16x16x32_bf16 v[252:255], a[252:255], a[220:223], v[252:255]
ds_read_b64_tr_b16 a[234:235], v13 offset:33792
v_mfma_f32_16x16x32_bf16 v[248:251], a[248:251], a[208:211], v[248:251]
ds_read_b64_tr_b16 a[236:237], v13 offset:36864
v_mfma_f32_16x16x32_bf16 v[248:251], a[252:255], a[212:215], v[248:251]
ds_read_b64_tr_b16 a[238:239], v13 offset:37888
v_mfma_f32_16x16x32_bf16 v[244:247], a[248:251], a[200:203], v[244:247]
buffer_load_dwordx4 a[96:99], v1, s[36:39], s82 offen offset:0 sc1
v_mfma_f32_16x16x32_bf16 v[244:247], a[252:255], a[204:207], v[244:247]
v_mfma_f32_16x16x32_bf16 v[240:243], a[248:251], a[192:195], v[240:243]
buffer_load_dwordx4 a[100:103], v1, s[36:39], s83 offen offset:0 sc1
v_mfma_f32_16x16x32_bf16 v[240:243], a[252:255], a[196:199], v[240:243]
s_waitcnt vmcnt(42) lgkmcnt(4)
v_mfma_f32_16x16x32_bf16 v[128:131], a[224:227], a[0:3], v[128:131]
ds_read_b64_tr_b16 a[240:241], v14 offset:32768
v_mfma_f32_16x16x32_bf16 v[128:131], a[228:231], a[4:7], v[128:131]
ds_read_b64_tr_b16 a[242:243], v14 offset:33792
v_mfma_f32_16x16x32_bf16 v[132:135], a[224:227], a[8:11], v[132:135]
ds_read_b64_tr_b16 a[244:245], v14 offset:36864
v_mfma_f32_16x16x32_bf16 v[132:135], a[228:231], a[12:15], v[132:135]
ds_read_b64_tr_b16 a[246:247], v14 offset:37888
v_mfma_f32_16x16x32_bf16 v[136:139], a[224:227], a[16:19], v[136:139]
buffer_load_dwordx4 a[104:107], v1, s[36:39], s82 offen offset:1024 sc1
v_mfma_f32_16x16x32_bf16 v[136:139], a[228:231], a[20:23], v[136:139]
v_mfma_f32_16x16x32_bf16 v[140:143], a[224:227], a[24:27], v[140:143]
buffer_load_dwordx4 a[108:111], v1, s[36:39], s83 offen offset:1024 sc1
v_mfma_f32_16x16x32_bf16 v[140:143], a[228:231], a[28:31], v[140:143]
s_waitcnt lgkmcnt(4)
v_mfma_f32_16x16x32_bf16 v[156:159], a[232:235], a[24:27], v[156:159]
ds_read_b64_tr_b16 a[248:249], v15 offset:32768
v_mfma_f32_16x16x32_bf16 v[156:159], a[236:239], a[28:31], v[156:159]
ds_read_b64_tr_b16 a[250:251], v15 offset:33792
v_mfma_f32_16x16x32_bf16 v[152:155], a[232:235], a[16:19], v[152:155]
ds_read_b64_tr_b16 a[252:253], v15 offset:36864
v_mfma_f32_16x16x32_bf16 v[152:155], a[236:239], a[20:23], v[152:155]
ds_read_b64_tr_b16 a[254:255], v15 offset:37888
v_mfma_f32_16x16x32_bf16 v[148:151], a[232:235], a[8:11], v[148:151]
buffer_load_dwordx4 a[112:115], v1, s[36:39], s82 offen offset:2048 sc1
v_mfma_f32_16x16x32_bf16 v[148:151], a[236:239], a[12:15], v[148:151]
v_mfma_f32_16x16x32_bf16 v[144:147], a[232:235], a[0:3], v[144:147]
buffer_load_dwordx4 a[116:119], v1, s[36:39], s83 offen offset:2048 sc1
v_mfma_f32_16x16x32_bf16 v[144:147], a[236:239], a[4:7], v[144:147]
s_waitcnt lgkmcnt(4)
v_mfma_f32_16x16x32_bf16 v[160:163], a[240:243], a[0:3], v[160:163]
ds_read_b64_tr_b16 a[224:225], v12 offset:40960
v_mfma_f32_16x16x32_bf16 v[160:163], a[244:247], a[4:7], v[160:163]
ds_read_b64_tr_b16 a[226:227], v12 offset:41984
v_mfma_f32_16x16x32_bf16 v[164:167], a[240:243], a[8:11], v[164:167]
ds_read_b64_tr_b16 a[228:229], v12 offset:45056
v_mfma_f32_16x16x32_bf16 v[164:167], a[244:247], a[12:15], v[164:167]
ds_read_b64_tr_b16 a[230:231], v12 offset:46080
v_mfma_f32_16x16x32_bf16 v[168:171], a[240:243], a[16:19], v[168:171]
buffer_load_dwordx4 a[120:123], v1, s[36:39], s82 offen offset:3072 sc1
s_add_u32 s82, s82, 16384
v_mfma_f32_16x16x32_bf16 v[168:171], a[244:247], a[20:23], v[168:171]
v_mfma_f32_16x16x32_bf16 v[172:175], a[240:243], a[24:27], v[172:175]
buffer_load_dwordx4 a[124:127], v1, s[36:39], s83 offen offset:3072 sc1
s_add_u32 s83, s83, 16384
v_mfma_f32_16x16x32_bf16 v[172:175], a[244:247], a[28:31], v[172:175]
s_waitcnt lgkmcnt(4)
v_mfma_f32_16x16x32_bf16 v[188:191], a[248:251], a[24:27], v[188:191]
ds_read_b64_tr_b16 a[232:233], v13 offset:40960
v_mfma_f32_16x16x32_bf16 v[188:191], a[252:255], a[28:31], v[188:191]
ds_read_b64_tr_b16 a[234:235], v13 offset:41984
v_mfma_f32_16x16x32_bf16 v[184:187], a[248:251], a[16:19], v[184:187]
ds_read_b64_tr_b16 a[236:237], v13 offset:45056
v_mfma_f32_16x16x32_bf16 v[184:187], a[252:255], a[20:23], v[184:187]
ds_read_b64_tr_b16 a[238:239], v13 offset:46080
s_add_u32 m0, s85, 65536
v_mfma_f32_16x16x32_bf16 v[180:183], a[248:251], a[8:11], v[180:183]
buffer_load_dwordx4 v7, s[28:31], s84 offen offset:0 lds
s_add_u32 s84, s84, 15360
v_mfma_f32_16x16x32_bf16 v[180:183], a[252:255], a[12:15], v[180:183]
v_mfma_f32_16x16x32_bf16 v[176:179], a[248:251], a[0:3], v[176:179]
buffer_load_dwordx4 v7, s[28:31], s84 offen offset:1024 lds
s_add_u32 s84, s84, 15360
v_mfma_f32_16x16x32_bf16 v[176:179], a[252:255], a[4:7], v[176:179]
s_waitcnt lgkmcnt(4)
v_mfma_f32_16x16x32_bf16 v[192:195], a[224:227], a[0:3], v[192:195]
ds_read_b64_tr_b16 a[240:241], v14 offset:40960
v_mfma_f32_16x16x32_bf16 v[192:195], a[228:231], a[4:7], v[192:195]
ds_read_b64_tr_b16 a[242:243], v14 offset:41984
v_mfma_f32_16x16x32_bf16 v[196:199], a[224:227], a[8:11], v[196:199]
ds_read_b64_tr_b16 a[244:245], v14 offset:45056
v_mfma_f32_16x16x32_bf16 v[196:199], a[228:231], a[12:15], v[196:199]
ds_read_b64_tr_b16 a[246:247], v14 offset:46080
v_mfma_f32_16x16x32_bf16 v[200:203], a[224:227], a[16:19], v[200:203]
buffer_load_dwordx4 v7, s[28:31], s84 offen offset:2048 lds
s_add_u32 s84, s84, 15360
v_mfma_f32_16x16x32_bf16 v[200:203], a[228:231], a[20:23], v[200:203]
v_mfma_f32_16x16x32_bf16 v[204:207], a[224:227], a[24:27], v[204:207]
v_mfma_f32_16x16x32_bf16 v[204:207], a[228:231], a[28:31], v[204:207]
s_waitcnt lgkmcnt(4)
v_mfma_f32_16x16x32_bf16 v[220:223], a[232:235], a[24:27], v[220:223]
ds_read_b64_tr_b16 a[248:249], v15 offset:40960
v_mfma_f32_16x16x32_bf16 v[220:223], a[236:239], a[28:31], v[220:223]
ds_read_b64_tr_b16 a[250:251], v15 offset:41984
v_mfma_f32_16x16x32_bf16 v[216:219], a[232:235], a[16:19], v[216:219]
ds_read_b64_tr_b16 a[252:253], v15 offset:45056
v_mfma_f32_16x16x32_bf16 v[216:219], a[236:239], a[20:23], v[216:219]
ds_read_b64_tr_b16 a[254:255], v15 offset:46080
v_mfma_f32_16x16x32_bf16 v[212:215], a[232:235], a[8:11], v[212:215]
buffer_load_dwordx4 v7, s[28:31], s84 offen offset:3072 lds
s_add_u32 s84, s84, 19456
v_mfma_f32_16x16x32_bf16 v[212:215], a[236:239], a[12:15], v[212:215]
s_add_u32 m0, s85, 69632
v_mfma_f32_16x16x32_bf16 v[208:211], a[232:235], a[0:3], v[208:211]
buffer_load_dwordx4 v7, s[28:31], s84 offen offset:0 lds
s_add_u32 s84, s84, 15360
v_mfma_f32_16x16x32_bf16 v[208:211], a[236:239], a[4:7], v[208:211]
s_waitcnt vmcnt(45) lgkmcnt(0)
s_barrier
v_mfma_f32_16x16x32_bf16 v[224:227], a[240:243], a[0:3], v[224:227]
ds_read_b64_tr_b16 a[224:225], v16 offset:0
v_mfma_f32_16x16x32_bf16 v[224:227], a[244:247], a[4:7], v[224:227]
ds_read_b64_tr_b16 a[226:227], v16 offset:1024
v_mfma_f32_16x16x32_bf16 v[228:231], a[240:243], a[8:11], v[228:231]
ds_read_b64_tr_b16 a[228:229], v16 offset:4096
v_mfma_f32_16x16x32_bf16 v[228:231], a[244:247], a[12:15], v[228:231]
ds_read_b64_tr_b16 a[230:231], v16 offset:5120
v_mfma_f32_16x16x32_bf16 v[232:235], a[240:243], a[16:19], v[232:235]
buffer_load_dwordx4 v7, s[28:31], s84 offen offset:1024 lds
s_add_u32 s84, s84, 15360
v_mfma_f32_16x16x32_bf16 v[232:235], a[244:247], a[20:23], v[232:235]
v_mfma_f32_16x16x32_bf16 v[236:239], a[240:243], a[24:27], v[236:239]
buffer_load_dwordx4 v7, s[28:31], s84 offen offset:2048 lds
s_add_u32 s84, s84, 15360
v_mfma_f32_16x16x32_bf16 v[236:239], a[244:247], a[28:31], v[236:239]
v_mfma_f32_16x16x32_bf16 v[252:255], a[248:251], a[24:27], v[252:255]
ds_read_b64_tr_b16 a[232:233], v17 offset:0
v_mfma_f32_16x16x32_bf16 v[252:255], a[252:255], a[28:31], v[252:255]
ds_read_b64_tr_b16 a[234:235], v17 offset:1024
v_mfma_f32_16x16x32_bf16 v[248:251], a[248:251], a[16:19], v[248:251]
ds_read_b64_tr_b16 a[236:237], v17 offset:4096
v_mfma_f32_16x16x32_bf16 v[248:251], a[252:255], a[20:23], v[248:251]
ds_read_b64_tr_b16 a[238:239], v17 offset:5120
v_mfma_f32_16x16x32_bf16 v[244:247], a[248:251], a[8:11], v[244:247]
buffer_load_dwordx4 v7, s[28:31], s84 offen offset:3072 lds
s_add_u32 s84, s84, 19456
v_mfma_f32_16x16x32_bf16 v[244:247], a[252:255], a[12:15], v[244:247]
v_mfma_f32_16x16x32_bf16 v[240:243], a[248:251], a[0:3], v[240:243]
buffer_load_dwordx4 a[192:195], v1, s[36:39], s82 offen offset:0 sc1
v_mfma_f32_16x16x32_bf16 v[240:243], a[252:255], a[4:7], v[240:243]
s_waitcnt vmcnt(41) lgkmcnt(4)
v_mfma_f32_16x16x32_bf16 v[128:131], a[224:227], a[32:35], v[128:131]
ds_read_b64_tr_b16 a[240:241], v18 offset:0
v_mfma_f32_16x16x32_bf16 v[128:131], a[228:231], a[36:39], v[128:131]
ds_read_b64_tr_b16 a[242:243], v18 offset:1024
v_mfma_f32_16x16x32_bf16 v[132:135], a[224:227], a[40:43], v[132:135]
ds_read_b64_tr_b16 a[244:245], v18 offset:4096
v_mfma_f32_16x16x32_bf16 v[132:135], a[228:231], a[44:47], v[132:135]
ds_read_b64_tr_b16 a[246:247], v18 offset:5120
v_mfma_f32_16x16x32_bf16 v[136:139], a[224:227], a[48:51], v[136:139]
buffer_load_dwordx4 a[196:199], v1, s[36:39], s83 offen offset:0 sc1
v_mfma_f32_16x16x32_bf16 v[136:139], a[228:231], a[52:55], v[136:139]
v_mfma_f32_16x16x32_bf16 v[140:143], a[224:227], a[56:59], v[140:143]
buffer_load_dwordx4 a[200:203], v1, s[36:39], s82 offen offset:1024 sc1
v_mfma_f32_16x16x32_bf16 v[140:143], a[228:231], a[60:63], v[140:143]
s_waitcnt lgkmcnt(4)
v_mfma_f32_16x16x32_bf16 v[156:159], a[232:235], a[56:59], v[156:159]
ds_read_b64_tr_b16 a[248:249], v19 offset:0
v_mfma_f32_16x16x32_bf16 v[156:159], a[236:239], a[60:63], v[156:159]
ds_read_b64_tr_b16 a[250:251], v19 offset:1024
v_mfma_f32_16x16x32_bf16 v[152:155], a[232:235], a[48:51], v[152:155]
ds_read_b64_tr_b16 a[252:253], v19 offset:4096
v_mfma_f32_16x16x32_bf16 v[152:155], a[236:239], a[52:55], v[152:155]
ds_read_b64_tr_b16 a[254:255], v19 offset:5120
v_mfma_f32_16x16x32_bf16 v[148:151], a[232:235], a[40:43], v[148:151]
buffer_load_dwordx4 a[204:207], v1, s[36:39], s83 offen offset:1024 sc1
v_mfma_f32_16x16x32_bf16 v[148:151], a[236:239], a[44:47], v[148:151]
v_mfma_f32_16x16x32_bf16 v[144:147], a[232:235], a[32:35], v[144:147]
buffer_load_dwordx4 a[208:211], v1, s[36:39], s82 offen offset:2048 sc1
v_mfma_f32_16x16x32_bf16 v[144:147], a[236:239], a[36:39], v[144:147]
s_waitcnt lgkmcnt(4)
v_mfma_f32_16x16x32_bf16 v[160:163], a[240:243], a[32:35], v[160:163]
ds_read_b64_tr_b16 a[224:225], v16 offset:8192
v_mfma_f32_16x16x32_bf16 v[160:163], a[244:247], a[36:39], v[160:163]
ds_read_b64_tr_b16 a[226:227], v16 offset:9216
v_mfma_f32_16x16x32_bf16 v[164:167], a[240:243], a[40:43], v[164:167]
ds_read_b64_tr_b16 a[228:229], v16 offset:12288
v_mfma_f32_16x16x32_bf16 v[164:167], a[244:247], a[44:47], v[164:167]
ds_read_b64_tr_b16 a[230:231], v16 offset:13312
v_mfma_f32_16x16x32_bf16 v[168:171], a[240:243], a[48:51], v[168:171]
buffer_load_dwordx4 a[212:215], v1, s[36:39], s83 offen offset:2048 sc1
v_mfma_f32_16x16x32_bf16 v[168:171], a[244:247], a[52:55], v[168:171]
v_mfma_f32_16x16x32_bf16 v[172:175], a[240:243], a[56:59], v[172:175]
buffer_load_dwordx4 a[216:219], v1, s[36:39], s82 offen offset:3072 sc1
s_add_u32 s82, s82, 16384
v_mfma_f32_16x16x32_bf16 v[172:175], a[244:247], a[60:63], v[172:175]
s_waitcnt lgkmcnt(4)
v_mfma_f32_16x16x32_bf16 v[188:191], a[248:251], a[56:59], v[188:191]
ds_read_b64_tr_b16 a[232:233], v17 offset:8192
v_mfma_f32_16x16x32_bf16 v[188:191], a[252:255], a[60:63], v[188:191]
ds_read_b64_tr_b16 a[234:235], v17 offset:9216
v_mfma_f32_16x16x32_bf16 v[184:187], a[248:251], a[48:51], v[184:187]
ds_read_b64_tr_b16 a[236:237], v17 offset:12288
v_mfma_f32_16x16x32_bf16 v[184:187], a[252:255], a[52:55], v[184:187]
ds_read_b64_tr_b16 a[238:239], v17 offset:13312
v_mfma_f32_16x16x32_bf16 v[180:183], a[248:251], a[40:43], v[180:183]
buffer_load_dwordx4 a[220:223], v1, s[36:39], s83 offen offset:3072 sc1
s_add_u32 s83, s83, 16384
v_mfma_f32_16x16x32_bf16 v[180:183], a[252:255], a[44:47], v[180:183]
v_mfma_f32_16x16x32_bf16 v[176:179], a[248:251], a[32:35], v[176:179]
v_mfma_f32_16x16x32_bf16 v[176:179], a[252:255], a[36:39], v[176:179]
s_waitcnt lgkmcnt(4)
v_mfma_f32_16x16x32_bf16 v[192:195], a[224:227], a[32:35], v[192:195]
ds_read_b64_tr_b16 a[240:241], v18 offset:8192
v_mfma_f32_16x16x32_bf16 v[192:195], a[228:231], a[36:39], v[192:195]
ds_read_b64_tr_b16 a[242:243], v18 offset:9216
v_mfma_f32_16x16x32_bf16 v[196:199], a[224:227], a[40:43], v[196:199]
ds_read_b64_tr_b16 a[244:245], v18 offset:12288
v_mfma_f32_16x16x32_bf16 v[196:199], a[228:231], a[44:47], v[196:199]
ds_read_b64_tr_b16 a[246:247], v18 offset:13312
s_add_u32 m0, s85, 98304
v_mfma_f32_16x16x32_bf16 v[200:203], a[224:227], a[48:51], v[200:203]
buffer_load_dwordx4 v7, s[28:31], s84 offen offset:0 lds
s_add_u32 s84, s84, 15360
v_mfma_f32_16x16x32_bf16 v[200:203], a[228:231], a[52:55], v[200:203]
v_mfma_f32_16x16x32_bf16 v[204:207], a[224:227], a[56:59], v[204:207]
buffer_load_dwordx4 v7, s[28:31], s84 offen offset:1024 lds
s_add_u32 s84, s84, 15360
v_mfma_f32_16x16x32_bf16 v[204:207], a[228:231], a[60:63], v[204:207]
s_waitcnt lgkmcnt(4)
v_mfma_f32_16x16x32_bf16 v[220:223], a[232:235], a[56:59], v[220:223]
ds_read_b64_tr_b16 a[248:249], v19 offset:8192
v_mfma_f32_16x16x32_bf16 v[220:223], a[236:239], a[60:63], v[220:223]
ds_read_b64_tr_b16 a[250:251], v19 offset:9216
v_mfma_f32_16x16x32_bf16 v[216:219], a[232:235], a[48:51], v[216:219]
ds_read_b64_tr_b16 a[252:253], v19 offset:12288
v_mfma_f32_16x16x32_bf16 v[216:219], a[236:239], a[52:55], v[216:219]
ds_read_b64_tr_b16 a[254:255], v19 offset:13312
v_mfma_f32_16x16x32_bf16 v[212:215], a[232:235], a[40:43], v[212:215]
buffer_load_dwordx4 v7, s[28:31], s84 offen offset:2048 lds
s_add_u32 s84, s84, 15360
v_mfma_f32_16x16x32_bf16 v[212:215], a[236:239], a[44:47], v[212:215]
v_mfma_f32_16x16x32_bf16 v[208:211], a[232:235], a[32:35], v[208:211]
buffer_load_dwordx4 v7, s[28:31], s84 offen offset:3072 lds
s_add_u32 s84, s84, 19456
v_mfma_f32_16x16x32_bf16 v[208:211], a[236:239], a[36:39], v[208:211]
s_waitcnt vmcnt(44) lgkmcnt(0)
s_barrier
v_mfma_f32_16x16x32_bf16 v[224:227], a[240:243], a[32:35], v[224:227]
ds_read_b64_tr_b16 a[224:225], v8 offset:0
v_mfma_f32_16x16x32_bf16 v[224:227], a[244:247], a[36:39], v[224:227]
ds_read_b64_tr_b16 a[226:227], v8 offset:1024
v_mfma_f32_16x16x32_bf16 v[228:231], a[240:243], a[40:43], v[228:231]
ds_read_b64_tr_b16 a[228:229], v8 offset:4096
v_mfma_f32_16x16x32_bf16 v[228:231], a[244:247], a[44:47], v[228:231]
ds_read_b64_tr_b16 a[230:231], v8 offset:5120
s_add_u32 m0, s85, 102400
v_mfma_f32_16x16x32_bf16 v[232:235], a[240:243], a[48:51], v[232:235]
buffer_load_dwordx4 v7, s[28:31], s84 offen offset:0 lds
s_add_u32 s84, s84, 15360
v_mfma_f32_16x16x32_bf16 v[232:235], a[244:247], a[52:55], v[232:235]
v_mfma_f32_16x16x32_bf16 v[236:239], a[240:243], a[56:59], v[236:239]
buffer_load_dwordx4 v7, s[28:31], s84 offen offset:1024 lds
s_add_u32 s84, s84, 15360
v_mfma_f32_16x16x32_bf16 v[236:239], a[244:247], a[60:63], v[236:239]
v_mfma_f32_16x16x32_bf16 v[252:255], a[248:251], a[56:59], v[252:255]
ds_read_b64_tr_b16 a[232:233], v9 offset:0
v_mfma_f32_16x16x32_bf16 v[252:255], a[252:255], a[60:63], v[252:255]
ds_read_b64_tr_b16 a[234:235], v9 offset:1024
v_mfma_f32_16x16x32_bf16 v[248:251], a[248:251], a[48:51], v[248:251]
ds_read_b64_tr_b16 a[236:237], v9 offset:4096
v_mfma_f32_16x16x32_bf16 v[248:251], a[252:255], a[52:55], v[248:251]
ds_read_b64_tr_b16 a[238:239], v9 offset:5120
v_mfma_f32_16x16x32_bf16 v[244:247], a[248:251], a[40:43], v[244:247]
buffer_load_dwordx4 v7, s[28:31], s84 offen offset:2048 lds
s_add_u32 s84, s84, 15360
v_mfma_f32_16x16x32_bf16 v[244:247], a[252:255], a[44:47], v[244:247]
v_mfma_f32_16x16x32_bf16 v[240:243], a[248:251], a[32:35], v[240:243]
buffer_load_dwordx4 v7, s[28:31], s84 offen offset:3072 lds
s_add_u32 s84, s84, 19456
v_mfma_f32_16x16x32_bf16 v[240:243], a[252:255], a[36:39], v[240:243]
s_waitcnt vmcnt(40) lgkmcnt(4)
v_mfma_f32_16x16x32_bf16 v[128:131], a[224:227], a[64:67], v[128:131]
ds_read_b64_tr_b16 a[240:241], v10 offset:0
v_mfma_f32_16x16x32_bf16 v[128:131], a[228:231], a[68:71], v[128:131]
ds_read_b64_tr_b16 a[242:243], v10 offset:1024
v_mfma_f32_16x16x32_bf16 v[132:135], a[224:227], a[72:75], v[132:135]
ds_read_b64_tr_b16 a[244:245], v10 offset:4096
v_mfma_f32_16x16x32_bf16 v[132:135], a[228:231], a[76:79], v[132:135]
ds_read_b64_tr_b16 a[246:247], v10 offset:5120
v_mfma_f32_16x16x32_bf16 v[136:139], a[224:227], a[80:83], v[136:139]
buffer_load_dwordx4 a[0:3], v1, s[36:39], s82 offen offset:0 sc1
v_mfma_f32_16x16x32_bf16 v[136:139], a[228:231], a[84:87], v[136:139]
v_mfma_f32_16x16x32_bf16 v[140:143], a[224:227], a[88:91], v[140:143]
buffer_load_dwordx4 a[4:7], v1, s[36:39], s83 offen offset:0 sc1
v_mfma_f32_16x16x32_bf16 v[140:143], a[228:231], a[92:95], v[140:143]
s_waitcnt lgkmcnt(4)
v_mfma_f32_16x16x32_bf16 v[156:159], a[232:235], a[88:91], v[156:159]
ds_read_b64_tr_b16 a[248:249], v11 offset:0
v_mfma_f32_16x16x32_bf16 v[156:159], a[236:239], a[92:95], v[156:159]
ds_read_b64_tr_b16 a[250:251], v11 offset:1024
v_mfma_f32_16x16x32_bf16 v[152:155], a[232:235], a[80:83], v[152:155]
ds_read_b64_tr_b16 a[252:253], v11 offset:4096
v_mfma_f32_16x16x32_bf16 v[152:155], a[236:239], a[84:87], v[152:155]
ds_read_b64_tr_b16 a[254:255], v11 offset:5120
v_mfma_f32_16x16x32_bf16 v[148:151], a[232:235], a[72:75], v[148:151]
buffer_load_dwordx4 a[8:11], v1, s[36:39], s82 offen offset:1024 sc1
v_mfma_f32_16x16x32_bf16 v[148:151], a[236:239], a[76:79], v[148:151]
v_mfma_f32_16x16x32_bf16 v[144:147], a[232:235], a[64:67], v[144:147]
buffer_load_dwordx4 a[12:15], v1, s[36:39], s83 offen offset:1024 sc1
v_mfma_f32_16x16x32_bf16 v[144:147], a[236:239], a[68:71], v[144:147]
s_waitcnt lgkmcnt(4)
v_mfma_f32_16x16x32_bf16 v[160:163], a[240:243], a[64:67], v[160:163]
ds_read_b64_tr_b16 a[224:225], v8 offset:8192
v_mfma_f32_16x16x32_bf16 v[160:163], a[244:247], a[68:71], v[160:163]
ds_read_b64_tr_b16 a[226:227], v8 offset:9216
v_mfma_f32_16x16x32_bf16 v[164:167], a[240:243], a[72:75], v[164:167]
ds_read_b64_tr_b16 a[228:229], v8 offset:12288
v_mfma_f32_16x16x32_bf16 v[164:167], a[244:247], a[76:79], v[164:167]
ds_read_b64_tr_b16 a[230:231], v8 offset:13312
v_mfma_f32_16x16x32_bf16 v[168:171], a[240:243], a[80:83], v[168:171]
buffer_load_dwordx4 a[16:19], v1, s[36:39], s82 offen offset:2048 sc1
v_mfma_f32_16x16x32_bf16 v[168:171], a[244:247], a[84:87], v[168:171]
v_mfma_f32_16x16x32_bf16 v[172:175], a[240:243], a[88:91], v[172:175]
buffer_load_dwordx4 a[20:23], v1, s[36:39], s83 offen offset:2048 sc1
v_mfma_f32_16x16x32_bf16 v[172:175], a[244:247], a[92:95], v[172:175]
s_waitcnt lgkmcnt(4)
v_mfma_f32_16x16x32_bf16 v[188:191], a[248:251], a[88:91], v[188:191]
ds_read_b64_tr_b16 a[232:233], v9 offset:8192
v_mfma_f32_16x16x32_bf16 v[188:191], a[252:255], a[92:95], v[188:191]
ds_read_b64_tr_b16 a[234:235], v9 offset:9216
v_mfma_f32_16x16x32_bf16 v[184:187], a[248:251], a[80:83], v[184:187]
ds_read_b64_tr_b16 a[236:237], v9 offset:12288
v_mfma_f32_16x16x32_bf16 v[184:187], a[252:255], a[84:87], v[184:187]
ds_read_b64_tr_b16 a[238:239], v9 offset:13312
v_mfma_f32_16x16x32_bf16 v[180:183], a[248:251], a[72:75], v[180:183]
buffer_load_dwordx4 a[24:27], v1, s[36:39], s82 offen offset:3072 sc1
s_add_u32 s82, s82, 16384
v_mfma_f32_16x16x32_bf16 v[180:183], a[252:255], a[76:79], v[180:183]
v_mfma_f32_16x16x32_bf16 v[176:179], a[248:251], a[64:67], v[176:179]
v_mfma_f32_16x16x32_bf16 v[176:179], a[252:255], a[68:71], v[176:179]
s_waitcnt lgkmcnt(4)
v_mfma_f32_16x16x32_bf16 v[192:195], a[224:227], a[64:67], v[192:195]
ds_read_b64_tr_b16 a[240:241], v10 offset:8192
v_mfma_f32_16x16x32_bf16 v[192:195], a[228:231], a[68:71], v[192:195]
ds_read_b64_tr_b16 a[242:243], v10 offset:9216
v_mfma_f32_16x16x32_bf16 v[196:199], a[224:227], a[72:75], v[196:199]
ds_read_b64_tr_b16 a[244:245], v10 offset:12288
v_mfma_f32_16x16x32_bf16 v[196:199], a[228:231], a[76:79], v[196:199]
ds_read_b64_tr_b16 a[246:247], v10 offset:13312
v_mfma_f32_16x16x32_bf16 v[200:203], a[224:227], a[80:83], v[200:203]
buffer_load_dwordx4 a[28:31], v1, s[36:39], s83 offen offset:3072 sc1
s_add_u32 s83, s83, 16384
v_mfma_f32_16x16x32_bf16 v[200:203], a[228:231], a[84:87], v[200:203]
s_add_u32 m0, s85, 131072
v_mfma_f32_16x16x32_bf16 v[204:207], a[224:227], a[88:91], v[204:207]
buffer_load_dwordx4 v7, s[28:31], s84 offen offset:0 lds
s_add_u32 s84, s84, 15360
v_mfma_f32_16x16x32_bf16 v[204:207], a[228:231], a[92:95], v[204:207]
s_waitcnt lgkmcnt(4)
v_mfma_f32_16x16x32_bf16 v[220:223], a[232:235], a[88:91], v[220:223]
ds_read_b64_tr_b16 a[248:249], v11 offset:8192
v_mfma_f32_16x16x32_bf16 v[220:223], a[236:239], a[92:95], v[220:223]
ds_read_b64_tr_b16 a[250:251], v11 offset:9216
v_mfma_f32_16x16x32_bf16 v[216:219], a[232:235], a[80:83], v[216:219]
ds_read_b64_tr_b16 a[252:253], v11 offset:12288
v_mfma_f32_16x16x32_bf16 v[216:219], a[236:239], a[84:87], v[216:219]
ds_read_b64_tr_b16 a[254:255], v11 offset:13312
v_mfma_f32_16x16x32_bf16 v[212:215], a[232:235], a[72:75], v[212:215]
buffer_load_dwordx4 v7, s[28:31], s84 offen offset:1024 lds
s_add_u32 s84, s84, 15360
v_mfma_f32_16x16x32_bf16 v[212:215], a[236:239], a[76:79], v[212:215]
v_mfma_f32_16x16x32_bf16 v[208:211], a[232:235], a[64:67], v[208:211]
buffer_load_dwordx4 v7, s[28:31], s84 offen offset:2048 lds
s_add_u32 s84, s84, 15360
v_mfma_f32_16x16x32_bf16 v[208:211], a[236:239], a[68:71], v[208:211]
s_waitcnt vmcnt(43) lgkmcnt(0)
s_barrier
v_mfma_f32_16x16x32_bf16 v[224:227], a[240:243], a[64:67], v[224:227]
ds_read_b64_tr_b16 a[224:225], v8 offset:32768
v_mfma_f32_16x16x32_bf16 v[224:227], a[244:247], a[68:71], v[224:227]
ds_read_b64_tr_b16 a[226:227], v8 offset:33792
v_mfma_f32_16x16x32_bf16 v[228:231], a[240:243], a[72:75], v[228:231]
ds_read_b64_tr_b16 a[228:229], v8 offset:36864
v_mfma_f32_16x16x32_bf16 v[228:231], a[244:247], a[76:79], v[228:231]
ds_read_b64_tr_b16 a[230:231], v8 offset:37888
v_mfma_f32_16x16x32_bf16 v[232:235], a[240:243], a[80:83], v[232:235]
buffer_load_dwordx4 v7, s[28:31], s84 offen offset:3072 lds
s_add_u32 s84, s84, 19456
v_mfma_f32_16x16x32_bf16 v[232:235], a[244:247], a[84:87], v[232:235]
s_add_u32 m0, s85, 135168
v_mfma_f32_16x16x32_bf16 v[236:239], a[240:243], a[88:91], v[236:239]
buffer_load_dwordx4 v7, s[28:31], s84 offen offset:0 lds
s_add_u32 s84, s84, 15360
v_mfma_f32_16x16x32_bf16 v[236:239], a[244:247], a[92:95], v[236:239]
v_mfma_f32_16x16x32_bf16 v[252:255], a[248:251], a[88:91], v[252:255]
ds_read_b64_tr_b16 a[232:233], v9 offset:32768
v_mfma_f32_16x16x32_bf16 v[252:255], a[252:255], a[92:95], v[252:255]
ds_read_b64_tr_b16 a[234:235], v9 offset:33792
v_mfma_f32_16x16x32_bf16 v[248:251], a[248:251], a[80:83], v[248:251]
ds_read_b64_tr_b16 a[236:237], v9 offset:36864
v_mfma_f32_16x16x32_bf16 v[248:251], a[252:255], a[84:87], v[248:251]
ds_read_b64_tr_b16 a[238:239], v9 offset:37888
v_mfma_f32_16x16x32_bf16 v[244:247], a[248:251], a[72:75], v[244:247]
buffer_load_dwordx4 v7, s[28:31], s84 offen offset:1024 lds
s_add_u32 s84, s84, 15360
v_mfma_f32_16x16x32_bf16 v[244:247], a[252:255], a[76:79], v[244:247]
v_mfma_f32_16x16x32_bf16 v[240:243], a[248:251], a[64:67], v[240:243]
buffer_load_dwordx4 v7, s[28:31], s84 offen offset:2048 lds
s_add_u32 s84, s84, 15360
v_mfma_f32_16x16x32_bf16 v[240:243], a[252:255], a[68:71], v[240:243]
s_waitcnt vmcnt(39) lgkmcnt(4)
v_mfma_f32_16x16x32_bf16 v[128:131], a[224:227], a[96:99], v[128:131]
ds_read_b64_tr_b16 a[240:241], v10 offset:32768
v_mfma_f32_16x16x32_bf16 v[128:131], a[228:231], a[100:103], v[128:131]
ds_read_b64_tr_b16 a[242:243], v10 offset:33792
v_mfma_f32_16x16x32_bf16 v[132:135], a[224:227], a[104:107], v[132:135]
ds_read_b64_tr_b16 a[244:245], v10 offset:36864
v_mfma_f32_16x16x32_bf16 v[132:135], a[228:231], a[108:111], v[132:135]
ds_read_b64_tr_b16 a[246:247], v10 offset:37888
v_mfma_f32_16x16x32_bf16 v[136:139], a[224:227], a[112:115], v[136:139]
buffer_load_dwordx4 v7, s[28:31], s84 offen offset:3072 lds
s_add_u32 s84, s84, 19456
v_mfma_f32_16x16x32_bf16 v[136:139], a[228:231], a[116:119], v[136:139]
v_mfma_f32_16x16x32_bf16 v[140:143], a[224:227], a[120:123], v[140:143]
buffer_load_dwordx4 a[32:35], v1, s[36:39], s82 offen offset:0 sc1
v_mfma_f32_16x16x32_bf16 v[140:143], a[228:231], a[124:127], v[140:143]
s_waitcnt lgkmcnt(4)
v_mfma_f32_16x16x32_bf16 v[156:159], a[232:235], a[120:123], v[156:159]
ds_read_b64_tr_b16 a[248:249], v11 offset:32768
v_mfma_f32_16x16x32_bf16 v[156:159], a[236:239], a[124:127], v[156:159]
ds_read_b64_tr_b16 a[250:251], v11 offset:33792
v_mfma_f32_16x16x32_bf16 v[152:155], a[232:235], a[112:115], v[152:155]
ds_read_b64_tr_b16 a[252:253], v11 offset:36864
v_mfma_f32_16x16x32_bf16 v[152:155], a[236:239], a[116:119], v[152:155]
ds_read_b64_tr_b16 a[254:255], v11 offset:37888
v_mfma_f32_16x16x32_bf16 v[148:151], a[232:235], a[104:107], v[148:151]
buffer_load_dwordx4 a[36:39], v1, s[36:39], s83 offen offset:0 sc1
v_mfma_f32_16x16x32_bf16 v[148:151], a[236:239], a[108:111], v[148:151]
v_mfma_f32_16x16x32_bf16 v[144:147], a[232:235], a[96:99], v[144:147]
buffer_load_dwordx4 a[40:43], v1, s[36:39], s82 offen offset:1024 sc1
v_mfma_f32_16x16x32_bf16 v[144:147], a[236:239], a[100:103], v[144:147]
s_waitcnt lgkmcnt(4)
v_mfma_f32_16x16x32_bf16 v[160:163], a[240:243], a[96:99], v[160:163]
ds_read_b64_tr_b16 a[224:225], v8 offset:40960
v_mfma_f32_16x16x32_bf16 v[160:163], a[244:247], a[100:103], v[160:163]
ds_read_b64_tr_b16 a[226:227], v8 offset:41984
v_mfma_f32_16x16x32_bf16 v[164:167], a[240:243], a[104:107], v[164:167]
ds_read_b64_tr_b16 a[228:229], v8 offset:45056
v_mfma_f32_16x16x32_bf16 v[164:167], a[244:247], a[108:111], v[164:167]
ds_read_b64_tr_b16 a[230:231], v8 offset:46080
v_mfma_f32_16x16x32_bf16 v[168:171], a[240:243], a[112:115], v[168:171]
buffer_load_dwordx4 a[44:47], v1, s[36:39], s83 offen offset:1024 sc1
v_mfma_f32_16x16x32_bf16 v[168:171], a[244:247], a[116:119], v[168:171]
v_mfma_f32_16x16x32_bf16 v[172:175], a[240:243], a[120:123], v[172:175]
v_mfma_f32_16x16x32_bf16 v[172:175], a[244:247], a[124:127], v[172:175]
s_waitcnt lgkmcnt(4)
v_mfma_f32_16x16x32_bf16 v[188:191], a[248:251], a[120:123], v[188:191]
ds_read_b64_tr_b16 a[232:233], v9 offset:40960
v_mfma_f32_16x16x32_bf16 v[188:191], a[252:255], a[124:127], v[188:191]
ds_read_b64_tr_b16 a[234:235], v9 offset:41984
v_mfma_f32_16x16x32_bf16 v[184:187], a[248:251], a[112:115], v[184:187]
ds_read_b64_tr_b16 a[236:237], v9 offset:45056
v_mfma_f32_16x16x32_bf16 v[184:187], a[252:255], a[116:119], v[184:187]
ds_read_b64_tr_b16 a[238:239], v9 offset:46080
v_mfma_f32_16x16x32_bf16 v[180:183], a[248:251], a[104:107], v[180:183]
buffer_load_dwordx4 a[48:51], v1, s[36:39], s82 offen offset:2048 sc1
v_mfma_f32_16x16x32_bf16 v[180:183], a[252:255], a[108:111], v[180:183]
v_mfma_f32_16x16x32_bf16 v[176:179], a[248:251], a[96:99], v[176:179]
buffer_load_dwordx4 a[52:55], v1, s[36:39], s83 offen offset:2048 sc1
v_mfma_f32_16x16x32_bf16 v[176:179], a[252:255], a[100:103], v[176:179]
s_waitcnt lgkmcnt(4)
v_mfma_f32_16x16x32_bf16 v[192:195], a[224:227], a[96:99], v[192:195]
ds_read_b64_tr_b16 a[240:241], v10 offset:40960
v_mfma_f32_16x16x32_bf16 v[192:195], a[228:231], a[100:103], v[192:195]
ds_read_b64_tr_b16 a[242:243], v10 offset:41984
v_mfma_f32_16x16x32_bf16 v[196:199], a[224:227], a[104:107], v[196:199]
ds_read_b64_tr_b16 a[244:245], v10 offset:45056
v_mfma_f32_16x16x32_bf16 v[196:199], a[228:231], a[108:111], v[196:199]
ds_read_b64_tr_b16 a[246:247], v10 offset:46080
v_mfma_f32_16x16x32_bf16 v[200:203], a[224:227], a[112:115], v[200:203]
buffer_load_dwordx4 a[56:59], v1, s[36:39], s82 offen offset:3072 sc1
s_add_u32 s82, s82, 16384
v_mfma_f32_16x16x32_bf16 v[200:203], a[228:231], a[116:119], v[200:203]
v_mfma_f32_16x16x32_bf16 v[204:207], a[224:227], a[120:123], v[204:207]
buffer_load_dwordx4 a[60:63], v1, s[36:39], s83 offen offset:3072 sc1
s_add_u32 s83, s83, 16384
v_mfma_f32_16x16x32_bf16 v[204:207], a[228:231], a[124:127], v[204:207]
s_waitcnt lgkmcnt(4)
v_mfma_f32_16x16x32_bf16 v[220:223], a[232:235], a[120:123], v[220:223]
ds_read_b64_tr_b16 a[248:249], v11 offset:40960
v_mfma_f32_16x16x32_bf16 v[220:223], a[236:239], a[124:127], v[220:223]
ds_read_b64_tr_b16 a[250:251], v11 offset:41984
v_mfma_f32_16x16x32_bf16 v[216:219], a[232:235], a[112:115], v[216:219]
ds_read_b64_tr_b16 a[252:253], v11 offset:45056
v_mfma_f32_16x16x32_bf16 v[216:219], a[236:239], a[116:119], v[216:219]
ds_read_b64_tr_b16 a[254:255], v11 offset:46080
s_add_u32 m0, s85, 0
v_mfma_f32_16x16x32_bf16 v[212:215], a[232:235], a[104:107], v[212:215]
buffer_load_dwordx4 v7, s[28:31], s84 offen offset:0 lds
s_add_u32 s84, s84, 15360
v_mfma_f32_16x16x32_bf16 v[212:215], a[236:239], a[108:111], v[212:215]
v_mfma_f32_16x16x32_bf16 v[208:211], a[232:235], a[96:99], v[208:211]
buffer_load_dwordx4 v7, s[28:31], s84 offen offset:1024 lds
s_add_u32 s84, s84, 15360
v_mfma_f32_16x16x32_bf16 v[208:211], a[236:239], a[100:103], v[208:211]
s_waitcnt vmcnt(42) lgkmcnt(0)
s_barrier
buffer_load_dword v27, v26, s[36:39], s62 offen sc1
v_mfma_f32_16x16x32_bf16 v[224:227], a[240:243], a[96:99], v[224:227]
ds_read_b64_tr_b16 a[224:225], v12 offset:0
v_mfma_f32_16x16x32_bf16 v[224:227], a[244:247], a[100:103], v[224:227]
ds_read_b64_tr_b16 a[226:227], v12 offset:1024
v_mfma_f32_16x16x32_bf16 v[228:231], a[240:243], a[104:107], v[228:231]
ds_read_b64_tr_b16 a[228:229], v12 offset:4096
v_mfma_f32_16x16x32_bf16 v[228:231], a[244:247], a[108:111], v[228:231]
ds_read_b64_tr_b16 a[230:231], v12 offset:5120
v_mfma_f32_16x16x32_bf16 v[232:235], a[240:243], a[112:115], v[232:235]
buffer_load_dwordx4 v7, s[28:31], s84 offen offset:2048 lds
s_add_u32 s84, s84, 15360
v_mfma_f32_16x16x32_bf16 v[232:235], a[244:247], a[116:119], v[232:235]
v_mfma_f32_16x16x32_bf16 v[236:239], a[240:243], a[120:123], v[236:239]
buffer_load_dwordx4 v7, s[28:31], s84 offen offset:3072 lds
s_add_u32 s84, s84, 19456
v_mfma_f32_16x16x32_bf16 v[236:239], a[244:247], a[124:127], v[236:239]
v_mfma_f32_16x16x32_bf16 v[252:255], a[248:251], a[120:123], v[252:255]
ds_read_b64_tr_b16 a[232:233], v13 offset:0
v_mfma_f32_16x16x32_bf16 v[252:255], a[252:255], a[124:127], v[252:255]
ds_read_b64_tr_b16 a[234:235], v13 offset:1024
v_mfma_f32_16x16x32_bf16 v[248:251], a[248:251], a[112:115], v[248:251]
ds_read_b64_tr_b16 a[236:237], v13 offset:4096
v_mfma_f32_16x16x32_bf16 v[248:251], a[252:255], a[116:119], v[248:251]
ds_read_b64_tr_b16 a[238:239], v13 offset:5120
s_add_u32 m0, s85, 4096
v_mfma_f32_16x16x32_bf16 v[244:247], a[248:251], a[104:107], v[244:247]
buffer_load_dwordx4 v7, s[28:31], s84 offen offset:0 lds
s_add_u32 s84, s84, 15360
v_mfma_f32_16x16x32_bf16 v[244:247], a[252:255], a[108:111], v[244:247]
v_mfma_f32_16x16x32_bf16 v[240:243], a[248:251], a[96:99], v[240:243]
buffer_load_dwordx4 v7, s[28:31], s84 offen offset:1024 lds
s_add_u32 s84, s84, 15360
v_mfma_f32_16x16x32_bf16 v[240:243], a[252:255], a[100:103], v[240:243]
s_waitcnt vmcnt(39) lgkmcnt(4)
v_mfma_f32_16x16x32_bf16 v[128:131], a[224:227], a[192:195], v[128:131]
ds_read_b64_tr_b16 a[240:241], v14 offset:0
v_mfma_f32_16x16x32_bf16 v[128:131], a[228:231], a[196:199], v[128:131]
ds_read_b64_tr_b16 a[242:243], v14 offset:1024
v_mfma_f32_16x16x32_bf16 v[132:135], a[224:227], a[200:203], v[132:135]
ds_read_b64_tr_b16 a[244:245], v14 offset:4096
v_mfma_f32_16x16x32_bf16 v[132:135], a[228:231], a[204:207], v[132:135]
ds_read_b64_tr_b16 a[246:247], v14 offset:5120
v_mfma_f32_16x16x32_bf16 v[136:139], a[224:227], a[208:211], v[136:139]
buffer_load_dwordx4 v7, s[28:31], s84 offen offset:2048 lds
s_add_u32 s84, s84, 15360
v_mfma_f32_16x16x32_bf16 v[136:139], a[228:231], a[212:215], v[136:139]
v_mfma_f32_16x16x32_bf16 v[140:143], a[224:227], a[216:219], v[140:143]
buffer_load_dwordx4 v7, s[28:31], s84 offen offset:3072 lds
s_lshl_b32 s84, s10, 19
v_mfma_f32_16x16x32_bf16 v[140:143], a[228:231], a[220:223], v[140:143]
s_waitcnt lgkmcnt(4)
v_mfma_f32_16x16x32_bf16 v[156:159], a[232:235], a[216:219], v[156:159]
ds_read_b64_tr_b16 a[248:249], v15 offset:0
v_mfma_f32_16x16x32_bf16 v[156:159], a[236:239], a[220:223], v[156:159]
ds_read_b64_tr_b16 a[250:251], v15 offset:1024
v_mfma_f32_16x16x32_bf16 v[152:155], a[232:235], a[208:211], v[152:155]
ds_read_b64_tr_b16 a[252:253], v15 offset:4096
v_mfma_f32_16x16x32_bf16 v[152:155], a[236:239], a[212:215], v[152:155]
ds_read_b64_tr_b16 a[254:255], v15 offset:5120
v_mfma_f32_16x16x32_bf16 v[148:151], a[232:235], a[200:203], v[148:151]
buffer_load_dwordx4 a[64:67], v1, s[36:39], s82 offen offset:0 sc1
v_mfma_f32_16x16x32_bf16 v[148:151], a[236:239], a[204:207], v[148:151]
v_mfma_f32_16x16x32_bf16 v[144:147], a[232:235], a[192:195], v[144:147]
buffer_load_dwordx4 a[68:71], v1, s[36:39], s83 offen offset:0 sc1
v_mfma_f32_16x16x32_bf16 v[144:147], a[236:239], a[196:199], v[144:147]
s_waitcnt lgkmcnt(4)
v_mfma_f32_16x16x32_bf16 v[160:163], a[240:243], a[192:195], v[160:163]
ds_read_b64_tr_b16 a[224:225], v12 offset:8192
v_mfma_f32_16x16x32_bf16 v[160:163], a[244:247], a[196:199], v[160:163]
ds_read_b64_tr_b16 a[226:227], v12 offset:9216
v_mfma_f32_16x16x32_bf16 v[164:167], a[240:243], a[200:203], v[164:167]
ds_read_b64_tr_b16 a[228:229], v12 offset:12288
v_mfma_f32_16x16x32_bf16 v[164:167], a[244:247], a[204:207], v[164:167]
ds_read_b64_tr_b16 a[230:231], v12 offset:13312
v_mfma_f32_16x16x32_bf16 v[168:171], a[240:243], a[208:211], v[168:171]
buffer_load_dwordx4 a[72:75], v1, s[36:39], s82 offen offset:1024 sc1
v_mfma_f32_16x16x32_bf16 v[168:171], a[244:247], a[212:215], v[168:171]
v_mfma_f32_16x16x32_bf16 v[172:175], a[240:243], a[216:219], v[172:175]
v_mfma_f32_16x16x32_bf16 v[172:175], a[244:247], a[220:223], v[172:175]
s_waitcnt lgkmcnt(4)
v_mfma_f32_16x16x32_bf16 v[188:191], a[248:251], a[216:219], v[188:191]
ds_read_b64_tr_b16 a[232:233], v13 offset:8192
v_mfma_f32_16x16x32_bf16 v[188:191], a[252:255], a[220:223], v[188:191]
ds_read_b64_tr_b16 a[234:235], v13 offset:9216
v_mfma_f32_16x16x32_bf16 v[184:187], a[248:251], a[208:211], v[184:187]
ds_read_b64_tr_b16 a[236:237], v13 offset:12288
v_mfma_f32_16x16x32_bf16 v[184:187], a[252:255], a[212:215], v[184:187]
ds_read_b64_tr_b16 a[238:239], v13 offset:13312
v_mfma_f32_16x16x32_bf16 v[180:183], a[248:251], a[200:203], v[180:183]
buffer_load_dwordx4 a[76:79], v1, s[36:39], s83 offen offset:1024 sc1
v_mfma_f32_16x16x32_bf16 v[180:183], a[252:255], a[204:207], v[180:183]
v_mfma_f32_16x16x32_bf16 v[176:179], a[248:251], a[192:195], v[176:179]
buffer_load_dwordx4 a[80:83], v1, s[36:39], s82 offen offset:2048 sc1
v_mfma_f32_16x16x32_bf16 v[176:179], a[252:255], a[196:199], v[176:179]
s_waitcnt lgkmcnt(4)
v_mfma_f32_16x16x32_bf16 v[192:195], a[224:227], a[192:195], v[192:195]
ds_read_b64_tr_b16 a[240:241], v14 offset:8192
v_mfma_f32_16x16x32_bf16 v[192:195], a[228:231], a[196:199], v[192:195]
ds_read_b64_tr_b16 a[242:243], v14 offset:9216
v_mfma_f32_16x16x32_bf16 v[196:199], a[224:227], a[200:203], v[196:199]
ds_read_b64_tr_b16 a[244:245], v14 offset:12288
v_mfma_f32_16x16x32_bf16 v[196:199], a[228:231], a[204:207], v[196:199]
ds_read_b64_tr_b16 a[246:247], v14 offset:13312
v_mfma_f32_16x16x32_bf16 v[200:203], a[224:227], a[208:211], v[200:203]
buffer_load_dwordx4 a[84:87], v1, s[36:39], s83 offen offset:2048 sc1
v_mfma_f32_16x16x32_bf16 v[200:203], a[228:231], a[212:215], v[200:203]
v_mfma_f32_16x16x32_bf16 v[204:207], a[224:227], a[216:219], v[204:207]
buffer_load_dwordx4 a[88:91], v1, s[36:39], s82 offen offset:3072 sc1
s_add_u32 s82, s82, 16384
s_mul_i32 s50, s10, 163840
s_sub_u32 s82, s82, s50
s_add_u32 s82, s82, 688128
v_mfma_f32_16x16x32_bf16 v[204:207], a[228:231], a[220:223], v[204:207]
s_waitcnt lgkmcnt(4)
v_mfma_f32_16x16x32_bf16 v[220:223], a[232:235], a[216:219], v[220:223]
ds_read_b64_tr_b16 a[248:249], v15 offset:8192
v_mfma_f32_16x16x32_bf16 v[220:223], a[236:239], a[220:223], v[220:223]
ds_read_b64_tr_b16 a[250:251], v15 offset:9216
v_mfma_f32_16x16x32_bf16 v[216:219], a[232:235], a[208:211], v[216:219]
ds_read_b64_tr_b16 a[252:253], v15 offset:12288
v_mfma_f32_16x16x32_bf16 v[216:219], a[236:239], a[212:215], v[216:219]
ds_read_b64_tr_b16 a[254:255], v15 offset:13312
v_mfma_f32_16x16x32_bf16 v[212:215], a[232:235], a[200:203], v[212:215]
buffer_load_dwordx4 a[92:95], v1, s[36:39], s83 offen offset:3072 sc1
s_add_u32 s83, s83, 16384
s_mul_i32 s50, s10, 163840
s_sub_u32 s83, s83, s50
s_add_u32 s83, s83, 688128
v_mfma_f32_16x16x32_bf16 v[212:215], a[236:239], a[204:207], v[212:215]
s_add_u32 m0, s85, 32768
v_mfma_f32_16x16x32_bf16 v[208:211], a[232:235], a[192:195], v[208:211]
buffer_load_dwordx4 v7, s[32:35], s84 offen offset:0 lds
s_add_u32 s84, s84, 15360
v_mfma_f32_16x16x32_bf16 v[208:211], a[236:239], a[196:199], v[208:211]
s_waitcnt vmcnt(42) lgkmcnt(0)
s_barrier
v_mfma_f32_16x16x32_bf16 v[224:227], a[240:243], a[192:195], v[224:227]
ds_read_b64_tr_b16 a[224:225], v12 offset:32768
v_mfma_f32_16x16x32_bf16 v[224:227], a[244:247], a[196:199], v[224:227]
ds_read_b64_tr_b16 a[226:227], v12 offset:33792
v_mfma_f32_16x16x32_bf16 v[228:231], a[240:243], a[200:203], v[228:231]
ds_read_b64_tr_b16 a[228:229], v12 offset:36864
v_mfma_f32_16x16x32_bf16 v[228:231], a[244:247], a[204:207], v[228:231]
ds_read_b64_tr_b16 a[230:231], v12 offset:37888
v_mfma_f32_16x16x32_bf16 v[232:235], a[240:243], a[208:211], v[232:235]
buffer_load_dwordx4 v7, s[32:35], s84 offen offset:1024 lds
s_add_u32 s84, s84, 15360
v_mfma_f32_16x16x32_bf16 v[232:235], a[244:247], a[212:215], v[232:235]
v_mfma_f32_16x16x32_bf16 v[236:239], a[240:243], a[216:219], v[236:239]
buffer_load_dwordx4 v7, s[32:35], s84 offen offset:2048 lds
s_add_u32 s84, s84, 15360
v_mfma_f32_16x16x32_bf16 v[236:239], a[244:247], a[220:223], v[236:239]
v_mfma_f32_16x16x32_bf16 v[252:255], a[248:251], a[216:219], v[252:255]
ds_read_b64_tr_b16 a[232:233], v13 offset:32768
v_mfma_f32_16x16x32_bf16 v[252:255], a[252:255], a[220:223], v[252:255]
ds_read_b64_tr_b16 a[234:235], v13 offset:33792
v_mfma_f32_16x16x32_bf16 v[248:251], a[248:251], a[208:211], v[248:251]
ds_read_b64_tr_b16 a[236:237], v13 offset:36864
v_mfma_f32_16x16x32_bf16 v[248:251], a[252:255], a[212:215], v[248:251]
ds_read_b64_tr_b16 a[238:239], v13 offset:37888
v_mfma_f32_16x16x32_bf16 v[244:247], a[248:251], a[200:203], v[244:247]
buffer_load_dwordx4 v7, s[32:35], s84 offen offset:3072 lds
s_add_u32 s84, s84, 19456
v_mfma_f32_16x16x32_bf16 v[244:247], a[252:255], a[204:207], v[244:247]
s_add_u32 m0, s85, 36864
v_mfma_f32_16x16x32_bf16 v[240:243], a[248:251], a[192:195], v[240:243]
buffer_load_dwordx4 v7, s[32:35], s84 offen offset:0 lds
s_add_u32 s84, s84, 15360
v_mfma_f32_16x16x32_bf16 v[240:243], a[252:255], a[196:199], v[240:243]
s_waitcnt vmcnt(38) lgkmcnt(4)
v_mfma_f32_16x16x32_bf16 v[128:131], a[224:227], a[0:3], v[128:131]
ds_read_b64_tr_b16 a[240:241], v14 offset:32768
v_mfma_f32_16x16x32_bf16 v[128:131], a[228:231], a[4:7], v[128:131]
ds_read_b64_tr_b16 a[242:243], v14 offset:33792
v_mfma_f32_16x16x32_bf16 v[132:135], a[224:227], a[8:11], v[132:135]
ds_read_b64_tr_b16 a[244:245], v14 offset:36864
v_mfma_f32_16x16x32_bf16 v[132:135], a[228:231], a[12:15], v[132:135]
ds_read_b64_tr_b16 a[246:247], v14 offset:37888
v_mfma_f32_16x16x32_bf16 v[136:139], a[224:227], a[16:19], v[136:139]
buffer_load_dwordx4 v7, s[32:35], s84 offen offset:1024 lds
s_add_u32 s84, s84, 15360
v_mfma_f32_16x16x32_bf16 v[136:139], a[228:231], a[20:23], v[136:139]
v_mfma_f32_16x16x32_bf16 v[140:143], a[224:227], a[24:27], v[140:143]
buffer_load_dwordx4 v7, s[32:35], s84 offen offset:2048 lds
s_add_u32 s84, s84, 15360
v_mfma_f32_16x16x32_bf16 v[140:143], a[228:231], a[28:31], v[140:143]
s_waitcnt lgkmcnt(4)
v_mfma_f32_16x16x32_bf16 v[156:159], a[232:235], a[24:27], v[156:159]
ds_read_b64_tr_b16 a[248:249], v15 offset:32768
v_mfma_f32_16x16x32_bf16 v[156:159], a[236:239], a[28:31], v[156:159]
ds_read_b64_tr_b16 a[250:251], v15 offset:33792
v_mfma_f32_16x16x32_bf16 v[152:155], a[232:235], a[16:19], v[152:155]
ds_read_b64_tr_b16 a[252:253], v15 offset:36864
v_mfma_f32_16x16x32_bf16 v[152:155], a[236:239], a[20:23], v[152:155]
ds_read_b64_tr_b16 a[254:255], v15 offset:37888
v_mfma_f32_16x16x32_bf16 v[148:151], a[232:235], a[8:11], v[148:151]
buffer_load_dwordx4 v7, s[32:35], s84 offen offset:3072 lds
s_add_u32 s84, s84, 19456
v_mfma_f32_16x16x32_bf16 v[148:151], a[236:239], a[12:15], v[148:151]
v_mfma_f32_16x16x32_bf16 v[144:147], a[232:235], a[0:3], v[144:147]
v_mfma_f32_16x16x32_bf16 v[144:147], a[236:239], a[4:7], v[144:147]
s_waitcnt vmcnt(22)
v_cmp_ne_u32 vcc, 1, v27
s_cbranch_vccnz L_pl4_slow
L_pl4_ok:
s_waitcnt lgkmcnt(4)
v_mfma_f32_16x16x32_bf16 v[160:163], a[240:243], a[0:3], v[160:163]
ds_read_b64_tr_b16 a[224:225], v12 offset:40960
v_mfma_f32_16x16x32_bf16 v[160:163], a[244:247], a[4:7], v[160:163]
ds_read_b64_tr_b16 a[226:227], v12 offset:41984
v_mfma_f32_16x16x32_bf16 v[164:167], a[240:243], a[8:11], v[164:167]
ds_read_b64_tr_b16 a[228:229], v12 offset:45056
v_mfma_f32_16x16x32_bf16 v[164:167], a[244:247], a[12:15], v[164:167]
ds_read_b64_tr_b16 a[230:231], v12 offset:46080
v_mfma_f32_16x16x32_bf16 v[168:171], a[240:243], a[16:19], v[168:171]
buffer_load_dwordx4 a[96:99], v1, s[36:39], s82 offen offset:0 sc1
v_mfma_f32_16x16x32_bf16 v[168:171], a[244:247], a[20:23], v[168:171]
v_mfma_f32_16x16x32_bf16 v[172:175], a[240:243], a[24:27], v[172:175]
buffer_load_dwordx4 a[100:103], v1, s[36:39], s83 offen offset:0 sc1
v_mfma_f32_16x16x32_bf16 v[172:175], a[244:247], a[28:31], v[172:175]
s_waitcnt lgkmcnt(4)
v_mfma_f32_16x16x32_bf16 v[188:191], a[248:251], a[24:27], v[188:191]
ds_read_b64_tr_b16 a[232:233], v13 offset:40960
v_mfma_f32_16x16x32_bf16 v[188:191], a[252:255], a[28:31], v[188:191]
ds_read_b64_tr_b16 a[234:235], v13 offset:41984
v_mfma_f32_16x16x32_bf16 v[184:187], a[248:251], a[16:19], v[184:187]
ds_read_b64_tr_b16 a[236:237], v13 offset:45056
v_mfma_f32_16x16x32_bf16 v[184:187], a[252:255], a[20:23], v[184:187]
ds_read_b64_tr_b16 a[238:239], v13 offset:46080
v_mfma_f32_16x16x32_bf16 v[180:183], a[248:251], a[8:11], v[180:183]
buffer_load_dwordx4 a[104:107], v1, s[36:39], s82 offen offset:1024 sc1
v_mfma_f32_16x16x32_bf16 v[180:183], a[252:255], a[12:15], v[180:183]
v_mfma_f32_16x16x32_bf16 v[176:179], a[248:251], a[0:3], v[176:179]
buffer_load_dwordx4 a[108:111], v1, s[36:39], s83 offen offset:1024 sc1
v_mfma_f32_16x16x32_bf16 v[176:179], a[252:255], a[4:7], v[176:179]
s_waitcnt lgkmcnt(4)
v_mfma_f32_16x16x32_bf16 v[192:195], a[224:227], a[0:3], v[192:195]
ds_read_b64_tr_b16 a[240:241], v14 offset:40960
v_mfma_f32_16x16x32_bf16 v[192:195], a[228:231], a[4:7], v[192:195]
ds_read_b64_tr_b16 a[242:243], v14 offset:41984
v_mfma_f32_16x16x32_bf16 v[196:199], a[224:227], a[8:11], v[196:199]
ds_read_b64_tr_b16 a[244:245], v14 offset:45056
v_mfma_f32_16x16x32_bf16 v[196:199], a[228:231], a[12:15], v[196:199]
ds_read_b64_tr_b16 a[246:247], v14 offset:46080
v_mfma_f32_16x16x32_bf16 v[200:203], a[224:227], a[16:19], v[200:203]
buffer_load_dwordx4 a[112:115], v1, s[36:39], s82 offen offset:2048 sc1
v_mfma_f32_16x16x32_bf16 v[200:203], a[228:231], a[20:23], v[200:203]
v_mfma_f32_16x16x32_bf16 v[204:207], a[224:227], a[24:27], v[204:207]
buffer_load_dwordx4 a[116:119], v1, s[36:39], s83 offen offset:2048 sc1
v_mfma_f32_16x16x32_bf16 v[204:207], a[228:231], a[28:31], v[204:207]
s_waitcnt lgkmcnt(4)
v_mfma_f32_16x16x32_bf16 v[220:223], a[232:235], a[24:27], v[220:223]
ds_read_b64_tr_b16 a[248:249], v15 offset:40960
v_mfma_f32_16x16x32_bf16 v[220:223], a[236:239], a[28:31], v[220:223]
ds_read_b64_tr_b16 a[250:251], v15 offset:41984
v_mfma_f32_16x16x32_bf16 v[216:219], a[232:235], a[16:19], v[216:219]
ds_read_b64_tr_b16 a[252:253], v15 offset:45056
v_mfma_f32_16x16x32_bf16 v[216:219], a[236:239], a[20:23], v[216:219]
ds_read_b64_tr_b16 a[254:255], v15 offset:46080
v_mfma_f32_16x16x32_bf16 v[212:215], a[232:235], a[8:11], v[212:215]
buffer_load_dwordx4 a[120:123], v1, s[36:39], s82 offen offset:3072 sc1
s_add_u32 s82, s82, 16384
v_mfma_f32_16x16x32_bf16 v[212:215], a[236:239], a[12:15], v[212:215]
v_mfma_f32_16x16x32_bf16 v[208:211], a[232:235], a[0:3], v[208:211]
buffer_load_dwordx4 a[124:127], v1, s[36:39], s83 offen offset:3072 sc1
s_add_u32 s83, s83, 16384
v_mfma_f32_16x16x32_bf16 v[208:211], a[236:239], a[4:7], v[208:211]
s_waitcnt lgkmcnt(0)
s_barrier
v_mfma_f32_16x16x32_bf16 v[224:227], a[240:243], a[0:3], v[224:227]
ds_read_b64_tr_b16 a[224:225], v16 offset:0
v_mfma_f32_16x16x32_bf16 v[224:227], a[244:247], a[4:7], v[224:227]
ds_read_b64_tr_b16 a[226:227], v16 offset:1024
v_mfma_f32_16x16x32_bf16 v[228:231], a[240:243], a[8:11], v[228:231]
ds_read_b64_tr_b16 a[228:229], v16 offset:4096
v_mfma_f32_16x16x32_bf16 v[228:231], a[244:247], a[12:15], v[228:231]
ds_read_b64_tr_b16 a[230:231], v16 offset:5120
s_add_u32 m0, s85, 65536
v_mfma_f32_16x16x32_bf16 v[232:235], a[240:243], a[16:19], v[232:235]
buffer_load_dwordx4 v7, s[32:35], s84 offen offset:0 lds
s_add_u32 s84, s84, 15360
v_mfma_f32_16x16x32_bf16 v[232:235], a[244:247], a[20:23], v[232:235]
v_mfma_f32_16x16x32_bf16 v[236:239], a[240:243], a[24:27], v[236:239]
buffer_load_dwordx4 v7, s[32:35], s84 offen offset:1024 lds
s_add_u32 s84, s84, 15360
v_mfma_f32_16x16x32_bf16 v[236:239], a[244:247], a[28:31], v[236:239]
v_mfma_f32_16x16x32_bf16 v[252:255], a[248:251], a[24:27], v[252:255]
ds_read_b64_tr_b16 a[232:233], v17 offset:0
v_mfma_f32_16x16x32_bf16 v[252:255], a[252:255], a[28:31], v[252:255]
ds_read_b64_tr_b16 a[234:235], v17 offset:1024
v_mfma_f32_16x16x32_bf16 v[248:251], a[248:251], a[16:19], v[248:251]
ds_read_b64_tr_b16 a[236:237], v17 offset:4096
v_mfma_f32_16x16x32_bf16 v[248:251], a[252:255], a[20:23], v[248:251]
ds_read_b64_tr_b16 a[238:239], v17 offset:5120
v_mfma_f32_16x16x32_bf16 v[244:247], a[248:251], a[8:11], v[244:247]
buffer_load_dwordx4 v7, s[32:35], s84 offen offset:2048 lds
s_add_u32 s84, s84, 15360
v_mfma_f32_16x16x32_bf16 v[244:247], a[252:255], a[12:15], v[244:247]
v_mfma_f32_16x16x32_bf16 v[240:243], a[248:251], a[0:3], v[240:243]
buffer_load_dwordx4 v7, s[32:35], s84 offen offset:3072 lds
s_add_u32 s84, s84, 19456
v_mfma_f32_16x16x32_bf16 v[240:243], a[252:255], a[4:7], v[240:243]
s_waitcnt lgkmcnt(4)
v_mfma_f32_16x16x32_bf16 v[128:131], a[224:227], a[32:35], v[128:131]
ds_read_b64_tr_b16 a[240:241], v18 offset:0
v_mfma_f32_16x16x32_bf16 v[128:131], a[228:231], a[36:39], v[128:131]
ds_read_b64_tr_b16 a[242:243], v18 offset:1024
v_mfma_f32_16x16x32_bf16 v[132:135], a[224:227], a[40:43], v[132:135]
ds_read_b64_tr_b16 a[244:245], v18 offset:4096
v_mfma_f32_16x16x32_bf16 v[132:135], a[228:231], a[44:47], v[132:135]
ds_read_b64_tr_b16 a[246:247], v18 offset:5120
s_add_u32 m0, s85, 69632
v_mfma_f32_16x16x32_bf16 v[136:139], a[224:227], a[48:51], v[136:139]
buffer_load_dwordx4 v7, s[32:35], s84 offen offset:0 lds
s_add_u32 s84, s84, 15360
v_mfma_f32_16x16x32_bf16 v[136:139], a[228:231], a[52:55], v[136:139]
v_mfma_f32_16x16x32_bf16 v[140:143], a[224:227], a[56:59], v[140:143]
buffer_load_dwordx4 v7, s[32:35], s84 offen offset:1024 lds
s_add_u32 s84, s84, 15360
v_mfma_f32_16x16x32_bf16 v[140:143], a[228:231], a[60:63], v[140:143]
s_waitcnt lgkmcnt(4)
v_mfma_f32_16x16x32_bf16 v[156:159], a[232:235], a[56:59], v[156:159]
ds_read_b64_tr_b16 a[248:249], v19 offset:0
v_mfma_f32_16x16x32_bf16 v[156:159], a[236:239], a[60:63], v[156:159]
ds_read_b64_tr_b16 a[250:251], v19 offset:1024
v_mfma_f32_16x16x32_bf16 v[152:155], a[232:235], a[48:51], v[152:155]
ds_read_b64_tr_b16 a[252:253], v19 offset:4096
v_mfma_f32_16x16x32_bf16 v[152:155], a[236:239], a[52:55], v[152:155]
ds_read_b64_tr_b16 a[254:255], v19 offset:5120
v_mfma_f32_16x16x32_bf16 v[148:151], a[232:235], a[40:43], v[148:151]
buffer_load_dwordx4 v7, s[32:35], s84 offen offset:2048 lds
s_add_u32 s84, s84, 15360
v_mfma_f32_16x16x32_bf16 v[148:151], a[236:239], a[44:47], v[148:151]
v_mfma_f32_16x16x32_bf16 v[144:147], a[232:235], a[32:35], v[144:147]
v_mfma_f32_16x16x32_bf16 v[144:147], a[236:239], a[36:39], v[144:147]
s_waitcnt lgkmcnt(4)
v_mfma_f32_16x16x32_bf16 v[160:163], a[240:243], a[32:35], v[160:163]
ds_read_b64_tr_b16 a[224:225], v16 offset:8192
v_mfma_f32_16x16x32_bf16 v[160:163], a[244:247], a[36:39], v[160:163]
ds_read_b64_tr_b16 a[226:227], v16 offset:9216
v_mfma_f32_16x16x32_bf16 v[164:167], a[240:243], a[40:43], v[164:167]
ds_read_b64_tr_b16 a[228:229], v16 offset:12288
v_mfma_f32_16x16x32_bf16 v[164:167], a[244:247], a[44:47], v[164:167]
ds_read_b64_tr_b16 a[230:231], v16 offset:13312
v_mfma_f32_16x16x32_bf16 v[168:171], a[240:243], a[48:51], v[168:171]
buffer_load_dwordx4 v7, s[32:35], s84 offen offset:3072 lds
s_add_u32 s84, s84, 19456
v_mfma_f32_16x16x32_bf16 v[168:171], a[244:247], a[52:55], v[168:171]
v_mfma_f32_16x16x32_bf16 v[172:175], a[240:243], a[56:59], v[172:175]
buffer_load_dwordx4 a[192:195], v1, s[36:39], s82 offen offset:0 sc1
v_mfma_f32_16x16x32_bf16 v[172:175], a[244:247], a[60:63], v[172:175]
s_waitcnt lgkmcnt(4)
v_mfma_f32_16x16x32_bf16 v[188:191], a[248:251], a[56:59], v[188:191]
ds_read_b64_tr_b16 a[232:233], v17 offset:8192
v_mfma_f32_16x16x32_bf16 v[188:191], a[252:255], a[60:63], v[188:191]
ds_read_b64_tr_b16 a[234:235], v17 offset:9216
v_mfma_f32_16x16x32_bf16 v[184:187], a[248:251], a[48:51], v[184:187]
ds_read_b64_tr_b16 a[236:237], v17 offset:12288
v_mfma_f32_16x16x32_bf16 v[184:187], a[252:255], a[52:55], v[184:187]
ds_read_b64_tr_b16 a[238:239], v17 offset:13312
v_mfma_f32_16x16x32_bf16 v[180:183], a[248:251], a[40:43], v[180:183]
buffer_load_dwordx4 a[196:199], v1, s[36:39], s83 offen offset:0 sc1
v_mfma_f32_16x16x32_bf16 v[180:183], a[252:255], a[44:47], v[180:183]
v_mfma_f32_16x16x32_bf16 v[176:179], a[248:251], a[32:35], v[176:179]
buffer_load_dwordx4 a[200:203], v1, s[36:39], s82 offen offset:1024 sc1
v_mfma_f32_16x16x32_bf16 v[176:179], a[252:255], a[36:39], v[176:179]
s_waitcnt lgkmcnt(4)
v_mfma_f32_16x16x32_bf16 v[192:195], a[224:227], a[32:35], v[192:195]
ds_read_b64_tr_b16 a[240:241], v18 offset:8192
v_mfma_f32_16x16x32_bf16 v[192:195], a[228:231], a[36:39], v[192:195]
ds_read_b64_tr_b16 a[242:243], v18 offset:9216
v_mfma_f32_16x16x32_bf16 v[196:199], a[224:227], a[40:43], v[196:199]
ds_read_b64_tr_b16 a[244:245], v18 offset:12288
v_mfma_f32_16x16x32_bf16 v[196:199], a[228:231], a[44:47], v[196:199]
ds_read_b64_tr_b16 a[246:247], v18 offset:13312
v_mfma_f32_16x16x32_bf16 v[200:203], a[224:227], a[48:51], v[200:203]
buffer_load_dwordx4 a[204:207], v1, s[36:39], s83 offen offset:1024 sc1
v_mfma_f32_16x16x32_bf16 v[200:203], a[228:231], a[52:55], v[200:203]
v_mfma_f32_16x16x32_bf16 v[204:207], a[224:227], a[56:59], v[204:207]
buffer_load_dwordx4 a[208:211], v1, s[36:39], s82 offen offset:2048 sc1
v_mfma_f32_16x16x32_bf16 v[204:207], a[228:231], a[60:63], v[204:207]
s_waitcnt lgkmcnt(4)
v_mfma_f32_16x16x32_bf16 v[220:223], a[232:235], a[56:59], v[220:223]
ds_read_b64_tr_b16 a[248:249], v19 offset:8192
v_mfma_f32_16x16x32_bf16 v[220:223], a[236:239], a[60:63], v[220:223]
ds_read_b64_tr_b16 a[250:251], v19 offset:9216
v_mfma_f32_16x16x32_bf16 v[216:219], a[232:235], a[48:51], v[216:219]
ds_read_b64_tr_b16 a[252:253], v19 offset:12288
v_mfma_f32_16x16x32_bf16 v[216:219], a[236:239], a[52:55], v[216:219]
ds_read_b64_tr_b16 a[254:255], v19 offset:13312
v_mfma_f32_16x16x32_bf16 v[212:215], a[232:235], a[40:43], v[212:215]
buffer_load_dwordx4 a[212:215], v1, s[36:39], s83 offen offset:2048 sc1
v_mfma_f32_16x16x32_bf16 v[212:215], a[236:239], a[44:47], v[212:215]
v_mfma_f32_16x16x32_bf16 v[208:211], a[232:235], a[32:35], v[208:211]
buffer_load_dwordx4 a[216:219], v1, s[36:39], s82 offen offset:3072 sc1
s_add_u32 s82, s82, 16384
v_mfma_f32_16x16x32_bf16 v[208:211], a[236:239], a[36:39], v[208:211]
s_waitcnt vmcnt(39) lgkmcnt(0)
s_barrier
v_mfma_f32_16x16x32_bf16 v[224:227], a[240:243], a[32:35], v[224:227]
ds_read_b64_tr_b16 a[224:225], v8 offset:0
v_mfma_f32_16x16x32_bf16 v[224:227], a[244:247], a[36:39], v[224:227]
ds_read_b64_tr_b16 a[226:227], v8 offset:1024
v_mfma_f32_16x16x32_bf16 v[228:231], a[240:243], a[40:43], v[228:231]
ds_read_b64_tr_b16 a[228:229], v8 offset:4096
v_mfma_f32_16x16x32_bf16 v[228:231], a[244:247], a[44:47], v[228:231]
ds_read_b64_tr_b16 a[230:231], v8 offset:5120
v_mfma_f32_16x16x32_bf16 v[232:235], a[240:243], a[48:51], v[232:235]
buffer_load_dwordx4 a[220:223], v1, s[36:39], s83 offen offset:3072 sc1
s_add_u32 s83, s83, 16384
v_mfma_f32_16x16x32_bf16 v[232:235], a[244:247], a[52:55], v[232:235]
s_add_u32 m0, s85, 98304
v_mfma_f32_16x16x32_bf16 v[236:239], a[240:243], a[56:59], v[236:239]
buffer_load_dwordx4 v7, s[32:35], s84 offen offset:0 lds
s_add_u32 s84, s84, 15360
v_mfma_f32_16x16x32_bf16 v[236:239], a[244:247], a[60:63], v[236:239]
v_mfma_f32_16x16x32_bf16 v[252:255], a[248:251], a[56:59], v[252:255]
ds_read_b64_tr_b16 a[232:233], v9 offset:0
v_mfma_f32_16x16x32_bf16 v[252:255], a[252:255], a[60:63], v[252:255]
ds_read_b64_tr_b16 a[234:235], v9 offset:1024
v_mfma_f32_16x16x32_bf16 v[248:251], a[248:251], a[48:51], v[248:251]
ds_read_b64_tr_b16 a[236:237], v9 offset:4096
v_mfma_f32_16x16x32_bf16 v[248:251], a[252:255], a[52:55], v[248:251]
ds_read_b64_tr_b16 a[238:239], v9 offset:5120
v_mfma_f32_16x16x32_bf16 v[244:247], a[248:251], a[40:43], v[244:247]
buffer_load_dwordx4 v7, s[32:35], s84 offen offset:1024 lds
s_add_u32 s84, s84, 15360
v_mfma_f32_16x16x32_bf16 v[244:247], a[252:255], a[44:47], v[244:247]
v_mfma_f32_16x16x32_bf16 v[240:243], a[248:251], a[32:35], v[240:243]
buffer_load_dwordx4 v7, s[32:35], s84 offen offset:2048 lds
s_add_u32 s84, s84, 15360
v_mfma_f32_16x16x32_bf16 v[240:243], a[252:255], a[36:39], v[240:243]
s_waitcnt vmcnt(35) lgkmcnt(4)
v_mfma_f32_16x16x32_bf16 v[128:131], a[224:227], a[64:67], v[128:131]
ds_read_b64_tr_b16 a[240:241], v10 offset:0
v_and_b32 v21, 15, v0
v_mfma_f32_16x16x32_bf16 v[128:131], a[228:231], a[68:71], v[128:131]
ds_read_b64_tr_b16 a[242:243], v10 offset:1024
v_lshrrev_b32 v22, 4, v0
v_mfma_f32_16x16x32_bf16 v[132:135], a[224:227], a[72:75], v[132:135]
ds_read_b64_tr_b16 a[244:245], v10 offset:4096
v_xor_b32 v22, v22, v21
v_mfma_f32_16x16x32_bf16 v[132:135], a[228:231], a[76:79], v[132:135]
ds_read_b64_tr_b16 a[246:247], v10 offset:5120
s_lshl_b32 s50, s40, 14
v_mfma_f32_16x16x32_bf16 v[136:139], a[224:227], a[80:83], v[136:139]
buffer_load_dwordx4 v7, s[32:35], s84 offen offset:3072 lds
s_add_u32 s84, s84, 19456
v_mfma_f32_16x16x32_bf16 v[136:139], a[228:231], a[84:87], v[136:139]
v_mfma_f32_16x16x32_bf16 v[140:143], a[224:227], a[88:91], v[140:143]
v_mfma_f32_16x16x32_bf16 v[140:143], a[228:231], a[92:95], v[140:143]
s_waitcnt lgkmcnt(4)
v_mfma_f32_16x16x32_bf16 v[156:159], a[232:235], a[88:91], v[156:159]
ds_read_b64_tr_b16 a[248:249], v11 offset:0
v_lshlrev_b32 v21, 8, v21
v_mfma_f32_16x16x32_bf16 v[156:159], a[236:239], a[92:95], v[156:159]
ds_read_b64_tr_b16 a[250:251], v11 offset:1024
v_add_u32 v21, s50, v21
v_mfma_f32_16x16x32_bf16 v[152:155], a[232:235], a[80:83], v[152:155]
ds_read_b64_tr_b16 a[252:253], v11 offset:4096
v_xor_b32 v23, 0, v22
v_mfma_f32_16x16x32_bf16 v[152:155], a[236:239], a[84:87], v[152:155]
ds_read_b64_tr_b16 a[254:255], v11 offset:5120
s_add_u32 m0, s85, 102400
v_mfma_f32_16x16x32_bf16 v[148:151], a[232:235], a[72:75], v[148:151]
buffer_load_dwordx4 v7, s[32:35], s84 offen offset:0 lds
s_add_u32 s84, s84, 15360
v_mfma_f32_16x16x32_bf16 v[148:151], a[236:239], a[76:79], v[148:151]
v_lshl_add_u32 v28, v23, 4, v21
v_mfma_f32_16x16x32_bf16 v[144:147], a[232:235], a[64:67], v[144:147]
buffer_load_dwordx4 v7, s[32:35], s84 offen offset:1024 lds
s_add_u32 s84, s84, 15360
v_mfma_f32_16x16x32_bf16 v[144:147], a[236:239], a[68:71], v[144:147]
s_waitcnt lgkmcnt(4)
v_mfma_f32_16x16x32_bf16 v[160:163], a[240:243], a[64:67], v[160:163]
ds_read_b64_tr_b16 a[224:225], v8 offset:8192
v_xor_b32 v23, 4, v22
v_mfma_f32_16x16x32_bf16 v[160:163], a[244:247], a[68:71], v[160:163]
ds_read_b64_tr_b16 a[226:227], v8 offset:9216
v_lshl_add_u32 v29, v23, 4, v21
v_mfma_f32_16x16x32_bf16 v[164:167], a[240:243], a[72:75], v[164:167]
ds_read_b64_tr_b16 a[228:229], v8 offset:12288
v_xor_b32 v23, 8, v22
v_mfma_f32_16x16x32_bf16 v[164:167], a[244:247], a[76:79], v[164:167]
ds_read_b64_tr_b16 a[230:231], v8 offset:13312
v_lshl_add_u32 v30, v23, 4, v21
v_mfma_f32_16x16x32_bf16 v[168:171], a[240:243], a[80:83], v[168:171]
buffer_load_dwordx4 v7, s[32:35], s84 offen offset:2048 lds
s_add_u32 s84, s84, 15360
v_mfma_f32_16x16x32_bf16 v[168:171], a[244:247], a[84:87], v[168:171]
v_xor_b32 v23, 12, v22
v_mfma_f32_16x16x32_bf16 v[172:175], a[240:243], a[88:91], v[172:175]
buffer_load_dwordx4 v7, s[32:35], s84 offen offset:3072 lds
s_add_u32 s84, s84, 19456
v_mfma_f32_16x16x32_bf16 v[172:175], a[244:247], a[92:95], v[172:175]
s_waitcnt lgkmcnt(4)
v_mfma_f32_16x16x32_bf16 v[188:191], a[248:251], a[88:91], v[188:191]
ds_read_b64_tr_b16 a[232:233], v9 offset:8192
v_lshl_add_u32 v31, v23, 4, v21
v_mfma_f32_16x16x32_bf16 v[188:191], a[252:255], a[92:95], v[188:191]
ds_read_b64_tr_b16 a[234:235], v9 offset:9216
v_lshrrev_b32 v21, 3, v0
v_mfma_f32_16x16x32_bf16 v[184:187], a[248:251], a[80:83], v[184:187]
ds_read_b64_tr_b16 a[236:237], v9 offset:12288
v_and_b32 v22, 7, v0
v_mfma_f32_16x16x32_bf16 v[184:187], a[252:255], a[84:87], v[184:187]
ds_read_b64_tr_b16 a[238:239], v9 offset:13312
s_add_u32 m0, s85, 131072
v_mfma_f32_16x16x32_bf16 v[180:183], a[248:251], a[72:75], v[180:183]
buffer_load_dwordx4 v7, s[32:35], s84 offen offset:0 lds
s_add_u32 s84, s84, 15360
v_mfma_f32_16x16x32_bf16 v[180:183], a[252:255], a[76:79], v[180:183]
v_lshlrev_b32 v22, 1, v22
v_mfma_f32_16x16x32_bf16 v[176:179], a[248:251], a[64:67], v[176:179]
buffer_load_dwordx4 v7, s[32:35], s84 offen offset:1024 lds
s_add_u32 s84, s84, 15360
v_mfma_f32_16x16x32_bf16 v[176:179], a[252:255], a[68:71], v[176:179]
s_waitcnt lgkmcnt(4)
v_mfma_f32_16x16x32_bf16 v[192:195], a[224:227], a[64:67], v[192:195]
ds_read_b64_tr_b16 a[240:241], v10 offset:8192
v_xor_b32 v22, v22, v21
v_mfma_f32_16x16x32_bf16 v[192:195], a[228:231], a[68:71], v[192:195]
ds_read_b64_tr_b16 a[242:243], v10 offset:9216
s_and_b32 s50, s40, 1
v_mfma_f32_16x16x32_bf16 v[196:199], a[224:227], a[72:75], v[196:199]
ds_read_b64_tr_b16 a[244:245], v10 offset:12288
s_lshl_b32 s50, s50, 14
v_mfma_f32_16x16x32_bf16 v[196:199], a[228:231], a[76:79], v[196:199]
ds_read_b64_tr_b16 a[246:247], v10 offset:13312
s_lshr_b32 s51, s40, 1
v_mfma_f32_16x16x32_bf16 v[200:203], a[224:227], a[80:83], v[200:203]
buffer_load_dwordx4 v7, s[32:35], s84 offen offset:2048 lds
s_add_u32 s84, s84, 15360
v_mfma_f32_16x16x32_bf16 v[200:203], a[228:231], a[84:87], v[200:203]
v_mfma_f32_16x16x32_bf16 v[204:207], a[224:227], a[88:91], v[204:207]
buffer_load_dwordx4 v7, s[32:35], s84 offen offset:3072 lds
s_add_u32 s84, s84, 19456
v_mfma_f32_16x16x32_bf16 v[204:207], a[228:231], a[92:95], v[204:207]
s_waitcnt lgkmcnt(4)
v_mfma_f32_16x16x32_bf16 v[220:223], a[232:235], a[88:91], v[220:223]
ds_read_b64_tr_b16 a[248:249], v11 offset:8192
s_lshl_b32 s51, s51, 13
v_mfma_f32_16x16x32_bf16 v[220:223], a[236:239], a[92:95], v[220:223]
ds_read_b64_tr_b16 a[250:251], v11 offset:9216
s_add_u32 s50, s50, s51
v_mfma_f32_16x16x32_bf16 v[216:219], a[232:235], a[80:83], v[216:219]
ds_read_b64_tr_b16 a[252:253], v11 offset:12288
v_lshlrev_b32 v21, 8, v21
v_mfma_f32_16x16x32_bf16 v[216:219], a[236:239], a[84:87], v[216:219]
ds_read_b64_tr_b16 a[254:255], v11 offset:13312
s_add_u32 m0, s85, 135168
v_mfma_f32_16x16x32_bf16 v[212:215], a[232:235], a[72:75], v[212:215]
buffer_load_dwordx4 v7, s[32:35], s84 offen offset:0 lds
s_add_u32 s84, s84, 15360
v_mfma_f32_16x16x32_bf16 v[212:215], a[236:239], a[76:79], v[212:215]
v_add_u32 v21, s50, v21
v_xor_b32 v23, 0, v22
v_mfma_f32_16x16x32_bf16 v[208:211], a[232:235], a[64:67], v[208:211]
buffer_load_dwordx4 v7, s[32:35], s84 offen offset:1024 lds
s_add_u32 s84, s84, 15360
v_mfma_f32_16x16x32_bf16 v[208:211], a[236:239], a[68:71], v[208:211]
s_waitcnt vmcnt(38) lgkmcnt(0)
s_barrier
v_mfma_f32_16x16x32_bf16 v[224:227], a[240:243], a[64:67], v[224:227]
ds_read_b64_tr_b16 a[224:225], v8 offset:32768
v_lshl_add_u32 v2, v23, 4, v21
v_mfma_f32_16x16x32_bf16 v[224:227], a[244:247], a[68:71], v[224:227]
ds_read_b64_tr_b16 a[226:227], v8 offset:33792
v_xor_b32 v23, 1, v22
v_mfma_f32_16x16x32_bf16 v[228:231], a[240:243], a[72:75], v[228:231]
ds_read_b64_tr_b16 a[228:229], v8 offset:36864
v_lshl_add_u32 v3, v23, 4, v21
v_mfma_f32_16x16x32_bf16 v[228:231], a[244:247], a[76:79], v[228:231]
ds_read_b64_tr_b16 a[230:231], v8 offset:37888
v_xor_b32 v23, 8, v22
v_mfma_f32_16x16x32_bf16 v[232:235], a[240:243], a[80:83], v[232:235]
buffer_load_dwordx4 v7, s[32:35], s84 offen offset:2048 lds
s_add_u32 s84, s84, 15360
v_mfma_f32_16x16x32_bf16 v[232:235], a[244:247], a[84:87], v[232:235]
v_mfma_f32_16x16x32_bf16 v[236:239], a[240:243], a[88:91], v[236:239]
buffer_load_dwordx4 v7, s[32:35], s84 offen offset:3072 lds
s_add_u32 s84, s84, 19456
v_mfma_f32_16x16x32_bf16 v[236:239], a[244:247], a[92:95], v[236:239]
v_mfma_f32_16x16x32_bf16 v[252:255], a[248:251], a[88:91], v[252:255]
ds_read_b64_tr_b16 a[232:233], v9 offset:32768
v_lshl_add_u32 v4, v23, 4, v21
v_mfma_f32_16x16x32_bf16 v[252:255], a[252:255], a[92:95], v[252:255]
ds_read_b64_tr_b16 a[234:235], v9 offset:33792
v_add_u32 v4, 2048, v4
v_mfma_f32_16x16x32_bf16 v[248:251], a[248:251], a[80:83], v[248:251]
ds_read_b64_tr_b16 a[236:237], v9 offset:36864
v_xor_b32 v23, 9, v22
v_mfma_f32_16x16x32_bf16 v[248:251], a[252:255], a[84:87], v[248:251]
ds_read_b64_tr_b16 a[238:239], v9 offset:37888
v_lshl_add_u32 v5, v23, 4, v21
v_mfma_f32_16x16x32_bf16 v[244:247], a[248:251], a[72:75], v[244:247]
buffer_load_dwordx4 a[0:3], v1, s[36:39], s82 offen offset:0 sc1
v_add_u32 v5, 2048, v5
v_mfma_f32_16x16x32_bf16 v[244:247], a[252:255], a[76:79], v[244:247]
v_mfma_f32_16x16x32_bf16 v[240:243], a[248:251], a[64:67], v[240:243]
buffer_load_dwordx4 a[4:7], v1, s[36:39], s83 offen offset:0 sc1
v_mfma_f32_16x16x32_bf16 v[240:243], a[252:255], a[68:71], v[240:243]
s_waitcnt vmcnt(34) lgkmcnt(4)
v_mfma_f32_16x16x32_bf16 v[128:131], a[224:227], a[96:99], v[128:131]
ds_read_b64_tr_b16 a[240:241], v10 offset:32768
v_mfma_f32_16x16x32_bf16 v[128:131], a[228:231], a[100:103], v[128:131]
ds_read_b64_tr_b16 a[242:243], v10 offset:33792
v_mfma_f32_16x16x32_bf16 v[132:135], a[224:227], a[104:107], v[132:135]
ds_read_b64_tr_b16 a[244:245], v10 offset:36864
v_mfma_f32_16x16x32_bf16 v[132:135], a[228:231], a[108:111], v[132:135]
ds_read_b64_tr_b16 a[246:247], v10 offset:37888
v_mfma_f32_16x16x32_bf16 v[136:139], a[224:227], a[112:115], v[136:139]
buffer_load_dwordx4 a[8:11], v1, s[36:39], s82 offen offset:1024 sc1
v_mfma_f32_16x16x32_bf16 v[136:139], a[228:231], a[116:119], v[136:139]
s_xor_b32 s72, s11, 16384
v_mfma_f32_16x16x32_bf16 v[140:143], a[224:227], a[120:123], v[140:143]
s_mov_b32 s73, 0x7f817f81
v_mfma_f32_16x16x32_bf16 v[140:143], a[228:231], a[124:127], v[140:143]
s_waitcnt lgkmcnt(4)
v_mfma_f32_16x16x32_bf16 v[156:159], a[232:235], a[120:123], v[156:159]
ds_read_b64_tr_b16 a[248:249], v11 offset:32768
v_mfma_f32_16x16x32_bf16 v[156:159], a[236:239], a[124:127], v[156:159]
ds_read_b64_tr_b16 a[250:251], v11 offset:33792
v_mfma_f32_16x16x32_bf16 v[152:155], a[232:235], a[112:115], v[152:155]
ds_read_b64_tr_b16 a[252:253], v11 offset:36864
v_mfma_f32_16x16x32_bf16 v[152:155], a[236:239], a[116:119], v[152:155]
ds_read_b64_tr_b16 a[254:255], v11 offset:37888
v_mfma_f32_16x16x32_bf16 v[148:151], a[232:235], a[104:107], v[148:151]
buffer_load_dwordx4 a[12:15], v1, s[36:39], s83 offen offset:1024 sc1
v_mfma_f32_16x16x32_bf16 v[148:151], a[236:239], a[108:111], v[148:151]
v_mfma_f32_16x16x32_bf16 v[144:147], a[232:235], a[96:99], v[144:147]
buffer_load_dwordx4 a[16:19], v1, s[36:39], s82 offen offset:2048 sc1
v_mfma_f32_16x16x32_bf16 v[144:147], a[236:239], a[100:103], v[144:147]
s_waitcnt lgkmcnt(4)
v_mfma_f32_16x16x32_bf16 v[160:163], a[240:243], a[96:99], v[160:163]
ds_read_b64_tr_b16 a[224:225], v8 offset:40960
v_mfma_f32_16x16x32_bf16 v[160:163], a[244:247], a[100:103], v[160:163]
ds_read_b64_tr_b16 a[226:227], v8 offset:41984
v_mfma_f32_16x16x32_bf16 v[164:167], a[240:243], a[104:107], v[164:167]
ds_read_b64_tr_b16 a[228:229], v8 offset:45056
v_mfma_f32_16x16x32_bf16 v[164:167], a[244:247], a[108:111], v[164:167]
ds_read_b64_tr_b16 a[230:231], v8 offset:46080
v_mfma_f32_16x16x32_bf16 v[168:171], a[240:243], a[112:115], v[168:171]
buffer_load_dwordx4 a[20:23], v1, s[36:39], s83 offen offset:2048 sc1
v_mfma_f32_16x16x32_bf16 v[168:171], a[244:247], a[116:119], v[168:171]
v_mfma_f32_16x16x32_bf16 v[172:175], a[240:243], a[120:123], v[172:175]
buffer_load_dwordx4 a[24:27], v1, s[36:39], s82 offen offset:3072 sc1
s_add_u32 s82, s82, 16384
v_mfma_f32_16x16x32_bf16 v[172:175], a[244:247], a[124:127], v[172:175]
s_waitcnt lgkmcnt(4)
v_mfma_f32_16x16x32_bf16 v[188:191], a[248:251], a[120:123], v[188:191]
ds_read_b64_tr_b16 a[232:233], v9 offset:40960
v_mfma_f32_16x16x32_bf16 v[188:191], a[252:255], a[124:127], v[188:191]
ds_read_b64_tr_b16 a[234:235], v9 offset:41984
v_mfma_f32_16x16x32_bf16 v[184:187], a[248:251], a[112:115], v[184:187]
ds_read_b64_tr_b16 a[236:237], v9 offset:45056
v_mfma_f32_16x16x32_bf16 v[184:187], a[252:255], a[116:119], v[184:187]
ds_read_b64_tr_b16 a[238:239], v9 offset:46080
v_mfma_f32_16x16x32_bf16 v[180:183], a[248:251], a[104:107], v[180:183]
buffer_load_dwordx4 a[28:31], v1, s[36:39], s83 offen offset:3072 sc1
s_add_u32 s83, s83, 16384
v_mfma_f32_16x16x32_bf16 v[180:183], a[252:255], a[108:111], v[180:183]
v_mfma_f32_16x16x32_bf16 v[176:179], a[248:251], a[96:99], v[176:179]
buffer_load_dwordx4 a[32:35], v1, s[36:39], s82 offen offset:0 sc1
v_mfma_f32_16x16x32_bf16 v[176:179], a[252:255], a[100:103], v[176:179]
s_waitcnt lgkmcnt(4)
v_mfma_f32_16x16x32_bf16 v[192:195], a[224:227], a[96:99], v[192:195]
ds_read_b64_tr_b16 a[240:241], v10 offset:40960
v_mfma_f32_16x16x32_bf16 v[192:195], a[228:231], a[100:103], v[192:195]
ds_read_b64_tr_b16 a[242:243], v10 offset:41984
v_mfma_f32_16x16x32_bf16 v[196:199], a[224:227], a[104:107], v[196:199]
ds_read_b64_tr_b16 a[244:245], v10 offset:45056
v_mfma_f32_16x16x32_bf16 v[196:199], a[228:231], a[108:111], v[196:199]
ds_read_b64_tr_b16 a[246:247], v10 offset:46080
v_mfma_f32_16x16x32_bf16 v[200:203], a[224:227], a[112:115], v[200:203]
buffer_load_dwordx4 a[36:39], v1, s[36:39], s83 offen offset:0 sc1
v_mfma_f32_16x16x32_bf16 v[200:203], a[228:231], a[116:119], v[200:203]
v_mfma_f32_16x16x32_bf16 v[204:207], a[224:227], a[120:123], v[204:207]
buffer_load_dwordx4 a[40:43], v1, s[36:39], s82 offen offset:1024 sc1
v_mfma_f32_16x16x32_bf16 v[204:207], a[228:231], a[124:127], v[204:207]
s_waitcnt lgkmcnt(4)
v_mfma_f32_16x16x32_bf16 v[220:223], a[232:235], a[120:123], v[220:223]
ds_read_b64_tr_b16 a[248:249], v11 offset:40960
v_mfma_f32_16x16x32_bf16 v[220:223], a[236:239], a[124:127], v[220:223]
ds_read_b64_tr_b16 a[250:251], v11 offset:41984
v_mfma_f32_16x16x32_bf16 v[216:219], a[232:235], a[112:115], v[216:219]
ds_read_b64_tr_b16 a[252:253], v11 offset:45056
v_mfma_f32_16x16x32_bf16 v[216:219], a[236:239], a[116:119], v[216:219]
ds_read_b64_tr_b16 a[254:255], v11 offset:46080
v_mfma_f32_16x16x32_bf16 v[212:215], a[232:235], a[104:107], v[212:215]
buffer_load_dwordx4 a[44:47], v1, s[36:39], s83 offen offset:1024 sc1
v_mfma_f32_16x16x32_bf16 v[212:215], a[236:239], a[108:111], v[212:215]
v_mfma_f32_16x16x32_bf16 v[208:211], a[232:235], a[96:99], v[208:211]
buffer_load_dwordx4 a[48:51], v1, s[36:39], s82 offen offset:2048 sc1
v_mfma_f32_16x16x32_bf16 v[208:211], a[236:239], a[100:103], v[208:211]
s_waitcnt vmcnt(37) lgkmcnt(0)
s_barrier
v_mfma_f32_16x16x32_bf16 v[224:227], a[240:243], a[96:99], v[224:227]
ds_read_b64_tr_b16 a[224:225], v12 offset:0
v_mfma_f32_16x16x32_bf16 v[224:227], a[244:247], a[100:103], v[224:227]
ds_read_b64_tr_b16 a[226:227], v12 offset:1024
v_mfma_f32_16x16x32_bf16 v[228:231], a[240:243], a[104:107], v[228:231]
ds_read_b64_tr_b16 a[228:229], v12 offset:4096
v_mfma_f32_16x16x32_bf16 v[228:231], a[244:247], a[108:111], v[228:231]
ds_read_b64_tr_b16 a[230:231], v12 offset:5120
v_mfma_f32_16x16x32_bf16 v[232:235], a[240:243], a[112:115], v[232:235]
buffer_load_dwordx4 a[52:55], v1, s[36:39], s83 offen offset:2048 sc1
v_mfma_f32_16x16x32_bf16 v[232:235], a[244:247], a[116:119], v[232:235]
v_mfma_f32_16x16x32_bf16 v[236:239], a[240:243], a[120:123], v[236:239]
buffer_load_dwordx4 a[56:59], v1, s[36:39], s82 offen offset:3072 sc1
s_add_u32 s82, s82, 16384
v_mfma_f32_16x16x32_bf16 v[236:239], a[244:247], a[124:127], v[236:239]
v_mfma_f32_16x16x32_bf16 v[252:255], a[248:251], a[120:123], v[252:255]
ds_read_b64_tr_b16 a[232:233], v13 offset:0
v_mfma_f32_16x16x32_bf16 v[252:255], a[252:255], a[124:127], v[252:255]
ds_read_b64_tr_b16 a[234:235], v13 offset:1024
v_mfma_f32_16x16x32_bf16 v[248:251], a[248:251], a[112:115], v[248:251]
ds_read_b64_tr_b16 a[236:237], v13 offset:4096
v_mfma_f32_16x16x32_bf16 v[248:251], a[252:255], a[116:119], v[248:251]
ds_read_b64_tr_b16 a[238:239], v13 offset:5120
v_mfma_f32_16x16x32_bf16 v[244:247], a[248:251], a[104:107], v[244:247]
buffer_load_dwordx4 a[60:63], v1, s[36:39], s83 offen offset:3072 sc1
s_add_u32 s83, s83, 16384
v_mfma_f32_16x16x32_bf16 v[244:247], a[252:255], a[108:111], v[244:247]
v_mfma_f32_16x16x32_bf16 v[240:243], a[248:251], a[96:99], v[240:243]
v_mfma_f32_16x16x32_bf16 v[240:243], a[252:255], a[100:103], v[240:243]
s_waitcnt vmcnt(32) lgkmcnt(4)
v_mfma_f32_16x16x32_bf16 v[128:131], a[224:227], a[192:195], v[128:131]
ds_read_b64_tr_b16 a[240:241], v14 offset:0
v_mfma_f32_16x16x32_bf16 v[128:131], a[228:231], a[196:199], v[128:131]
ds_read_b64_tr_b16 a[242:243], v14 offset:1024
v_mfma_f32_16x16x32_bf16 v[132:135], a[224:227], a[200:203], v[132:135]
ds_read_b64_tr_b16 a[244:245], v14 offset:4096
v_mfma_f32_16x16x32_bf16 v[132:135], a[228:231], a[204:207], v[132:135]
ds_read_b64_tr_b16 a[246:247], v14 offset:5120
v_mfma_f32_16x16x32_bf16 v[136:139], a[224:227], a[208:211], v[136:139]
v_mfma_f32_16x16x32_bf16 v[136:139], a[228:231], a[212:215], v[136:139]
v_mfma_f32_16x16x32_bf16 v[140:143], a[224:227], a[216:219], v[140:143]
v_mfma_f32_16x16x32_bf16 v[140:143], a[228:231], a[220:223], v[140:143]
s_waitcnt lgkmcnt(4)
v_mfma_f32_16x16x32_bf16 v[156:159], a[232:235], a[216:219], v[156:159]
ds_read_b64_tr_b16 a[248:249], v15 offset:0
v_mfma_f32_16x16x32_bf16 v[156:159], a[236:239], a[220:223], v[156:159]
ds_read_b64_tr_b16 a[250:251], v15 offset:1024
v_mfma_f32_16x16x32_bf16 v[152:155], a[232:235], a[208:211], v[152:155]
ds_read_b64_tr_b16 a[252:253], v15 offset:4096
v_mfma_f32_16x16x32_bf16 v[152:155], a[236:239], a[212:215], v[152:155]
ds_read_b64_tr_b16 a[254:255], v15 offset:5120
v_mfma_f32_16x16x32_bf16 v[148:151], a[232:235], a[200:203], v[148:151]
v_mfma_f32_16x16x32_bf16 v[148:151], a[236:239], a[204:207], v[148:151]
v_mfma_f32_16x16x32_bf16 v[144:147], a[232:235], a[192:195], v[144:147]
v_mfma_f32_16x16x32_bf16 v[144:147], a[236:239], a[196:199], v[144:147]
s_waitcnt vmcnt(16) lgkmcnt(0)
s_barrier
v_mfma_f32_16x16x32_bf16 v[160:163], a[240:243], a[192:195], v[160:163]
ds_read_b64_tr_b16 a[224:225], v12 offset:32768
v_mfma_f32_16x16x32_bf16 v[160:163], a[244:247], a[196:199], v[160:163]
ds_read_b64_tr_b16 a[226:227], v12 offset:33792
v_mfma_f32_16x16x32_bf16 v[164:167], a[240:243], a[200:203], v[164:167]
ds_read_b64_tr_b16 a[228:229], v12 offset:36864
v_mfma_f32_16x16x32_bf16 v[164:167], a[244:247], a[204:207], v[164:167]
ds_read_b64_tr_b16 a[230:231], v12 offset:37888
v_mfma_f32_16x16x32_bf16 v[168:171], a[240:243], a[208:211], v[168:171]
v_mfma_f32_16x16x32_bf16 v[168:171], a[244:247], a[212:215], v[168:171]
v_mfma_f32_16x16x32_bf16 v[172:175], a[240:243], a[216:219], v[172:175]
v_mfma_f32_16x16x32_bf16 v[172:175], a[244:247], a[220:223], v[172:175]
v_mfma_f32_16x16x32_bf16 v[188:191], a[248:251], a[216:219], v[188:191]
ds_read_b64_tr_b16 a[232:233], v16 offset:0
v_mfma_f32_16x16x32_bf16 v[188:191], a[252:255], a[220:223], v[188:191]
ds_read_b64_tr_b16 a[234:235], v16 offset:1024
v_mfma_f32_16x16x32_bf16 v[184:187], a[248:251], a[208:211], v[184:187]
ds_read_b64_tr_b16 a[236:237], v16 offset:4096
v_mfma_f32_16x16x32_bf16 v[184:187], a[252:255], a[212:215], v[184:187]
ds_read_b64_tr_b16 a[238:239], v16 offset:5120
v_mfma_f32_16x16x32_bf16 v[180:183], a[248:251], a[200:203], v[180:183]
v_mfma_f32_16x16x32_bf16 v[180:183], a[252:255], a[204:207], v[180:183]
v_mfma_f32_16x16x32_bf16 v[176:179], a[248:251], a[192:195], v[176:179]
v_mfma_f32_16x16x32_bf16 v[176:179], a[252:255], a[196:199], v[176:179]
s_waitcnt vmcnt(8) lgkmcnt(4)
v_mfma_f32_16x16x32_bf16 v[128:131], a[224:227], a[0:3], v[128:131]
ds_read_b64_tr_b16 a[240:241], v13 offset:32768
s_add_u32 s52, s68, 0
v_mfma_f32_16x16x32_bf16 v[128:131], a[228:231], a[4:7], v[128:131]
ds_read_b64_tr_b16 a[242:243], v13 offset:33792
buffer_load_dwordx4 v[32:35], v20, s[24:27], s52 offen
v_mfma_f32_16x16x32_bf16 v[132:135], a[224:227], a[8:11], v[132:135]
ds_read_b64_tr_b16 a[244:245], v13 offset:36864
s_add_u32 s52, s68, 16384
v_mfma_f32_16x16x32_bf16 v[132:135], a[228:231], a[12:15], v[132:135]
ds_read_b64_tr_b16 a[246:247], v13 offset:37888
buffer_load_dwordx4 v[36:39], v20, s[24:27], s52 offen
v_mfma_f32_16x16x32_bf16 v[136:139], a[224:227], a[16:19], v[136:139]
s_add_u32 s52, s68, 32768
buffer_load_dwordx4 v[40:43], v20, s[24:27], s52 offen
v_mfma_f32_16x16x32_bf16 v[136:139], a[228:231], a[20:23], v[136:139]
s_add_u32 s52, s68, 49152
buffer_load_dwordx4 v[44:47], v20, s[24:27], s52 offen
v_mfma_f32_16x16x32_bf16 v[140:143], a[224:227], a[24:27], v[140:143]
v_mfma_f32_16x16x32_bf16 v[140:143], a[228:231], a[28:31], v[140:143]
s_waitcnt vmcnt(4) lgkmcnt(4)
v_mfma_f32_16x16x32_bf16 v[140:143], a[232:235], a[56:59], v[140:143]
ds_read_b64_tr_b16 a[248:249], v17 offset:0
v_mfma_f32_16x16x32_bf16 v[140:143], a[236:239], a[60:63], v[140:143]
ds_read_b64_tr_b16 a[250:251], v17 offset:1024
v_mfma_f32_16x16x32_bf16 v[136:139], a[232:235], a[48:51], v[136:139]
ds_read_b64_tr_b16 a[252:253], v17 offset:4096
v_mfma_f32_16x16x32_bf16 v[136:139], a[236:239], a[52:55], v[136:139]
ds_read_b64_tr_b16 a[254:255], v17 offset:5120
v_mfma_f32_16x16x32_bf16 v[132:135], a[232:235], a[40:43], v[132:135]
v_mfma_f32_16x16x32_bf16 v[132:135], a[236:239], a[44:47], v[132:135]
v_mfma_f32_16x16x32_bf16 v[128:131], a[232:235], a[32:35], v[128:131]
v_mfma_f32_16x16x32_bf16 v[128:131], a[236:239], a[36:39], v[128:131]
s_waitcnt lgkmcnt(4)
v_mfma_f32_16x16x32_bf16 v[144:147], a[240:243], a[0:3], v[144:147]
ds_read_b64_tr_b16 a[224:225], v14 offset:32768
v_mfma_f32_16x16x32_bf16 v[144:147], a[244:247], a[4:7], v[144:147]
ds_read_b64_tr_b16 a[226:227], v14 offset:33792
v_mfma_f32_16x16x32_bf16 v[148:151], a[240:243], a[8:11], v[148:151]
ds_read_b64_tr_b16 a[228:229], v14 offset:36864
v_mfma_f32_16x16x32_bf16 v[148:151], a[244:247], a[12:15], v[148:151]
ds_read_b64_tr_b16 a[230:231], v14 offset:37888
v_mfma_f32_16x16x32_bf16 v[152:155], a[240:243], a[16:19], v[152:155]
ds_write_b128 v28, v[140:143] offset:12288
v_mfma_f32_16x16x32_bf16 v[152:155], a[244:247], a[20:23], v[152:155]
ds_write_b128 v28, v[136:139] offset:8192
v_mfma_f32_16x16x32_bf16 v[156:159], a[240:243], a[24:27], v[156:159]
v_mfma_f32_16x16x32_bf16 v[156:159], a[244:247], a[28:31], v[156:159]
s_waitcnt lgkmcnt(6)
v_mfma_f32_16x16x32_bf16 v[156:159], a[248:251], a[56:59], v[156:159]
ds_read_b64_tr_b16 a[232:233], v18 offset:0
v_mfma_f32_16x16x32_bf16 v[156:159], a[252:255], a[60:63], v[156:159]
ds_read_b64_tr_b16 a[234:235], v18 offset:1024
v_mfma_f32_16x16x32_bf16 v[152:155], a[248:251], a[48:51], v[152:155]
ds_read_b64_tr_b16 a[236:237], v18 offset:4096
v_mfma_f32_16x16x32_bf16 v[152:155], a[252:255], a[52:55], v[152:155]
ds_read_b64_tr_b16 a[238:239], v18 offset:5120
v_mfma_f32_16x16x32_bf16 v[148:151], a[248:251], a[40:43], v[148:151]
ds_write_b128 v28, v[132:135] offset:4096
v_mfma_f32_16x16x32_bf16 v[148:151], a[252:255], a[44:47], v[148:151]
ds_write_b128 v28, v[128:131] offset:0
v_mfma_f32_16x16x32_bf16 v[144:147], a[248:251], a[32:35], v[144:147]
v_mfma_f32_16x16x32_bf16 v[144:147], a[252:255], a[36:39], v[144:147]
s_waitcnt lgkmcnt(8)
v_mfma_f32_16x16x32_bf16 v[160:163], a[224:227], a[0:3], v[160:163]
ds_read_b64_tr_b16 a[240:241], v15 offset:32768
v_mfma_f32_16x16x32_bf16 v[160:163], a[228:231], a[4:7], v[160:163]
ds_read_b64_tr_b16 a[242:243], v15 offset:33792
v_mfma_f32_16x16x32_bf16 v[164:167], a[224:227], a[8:11], v[164:167]
ds_read_b64_tr_b16 a[244:245], v15 offset:36864
v_mfma_f32_16x16x32_bf16 v[164:167], a[228:231], a[12:15], v[164:167]
ds_read_b64_tr_b16 a[246:247], v15 offset:37888
v_mfma_f32_16x16x32_bf16 v[168:171], a[224:227], a[16:19], v[168:171]
ds_write_b128 v29, v[156:159] offset:12288
v_mfma_f32_16x16x32_bf16 v[168:171], a[228:231], a[20:23], v[168:171]
ds_write_b128 v29, v[152:155] offset:8192
v_mfma_f32_16x16x32_bf16 v[172:175], a[224:227], a[24:27], v[172:175]
v_mfma_f32_16x16x32_bf16 v[172:175], a[228:231], a[28:31], v[172:175]
s_waitcnt lgkmcnt(8)
v_mfma_f32_16x16x32_bf16 v[172:175], a[232:235], a[56:59], v[172:175]
ds_read_b64_tr_b16 a[248:249], v19 offset:0
v_mfma_f32_16x16x32_bf16 v[172:175], a[236:239], a[60:63], v[172:175]
ds_read_b64_tr_b16 a[250:251], v19 offset:1024
v_mfma_f32_16x16x32_bf16 v[168:171], a[232:235], a[48:51], v[168:171]
ds_read_b64_tr_b16 a[252:253], v19 offset:4096
v_mfma_f32_16x16x32_bf16 v[168:171], a[236:239], a[52:55], v[168:171]
ds_read_b64_tr_b16 a[254:255], v19 offset:5120
v_mfma_f32_16x16x32_bf16 v[164:167], a[232:235], a[40:43], v[164:167]
ds_write_b128 v29, v[148:151] offset:4096
v_mfma_f32_16x16x32_bf16 v[164:167], a[236:239], a[44:47], v[164:167]
ds_write_b128 v29, v[144:147] offset:0
v_mfma_f32_16x16x32_bf16 v[160:163], a[232:235], a[32:35], v[160:163]
v_mfma_f32_16x16x32_bf16 v[160:163], a[236:239], a[36:39], v[160:163]
s_waitcnt lgkmcnt(8)
v_mfma_f32_16x16x32_bf16 v[176:179], a[240:243], a[0:3], v[176:179]
ds_read_b64_tr_b16 a[224:225], v12 offset:8192
v_mfma_f32_16x16x32_bf16 v[176:179], a[244:247], a[4:7], v[176:179]
ds_read_b64_tr_b16 a[226:227], v12 offset:9216
v_mfma_f32_16x16x32_bf16 v[180:183], a[240:243], a[8:11], v[180:183]
ds_read_b64_tr_b16 a[228:229], v12 offset:12288
v_mfma_f32_16x16x32_bf16 v[180:183], a[244:247], a[12:15], v[180:183]
ds_read_b64_tr_b16 a[230:231], v12 offset:13312
v_mfma_f32_16x16x32_bf16 v[184:187], a[240:243], a[16:19], v[184:187]
ds_write_b128 v30, v[172:175] offset:12288
v_mfma_f32_16x16x32_bf16 v[184:187], a[244:247], a[20:23], v[184:187]
ds_write_b128 v30, v[168:171] offset:8192
v_mfma_f32_16x16x32_bf16 v[188:191], a[240:243], a[24:27], v[188:191]
v_mfma_f32_16x16x32_bf16 v[188:191], a[244:247], a[28:31], v[188:191]
s_waitcnt lgkmcnt(8)
v_mfma_f32_16x16x32_bf16 v[188:191], a[248:251], a[56:59], v[188:191]
ds_read_b64_tr_b16 a[232:233], v12 offset:40960
v_mfma_f32_16x16x32_bf16 v[188:191], a[252:255], a[60:63], v[188:191]
ds_read_b64_tr_b16 a[234:235], v12 offset:41984
v_mfma_f32_16x16x32_bf16 v[184:187], a[248:251], a[48:51], v[184:187]
ds_read_b64_tr_b16 a[236:237], v12 offset:45056
v_mfma_f32_16x16x32_bf16 v[184:187], a[252:255], a[52:55], v[184:187]
ds_read_b64_tr_b16 a[238:239], v12 offset:46080
v_mfma_f32_16x16x32_bf16 v[180:183], a[248:251], a[40:43], v[180:183]
ds_write_b128 v30, v[164:167] offset:4096
v_mfma_f32_16x16x32_bf16 v[180:183], a[252:255], a[44:47], v[180:183]
ds_write_b128 v30, v[160:163] offset:0
v_mfma_f32_16x16x32_bf16 v[176:179], a[248:251], a[32:35], v[176:179]
v_mfma_f32_16x16x32_bf16 v[176:179], a[252:255], a[36:39], v[176:179]
s_waitcnt lgkmcnt(8)
v_mfma_f32_16x16x32_bf16 v[192:195], a[224:227], a[192:195], v[192:195]
ds_read_b64_tr_b16 a[240:241], v16 offset:8192
v_mfma_f32_16x16x32_bf16 v[192:195], a[228:231], a[196:199], v[192:195]
ds_read_b64_tr_b16 a[242:243], v16 offset:9216
v_mfma_f32_16x16x32_bf16 v[196:199], a[224:227], a[200:203], v[196:199]
ds_read_b64_tr_b16 a[244:245], v16 offset:12288
v_mfma_f32_16x16x32_bf16 v[196:199], a[228:231], a[204:207], v[196:199]
ds_read_b64_tr_b16 a[246:247], v16 offset:13312
v_mfma_f32_16x16x32_bf16 v[200:203], a[224:227], a[208:211], v[200:203]
ds_write_b128 v31, v[188:191] offset:12288
v_mfma_f32_16x16x32_bf16 v[200:203], a[228:231], a[212:215], v[200:203]
ds_write_b128 v31, v[184:187] offset:8192
v_mfma_f32_16x16x32_bf16 v[204:207], a[224:227], a[216:219], v[204:207]
ds_write_b128 v31, v[180:183] offset:4096
v_mfma_f32_16x16x32_bf16 v[204:207], a[228:231], a[220:223], v[204:207]
ds_write_b128 v31, v[176:179] offset:0
s_waitcnt lgkmcnt(0)
s_barrier
v_mfma_f32_16x16x32_bf16 v[204:207], a[232:235], a[24:27], v[204:207]
ds_read_b64_tr_b16 a[248:249], v13 offset:8192
ds_read_b128 v[64:67], v2 offset:0
v_mfma_f32_16x16x32_bf16 v[204:207], a[236:239], a[28:31], v[204:207]
ds_read_b64_tr_b16 a[250:251], v13 offset:9216
ds_read_b128 v[68:71], v3 offset:0
v_mfma_f32_16x16x32_bf16 v[200:203], a[232:235], a[16:19], v[200:203]
ds_read_b64_tr_b16 a[252:253], v13 offset:12288
ds_read_b128 v[72:75], v2 offset:32768
v_mfma_f32_16x16x32_bf16 v[200:203], a[236:239], a[20:23], v[200:203]
ds_read_b64_tr_b16 a[254:255], v13 offset:13312
ds_read_b128 v[76:79], v3 offset:32768
v_mfma_f32_16x16x32_bf16 v[196:199], a[232:235], a[8:11], v[196:199]
ds_read_b128 v[80:83], v4 offset:0
ds_read_b128 v[84:87], v5 offset:0
v_mfma_f32_16x16x32_bf16 v[196:199], a[236:239], a[12:15], v[196:199]
ds_read_b128 v[88:91], v4 offset:32768
ds_read_b128 v[92:95], v5 offset:32768
v_mfma_f32_16x16x32_bf16 v[192:195], a[232:235], a[0:3], v[192:195]
v_mfma_f32_16x16x32_bf16 v[192:195], a[236:239], a[4:7], v[192:195]
v_mfma_f32_16x16x32_bf16 v[192:195], a[240:243], a[32:35], v[192:195]
ds_read_b64_tr_b16 a[224:225], v13 offset:40960
ds_read_b128 v[96:99], v2 offset:4096
ds_read_b128 v[100:103], v3 offset:4096
ds_read_b128 v[104:107], v2 offset:36864
ds_read_b128 v[108:111], v3 offset:36864
ds_read_b128 v[112:115], v4 offset:4096
ds_read_b128 v[116:119], v5 offset:4096
ds_read_b128 v[120:123], v4 offset:36864
v_mfma_f32_16x16x32_bf16 v[192:195], a[244:247], a[36:39], v[192:195]
ds_read_b64_tr_b16 a[226:227], v13 offset:41984
ds_read_b128 v[124:127], v5 offset:36864
s_waitcnt lgkmcnt(14)
v_add_f32 v64, v64, v72
v_add_f32 v65, v65, v73
v_add_f32 v66, v66, v74
v_add_f32 v67, v67, v75
v_add_f32 v68, v68, v76
v_add_f32 v69, v69, v77
v_mfma_f32_16x16x32_bf16 v[196:199], a[240:243], a[40:43], v[196:199]
ds_read_b64_tr_b16 a[228:229], v13 offset:45056
v_add_f32 v70, v70, v78
v_add_f32 v71, v71, v79
v_cvt_pk_bf16_f32 v72, v64, v65
v_cvt_pk_bf16_f32 v73, v66, v67
v_cvt_pk_bf16_f32 v74, v68, v69
v_cvt_pk_bf16_f32 v75, v70, v71
buffer_store_dwordx4 v[72:75], v1, s[36:39], s11 offen offset:0 sc1
v_mfma_f32_16x16x32_bf16 v[196:199], a[244:247], a[44:47], v[196:199]
ds_read_b64_tr_b16 a[230:231], v13 offset:46080
s_waitcnt lgkmcnt(12)
v_add_f32 v80, v80, v88
v_add_f32 v81, v81, v89
v_add_f32 v82, v82, v90
v_add_f32 v83, v83, v91
v_add_f32 v84, v84, v92
v_add_f32 v85, v85, v93
v_add_f32 v86, v86, v94
v_mfma_f32_16x16x32_bf16 v[200:203], a[240:243], a[48:51], v[200:203]
v_add_f32 v87, v87, v95
v_cvt_pk_bf16_f32 v88, v80, v81
v_cvt_pk_bf16_f32 v89, v82, v83
v_cvt_pk_bf16_f32 v90, v84, v85
v_cvt_pk_bf16_f32 v91, v86, v87
buffer_store_dwordx4 v[88:91], v1, s[36:39], s11 offen offset:1024 sc1
s_waitcnt lgkmcnt(7)
v_add_f32 v96, v96, v104
v_add_f32 v97, v97, v105
v_mfma_f32_16x16x32_bf16 v[200:203], a[244:247], a[52:55], v[200:203]
v_add_f32 v98, v98, v106
v_add_f32 v99, v99, v107
v_add_f32 v100, v100, v108
v_add_f32 v101, v101, v109
v_add_f32 v102, v102, v110
v_add_f32 v103, v103, v111
v_cvt_pk_bf16_f32 v104, v96, v97
v_cvt_pk_bf16_f32 v105, v98, v99
v_mfma_f32_16x16x32_bf16 v[204:207], a[240:243], a[56:59], v[204:207]
v_cvt_pk_bf16_f32 v106, v100, v101
v_cvt_pk_bf16_f32 v107, v102, v103
buffer_store_dwordx4 v[104:107], v1, s[36:39], s11 offen offset:2048 sc1
s_waitcnt lgkmcnt(2)
v_add_f32 v112, v112, v120
v_add_f32 v113, v113, v121
v_add_f32 v114, v114, v122
v_add_f32 v115, v115, v123
v_add_f32 v116, v116, v124
v_mfma_f32_16x16x32_bf16 v[204:207], a[244:247], a[60:63], v[204:207]
v_add_f32 v117, v117, v125
v_add_f32 v118, v118, v126
v_add_f32 v119, v119, v127
v_cvt_pk_bf16_f32 v120, v112, v113
v_cvt_pk_bf16_f32 v121, v114, v115
v_cvt_pk_bf16_f32 v122, v116, v117
v_cvt_pk_bf16_f32 v123, v118, v119
buffer_store_dwordx4 v[120:123], v1, s[36:39], s11 offen offset:3072 sc1
s_barrier
v_mfma_f32_16x16x32_bf16 v[220:223], a[248:251], a[216:219], v[220:223]
ds_read_b64_tr_b16 a[232:233], v17 offset:8192
v_mfma_f32_16x16x32_bf16 v[220:223], a[252:255], a[220:223], v[220:223]
ds_read_b64_tr_b16 a[234:235], v17 offset:9216
v_mfma_f32_16x16x32_bf16 v[216:219], a[248:251], a[208:211], v[216:219]
ds_read_b64_tr_b16 a[236:237], v17 offset:12288
v_mfma_f32_16x16x32_bf16 v[216:219], a[252:255], a[212:215], v[216:219]
ds_read_b64_tr_b16 a[238:239], v17 offset:13312
v_mfma_f32_16x16x32_bf16 v[212:215], a[248:251], a[200:203], v[212:215]
ds_write_b128 v28, v[192:195] offset:0
v_mfma_f32_16x16x32_bf16 v[212:215], a[252:255], a[204:207], v[212:215]
ds_write_b128 v28, v[196:199] offset:4096
v_mfma_f32_16x16x32_bf16 v[208:211], a[248:251], a[192:195], v[208:211]
ds_write_b128 v28, v[200:203] offset:8192
v_mfma_f32_16x16x32_bf16 v[208:211], a[252:255], a[196:199], v[208:211]
ds_write_b128 v28, v[204:207] offset:12288
s_waitcnt lgkmcnt(8)
v_mfma_f32_16x16x32_bf16 v[208:211], a[224:227], a[0:3], v[208:211]
ds_read_b64_tr_b16 a[240:241], v14 offset:8192
v_mfma_f32_16x16x32_bf16 v[208:211], a[228:231], a[4:7], v[208:211]
ds_read_b64_tr_b16 a[242:243], v14 offset:9216
v_mfma_f32_16x16x32_bf16 v[212:215], a[224:227], a[8:11], v[212:215]
ds_read_b64_tr_b16 a[244:245], v14 offset:12288
v_mfma_f32_16x16x32_bf16 v[212:215], a[228:231], a[12:15], v[212:215]
ds_read_b64_tr_b16 a[246:247], v14 offset:13312
v_mfma_f32_16x16x32_bf16 v[216:219], a[224:227], a[16:19], v[216:219]
v_mfma_f32_16x16x32_bf16 v[216:219], a[228:231], a[20:23], v[216:219]
v_mfma_f32_16x16x32_bf16 v[220:223], a[224:227], a[24:27], v[220:223]
v_mfma_f32_16x16x32_bf16 v[220:223], a[228:231], a[28:31], v[220:223]
s_waitcnt lgkmcnt(8)
v_mfma_f32_16x16x32_bf16 v[220:223], a[232:235], a[56:59], v[220:223]
ds_read_b64_tr_b16 a[248:249], v14 offset:40960
s_waitcnt vmcnt(4)
v_lshlrev_b32 v128, 16, v32
v_mfma_f32_16x16x32_bf16 v[220:223], a[236:239], a[60:63], v[220:223]
ds_read_b64_tr_b16 a[250:251], v14 offset:41984
v_and_b32 v129, 0xffff0000, v32
v_mfma_f32_16x16x32_bf16 v[216:219], a[232:235], a[48:51], v[216:219]
ds_read_b64_tr_b16 a[252:253], v14 offset:45056
v_lshlrev_b32 v130, 16, v33
v_mfma_f32_16x16x32_bf16 v[216:219], a[236:239], a[52:55], v[216:219]
ds_read_b64_tr_b16 a[254:255], v14 offset:46080
v_and_b32 v131, 0xffff0000, v33
v_mfma_f32_16x16x32_bf16 v[212:215], a[232:235], a[40:43], v[212:215]
v_lshlrev_b32 v132, 16, v34
v_and_b32 v133, 0xffff0000, v34
v_mfma_f32_16x16x32_bf16 v[212:215], a[236:239], a[44:47], v[212:215]
v_lshlrev_b32 v134, 16, v35
v_mfma_f32_16x16x32_bf16 v[208:211], a[232:235], a[32:35], v[208:211]
v_mfma_f32_16x16x32_bf16 v[208:211], a[236:239], a[36:39], v[208:211]
s_waitcnt lgkmcnt(4)
v_mfma_f32_16x16x32_bf16 v[224:227], a[240:243], a[192:195], v[224:227]
ds_read_b64_tr_b16 a[224:225], v18 offset:8192
ds_write_b128 v29, v[220:223] offset:12288
v_mfma_f32_16x16x32_bf16 v[224:227], a[244:247], a[196:199], v[224:227]
ds_read_b64_tr_b16 a[226:227], v18 offset:9216
ds_write_b128 v29, v[216:219] offset:8192
v_mfma_f32_16x16x32_bf16 v[228:231], a[240:243], a[200:203], v[228:231]
ds_read_b64_tr_b16 a[228:229], v18 offset:12288
ds_write_b128 v29, v[212:215] offset:4096
v_mfma_f32_16x16x32_bf16 v[228:231], a[244:247], a[204:207], v[228:231]
ds_read_b64_tr_b16 a[230:231], v18 offset:13312
ds_write_b128 v29, v[208:211] offset:0
v_mfma_f32_16x16x32_bf16 v[232:235], a[240:243], a[208:211], v[232:235]
v_and_b32 v135, 0xffff0000, v35
v_lshlrev_b32 v136, 16, v36
v_mfma_f32_16x16x32_bf16 v[232:235], a[244:247], a[212:215], v[232:235]
v_and_b32 v137, 0xffff0000, v36
v_lshlrev_b32 v138, 16, v37
v_mfma_f32_16x16x32_bf16 v[236:239], a[240:243], a[216:219], v[236:239]
v_and_b32 v139, 0xffff0000, v37
v_lshlrev_b32 v140, 16, v38
v_mfma_f32_16x16x32_bf16 v[236:239], a[244:247], a[220:223], v[236:239]
v_and_b32 v141, 0xffff0000, v38
v_lshlrev_b32 v142, 16, v39
s_waitcnt lgkmcnt(8)
v_mfma_f32_16x16x32_bf16 v[236:239], a[248:251], a[24:27], v[236:239]
ds_read_b64_tr_b16 a[232:233], v15 offset:8192
v_and_b32 v143, 0xffff0000, v39
v_mfma_f32_16x16x32_bf16 v[236:239], a[252:255], a[28:31], v[236:239]
ds_read_b64_tr_b16 a[234:235], v15 offset:9216
v_lshlrev_b32 v144, 16, v40
v_mfma_f32_16x16x32_bf16 v[232:235], a[248:251], a[16:19], v[232:235]
ds_read_b64_tr_b16 a[236:237], v15 offset:12288
v_and_b32 v145, 0xffff0000, v40
v_mfma_f32_16x16x32_bf16 v[232:235], a[252:255], a[20:23], v[232:235]
ds_read_b64_tr_b16 a[238:239], v15 offset:13312
v_lshlrev_b32 v146, 16, v41
v_mfma_f32_16x16x32_bf16 v[228:231], a[248:251], a[8:11], v[228:231]
v_and_b32 v147, 0xffff0000, v41
v_lshlrev_b32 v148, 16, v42
v_mfma_f32_16x16x32_bf16 v[228:231], a[252:255], a[12:15], v[228:231]
v_and_b32 v149, 0xffff0000, v42
v_lshlrev_b32 v150, 16, v43
v_mfma_f32_16x16x32_bf16 v[224:227], a[248:251], a[0:3], v[224:227]
v_mfma_f32_16x16x32_bf16 v[224:227], a[252:255], a[4:7], v[224:227]
s_waitcnt lgkmcnt(5)
v_mfma_f32_16x16x32_bf16 v[224:227], a[224:227], a[32:35], v[224:227]
ds_read_b64_tr_b16 a[240:241], v15 offset:40960
v_and_b32 v151, 0xffff0000, v43
v_mfma_f32_16x16x32_bf16 v[224:227], a[228:231], a[36:39], v[224:227]
ds_read_b64_tr_b16 a[242:243], v15 offset:41984
v_lshlrev_b32 v152, 16, v44
v_mfma_f32_16x16x32_bf16 v[228:231], a[224:227], a[40:43], v[228:231]
ds_read_b64_tr_b16 a[244:245], v15 offset:45056
v_and_b32 v153, 0xffff0000, v44
v_mfma_f32_16x16x32_bf16 v[228:231], a[228:231], a[44:47], v[228:231]
ds_read_b64_tr_b16 a[246:247], v15 offset:46080
v_lshlrev_b32 v154, 16, v45
v_mfma_f32_16x16x32_bf16 v[232:235], a[224:227], a[48:51], v[232:235]
v_and_b32 v155, 0xffff0000, v45
v_lshlrev_b32 v156, 16, v46
v_mfma_f32_16x16x32_bf16 v[232:235], a[228:231], a[52:55], v[232:235]
v_and_b32 v157, 0xffff0000, v46
v_lshlrev_b32 v158, 16, v47
v_mfma_f32_16x16x32_bf16 v[236:239], a[224:227], a[56:59], v[236:239]
v_and_b32 v159, 0xffff0000, v47
v_mfma_f32_16x16x32_bf16 v[236:239], a[228:231], a[60:63], v[236:239]
s_waitcnt lgkmcnt(4)
v_mfma_f32_16x16x32_bf16 v[252:255], a[232:235], a[216:219], v[252:255]
ds_read_b64_tr_b16 a[248:249], v19 offset:8192
v_mfma_f32_16x16x32_bf16 v[252:255], a[236:239], a[220:223], v[252:255]
ds_read_b64_tr_b16 a[250:251], v19 offset:9216
v_mfma_f32_16x16x32_bf16 v[248:251], a[232:235], a[208:211], v[248:251]
ds_read_b64_tr_b16 a[252:253], v19 offset:12288
v_mfma_f32_16x16x32_bf16 v[248:251], a[236:239], a[212:215], v[248:251]
ds_read_b64_tr_b16 a[254:255], v19 offset:13312
v_mfma_f32_16x16x32_bf16 v[244:247], a[232:235], a[200:203], v[244:247]
ds_write_b128 v30, v[224:227] offset:0
v_mfma_f32_16x16x32_bf16 v[244:247], a[236:239], a[204:207], v[244:247]
ds_write_b128 v30, v[228:231] offset:4096
v_mfma_f32_16x16x32_bf16 v[240:243], a[232:235], a[192:195], v[240:243]
ds_write_b128 v30, v[232:235] offset:8192
v_mfma_f32_16x16x32_bf16 v[240:243], a[236:239], a[196:199], v[240:243]
ds_write_b128 v30, v[236:239] offset:12288
buffer_load_dwordx4 v[48:51], v1, s[36:39], s72 offen offset:0 sc1
buffer_load_dwordx4 v[52:55], v1, s[36:39], s72 offen offset:1024 sc1
buffer_load_dwordx4 v[56:59], v1, s[36:39], s72 offen offset:2048 sc1
buffer_load_dwordx4 v[60:63], v1, s[36:39], s72 offen offset:3072 sc1
s_waitcnt lgkmcnt(8)
v_mfma_f32_16x16x32_bf16 v[240:243], a[240:243], a[0:3], v[240:243]
v_mfma_f32_16x16x32_bf16 v[240:243], a[244:247], a[4:7], v[240:243]
v_mfma_f32_16x16x32_bf16 v[244:247], a[240:243], a[8:11], v[244:247]
v_mfma_f32_16x16x32_bf16 v[244:247], a[244:247], a[12:15], v[244:247]
v_mfma_f32_16x16x32_bf16 v[248:251], a[240:243], a[16:19], v[248:251]
v_mfma_f32_16x16x32_bf16 v[248:251], a[244:247], a[20:23], v[248:251]
v_mfma_f32_16x16x32_bf16 v[252:255], a[240:243], a[24:27], v[252:255]
v_mfma_f32_16x16x32_bf16 v[252:255], a[244:247], a[28:31], v[252:255]
s_waitcnt lgkmcnt(4)
v_mfma_f32_16x16x32_bf16 v[252:255], a[248:251], a[56:59], v[252:255]
v_mfma_f32_16x16x32_bf16 v[252:255], a[252:255], a[60:63], v[252:255]
v_mfma_f32_16x16x32_bf16 v[248:251], a[248:251], a[48:51], v[248:251]
v_mfma_f32_16x16x32_bf16 v[248:251], a[252:255], a[52:55], v[248:251]
v_mfma_f32_16x16x32_bf16 v[244:247], a[248:251], a[40:43], v[244:247]
v_mfma_f32_16x16x32_bf16 v[244:247], a[252:255], a[44:47], v[244:247]
v_mfma_f32_16x16x32_bf16 v[240:243], a[248:251], a[32:35], v[240:243]
v_mfma_f32_16x16x32_bf16 v[240:243], a[252:255], a[36:39], v[240:243]
s_nop 1
ds_write_b128 v31, v[252:255] offset:12288
s_nop 0
ds_write_b128 v31, v[248:251] offset:8192
s_nop 0
ds_write_b128 v31, v[244:247] offset:4096
s_nop 0
ds_write_b128 v31, v[240:243] offset:0
s_waitcnt lgkmcnt(0)
s_barrier
ds_read_b128 v[64:67], v2 offset:0
ds_read_b128 v[68:71], v3 offset:0
ds_read_b128 v[72:75], v2 offset:32768
ds_read_b128 v[76:79], v3 offset:32768
ds_read_b128 v[80:83], v4 offset:0
ds_read_b128 v[84:87], v5 offset:0
ds_read_b128 v[88:91], v4 offset:32768
ds_read_b128 v[92:95], v5 offset:32768
ds_read_b128 v[96:99], v2 offset:4096
ds_read_b128 v[100:103], v3 offset:4096
ds_read_b128 v[104:107], v2 offset:36864
ds_read_b128 v[108:111], v3 offset:36864
ds_read_b128 v[112:115], v4 offset:4096
ds_read_b128 v[116:119], v5 offset:4096
ds_read_b128 v[120:123], v4 offset:36864
ds_read_b128 v[124:127], v5 offset:36864
s_waitcnt vmcnt(0)
v_cmp_eq_u32 vcc, s73, v48
v_cmp_eq_u32 s[74:75], s73, v52
v_cmp_eq_u32 s[76:77], s73, v56
v_cmp_eq_u32 s[78:79], s73, v60
s_or_b64 vcc, vcc, s[74:75]
s_or_b64 vcc, vcc, s[76:77]
s_or_b64 vcc, vcc, s[78:79]
s_cbranch_vccnz L_pl5_slow
L_pl5_ok:
v_lshlrev_b32 v160, 16, v48
v_and_b32 v161, 0xffff0000, v48
v_lshlrev_b32 v162, 16, v49
v_and_b32 v163, 0xffff0000, v49
v_lshlrev_b32 v164, 16, v50
v_and_b32 v165, 0xffff0000, v50
v_lshlrev_b32 v166, 16, v51
v_and_b32 v167, 0xffff0000, v51
v_pk_add_f32 v[128:129], v[128:129], v[160:161]
v_pk_add_f32 v[130:131], v[130:131], v[162:163]
v_pk_add_f32 v[132:133], v[132:133], v[164:165]
v_pk_add_f32 v[134:135], v[134:135], v[166:167]
v_lshlrev_b32 v168, 16, v52
v_and_b32 v169, 0xffff0000, v52
v_lshlrev_b32 v170, 16, v53
v_and_b32 v171, 0xffff0000, v53
v_lshlrev_b32 v172, 16, v54
v_and_b32 v173, 0xffff0000, v54
v_lshlrev_b32 v174, 16, v55
v_and_b32 v175, 0xffff0000, v55
v_pk_add_f32 v[136:137], v[136:137], v[168:169]
v_pk_add_f32 v[138:139], v[138:139], v[170:171]
v_pk_add_f32 v[140:141], v[140:141], v[172:173]
v_pk_add_f32 v[142:143], v[142:143], v[174:175]
v_lshlrev_b32 v176, 16, v56
v_and_b32 v177, 0xffff0000, v56
v_lshlrev_b32 v178, 16, v57
v_and_b32 v179, 0xffff0000, v57
v_lshlrev_b32 v180, 16, v58
v_and_b32 v181, 0xffff0000, v58
v_lshlrev_b32 v182, 16, v59
v_and_b32 v183, 0xffff0000, v59
v_pk_add_f32 v[144:145], v[144:145], v[176:177]
v_pk_add_f32 v[146:147], v[146:147], v[178:179]
v_pk_add_f32 v[148:149], v[148:149], v[180:181]
v_pk_add_f32 v[150:151], v[150:151], v[182:183]
v_lshlrev_b32 v184, 16, v60
v_and_b32 v185, 0xffff0000, v60
v_lshlrev_b32 v186, 16, v61
v_and_b32 v187, 0xffff0000, v61
v_lshlrev_b32 v188, 16, v62
v_and_b32 v189, 0xffff0000, v62
v_lshlrev_b32 v190, 16, v63
v_and_b32 v191, 0xffff0000, v63
v_pk_add_f32 v[152:153], v[152:153], v[184:185]
v_pk_add_f32 v[154:155], v[154:155], v[186:187]
v_pk_add_f32 v[156:157], v[156:157], v[188:189]
v_pk_add_f32 v[158:159], v[158:159], v[190:191]
s_waitcnt lgkmcnt(12)
v_pk_add_f32 v[64:65], v[64:65], v[72:73]
v_pk_add_f32 v[66:67], v[66:67], v[74:75]
v_pk_add_f32 v[68:69], v[68:69], v[76:77]
v_pk_add_f32 v[70:71], v[70:71], v[78:79]
v_pk_add_f32 v[64:65], v[64:65], v[128:129]
v_pk_add_f32 v[66:67], v[66:67], v[130:131]
v_pk_add_f32 v[68:69], v[68:69], v[132:133]
v_pk_add_f32 v[70:71], v[70:71], v[134:135]
v_cvt_pk_bf16_f32 v64, v64, v65
v_cvt_pk_bf16_f32 v65, v66, v67
v_cvt_pk_bf16_f32 v66, v68, v69
v_cvt_pk_bf16_f32 v67, v70, v71
s_add_u32 s52, s68, 0
buffer_store_dwordx4 v[64:67], v20, s[56:59], s52 offen sc1
s_waitcnt lgkmcnt(8)
v_pk_add_f32 v[80:81], v[80:81], v[88:89]
v_pk_add_f32 v[82:83], v[82:83], v[90:91]
v_pk_add_f32 v[84:85], v[84:85], v[92:93]
v_pk_add_f32 v[86:87], v[86:87], v[94:95]
v_pk_add_f32 v[80:81], v[80:81], v[136:137]
v_pk_add_f32 v[82:83], v[82:83], v[138:139]
v_pk_add_f32 v[84:85], v[84:85], v[140:141]
v_pk_add_f32 v[86:87], v[86:87], v[142:143]
v_cvt_pk_bf16_f32 v80, v80, v81
v_cvt_pk_bf16_f32 v81, v82, v83
v_cvt_pk_bf16_f32 v82, v84, v85
v_cvt_pk_bf16_f32 v83, v86, v87
s_add_u32 s52, s68, 16384
buffer_store_dwordx4 v[80:83], v20, s[56:59], s52 offen sc1
s_waitcnt lgkmcnt(4)
v_pk_add_f32 v[96:97], v[96:97], v[104:105]
v_pk_add_f32 v[98:99], v[98:99], v[106:107]
v_pk_add_f32 v[100:101], v[100:101], v[108:109]
v_pk_add_f32 v[102:103], v[102:103], v[110:111]
v_pk_add_f32 v[96:97], v[96:97], v[144:145]
v_pk_add_f32 v[98:99], v[98:99], v[146:147]
v_pk_add_f32 v[100:101], v[100:101], v[148:149]
v_pk_add_f32 v[102:103], v[102:103], v[150:151]
v_cvt_pk_bf16_f32 v96, v96, v97
v_cvt_pk_bf16_f32 v97, v98, v99
v_cvt_pk_bf16_f32 v98, v100, v101
v_cvt_pk_bf16_f32 v99, v102, v103
s_add_u32 s52, s68, 32768
buffer_store_dwordx4 v[96:99], v20, s[56:59], s52 offen sc1
s_waitcnt lgkmcnt(0)
v_pk_add_f32 v[112:113], v[112:113], v[120:121]
v_pk_add_f32 v[114:115], v[114:115], v[122:123]
v_pk_add_f32 v[116:117], v[116:117], v[124:125]
v_pk_add_f32 v[118:119], v[118:119], v[126:127]
v_pk_add_f32 v[112:113], v[112:113], v[152:153]
v_pk_add_f32 v[114:115], v[114:115], v[154:155]
v_pk_add_f32 v[116:117], v[116:117], v[156:157]
v_pk_add_f32 v[118:119], v[118:119], v[158:159]
v_cvt_pk_bf16_f32 v112, v112, v113
v_cvt_pk_bf16_f32 v113, v114, v115
v_cvt_pk_bf16_f32 v114, v116, v117
v_cvt_pk_bf16_f32 v115, v118, v119
s_add_u32 s52, s68, 49152
buffer_store_dwordx4 v[112:115], v20, s[56:59], s52 offen sc1
L_end:
s_endpgm
L_pl1_slow:
s_mov_b32 s53, 0
L_pl1_spin:
buffer_load_dword v28, v29, s[64:67], 0 offen sc1
s_add_u32 s53, s53, 1
s_waitcnt vmcnt(0)
v_cmp_gt_u32 vcc, 4, v28
s_cmp_ge_u32 s53, 1048576
s_cbranch_scc1 L_pl1_ok
s_cbranch_vccnz L_pl1_spin
s_branch L_pl1_ok
L_pl2_slow:
s_mov_b32 s53, 0
L_pl2_spin:
buffer_load_dword v4, v3, s[36:39], s52 offen sc1
s_add_u32 s53, s53, 1
s_waitcnt vmcnt(0)
v_cmp_ne_u32 vcc, 1, v4
s_cmp_ge_u32 s53, 1048576
s_cbranch_scc1 L_pl2_ok
s_cbranch_vccnz L_pl2_spin
s_branch L_pl2_ok
L_pl3_slow:
s_mov_b32 s53, 0
L_pl3_spin:
buffer_load_dword v27, v26, s[36:39], s62 offen sc1
s_add_u32 s53, s53, 1
s_waitcnt vmcnt(0)
v_cmp_ne_u32 vcc, 1, v27
s_cmp_ge_u32 s53, 1048576
s_cbranch_scc1 L_pl3_ok
s_cbranch_vccnz L_pl3_spin
s_branch L_pl3_ok
L_pl4_slow:
s_mov_b32 s53, 0
L_pl4_spin:
buffer_load_dword v27, v26, s[36:39], s62 offen sc1
s_add_u32 s53, s53, 1
s_waitcnt vmcnt(0)
v_cmp_ne_u32 vcc, 1, v27
s_cmp_ge_u32 s53, 1048576
s_cbranch_scc1 L_pl4_ok
s_cbranch_vccnz L_pl4_spin
s_branch L_pl4_ok
L_pl5_slow:
s_mov_b32 s53, 0
L_pl5_spin:
buffer_load_dwordx4 v[48:51], v1, s[36:39], s72 offen offset:0 sc1
buffer_load_dwordx4 v[52:55], v1, s[36:39], s72 offen offset:1024 sc1
buffer_load_dwordx4 v[56:59], v1, s[36:39], s72 offen offset:2048 sc1
buffer_load_dwordx4 v[60:63], v1, s[36:39], s72 offen offset:3072 sc1
s_add_u32 s53, s53, 1
s_waitcnt vmcnt(0)
v_cmp_eq_u32 vcc, s73, v48
v_cmp_eq_u32 s[74:75], s73, v52
v_cmp_eq_u32 s[76:77], s73, v56
v_cmp_eq_u32 s[78:79], s73, v60
s_or_b64 vcc, vcc, s[74:75]
s_or_b64 vcc, vcc, s[76:77]
s_or_b64 vcc, vcc, s[78:79]
s_cmp_ge_u32 s53, 1048576
s_cbranch_scc1 L_pl5_ok
s_cbranch_vccnz L_pl5_spin
s_branch L_pl5_ok
L_codeend:
s_endpgm
.section .rodata,"a"
.p2align 6
.amdhsa_kernel parallel_sum__sliding_block__glu_gated_swiglu__prompt_kernel
  .amdhsa_next_free_vgpr 512
  .amdhsa_next_free_sgpr 102
  .amdhsa_accum_offset 256
  .amdhsa_group_segment_fixed_size 0
  .amdhsa_kernarg_size 80
  .amdhsa_user_sgpr_count 2
  .amdhsa_user_sgpr_kernarg_segment_ptr 1
  .amdhsa_system_sgpr_workgroup_id_x 1
.end_amdhsa_kernel
.text
```
